```python
import torch

def _softmax(x, axis=-1):
    return torch.softmax(x, dim=axis)

def _gelu(x):
    return torch.nn.functional.gelu(x, approximate='tanh')

def _silu(x):
    return torch.nn.functional.silu(x)

def _sigmoid(x):
    return torch.sigmoid(x)

def _layernorm(x, axis=-1, eps=1e-05):
    m = x.mean(dim=axis, keepdim=True)
    v = x.var(dim=axis, keepdim=True, unbiased=False)
    return (x - m) / torch.sqrt(v + eps)

def _scatter_add(tgt, idx, src, axis=0):
    return tgt.clone().index_add_(axis, idx, src)

def _segment_sum(src, seg, n):
    out = torch.zeros((n,) + src.shape[1:], dtype=src.dtype)
    return out.index_add_(0, seg, src)

def _pad(x, pw):
    flat = tuple((v for pair in reversed(pw) for v in pair))
    return torch.nn.functional.pad(x, flat)
kernel_name = 'adaLN_cond__mha_block_cached__geglu_ffn__prompt'

def setup_inputs():

    _w = lambda a: (lambda t: t.to(torch.bfloat16) if t.is_floating_point() else t)(torch.as_tensor(a))

    def _A_setup():
        B, Sq, D = (1, 2048, 1024)
        H, Sk, Dh = (32, 2048, 128)
        return {'x': _w((lambda *s: torch.randn(*s, dtype=torch.bfloat16) * 0.05)(B, Sq, D)), 'k_cache': _w((lambda *s: torch.randn(*s, dtype=torch.bfloat16) * 3.2)(B, H, Sk, Dh)), 'v_cache': _w((lambda *s: torch.randn(*s, dtype=torch.bfloat16) * 0.4)(B, H, Sk, Dh)), 'wq': _w((lambda *s: torch.randn(*s, dtype=torch.bfloat16) * 3.2)(D, H * Dh) * D ** (-0.5)), 'wo': _w((lambda *s: torch.randn(*s, dtype=torch.bfloat16) * 0.4)(H * Dh, D) * (H * Dh) ** (-0.5))}
    _A_in = _A_setup()

    def _B_setup():
        B, S, D, F = (1, 2048, 1024, 3584)
        return {'x': _w((lambda *s: torch.randn(*s, dtype=torch.bfloat16) * 0.05)(B, S, D)), 'w_gate': _w((lambda *s: torch.randn(*s, dtype=torch.bfloat16) * 0.05)(D, F)), 'w_up': _w((lambda *s: torch.randn(*s, dtype=torch.bfloat16) * 0.05)(D, F)), 'w_down': _w((lambda *s: torch.randn(*s, dtype=torch.bfloat16) * 0.05)(F, D))}
    _B_in = _B_setup()
    return {'A_x': _A_in['x'], 'A_k_cache': _A_in['k_cache'], 'A_v_cache': _A_in['v_cache'], 'A_wq': _A_in['wq'], 'A_wo': _A_in['wo'], 'B_x': _B_in['x'], 'B_w_gate': _B_in['w_gate'], 'B_w_up': _B_in['w_up'], 'B_w_down': _B_in['w_down'], 'c': _w((lambda *s: torch.randn(*s, dtype=torch.bfloat16) * 0.1)(1, 1024) * 8.0), 'w_mod': _w((lambda *s: torch.randn(*s, dtype=torch.bfloat16) * 0.1)(1024, 6 * 1024) * 1024 ** (-0.5) * 8.0)}

def reference(A_x, A_k_cache, A_v_cache, A_wq, A_wo, B_x, B_w_gate, B_w_up, B_w_down, c, w_mod):

    def _A_ref(x, k_cache, v_cache, wq, wo):
        B, Sq, D = x.shape
        H, Dh = (32, 128)
        q = (lambda x, *d: x.permute(*d))((x @ wq).reshape(B, Sq, H, Dh), 0, 2, 1, 3)
        scores = torch.einsum('bhqd,bhkd->bhqk', q, k_cache) * Dh ** (-0.5)
        p = _softmax(scores, axis=-1)
        o = torch.einsum('bhqk,bhkd->bhqd', p, v_cache)
        return (lambda x, *d: x.permute(*d))(o, 0, 2, 1, 3).reshape(B, Sq, H * Dh) @ wo

    def _B_ref(x, w_gate, w_up, w_down):
        return _gelu(x @ w_gate) * (x @ w_up) @ w_down
    x = A_x
    mod = (_silu(c) @ w_mod).reshape(c.shape[0], 6, 1, -1)
    sa, ca, ga, sb, cb, gb = (mod[:, 0].clone(), mod[:, 1].clone(), mod[:, 2].clone(), mod[:, 3].clone(), mod[:, 4].clone(), mod[:, 5].clone())
    h = _layernorm(x, axis=-1) * (1 + ca) + sa
    x = x + ga * _A_ref(h, A_k_cache, A_v_cache, A_wq, A_wo)
    h = _layernorm(x, axis=-1) * (1 + cb) + sb
    x = x + gb * _B_ref(h, B_w_gate, B_w_up, B_w_down)
    return x
```

```asm
; @launch kernel=modp_kernel grid=(256,1,1) block=(256,1,1) lds=1024
; @launch kernel=mattn_kernel grid=(256,1,1) block=(256,1,1) lds=163840
.amdgcn_target "amdgcn-amd-amdhsa--gfx950"
.macro MM d, a, b, c
v_mfma_f32_16x16x32_bf16 \d, \a, \b, \c
.endm
.macro TR d, a, o
ds_read_b64_tr_b16 \d, \a offset:\o
.endm
.text
.globl modp_kernel
.p2align 8
.type modp_kernel,@function
modp_kernel:
s_cmp_ge_u32 s2, 256
s_cbranch_scc1 L_modp_kernel_end
s_load_dwordx4 s[4:7], s[0:1], 72
s_load_dwordx2 s[12:13], s[0:1], 0
s_load_dwordx4 s[8:11], s[0:1], 96
s_getpc_b64 s[44:45]
L_modp_kernel_pc1:
s_mov_b32 s46, L_modp_kernel_codeend-L_modp_kernel_pc1
s_mov_b32 s47, 0x00020000
v_lshlrev_b32 v16, 7, v0
buffer_load_dword v17, v16, s[44:47], 0 offen
v_lshrrev_b32 v1, 6, v0
v_and_b32 v2, 63, v0
v_readfirstlane_b32 s20, v1
s_and_b32 s26, s2, 31
s_lshr_b32 s27, s2, 5
s_mul_i32 s32, s27, 1572864
s_lshl_b32 s33, s26, 7
s_add_u32 s32, s32, s33
s_lshl_b32 s33, s27, 8
v_lshrrev_b32 v6, 3, v0
v_and_b32 v7, 7, v0
s_movk_i32 s34, 12288
v_mul_lo_u32 v8, v6, s34
v_lshl_add_u32 v8, v7, 4, v8
v_lshlrev_b32 v9, 1, v6
s_waitcnt lgkmcnt(0)
s_mov_b32 s52, s6
s_mov_b32 s53, s7
s_mov_b32 s54, 12582912
s_mov_b32 s55, 0x00020000
s_mov_b32 s48, s4
s_mov_b32 s49, s5
s_mov_b32 s50, 2048
s_mov_b32 s51, 0x00020000
buffer_load_ushort v24, v9, s[48:51], s33 offen offset:0
buffer_load_ushort v25, v9, s[48:51], s33 offen offset:64
buffer_load_ushort v26, v9, s[48:51], s33 offen offset:128
buffer_load_ushort v27, v9, s[48:51], s33 offen offset:192
buffer_load_dwordx4 v[32:35], v8, s[52:55], s32 offen
s_add_u32 s32, s32, 393216
buffer_load_dwordx4 v[36:39], v8, s[52:55], s32 offen
s_add_u32 s32, s32, 393216
buffer_load_dwordx4 v[40:43], v8, s[52:55], s32 offen
s_add_u32 s32, s32, 393216
buffer_load_dwordx4 v[44:47], v8, s[52:55], s32 offen
s_mov_b32 s14, 4194304
s_mov_b32 s15, 0x00020000
s_lshl_b32 s23, s2, 14
v_lshlrev_b32 v10, 7, v0
s_cmp_ge_u32 s20, 2
s_cbranch_scc1 L_modp_kernel_nox
buffer_load_dword v11, v10, s[12:15], s23 offen
L_modp_kernel_nox:
s_cmp_lg_u32 s20, 3
s_cbranch_scc1 L_modp_kernel_noc
s_cmp_ge_u32 s2, 24
s_cbranch_scc1 L_modp_kernel_noc
s_getpc_b64 s[40:41]
L_modp_kernel_pc2:
s_mov_b32 s42, L_down_kernel_codeend-L_modp_kernel_pc2
s_mov_b32 s43, 0x00020000
s_lshl_b32 s37, s2, 13
v_lshlrev_b32 v10, 7, v2
buffer_load_dword v11, v10, s[40:43], s37 offen
L_modp_kernel_noc:
s_mov_b32 s16, s10
s_mov_b32 s17, s11
s_mov_b32 s18, 67108864
s_mov_b32 s19, 0x00020000
s_lshl_b32 s36, s2, 2
s_add_u32 s36, s36, s20
s_lshl_b32 s36, s36, 6
s_add_u32 s36, s36, 62914560
v_and_b32 v14, 3, v2
v_lshlrev_b32 v14, 16, v14
v_lshrrev_b32 v15, 2, v2
v_lshl_add_u32 v14, v15, 2, v14
v_mov_b32 v15, 0
buffer_store_dword v15, v14, s[16:19], s36 offen
s_lshl_b32 s36, s2, 10
s_add_u32 s36, s36, 63963136
v_lshlrev_b32 v14, 2, v0
v_mov_b32 v18, -1.0
buffer_store_dword v18, v14, s[16:19], s36 offen
s_mov_b32 s35, 0xbfb8aa3b
s_waitcnt vmcnt(9)
v_lshlrev_b32 v24, 16, v24
s_waitcnt vmcnt(8)
v_lshlrev_b32 v25, 16, v25
s_waitcnt vmcnt(7)
v_lshlrev_b32 v26, 16, v26
s_waitcnt vmcnt(6)
v_lshlrev_b32 v27, 16, v27
v_mul_f32 v28, s35, v24
v_mul_f32 v29, s35, v25
v_mul_f32 v30, s35, v26
v_mul_f32 v31, s35, v27
v_exp_f32 v28, v28
v_exp_f32 v29, v29
v_exp_f32 v30, v30
v_exp_f32 v31, v31
v_add_f32 v28, 1.0, v28
v_add_f32 v29, 1.0, v29
v_add_f32 v30, 1.0, v30
v_add_f32 v31, 1.0, v31
v_rcp_f32 v28, v28
v_rcp_f32 v29, v29
v_rcp_f32 v30, v30
v_rcp_f32 v31, v31
v_mul_f32 v24, v24, v28
v_mul_f32 v25, v25, v29
v_mul_f32 v26, v26, v30
v_mul_f32 v27, v27, v31
v_cvt_pk_bf16_f32 v24, v24, v24
v_cvt_pk_bf16_f32 v25, v25, v25
v_cvt_pk_bf16_f32 v26, v26, v26
v_cvt_pk_bf16_f32 v27, v27, v27
v_and_b32 v28, 0xffff0000, v24
v_and_b32 v29, 0xffff0000, v25
v_and_b32 v30, 0xffff0000, v26
v_and_b32 v31, 0xffff0000, v27
s_waitcnt vmcnt(5)
v_lshlrev_b32 v12, 16, v32
v_and_b32 v13, 0xffff0000, v32
v_pk_mul_f32 v[48:49], v[12:13], v[28:29] op_sel_hi:[1,0]
v_lshlrev_b32 v12, 16, v33
v_and_b32 v13, 0xffff0000, v33
v_pk_mul_f32 v[50:51], v[12:13], v[28:29] op_sel_hi:[1,0]
v_lshlrev_b32 v12, 16, v34
v_and_b32 v13, 0xffff0000, v34
v_pk_mul_f32 v[52:53], v[12:13], v[28:29] op_sel_hi:[1,0]
v_lshlrev_b32 v12, 16, v35
v_and_b32 v13, 0xffff0000, v35
v_pk_mul_f32 v[54:55], v[12:13], v[28:29] op_sel_hi:[1,0]
s_waitcnt vmcnt(4)
v_lshlrev_b32 v12, 16, v36
v_and_b32 v13, 0xffff0000, v36
v_pk_fma_f32 v[48:49], v[12:13], v[28:29], v[48:49] op_sel:[0,1,0] op_sel_hi:[1,1,1]
v_lshlrev_b32 v12, 16, v37
v_and_b32 v13, 0xffff0000, v37
v_pk_fma_f32 v[50:51], v[12:13], v[28:29], v[50:51] op_sel:[0,1,0] op_sel_hi:[1,1,1]
v_lshlrev_b32 v12, 16, v38
v_and_b32 v13, 0xffff0000, v38
v_pk_fma_f32 v[52:53], v[12:13], v[28:29], v[52:53] op_sel:[0,1,0] op_sel_hi:[1,1,1]
v_lshlrev_b32 v12, 16, v39
v_and_b32 v13, 0xffff0000, v39
v_pk_fma_f32 v[54:55], v[12:13], v[28:29], v[54:55] op_sel:[0,1,0] op_sel_hi:[1,1,1]
s_waitcnt vmcnt(3)
v_lshlrev_b32 v12, 16, v40
v_and_b32 v13, 0xffff0000, v40
v_pk_fma_f32 v[48:49], v[12:13], v[30:31], v[48:49] op_sel_hi:[1,0,1]
v_lshlrev_b32 v12, 16, v41
v_and_b32 v13, 0xffff0000, v41
v_pk_fma_f32 v[50:51], v[12:13], v[30:31], v[50:51] op_sel_hi:[1,0,1]
v_lshlrev_b32 v12, 16, v42
v_and_b32 v13, 0xffff0000, v42
v_pk_fma_f32 v[52:53], v[12:13], v[30:31], v[52:53] op_sel_hi:[1,0,1]
v_lshlrev_b32 v12, 16, v43
v_and_b32 v13, 0xffff0000, v43
v_pk_fma_f32 v[54:55], v[12:13], v[30:31], v[54:55] op_sel_hi:[1,0,1]
s_waitcnt vmcnt(2)
v_lshlrev_b32 v12, 16, v44
v_and_b32 v13, 0xffff0000, v44
v_pk_fma_f32 v[48:49], v[12:13], v[30:31], v[48:49] op_sel:[0,1,0] op_sel_hi:[1,1,1]
v_lshlrev_b32 v12, 16, v45
v_and_b32 v13, 0xffff0000, v45
v_pk_fma_f32 v[50:51], v[12:13], v[30:31], v[50:51] op_sel:[0,1,0] op_sel_hi:[1,1,1]
v_lshlrev_b32 v12, 16, v46
v_and_b32 v13, 0xffff0000, v46
v_pk_fma_f32 v[52:53], v[12:13], v[30:31], v[52:53] op_sel:[0,1,0] op_sel_hi:[1,1,1]
v_lshlrev_b32 v12, 16, v47
v_and_b32 v13, 0xffff0000, v47
v_pk_fma_f32 v[54:55], v[12:13], v[30:31], v[54:55] op_sel:[0,1,0] op_sel_hi:[1,1,1]
v_add_f32_dpp v48, v48, v48 row_ror:8 row_mask:0xf bank_mask:0xf
v_add_f32_dpp v49, v49, v49 row_ror:8 row_mask:0xf bank_mask:0xf
v_add_f32_dpp v50, v50, v50 row_ror:8 row_mask:0xf bank_mask:0xf
v_add_f32_dpp v51, v51, v51 row_ror:8 row_mask:0xf bank_mask:0xf
v_add_f32_dpp v52, v52, v52 row_ror:8 row_mask:0xf bank_mask:0xf
v_add_f32_dpp v53, v53, v53 row_ror:8 row_mask:0xf bank_mask:0xf
v_add_f32_dpp v54, v54, v54 row_ror:8 row_mask:0xf bank_mask:0xf
v_add_f32_dpp v55, v55, v55 row_ror:8 row_mask:0xf bank_mask:0xf
v_mov_b32 v56, v48
v_mov_b32 v57, v49
v_mov_b32 v58, v50
v_mov_b32 v59, v51
v_mov_b32 v60, v52
v_mov_b32 v61, v53
v_mov_b32 v62, v54
v_mov_b32 v63, v55
v_permlane16_swap_b32 v56, v48
v_permlane16_swap_b32 v57, v49
v_permlane16_swap_b32 v58, v50
v_permlane16_swap_b32 v59, v51
v_permlane16_swap_b32 v60, v52
v_permlane16_swap_b32 v61, v53
v_permlane16_swap_b32 v62, v54
v_permlane16_swap_b32 v63, v55
v_pk_add_f32 v[48:49], v[48:49], v[56:57]
v_pk_add_f32 v[50:51], v[50:51], v[58:59]
v_pk_add_f32 v[52:53], v[52:53], v[60:61]
v_pk_add_f32 v[54:55], v[54:55], v[62:63]
v_mov_b32 v56, v48
v_mov_b32 v57, v49
v_mov_b32 v58, v50
v_mov_b32 v59, v51
v_mov_b32 v60, v52
v_mov_b32 v61, v53
v_mov_b32 v62, v54
v_mov_b32 v63, v55
v_permlane32_swap_b32 v56, v48
v_permlane32_swap_b32 v57, v49
v_permlane32_swap_b32 v58, v50
v_permlane32_swap_b32 v59, v51
v_permlane32_swap_b32 v60, v52
v_permlane32_swap_b32 v61, v53
v_permlane32_swap_b32 v62, v54
v_permlane32_swap_b32 v63, v55
v_pk_add_f32 v[48:49], v[48:49], v[56:57]
v_pk_add_f32 v[50:51], v[50:51], v[58:59]
v_pk_add_f32 v[52:53], v[52:53], v[60:61]
v_pk_add_f32 v[54:55], v[54:55], v[62:63]
v_lshlrev_b32 v12, 8, v1
v_lshl_add_u32 v12, v7, 5, v12
ds_write_b128 v12, v[48:51]
ds_write_b128 v12, v[52:55] offset:16
v_lshlrev_b32 v13, 2, v2
s_cmp_lg_u32 s26, 0
s_cbranch_scc1 L_modp_kernel_nosc
s_add_u32 s34, s33, 32768
buffer_store_short v24, v9, s[16:19], s34 offen offset:0
buffer_store_short v25, v9, s[16:19], s34 offen offset:64
buffer_store_short v26, v9, s[16:19], s34 offen offset:128
buffer_store_short v27, v9, s[16:19], s34 offen offset:192
L_modp_kernel_nosc:
s_waitcnt lgkmcnt(0)
s_barrier
s_cmp_lg_u32 s20, 0
s_cbranch_scc1 L_modp_kernel_fin
ds_read_b32 v56, v13 offset:0
ds_read_b32 v57, v13 offset:256
ds_read_b32 v58, v13 offset:512
ds_read_b32 v59, v13 offset:768
s_lshl_b32 s34, s27, 13
s_lshl_b32 s35, s26, 8
s_add_u32 s34, s34, s35
s_add_u32 s34, s34, 65536
s_waitcnt lgkmcnt(2)
v_add_f32 v56, v56, v57
s_waitcnt lgkmcnt(0)
v_add_f32 v58, v58, v59
v_add_f32 v56, v56, v58
buffer_store_dword v56, v13, s[16:19], s34 offen
L_modp_kernel_fin:
L_modp_kernel_end:
s_endpgm
L_modp_kernel_codeend:
.globl mattn_kernel
.p2align 8
.type mattn_kernel,@function
mattn_kernel:
L_attn_kernel_entry:
s_cmp_ge_u32 s2, 256
s_cbranch_scc1 L_attn_kernel_end
s_load_dwordx2 s[28:29], s[0:1], 24
s_load_dwordx2 s[8:9], s[0:1], 0
s_load_dwordx2 s[24:25], s[0:1], 96
s_load_dwordx2 s[44:45], s[0:1], 104
s_load_dwordx4 s[4:7], s[0:1], 8
s_load_dwordx2 s[56:57], s[0:1], 32
s_load_dwordx4 s[84:87], s[0:1], 48
s_load_dwordx2 s[88:89], s[0:1], 64
s_load_dwordx2 s[90:91], s[0:1], 80
v_lshrrev_b32 v2, 6, v0
v_and_b32 v1, 63, v0
v_readfirstlane_b32 s30, v2
s_getpc_b64 s[80:81]
L_attn_kernel_pc1:
s_mov_b32 s82, L_attn_kernel_codeend-L_attn_kernel_pc1
s_mov_b32 s83, 0x00020000
s_lshr_b32 s53, s2, 3
s_lshl_b32 s53, s53, 2
s_add_u32 s53, s53, s30
s_and_b32 s53, s53, 63
s_lshl_b32 s53, s53, 9
v_lshlrev_b32 v4, 7, v1
v_cmp_gt_u32 vcc, 4, v1
v_mov_b32 v5, 0x40000000
s_nop 0
v_cndmask_b32 v4, v5, v4, vcc
buffer_load_dword v32, v4, s[80:83], s53 offen
s_and_b32 s40, s2, 7
s_lshl_b32 s40, s40, 2
s_lshr_b32 s41, s2, 6
s_add_u32 s40, s40, s41
s_bfe_u32 s41, s2, 0x30003
s_lshl_b32 s42, s40, 19
s_lshl_b32 s43, s40, 8
v_and_b32 v2, 15, v1
v_lshrrev_b32 v3, 4, v1
s_lshl_b32 s33, s30, 12
s_lshl_b32 s46, s30, 17
v_lshlrev_b32 v4, 13, v3
v_add_u32 v4, s46, v4
v_add_u32 v5, 0, v3
v_lshlrev_b32 v5, 1, v5
v_xor_b32 v5, v5, v2
v_lshl_add_u32 v5, v5, 4, v4
v_add_u32 v26, 0, v5
v_add_u32 v5, 0, v3
v_lshlrev_b32 v5, 1, v5
v_xor_b32 v5, v5, v2
v_lshl_add_u32 v5, v5, 4, v4
v_add_u32 v27, 31744, v5
v_add_u32 v5, 4, v3
v_lshlrev_b32 v5, 1, v5
v_xor_b32 v5, v5, v2
v_lshl_add_u32 v5, v5, 4, v4
v_add_u32 v28, 63488, v5
v_add_u32 v5, 4, v3
v_lshlrev_b32 v5, 1, v5
v_xor_b32 v5, v5, v2
v_lshl_add_u32 v5, v5, 4, v4
v_add_u32 v29, 95232, v5
v_lshlrev_b32 v30, 4, v1
s_lshl_b32 s46, s41, 2
s_add_u32 s46, s46, s30
s_lshl_b32 s47, s46, 12
s_lshl_b32 s48, s46, 12
s_lshl_b32 s49, s40, 19
s_add_u32 s48, s48, s49
s_waitcnt lgkmcnt(0)
s_add_u32 s16, s28, s43
s_addc_u32 s17, s29, 0
s_mov_b32 s18, 8380672
s_mov_b32 s19, 0x00020000
s_add_u32 s20, s44, 1048576
s_addc_u32 s21, s45, 0
s_mov_b32 s22, 4194304
s_mov_b32 s23, 0x00020000
s_mov_b32 s10, 4194304
s_mov_b32 s11, 0x00020000
s_mov_b32 s12, s44
s_mov_b32 s13, s45
s_mov_b32 s14, 67108864
s_mov_b32 s15, 0x00020000
s_lshl_b32 s50, s41, 8
s_lshl_b32 s51, s40, 3
s_add_u32 s50, s50, s51
s_lshl_b32 s51, s30, 1
s_add_u32 s51, s51, s50
s_lshl_b32 s51, s51, 11
buffer_load_dwordx4 v[192:195], v30, s[8:11], s51 offen offset:0
buffer_load_dwordx4 v[196:199], v30, s[8:11], s51 offen offset:1024
buffer_load_dwordx4 v[200:203], v30, s[8:11], s51 offen offset:2048
buffer_load_dwordx4 v[204:207], v30, s[8:11], s51 offen offset:3072
v_lshlrev_b32 v216, 4, v0
s_mov_b32 s52, 65536
buffer_load_dwordx4 v[96:99], v216, s[12:15], s52 offen
s_add_u32 s52, s52, 4096
buffer_load_dwordx4 v[100:103], v216, s[12:15], s52 offen
s_add_u32 s52, s52, 4096
buffer_load_dwordx4 v[104:107], v216, s[12:15], s52 offen
s_add_u32 s52, s52, 4096
buffer_load_dwordx4 v[108:111], v216, s[12:15], s52 offen
s_add_u32 s52, s52, 4096
buffer_load_dwordx4 v[112:115], v216, s[12:15], s52 offen
s_add_u32 s52, s52, 4096
buffer_load_dwordx4 v[116:119], v216, s[12:15], s52 offen
s_add_u32 s52, s52, 4096
buffer_load_dwordx4 v[120:123], v216, s[12:15], s52 offen
s_add_u32 s52, s52, 4096
buffer_load_dwordx4 v[124:127], v216, s[12:15], s52 offen
s_add_u32 s52, s52, 4096
buffer_load_dwordx4 v[128:131], v216, s[12:15], s52 offen
s_add_u32 s52, s52, 4096
buffer_load_dwordx4 v[132:135], v216, s[12:15], s52 offen
s_add_u32 s52, s52, 4096
buffer_load_dwordx4 v[136:139], v216, s[12:15], s52 offen
s_add_u32 s52, s52, 4096
buffer_load_dwordx4 v[140:143], v216, s[12:15], s52 offen
s_add_u32 s52, s52, 4096
buffer_load_dwordx4 v[144:147], v216, s[12:15], s52 offen
s_add_u32 s52, s52, 4096
buffer_load_dwordx4 v[148:151], v216, s[12:15], s52 offen
s_add_u32 s52, s52, 4096
buffer_load_dwordx4 v[152:155], v216, s[12:15], s52 offen
s_add_u32 s52, s52, 4096
buffer_load_dwordx4 v[156:159], v216, s[12:15], s52 offen
s_add_u32 s52, s52, 4096
s_lshr_b32 s53, s50, 4
s_lshl_b32 s53, s53, 10
s_and_b32 s52, s50, 8
s_lshl_b32 s52, s52, 4
s_add_u32 s53, s53, s52
s_lshl_b32 s52, s30, 20
s_add_u32 s53, s53, s52
s_waitcnt vmcnt(19)
v_lshlrev_b32 v64, 16, v192
v_and_b32 v65, 0xffff0000, v192
v_lshlrev_b32 v66, 16, v193
v_and_b32 v67, 0xffff0000, v193
v_lshlrev_b32 v68, 16, v194
v_and_b32 v69, 0xffff0000, v194
v_lshlrev_b32 v70, 16, v195
v_and_b32 v71, 0xffff0000, v195
s_waitcnt vmcnt(18)
v_lshlrev_b32 v72, 16, v196
v_and_b32 v73, 0xffff0000, v196
v_lshlrev_b32 v74, 16, v197
v_and_b32 v75, 0xffff0000, v197
v_lshlrev_b32 v76, 16, v198
v_and_b32 v77, 0xffff0000, v198
v_lshlrev_b32 v78, 16, v199
v_and_b32 v79, 0xffff0000, v199
s_waitcnt vmcnt(17)
v_lshlrev_b32 v80, 16, v200
v_and_b32 v81, 0xffff0000, v200
v_lshlrev_b32 v82, 16, v201
v_and_b32 v83, 0xffff0000, v201
v_lshlrev_b32 v84, 16, v202
v_and_b32 v85, 0xffff0000, v202
v_lshlrev_b32 v86, 16, v203
v_and_b32 v87, 0xffff0000, v203
s_waitcnt vmcnt(16)
v_lshlrev_b32 v88, 16, v204
v_and_b32 v89, 0xffff0000, v204
v_lshlrev_b32 v90, 16, v205
v_and_b32 v91, 0xffff0000, v205
v_lshlrev_b32 v92, 16, v206
v_and_b32 v93, 0xffff0000, v206
v_lshlrev_b32 v94, 16, v207
v_and_b32 v95, 0xffff0000, v207
v_pk_add_f32 v[208:209], v[64:65], v[66:67]
v_pk_add_f32 v[210:211], v[80:81], v[82:83]
v_pk_add_f32 v[208:209], v[208:209], v[68:69]
v_pk_add_f32 v[210:211], v[210:211], v[84:85]
v_pk_add_f32 v[208:209], v[208:209], v[70:71]
v_pk_add_f32 v[210:211], v[210:211], v[86:87]
v_pk_add_f32 v[208:209], v[208:209], v[72:73]
v_pk_add_f32 v[210:211], v[210:211], v[88:89]
v_pk_add_f32 v[208:209], v[208:209], v[74:75]
v_pk_add_f32 v[210:211], v[210:211], v[90:91]
v_pk_add_f32 v[208:209], v[208:209], v[76:77]
v_pk_add_f32 v[210:211], v[210:211], v[92:93]
v_pk_add_f32 v[208:209], v[208:209], v[78:79]
v_pk_add_f32 v[210:211], v[210:211], v[94:95]
v_add_f32 v208, v208, v209
v_add_f32 v210, v210, v211
s_nop 0
v_add_f32_dpp v208, v208, v208 row_ror:1 row_mask:0xf bank_mask:0xf
v_add_f32_dpp v210, v210, v210 row_ror:1 row_mask:0xf bank_mask:0xf
s_nop 0
v_add_f32_dpp v208, v208, v208 row_ror:2 row_mask:0xf bank_mask:0xf
v_add_f32_dpp v210, v210, v210 row_ror:2 row_mask:0xf bank_mask:0xf
s_nop 0
v_add_f32_dpp v208, v208, v208 row_ror:4 row_mask:0xf bank_mask:0xf
v_add_f32_dpp v210, v210, v210 row_ror:4 row_mask:0xf bank_mask:0xf
s_nop 0
v_add_f32_dpp v208, v208, v208 row_ror:8 row_mask:0xf bank_mask:0xf
v_add_f32_dpp v210, v210, v210 row_ror:8 row_mask:0xf bank_mask:0xf
v_mov_b32 v209, v208
v_mov_b32 v211, v210
s_nop 0
v_permlane16_swap_b32 v209, v208
v_permlane16_swap_b32 v211, v210
v_add_f32 v208, v208, v209
v_add_f32 v210, v210, v211
v_mov_b32 v209, v208
v_mov_b32 v211, v210
s_nop 0
v_permlane32_swap_b32 v209, v208
v_permlane32_swap_b32 v211, v210
v_add_f32 v208, v208, v209
v_add_f32 v210, v210, v211
v_mul_f32 v208, 0xba800000, v208
v_mul_f32 v210, 0xba800000, v210
v_pk_add_f32 v[64:65], v[64:65], v[208:209] op_sel_hi:[1,0]
v_pk_add_f32 v[66:67], v[66:67], v[208:209] op_sel_hi:[1,0]
v_pk_add_f32 v[68:69], v[68:69], v[208:209] op_sel_hi:[1,0]
v_pk_add_f32 v[70:71], v[70:71], v[208:209] op_sel_hi:[1,0]
v_pk_add_f32 v[72:73], v[72:73], v[208:209] op_sel_hi:[1,0]
v_pk_add_f32 v[74:75], v[74:75], v[208:209] op_sel_hi:[1,0]
v_pk_add_f32 v[76:77], v[76:77], v[208:209] op_sel_hi:[1,0]
v_pk_add_f32 v[78:79], v[78:79], v[208:209] op_sel_hi:[1,0]
v_pk_add_f32 v[80:81], v[80:81], v[210:211] op_sel_hi:[1,0]
v_pk_add_f32 v[82:83], v[82:83], v[210:211] op_sel_hi:[1,0]
v_pk_add_f32 v[84:85], v[84:85], v[210:211] op_sel_hi:[1,0]
v_pk_add_f32 v[86:87], v[86:87], v[210:211] op_sel_hi:[1,0]
v_pk_add_f32 v[88:89], v[88:89], v[210:211] op_sel_hi:[1,0]
v_pk_add_f32 v[90:91], v[90:91], v[210:211] op_sel_hi:[1,0]
v_pk_add_f32 v[92:93], v[92:93], v[210:211] op_sel_hi:[1,0]
v_pk_add_f32 v[94:95], v[94:95], v[210:211] op_sel_hi:[1,0]
v_pk_mul_f32 v[208:209], v[64:65], v[64:65]
v_pk_mul_f32 v[210:211], v[80:81], v[80:81]
v_pk_fma_f32 v[208:209], v[66:67], v[66:67], v[208:209]
v_pk_fma_f32 v[210:211], v[82:83], v[82:83], v[210:211]
v_pk_fma_f32 v[208:209], v[68:69], v[68:69], v[208:209]
v_pk_fma_f32 v[210:211], v[84:85], v[84:85], v[210:211]
v_pk_fma_f32 v[208:209], v[70:71], v[70:71], v[208:209]
v_pk_fma_f32 v[210:211], v[86:87], v[86:87], v[210:211]
v_pk_fma_f32 v[208:209], v[72:73], v[72:73], v[208:209]
v_pk_fma_f32 v[210:211], v[88:89], v[88:89], v[210:211]
v_pk_fma_f32 v[208:209], v[74:75], v[74:75], v[208:209]
v_pk_fma_f32 v[210:211], v[90:91], v[90:91], v[210:211]
v_pk_fma_f32 v[208:209], v[76:77], v[76:77], v[208:209]
v_pk_fma_f32 v[210:211], v[92:93], v[92:93], v[210:211]
v_pk_fma_f32 v[208:209], v[78:79], v[78:79], v[208:209]
v_pk_fma_f32 v[210:211], v[94:95], v[94:95], v[210:211]
v_add_f32 v208, v208, v209
v_add_f32 v210, v210, v211
s_mov_b32 s50, 0x3e0293ee
s_waitcnt vmcnt(13)
v_pk_add_f32 v[96:97], v[96:97], v[104:105]
v_pk_add_f32 v[98:99], v[98:99], v[106:107]
s_waitcnt vmcnt(12)
v_pk_add_f32 v[100:101], v[100:101], v[108:109]
v_pk_add_f32 v[102:103], v[102:103], v[110:111]
s_waitcnt vmcnt(11)
v_pk_add_f32 v[96:97], v[96:97], v[112:113]
v_pk_add_f32 v[98:99], v[98:99], v[114:115]
s_waitcnt vmcnt(10)
v_pk_add_f32 v[100:101], v[100:101], v[116:117]
v_pk_add_f32 v[102:103], v[102:103], v[118:119]
s_waitcnt vmcnt(9)
v_pk_add_f32 v[96:97], v[96:97], v[120:121]
v_pk_add_f32 v[98:99], v[98:99], v[122:123]
s_waitcnt vmcnt(8)
v_pk_add_f32 v[100:101], v[100:101], v[124:125]
v_pk_add_f32 v[102:103], v[102:103], v[126:127]
s_waitcnt vmcnt(7)
v_pk_add_f32 v[96:97], v[96:97], v[128:129]
v_pk_add_f32 v[98:99], v[98:99], v[130:131]
s_waitcnt vmcnt(6)
v_pk_add_f32 v[100:101], v[100:101], v[132:133]
v_pk_add_f32 v[102:103], v[102:103], v[134:135]
s_waitcnt vmcnt(5)
v_pk_add_f32 v[96:97], v[96:97], v[136:137]
v_pk_add_f32 v[98:99], v[98:99], v[138:139]
s_waitcnt vmcnt(4)
v_pk_add_f32 v[100:101], v[100:101], v[140:141]
v_pk_add_f32 v[102:103], v[102:103], v[142:143]
s_waitcnt vmcnt(3)
v_pk_add_f32 v[96:97], v[96:97], v[144:145]
v_pk_add_f32 v[98:99], v[98:99], v[146:147]
s_waitcnt vmcnt(2)
v_pk_add_f32 v[100:101], v[100:101], v[148:149]
v_pk_add_f32 v[102:103], v[102:103], v[150:151]
s_waitcnt vmcnt(1)
v_pk_add_f32 v[96:97], v[96:97], v[152:153]
v_pk_add_f32 v[98:99], v[98:99], v[154:155]
s_waitcnt vmcnt(0)
v_pk_add_f32 v[100:101], v[100:101], v[156:157]
v_pk_add_f32 v[102:103], v[102:103], v[158:159]
s_mov_b32 s36, s50
s_lshr_b32 s37, s2, 3
s_lshl_b32 s37, s37, 2
s_add_u32 s37, s37, s30
s_lshl_b32 s37, s37, 14
s_lshr_b32 s51, s2, 6
s_lshl_b32 s51, s51, 8
s_add_u32 s37, s37, 8192
s_sub_u32 s37, s37, s51
v_lshrrev_b32 v4, 3, v1
v_lshlrev_b32 v4, 13, v4
v_and_b32 v5, 7, v1
v_lshl_add_u32 v4, v5, 7, v4
v_cmp_gt_u32 vcc, 16, v1
v_mov_b32 v5, 0x40000000
s_nop 0
v_cndmask_b32 v7, v5, v4, vcc
buffer_load_dword v32, v7, s[16:19], s37 offen
s_mov_b32 s50, s36
v_cvt_pk_bf16_f32 v104, v96, v97
v_cvt_pk_bf16_f32 v105, v98, v99
v_cvt_pk_bf16_f32 v106, v100, v101
v_cvt_pk_bf16_f32 v107, v102, v103
v_lshlrev_b32 v96, 16, v104
v_and_b32 v97, 0xffff0000, v104
v_lshlrev_b32 v98, 16, v105
v_and_b32 v99, 0xffff0000, v105
v_lshlrev_b32 v100, 16, v106
v_and_b32 v101, 0xffff0000, v106
v_lshlrev_b32 v102, 16, v107
v_and_b32 v103, 0xffff0000, v107
v_mul_f32 v96, s50, v96
v_add_f32 v100, 1.0, v100
v_mul_f32 v97, s50, v97
v_add_f32 v101, 1.0, v101
v_mul_f32 v98, s50, v98
v_add_f32 v102, 1.0, v102
v_mul_f32 v99, s50, v99
v_add_f32 v103, 1.0, v103
v_cvt_pk_bf16_f32 v104, v100, v101
v_cvt_pk_bf16_f32 v105, v102, v103
v_lshlrev_b32 v100, 16, v104
v_and_b32 v101, 0xffff0000, v104
v_lshlrev_b32 v102, 16, v105
v_and_b32 v103, 0xffff0000, v105
ds_write_b128 v216, v[96:99]
ds_write_b128 v216, v[100:103] offset:4096
v_lshlrev_b32 v217, 5, v1
s_waitcnt lgkmcnt(0)
s_barrier
ds_read_b128 v[160:163], v217 offset:4096
ds_read_b128 v[176:179], v217 offset:0
ds_read_b128 v[164:167], v217 offset:4112
ds_read_b128 v[180:183], v217 offset:16
ds_read_b128 v[168:171], v217 offset:6144
ds_read_b128 v[184:187], v217 offset:2048
ds_read_b128 v[172:175], v217 offset:6160
ds_read_b128 v[188:191], v217 offset:2064
v_add_f32_dpp v208, v208, v208 row_ror:1 row_mask:0xf bank_mask:0xf
v_add_f32_dpp v210, v210, v210 row_ror:1 row_mask:0xf bank_mask:0xf
s_nop 0
v_add_f32_dpp v208, v208, v208 row_ror:2 row_mask:0xf bank_mask:0xf
v_add_f32_dpp v210, v210, v210 row_ror:2 row_mask:0xf bank_mask:0xf
s_nop 0
v_add_f32_dpp v208, v208, v208 row_ror:4 row_mask:0xf bank_mask:0xf
v_add_f32_dpp v210, v210, v210 row_ror:4 row_mask:0xf bank_mask:0xf
s_nop 0
v_add_f32_dpp v208, v208, v208 row_ror:8 row_mask:0xf bank_mask:0xf
v_add_f32_dpp v210, v210, v210 row_ror:8 row_mask:0xf bank_mask:0xf
v_mov_b32 v209, v208
v_mov_b32 v211, v210
s_nop 0
v_permlane16_swap_b32 v209, v208
v_permlane16_swap_b32 v211, v210
v_add_f32 v208, v208, v209
v_add_f32 v210, v210, v211
v_mov_b32 v209, v208
v_mov_b32 v211, v210
s_nop 0
v_permlane32_swap_b32 v209, v208
v_permlane32_swap_b32 v211, v210
v_add_f32 v208, v208, v209
v_add_f32 v210, v210, v211
s_mov_b32 s51, 0x3a800000
v_mov_b32 v212, 0x3727c5ac
v_fma_f32 v208, v208, s51, v212
v_fma_f32 v210, v210, s51, v212
v_rsq_f32 v208, v208
v_rsq_f32 v210, v210
v_mul_f32 v208, s50, v208
v_mul_f32 v210, s50, v210
v_lshlrev_b32 v218, 7, v1
v_and_b32 v219, 7, v1
s_lshl_b32 s51, s30, 1
v_pk_mul_f32 v[64:65], v[64:65], v[208:209] op_sel_hi:[1,0]
v_pk_mul_f32 v[66:67], v[66:67], v[208:209] op_sel_hi:[1,0]
v_pk_mul_f32 v[68:69], v[68:69], v[208:209] op_sel_hi:[1,0]
v_pk_mul_f32 v[70:71], v[70:71], v[208:209] op_sel_hi:[1,0]
v_pk_mul_f32 v[72:73], v[72:73], v[208:209] op_sel_hi:[1,0]
v_pk_mul_f32 v[74:75], v[74:75], v[208:209] op_sel_hi:[1,0]
v_pk_mul_f32 v[76:77], v[76:77], v[208:209] op_sel_hi:[1,0]
v_pk_mul_f32 v[78:79], v[78:79], v[208:209] op_sel_hi:[1,0]
s_waitcnt lgkmcnt(6)
v_pk_fma_f32 v[64:65], v[64:65], v[160:161], v[176:177]
v_pk_fma_f32 v[66:67], v[66:67], v[162:163], v[178:179]
s_waitcnt lgkmcnt(4)
v_pk_fma_f32 v[68:69], v[68:69], v[164:165], v[180:181]
v_pk_fma_f32 v[70:71], v[70:71], v[166:167], v[182:183]
s_waitcnt lgkmcnt(2)
v_pk_fma_f32 v[72:73], v[72:73], v[168:169], v[184:185]
v_pk_fma_f32 v[74:75], v[74:75], v[170:171], v[186:187]
s_waitcnt lgkmcnt(0)
v_pk_fma_f32 v[76:77], v[76:77], v[172:173], v[188:189]
v_pk_fma_f32 v[78:79], v[78:79], v[174:175], v[190:191]
v_cvt_pk_bf16_f32 v64, v64, v65
v_cvt_pk_bf16_f32 v65, v66, v67
v_cvt_pk_bf16_f32 v66, v68, v69
v_cvt_pk_bf16_f32 v67, v70, v71
v_cvt_pk_bf16_f32 v68, v72, v73
v_cvt_pk_bf16_f32 v69, v74, v75
v_cvt_pk_bf16_f32 v70, v76, v77
v_cvt_pk_bf16_f32 v71, v78, v79
v_xor_b32 v220, s51, v219
v_lshl_add_u32 v220, v220, 4, v218
ds_write_b128 v220, v[64:67] offset:8192
ds_write_b128 v220, v[68:71] offset:16384
s_add_u32 s51, s51, 1
v_pk_mul_f32 v[80:81], v[80:81], v[210:211] op_sel_hi:[1,0]
v_pk_mul_f32 v[82:83], v[82:83], v[210:211] op_sel_hi:[1,0]
v_pk_mul_f32 v[84:85], v[84:85], v[210:211] op_sel_hi:[1,0]
v_pk_mul_f32 v[86:87], v[86:87], v[210:211] op_sel_hi:[1,0]
v_pk_mul_f32 v[88:89], v[88:89], v[210:211] op_sel_hi:[1,0]
v_pk_mul_f32 v[90:91], v[90:91], v[210:211] op_sel_hi:[1,0]
v_pk_mul_f32 v[92:93], v[92:93], v[210:211] op_sel_hi:[1,0]
v_pk_mul_f32 v[94:95], v[94:95], v[210:211] op_sel_hi:[1,0]
v_pk_fma_f32 v[80:81], v[80:81], v[160:161], v[176:177]
v_pk_fma_f32 v[82:83], v[82:83], v[162:163], v[178:179]
v_pk_fma_f32 v[84:85], v[84:85], v[164:165], v[180:181]
v_pk_fma_f32 v[86:87], v[86:87], v[166:167], v[182:183]
v_pk_fma_f32 v[88:89], v[88:89], v[168:169], v[184:185]
v_pk_fma_f32 v[90:91], v[90:91], v[170:171], v[186:187]
v_pk_fma_f32 v[92:93], v[92:93], v[172:173], v[188:189]
v_pk_fma_f32 v[94:95], v[94:95], v[174:175], v[190:191]
v_cvt_pk_bf16_f32 v80, v80, v81
v_cvt_pk_bf16_f32 v81, v82, v83
v_cvt_pk_bf16_f32 v82, v84, v85
v_cvt_pk_bf16_f32 v83, v86, v87
v_cvt_pk_bf16_f32 v84, v88, v89
v_cvt_pk_bf16_f32 v85, v90, v91
v_cvt_pk_bf16_f32 v86, v92, v93
v_cvt_pk_bf16_f32 v87, v94, v95
v_xor_b32 v220, s51, v219
v_lshl_add_u32 v220, v220, 4, v218
ds_write_b128 v220, v[80:83] offset:8192
ds_write_b128 v220, v[84:87] offset:16384
s_add_u32 s51, s51, 1
v_lshrrev_b32 v221, 3, v1
v_xor_b32 v220, v221, v219
v_lshlrev_b32 v220, 4, v220
v_lshl_add_u32 v220, v221, 7, v220
v_add_u32 v220, s33, v220
v_lshrrev_b32 v222, 2, v221
v_lshlrev_b32 v222, 17, v222
v_and_b32 v223, 3, v221
v_lshl_add_u32 v222, v223, 8, v222
v_lshl_add_u32 v222, v219, 4, v222
s_waitcnt lgkmcnt(0)
s_barrier
ds_read_b128 v[96:99], v220 offset:8192
ds_read_b128 v[100:103], v220 offset:9216
ds_read_b128 v[104:107], v220 offset:10240
ds_read_b128 v[108:111], v220 offset:11264
s_waitcnt lgkmcnt(3)
buffer_store_dwordx4 v[96:99], v222, s[20:23], s53 offen sc1
s_add_u32 s53, s53, 262144
s_waitcnt lgkmcnt(2)
buffer_store_dwordx4 v[100:103], v222, s[20:23], s53 offen sc1
s_add_u32 s53, s53, 262144
s_waitcnt lgkmcnt(1)
buffer_store_dwordx4 v[104:107], v222, s[20:23], s53 offen sc1
s_add_u32 s53, s53, 262144
s_waitcnt lgkmcnt(0)
buffer_store_dwordx4 v[108:111], v222, s[20:23], s53 offen sc1
s_add_u32 s53, s53, 262144
s_lshl_b32 s52, s41, 7
s_add_u32 s52, s52, 63045632
s_lshl_b32 s53, s40, 2
s_add_u32 s53, s53, s52
s_mov_b64 s[80:81], s[12:13]
s_mov_b32 s82, 67108864
s_mov_b32 s83, 0x00020000
v_mov_b32 v208, 0
v_mov_b32 v209, 1
v_and_b32 v210, 31, v1
v_lshlrev_b32 v210, 2, v210
s_mov_b32 s39, s52
s_mov_b32 s38, s53
s_add_u32 s8, s4, s42
s_addc_u32 s9, s5, 0
s_mov_b32 s10, 524288
s_mov_b32 s11, 0x00020000
s_add_u32 s12, s6, s42
s_addc_u32 s13, s7, 0
s_mov_b32 s14, 524288
s_mov_b32 s15, 0x00020000
s_add_u32 s24, s44, 8388608
s_addc_u32 s25, s45, 0
s_mov_b32 s26, 16777216
s_mov_b32 s27, 0x00020000
v_lshlrev_b32 v4, 8, v3
v_add_u32 v4, s33, v4
v_add_u32 v5, 0, v3
v_xor_b32 v5, v5, v2
v_lshl_add_u32 v20, v5, 4, v4
v_add_u32 v5, 4, v3
v_xor_b32 v5, v5, v2
v_lshl_add_u32 v21, v5, 4, v4
v_add_u32 v5, 8, v3
v_xor_b32 v5, v5, v2
v_lshl_add_u32 v22, v5, 4, v4
v_add_u32 v5, 12, v3
v_xor_b32 v5, v5, v2
v_lshl_add_u32 v23, v5, 4, v4
v_add_u32 v5, 0, v3
v_lshlrev_b32 v5, 1, v5
v_xor_b32 v5, v5, v2
v_lshl_add_u32 v24, v5, 4, v4
v_add_u32 v5, 4, v3
v_lshlrev_b32 v5, 1, v5
v_xor_b32 v5, v5, v2
v_lshl_add_u32 v25, v5, 4, v4
v_and_b32 v4, 1, v3
v_lshlrev_b32 v4, 1, v4
v_lshrrev_b32 v5, 1, v3
v_or_b32 v4, v4, v5
v_lshlrev_b32 v6, 8, v2
v_lshl_add_u32 v42, v4, 4, v6
v_add_u32 v5, 0, v4
v_xor_b32 v5, v5, v2
v_lshl_add_u32 v8, v5, 4, v6
v_add_u32 v5, 4, v4
v_xor_b32 v5, v5, v2
v_lshl_add_u32 v9, v5, 4, v6
v_add_u32 v5, 8, v4
v_xor_b32 v5, v5, v2
v_lshl_add_u32 v10, v5, 4, v6
v_add_u32 v5, 12, v4
v_xor_b32 v5, v5, v2
v_lshl_add_u32 v11, v5, 4, v6
v_lshrrev_b32 v4, 2, v2
v_and_b32 v5, 1, v3
v_lshl_or_b32 v5, v5, 2, v4
v_lshlrev_b32 v5, 1, v5
v_bfe_u32 v6, v2, 1, 1
v_xor_b32 v5, v5, v6
v_lshl_add_u32 v4, v3, 3, v4
v_lshlrev_b32 v4, 8, v4
v_and_b32 v6, 1, v2
v_lshl_add_u32 v4, v6, 3, v4
v_add_u32 v4, 98304, v4
v_xor_b32 v6, 0, v5
v_lshl_add_u32 v12, v6, 4, v4
v_xor_b32 v6, 2, v5
v_lshl_add_u32 v13, v6, 4, v4
v_xor_b32 v6, 4, v5
v_lshl_add_u32 v14, v6, 4, v4
v_xor_b32 v6, 6, v5
v_lshl_add_u32 v15, v6, 4, v4
v_xor_b32 v6, 8, v5
v_lshl_add_u32 v16, v6, 4, v4
v_xor_b32 v6, 10, v5
v_lshl_add_u32 v17, v6, 4, v4
v_xor_b32 v6, 12, v5
v_lshl_add_u32 v18, v6, 4, v4
v_xor_b32 v6, 14, v5
v_lshl_add_u32 v19, v6, 4, v4
v_lshlrev_b32 v43, 10, v3
v_add_u32 v43, 32768, v43
s_mov_b32 s36, 0x57800000
s_mov_b32 s58, 8388608
s_mov_b32 s59, 0x00020000
s_lshl_b32 s54, s2, 2
s_add_u32 s54, s54, s30
s_lshl_b32 s54, s54, 13
v_lshlrev_b32 v31, 7, v1
v_cmp_gt_u32 vcc, 16, v1
v_mov_b32 v5, 0x40000000
s_nop 0
v_cndmask_b32 v31, v5, v31, vcc
v_mov_b32 v38, 0
v_mov_b32 v34, 0
v_mov_b32 v39, 0
v_mov_b32 v35, 0
v_mov_b32 v40, 0
v_mov_b32 v36, 0
v_mov_b32 v41, 0
v_mov_b32 v37, 0
s_mov_b32 s4, s90
s_mov_b32 s5, s91
s_mov_b32 s6, 12582912
s_mov_b32 s7, 0x00020000
v_lshrrev_b32 v4, 1, v1
s_movk_i32 s53, 12288
v_mul_lo_u32 v4, v4, s53
v_and_b32 v5, 1, v1
v_lshl_add_u32 v33, v5, 4, v4
s_and_b32 s28, s2, 7
s_lshl_b32 s28, s28, 5
s_lshr_b32 s29, s2, 3
s_add_u32 s28, s28, s29
s_mul_i32 s29, s30, 3145728
s_lshl_b32 s53, s28, 5
s_add_u32 s29, s29, s53
s_add_u32 s29, s29, 4096
s_lshr_b32 s55, s54, 13
s_mul_i32 s55, s55, 12288
s_add_u32 s55, s55, 4096
s_waitcnt vmcnt(0)
s_barrier
s_cmp_lg_u32 s30, 0
s_cbranch_scc1 L_attn_kernel_noflag
buffer_store_dword v209, v208, s[80:83], s38 offen sc1
L_attn_kernel_noflag:
s_add_u32 m0, s33, 98304
s_mov_b32 s50, 0
buffer_load_dwordx4 v26, s[16:19], s50 offen offset:0 lds
buffer_load_dwordx4 v27, s[16:19], s50 offen offset:1024 lds
buffer_load_dwordx4 v28, s[16:19], s50 offen offset:2048 lds
buffer_load_dwordx4 v29, s[16:19], s50 offen offset:3072 lds
s_add_u32 m0, s33, 114688
s_mov_b32 s50, 524288
buffer_load_dwordx4 v26, s[16:19], s50 offen offset:0 lds
buffer_load_dwordx4 v27, s[16:19], s50 offen offset:1024 lds
buffer_load_dwordx4 v28, s[16:19], s50 offen offset:2048 lds
buffer_load_dwordx4 v29, s[16:19], s50 offen offset:3072 lds
s_add_u32 m0, s33, 131072
s_mov_b32 s50, 1048576
buffer_load_dwordx4 v26, s[16:19], s50 offen offset:0 lds
buffer_load_dwordx4 v27, s[16:19], s50 offen offset:1024 lds
buffer_load_dwordx4 v28, s[16:19], s50 offen offset:2048 lds
buffer_load_dwordx4 v29, s[16:19], s50 offen offset:3072 lds
s_add_u32 m0, s33, 147456
s_mov_b32 s50, 1572864
buffer_load_dwordx4 v26, s[16:19], s50 offen offset:0 lds
buffer_load_dwordx4 v27, s[16:19], s50 offen offset:1024 lds
buffer_load_dwordx4 v28, s[16:19], s50 offen offset:2048 lds
buffer_load_dwordx4 v29, s[16:19], s50 offen offset:3072 lds
s_add_u32 s37, s37, 2097152
buffer_load_dword v32, v7, s[16:19], s37 offen
s_cmp_lg_u32 s30, 0
s_cbranch_scc1 L_attn_kernel_hgot
s_mov_b32 s53, 0
L_attn_kernel_hpoll:
buffer_load_dword v211, v210, s[80:83], s39 offen sc1
s_waitcnt vmcnt(0)
v_cmp_ne_u32 vcc, 1, v211
s_cbranch_vccz L_attn_kernel_hgot
s_sleep 1
s_add_u32 s53, s53, 1
s_cmp_lt_u32 s53, 0x40000
s_cbranch_scc1 L_attn_kernel_hpoll
L_attn_kernel_hgot:
s_waitcnt vmcnt(0)
s_barrier
s_add_u32 s51, s47, 0
buffer_load_dwordx4 a[0:3], v30, s[20:23], s51 offen offset:0 sc1
buffer_load_dwordx4 a[8:11], v30, s[20:23], s51 offen offset:1024 sc1
buffer_load_dwordx4 a[16:19], v30, s[20:23], s51 offen offset:2048 sc1
buffer_load_dwordx4 a[24:27], v30, s[20:23], s51 offen offset:3072 sc1
s_add_u32 s51, s47, 131072
buffer_load_dwordx4 a[4:7], v30, s[20:23], s51 offen offset:0 sc1
buffer_load_dwordx4 a[12:15], v30, s[20:23], s51 offen offset:1024 sc1
buffer_load_dwordx4 a[20:23], v30, s[20:23], s51 offen offset:2048 sc1
buffer_load_dwordx4 a[28:31], v30, s[20:23], s51 offen offset:3072 sc1
TR a[192:193],v12,0
TR a[194:195],v12,1024
TR a[196:197],v12,8192
TR a[198:199],v12,9216
TR a[200:201],v13,0
TR a[202:203],v13,1024
TR a[204:205],v13,8192
TR a[206:207],v13,9216
TR a[208:209],v14,0
TR a[210:211],v14,1024
TR a[212:213],v14,8192
TR a[214:215],v14,9216
s_waitcnt vmcnt(7) lgkmcnt(10)
MM v[64:67],a[192:195],a[0:3],0
s_waitcnt vmcnt(3) lgkmcnt(8)
s_add_u32 s51, s47, 262144
TR a[216:217],v15,0
MM v[64:67],a[196:199],a[4:7],v[64:67]
buffer_load_dwordx4 a[32:35], v30, s[20:23], s51 offen offset:0 sc1
MM v[96:99],a[192:195],a[8:11],0
s_waitcnt vmcnt(3)
TR a[218:219],v15,1024
MM v[96:99],a[196:199],a[12:15],v[96:99]
buffer_load_dwordx4 a[40:43], v30, s[20:23], s51 offen offset:1024 sc1
MM v[128:131],a[192:195],a[16:19],0
s_waitcnt vmcnt(3)
TR a[220:221],v15,8192
MM v[128:131],a[196:199],a[20:23],v[128:131]
MM v[160:163],a[192:195],a[24:27],0
s_waitcnt vmcnt(2)
TR a[222:223],v15,9216
MM v[160:163],a[196:199],a[28:31],v[160:163]
s_waitcnt lgkmcnt(10)
buffer_load_dwordx4 a[48:51], v30, s[20:23], s51 offen offset:2048 sc1
MM v[68:71],a[200:203],a[0:3],0
s_waitcnt lgkmcnt(8)
TR a[192:193],v16,0
MM v[68:71],a[204:207],a[4:7],v[68:71]
MM v[100:103],a[200:203],a[8:11],0
TR a[194:195],v16,1024
MM v[100:103],a[204:207],a[12:15],v[100:103]
buffer_load_dwordx4 a[56:59], v30, s[20:23], s51 offen offset:3072 sc1
MM v[132:135],a[200:203],a[16:19],0
TR a[196:197],v16,8192
MM v[132:135],a[204:207],a[20:23],v[132:135]
MM v[164:167],a[200:203],a[24:27],0
s_add_u32 s51, s47, 393216
TR a[198:199],v16,9216
MM v[164:167],a[204:207],a[28:31],v[164:167]
s_waitcnt lgkmcnt(10)
buffer_load_dwordx4 a[36:39], v30, s[20:23], s51 offen offset:0 sc1
MM v[72:75],a[208:211],a[0:3],0
s_waitcnt lgkmcnt(8)
TR a[200:201],v17,0
MM v[72:75],a[212:215],a[4:7],v[72:75]
MM v[104:107],a[208:211],a[8:11],0
TR a[202:203],v17,1024
MM v[104:107],a[212:215],a[12:15],v[104:107]
buffer_load_dwordx4 a[44:47], v30, s[20:23], s51 offen offset:1024 sc1
MM v[136:139],a[208:211],a[16:19],0
TR a[204:205],v17,8192
MM v[136:139],a[212:215],a[20:23],v[136:139]
buffer_load_dwordx4 a[52:55], v30, s[20:23], s51 offen offset:2048 sc1
MM v[168:171],a[208:211],a[24:27],0
TR a[206:207],v17,9216
MM v[168:171],a[212:215],a[28:31],v[168:171]
s_waitcnt lgkmcnt(10)
MM v[76:79],a[216:219],a[0:3],0
s_waitcnt lgkmcnt(8)
TR a[208:209],v18,0
MM v[76:79],a[220:223],a[4:7],v[76:79]
buffer_load_dwordx4 a[60:63], v30, s[20:23], s51 offen offset:3072 sc1
MM v[108:111],a[216:219],a[8:11],0
TR a[210:211],v18,1024
MM v[108:111],a[220:223],a[12:15],v[108:111]
MM v[140:143],a[216:219],a[16:19],0
s_add_u32 s51, s47, 524288
TR a[212:213],v18,8192
MM v[140:143],a[220:223],a[20:23],v[140:143]
buffer_load_dwordx4 a[64:67], v30, s[20:23], s51 offen offset:0 sc1
MM v[172:175],a[216:219],a[24:27],0
TR a[214:215],v18,9216
MM v[172:175],a[220:223],a[28:31],v[172:175]
s_waitcnt lgkmcnt(10)
MM v[80:83],a[192:195],a[0:3],0
s_waitcnt lgkmcnt(8)
TR a[216:217],v19,0
MM v[80:83],a[196:199],a[4:7],v[80:83]
buffer_load_dwordx4 a[72:75], v30, s[20:23], s51 offen offset:1024 sc1
MM v[112:115],a[192:195],a[8:11],0
TR a[218:219],v19,1024
MM v[112:115],a[196:199],a[12:15],v[112:115]
MM v[144:147],a[192:195],a[16:19],0
TR a[220:221],v19,8192
MM v[144:147],a[196:199],a[20:23],v[144:147]
buffer_load_dwordx4 a[80:83], v30, s[20:23], s51 offen offset:2048 sc1
MM v[176:179],a[192:195],a[24:27],0
TR a[222:223],v19,9216
MM v[176:179],a[196:199],a[28:31],v[176:179]
s_waitcnt lgkmcnt(10)
buffer_load_dwordx4 a[88:91], v30, s[20:23], s51 offen offset:3072 sc1
MM v[84:87],a[200:203],a[0:3],0
s_waitcnt lgkmcnt(8)
s_add_u32 s51, s47, 655360
MM v[84:87],a[204:207],a[4:7],v[84:87]
buffer_load_dwordx4 a[68:71], v30, s[20:23], s51 offen offset:0 sc1
MM v[116:119],a[200:203],a[8:11],0
MM v[116:119],a[204:207],a[12:15],v[116:119]
buffer_load_dwordx4 a[76:79], v30, s[20:23], s51 offen offset:1024 sc1
MM v[148:151],a[200:203],a[16:19],0
MM v[148:151],a[204:207],a[20:23],v[148:151]
buffer_load_dwordx4 a[84:87], v30, s[20:23], s51 offen offset:2048 sc1
MM v[180:183],a[200:203],a[24:27],0
MM v[180:183],a[204:207],a[28:31],v[180:183]
s_waitcnt vmcnt(25) lgkmcnt(0)
MM v[88:91],a[208:211],a[0:3],0
s_barrier
MM v[88:91],a[212:215],a[4:7],v[88:91]
TR a[192:193],v12,16384
MM v[120:123],a[208:211],a[8:11],0
TR a[194:195],v12,17408
MM v[120:123],a[212:215],a[12:15],v[120:123]
TR a[196:197],v12,24576
MM v[152:155],a[208:211],a[16:19],0
TR a[198:199],v12,25600
MM v[152:155],a[212:215],a[20:23],v[152:155]
TR a[200:201],v13,16384
MM v[184:187],a[208:211],a[24:27],0
TR a[202:203],v13,17408
MM v[184:187],a[212:215],a[28:31],v[184:187]
TR a[204:205],v13,24576
MM v[92:95],a[216:219],a[0:3],0
TR a[206:207],v13,25600
MM v[92:95],a[220:223],a[4:7],v[92:95]
TR a[208:209],v14,16384
MM v[124:127],a[216:219],a[8:11],0
TR a[210:211],v14,17408
MM v[124:127],a[220:223],a[12:15],v[124:127]
buffer_load_dwordx4 a[92:95], v30, s[20:23], s51 offen offset:3072 sc1
MM v[156:159],a[216:219],a[16:19],0
TR a[212:213],v14,24576
MM v[156:159],a[220:223],a[20:23],v[156:159]
MM v[188:191],a[216:219],a[24:27],0
TR a[214:215],v14,25600
MM v[188:191],a[220:223],a[28:31],v[188:191]
s_waitcnt vmcnt(15) lgkmcnt(10)
MM v[64:67],a[192:195],a[32:35],v[64:67]
s_waitcnt vmcnt(11) lgkmcnt(8)
s_add_u32 s51, s47, 786432
TR a[216:217],v15,16384
MM v[64:67],a[196:199],a[36:39],v[64:67]
buffer_load_dwordx4 a[96:99], v30, s[20:23], s51 offen offset:0 sc1
MM v[96:99],a[192:195],a[40:43],v[96:99]
s_waitcnt vmcnt(11)
TR a[218:219],v15,17408
MM v[96:99],a[196:199],a[44:47],v[96:99]
buffer_load_dwordx4 a[104:107], v30, s[20:23], s51 offen offset:1024 sc1
MM v[128:131],a[192:195],a[48:51],v[128:131]
s_waitcnt vmcnt(11)
TR a[220:221],v15,24576
MM v[128:131],a[196:199],a[52:55],v[128:131]
MM v[160:163],a[192:195],a[56:59],v[160:163]
s_waitcnt vmcnt(10)
TR a[222:223],v15,25600
MM v[160:163],a[196:199],a[60:63],v[160:163]
s_waitcnt lgkmcnt(10)
buffer_load_dwordx4 a[112:115], v30, s[20:23], s51 offen offset:2048 sc1
MM v[68:71],a[200:203],a[32:35],v[68:71]
s_waitcnt lgkmcnt(8)
TR a[192:193],v16,16384
MM v[68:71],a[204:207],a[36:39],v[68:71]
MM v[100:103],a[200:203],a[40:43],v[100:103]
TR a[194:195],v16,17408
MM v[100:103],a[204:207],a[44:47],v[100:103]
buffer_load_dwordx4 a[120:123], v30, s[20:23], s51 offen offset:3072 sc1
MM v[132:135],a[200:203],a[48:51],v[132:135]
TR a[196:197],v16,24576
MM v[132:135],a[204:207],a[52:55],v[132:135]
MM v[164:167],a[200:203],a[56:59],v[164:167]
s_add_u32 s51, s47, 917504
TR a[198:199],v16,25600
MM v[164:167],a[204:207],a[60:63],v[164:167]
s_waitcnt lgkmcnt(10)
buffer_load_dwordx4 a[100:103], v30, s[20:23], s51 offen offset:0 sc1
MM v[72:75],a[208:211],a[32:35],v[72:75]
s_waitcnt lgkmcnt(8)
TR a[200:201],v17,16384
MM v[72:75],a[212:215],a[36:39],v[72:75]
MM v[104:107],a[208:211],a[40:43],v[104:107]
TR a[202:203],v17,17408
MM v[104:107],a[212:215],a[44:47],v[104:107]
buffer_load_dwordx4 a[108:111], v30, s[20:23], s51 offen offset:1024 sc1
MM v[136:139],a[208:211],a[48:51],v[136:139]
TR a[204:205],v17,24576
MM v[136:139],a[212:215],a[52:55],v[136:139]
buffer_load_dwordx4 a[116:119], v30, s[20:23], s51 offen offset:2048 sc1
MM v[168:171],a[208:211],a[56:59],v[168:171]
TR a[206:207],v17,25600
MM v[168:171],a[212:215],a[60:63],v[168:171]
s_waitcnt lgkmcnt(10)
MM v[76:79],a[216:219],a[32:35],v[76:79]
s_waitcnt lgkmcnt(8)
TR a[208:209],v18,16384
MM v[76:79],a[220:223],a[36:39],v[76:79]
buffer_load_dwordx4 a[124:127], v30, s[20:23], s51 offen offset:3072 sc1
MM v[108:111],a[216:219],a[40:43],v[108:111]
TR a[210:211],v18,17408
MM v[108:111],a[220:223],a[44:47],v[108:111]
MM v[140:143],a[216:219],a[48:51],v[140:143]
s_add_u32 m0, s33, 98304
s_mov_b32 s50, 2097152
TR a[212:213],v18,24576
MM v[140:143],a[220:223],a[52:55],v[140:143]
buffer_load_dwordx4 v26, s[16:19], s50 offen offset:0 lds
MM v[172:175],a[216:219],a[56:59],v[172:175]
TR a[214:215],v18,25600
MM v[172:175],a[220:223],a[60:63],v[172:175]
s_waitcnt lgkmcnt(10)
MM v[80:83],a[192:195],a[32:35],v[80:83]
s_waitcnt lgkmcnt(8)
TR a[216:217],v19,16384
MM v[80:83],a[196:199],a[36:39],v[80:83]
buffer_load_dwordx4 v27, s[16:19], s50 offen offset:1024 lds
MM v[112:115],a[192:195],a[40:43],v[112:115]
TR a[218:219],v19,17408
MM v[112:115],a[196:199],a[44:47],v[112:115]
MM v[144:147],a[192:195],a[48:51],v[144:147]
TR a[220:221],v19,24576
MM v[144:147],a[196:199],a[52:55],v[144:147]
buffer_load_dwordx4 v28, s[16:19], s50 offen offset:2048 lds
MM v[176:179],a[192:195],a[56:59],v[176:179]
TR a[222:223],v19,25600
MM v[176:179],a[196:199],a[60:63],v[176:179]
s_waitcnt lgkmcnt(10)
buffer_load_dwordx4 v29, s[16:19], s50 offen offset:3072 lds
MM v[84:87],a[200:203],a[32:35],v[84:87]
s_waitcnt lgkmcnt(8)
s_add_u32 s51, s47, 1048576
MM v[84:87],a[204:207],a[36:39],v[84:87]
buffer_load_dwordx4 a[0:3], v30, s[20:23], s51 offen offset:0 sc1
MM v[116:119],a[200:203],a[40:43],v[116:119]
MM v[116:119],a[204:207],a[44:47],v[116:119]
buffer_load_dwordx4 a[8:11], v30, s[20:23], s51 offen offset:1024 sc1
MM v[148:151],a[200:203],a[48:51],v[148:151]
MM v[148:151],a[204:207],a[52:55],v[148:151]
buffer_load_dwordx4 a[16:19], v30, s[20:23], s51 offen offset:2048 sc1
MM v[180:183],a[200:203],a[56:59],v[180:183]
MM v[180:183],a[204:207],a[60:63],v[180:183]
s_waitcnt vmcnt(40) lgkmcnt(0)
MM v[88:91],a[208:211],a[32:35],v[88:91]
s_barrier
MM v[88:91],a[212:215],a[36:39],v[88:91]
TR a[192:193],v12,32768
MM v[120:123],a[208:211],a[40:43],v[120:123]
TR a[194:195],v12,33792
MM v[120:123],a[212:215],a[44:47],v[120:123]
TR a[196:197],v12,40960
MM v[152:155],a[208:211],a[48:51],v[152:155]
TR a[198:199],v12,41984
MM v[152:155],a[212:215],a[52:55],v[152:155]
TR a[200:201],v13,32768
MM v[184:187],a[208:211],a[56:59],v[184:187]
TR a[202:203],v13,33792
MM v[184:187],a[212:215],a[60:63],v[184:187]
TR a[204:205],v13,40960
MM v[92:95],a[216:219],a[32:35],v[92:95]
TR a[206:207],v13,41984
MM v[92:95],a[220:223],a[36:39],v[92:95]
TR a[208:209],v14,32768
MM v[124:127],a[216:219],a[40:43],v[124:127]
TR a[210:211],v14,33792
MM v[124:127],a[220:223],a[44:47],v[124:127]
buffer_load_dwordx4 a[24:27], v30, s[20:23], s51 offen offset:3072 sc1
MM v[156:159],a[216:219],a[48:51],v[156:159]
TR a[212:213],v14,40960
MM v[156:159],a[220:223],a[52:55],v[156:159]
MM v[188:191],a[216:219],a[56:59],v[188:191]
TR a[214:215],v14,41984
MM v[188:191],a[220:223],a[60:63],v[188:191]
s_waitcnt vmcnt(23) lgkmcnt(10)
MM v[64:67],a[192:195],a[64:67],v[64:67]
s_waitcnt vmcnt(19) lgkmcnt(8)
s_add_u32 s37, s37, 2097152
TR a[216:217],v15,32768
MM v[64:67],a[196:199],a[68:71],v[64:67]
buffer_load_dword v32, v7, s[16:19], s37 offen
MM v[96:99],a[192:195],a[72:75],v[96:99]
s_waitcnt vmcnt(19)
s_add_u32 s51, s47, 1179648
TR a[218:219],v15,33792
MM v[96:99],a[196:199],a[76:79],v[96:99]
buffer_load_dwordx4 a[4:7], v30, s[20:23], s51 offen offset:0 sc1
MM v[128:131],a[192:195],a[80:83],v[128:131]
s_waitcnt vmcnt(19)
TR a[220:221],v15,40960
MM v[128:131],a[196:199],a[84:87],v[128:131]
MM v[160:163],a[192:195],a[88:91],v[160:163]
s_waitcnt vmcnt(18)
TR a[222:223],v15,41984
MM v[160:163],a[196:199],a[92:95],v[160:163]
s_waitcnt lgkmcnt(10)
buffer_load_dwordx4 a[12:15], v30, s[20:23], s51 offen offset:1024 sc1
MM v[68:71],a[200:203],a[64:67],v[68:71]
s_waitcnt lgkmcnt(8)
TR a[192:193],v16,32768
MM v[68:71],a[204:207],a[68:71],v[68:71]
MM v[100:103],a[200:203],a[72:75],v[100:103]
TR a[194:195],v16,33792
MM v[100:103],a[204:207],a[76:79],v[100:103]
buffer_load_dwordx4 a[20:23], v30, s[20:23], s51 offen offset:2048 sc1
MM v[132:135],a[200:203],a[80:83],v[132:135]
TR a[196:197],v16,40960
MM v[132:135],a[204:207],a[84:87],v[132:135]
buffer_load_dwordx4 a[28:31], v30, s[20:23], s51 offen offset:3072 sc1
MM v[164:167],a[200:203],a[88:91],v[164:167]
TR a[198:199],v16,41984
MM v[164:167],a[204:207],a[92:95],v[164:167]
s_waitcnt lgkmcnt(10)
MM v[72:75],a[208:211],a[64:67],v[72:75]
s_waitcnt lgkmcnt(8)
s_add_u32 m0, s33, 114688
s_mov_b32 s50, 2621440
TR a[200:201],v17,32768
MM v[72:75],a[212:215],a[68:71],v[72:75]
buffer_load_dwordx4 v26, s[16:19], s50 offen offset:0 lds
MM v[104:107],a[208:211],a[72:75],v[104:107]
TR a[202:203],v17,33792
MM v[104:107],a[212:215],a[76:79],v[104:107]
MM v[136:139],a[208:211],a[80:83],v[136:139]
TR a[204:205],v17,40960
MM v[136:139],a[212:215],a[84:87],v[136:139]
buffer_load_dwordx4 v27, s[16:19], s50 offen offset:1024 lds
MM v[168:171],a[208:211],a[88:91],v[168:171]
TR a[206:207],v17,41984
MM v[168:171],a[212:215],a[92:95],v[168:171]
s_waitcnt lgkmcnt(10)
buffer_load_dwordx4 v28, s[16:19], s50 offen offset:2048 lds
MM v[76:79],a[216:219],a[64:67],v[76:79]
s_waitcnt lgkmcnt(8)
TR a[208:209],v18,32768
MM v[76:79],a[220:223],a[68:71],v[76:79]
MM v[108:111],a[216:219],a[72:75],v[108:111]
TR a[210:211],v18,33792
MM v[108:111],a[220:223],a[76:79],v[108:111]
buffer_load_dwordx4 v29, s[16:19], s50 offen offset:3072 lds
MM v[140:143],a[216:219],a[80:83],v[140:143]
TR a[212:213],v18,40960
MM v[140:143],a[220:223],a[84:87],v[140:143]
MM v[172:175],a[216:219],a[88:91],v[172:175]
s_add_u32 s51, s47, 1310720
TR a[214:215],v18,41984
MM v[172:175],a[220:223],a[92:95],v[172:175]
s_waitcnt lgkmcnt(10)
buffer_load_dwordx4 a[32:35], v30, s[20:23], s51 offen offset:0 sc1
MM v[80:83],a[192:195],a[64:67],v[80:83]
s_waitcnt lgkmcnt(8)
TR a[216:217],v19,32768
MM v[80:83],a[196:199],a[68:71],v[80:83]
MM v[112:115],a[192:195],a[72:75],v[112:115]
TR a[218:219],v19,33792
MM v[112:115],a[196:199],a[76:79],v[112:115]
buffer_load_dwordx4 a[40:43], v30, s[20:23], s51 offen offset:1024 sc1
MM v[144:147],a[192:195],a[80:83],v[144:147]
TR a[220:221],v19,40960
MM v[144:147],a[196:199],a[84:87],v[144:147]
buffer_load_dwordx4 a[48:51], v30, s[20:23], s51 offen offset:2048 sc1
MM v[176:179],a[192:195],a[88:91],v[176:179]
TR a[222:223],v19,41984
MM v[176:179],a[196:199],a[92:95],v[176:179]
s_waitcnt lgkmcnt(10)
MM v[84:87],a[200:203],a[64:67],v[84:87]
s_waitcnt lgkmcnt(8)
buffer_load_dwordx4 a[56:59], v30, s[20:23], s51 offen offset:3072 sc1
MM v[84:87],a[204:207],a[68:71],v[84:87]
s_add_u32 s51, s47, 1441792
MM v[116:119],a[200:203],a[72:75],v[116:119]
buffer_load_dwordx4 a[36:39], v30, s[20:23], s51 offen offset:0 sc1
MM v[116:119],a[204:207],a[76:79],v[116:119]
buffer_load_dwordx4 a[44:47], v30, s[20:23], s51 offen offset:1024 sc1
MM v[148:151],a[200:203],a[80:83],v[148:151]
MM v[148:151],a[204:207],a[84:87],v[148:151]
buffer_load_dwordx4 a[52:55], v30, s[20:23], s51 offen offset:2048 sc1
MM v[180:183],a[200:203],a[88:91],v[180:183]
MM v[180:183],a[204:207],a[92:95],v[180:183]
s_waitcnt vmcnt(56) lgkmcnt(0)
MM v[88:91],a[208:211],a[64:67],v[88:91]
s_barrier
MM v[88:91],a[212:215],a[68:71],v[88:91]
TR a[192:193],v12,49152
MM v[120:123],a[208:211],a[72:75],v[120:123]
TR a[194:195],v12,50176
MM v[120:123],a[212:215],a[76:79],v[120:123]
TR a[196:197],v12,57344
MM v[152:155],a[208:211],a[80:83],v[152:155]
TR a[198:199],v12,58368
MM v[152:155],a[212:215],a[84:87],v[152:155]
TR a[200:201],v13,49152
MM v[184:187],a[208:211],a[88:91],v[184:187]
TR a[202:203],v13,50176
MM v[184:187],a[212:215],a[92:95],v[184:187]
TR a[204:205],v13,57344
MM v[92:95],a[216:219],a[64:67],v[92:95]
TR a[206:207],v13,58368
MM v[92:95],a[220:223],a[68:71],v[92:95]
TR a[208:209],v14,49152
MM v[124:127],a[216:219],a[72:75],v[124:127]
TR a[210:211],v14,50176
MM v[124:127],a[220:223],a[76:79],v[124:127]
buffer_load_dwordx4 a[60:63], v30, s[20:23], s51 offen offset:3072 sc1
MM v[156:159],a[216:219],a[80:83],v[156:159]
TR a[212:213],v14,57344
MM v[156:159],a[220:223],a[84:87],v[156:159]
MM v[188:191],a[216:219],a[88:91],v[188:191]
TR a[214:215],v14,58368
MM v[188:191],a[220:223],a[92:95],v[188:191]
s_waitcnt vmcnt(32) lgkmcnt(10)
MM v[64:67],a[192:195],a[96:99],v[64:67]
s_waitcnt vmcnt(28) lgkmcnt(8)
s_add_u32 m0, s33, 131072
s_mov_b32 s50, 3145728
TR a[216:217],v15,49152
MM v[64:67],a[196:199],a[100:103],v[64:67]
buffer_load_dwordx4 v26, s[16:19], s50 offen offset:0 lds
MM v[96:99],a[192:195],a[104:107],v[96:99]
s_waitcnt vmcnt(28)
TR a[218:219],v15,50176
MM v[96:99],a[196:199],a[108:111],v[96:99]
MM v[128:131],a[192:195],a[112:115],v[128:131]
s_waitcnt vmcnt(27)
TR a[220:221],v15,57344
MM v[128:131],a[196:199],a[116:119],v[128:131]
buffer_load_dwordx4 v27, s[16:19], s50 offen offset:1024 lds
MM v[160:163],a[192:195],a[120:123],v[160:163]
s_waitcnt vmcnt(27)
TR a[222:223],v15,58368
MM v[160:163],a[196:199],a[124:127],v[160:163]
s_waitcnt lgkmcnt(10)
MM v[68:71],a[200:203],a[96:99],v[68:71]
s_waitcnt lgkmcnt(8)
TR a[192:193],v16,49152
MM v[68:71],a[204:207],a[100:103],v[68:71]
buffer_load_dwordx4 v28, s[16:19], s50 offen offset:2048 lds
MM v[100:103],a[200:203],a[104:107],v[100:103]
TR a[194:195],v16,50176
MM v[100:103],a[204:207],a[108:111],v[100:103]
MM v[132:135],a[200:203],a[112:115],v[132:135]
TR a[196:197],v16,57344
MM v[132:135],a[204:207],a[116:119],v[132:135]
MM v[164:167],a[200:203],a[120:123],v[164:167]
TR a[198:199],v16,58368
MM v[164:167],a[204:207],a[124:127],v[164:167]
s_waitcnt lgkmcnt(10)
buffer_load_dwordx4 v29, s[16:19], s50 offen offset:3072 lds
MM v[72:75],a[208:211],a[96:99],v[72:75]
s_waitcnt lgkmcnt(8)
TR a[200:201],v17,49152
MM v[72:75],a[212:215],a[100:103],v[72:75]
MM v[104:107],a[208:211],a[104:107],v[104:107]
s_add_u32 s51, s47, 1572864
TR a[202:203],v17,50176
MM v[104:107],a[212:215],a[108:111],v[104:107]
buffer_load_dwordx4 a[64:67], v30, s[20:23], s51 offen offset:0 sc1
MM v[136:139],a[208:211],a[112:115],v[136:139]
TR a[204:205],v17,57344
MM v[136:139],a[212:215],a[116:119],v[136:139]
MM v[168:171],a[208:211],a[120:123],v[168:171]
TR a[206:207],v17,58368
MM v[168:171],a[212:215],a[124:127],v[168:171]
s_waitcnt lgkmcnt(10)
MM v[76:79],a[216:219],a[96:99],v[76:79]
s_waitcnt lgkmcnt(8)
TR a[208:209],v18,49152
MM v[76:79],a[220:223],a[100:103],v[76:79]
buffer_load_dwordx4 a[72:75], v30, s[20:23], s51 offen offset:1024 sc1
MM v[108:111],a[216:219],a[104:107],v[108:111]
TR a[210:211],v18,50176
MM v[108:111],a[220:223],a[108:111],v[108:111]
MM v[140:143],a[216:219],a[112:115],v[140:143]
TR a[212:213],v18,57344
MM v[140:143],a[220:223],a[116:119],v[140:143]
buffer_load_dwordx4 a[80:83], v30, s[20:23], s51 offen offset:2048 sc1
MM v[172:175],a[216:219],a[120:123],v[172:175]
TR a[214:215],v18,58368
MM v[172:175],a[220:223],a[124:127],v[172:175]
s_waitcnt lgkmcnt(10)
MM v[80:83],a[192:195],a[96:99],v[80:83]
s_waitcnt lgkmcnt(8)
TR a[216:217],v19,49152
MM v[80:83],a[196:199],a[100:103],v[80:83]
buffer_load_dwordx4 a[88:91], v30, s[20:23], s51 offen offset:3072 sc1
MM v[112:115],a[192:195],a[104:107],v[112:115]
TR a[218:219],v19,50176
MM v[112:115],a[196:199],a[108:111],v[112:115]
MM v[144:147],a[192:195],a[112:115],v[144:147]
TR a[220:221],v19,57344
MM v[144:147],a[196:199],a[116:119],v[144:147]
MM v[176:179],a[192:195],a[120:123],v[176:179]
s_add_u32 s51, s47, 1703936
TR a[222:223],v19,58368
MM v[176:179],a[196:199],a[124:127],v[176:179]
s_waitcnt lgkmcnt(10)
buffer_load_dwordx4 a[68:71], v30, s[20:23], s51 offen offset:0 sc1
MM v[84:87],a[200:203],a[96:99],v[84:87]
s_waitcnt lgkmcnt(8)
MM v[84:87],a[204:207],a[100:103],v[84:87]
buffer_load_dwordx4 a[76:79], v30, s[20:23], s51 offen offset:1024 sc1
MM v[116:119],a[200:203],a[104:107],v[116:119]
MM v[116:119],a[204:207],a[108:111],v[116:119]
MM v[148:151],a[200:203],a[112:115],v[148:151]
buffer_load_dwordx4 a[84:87], v30, s[20:23], s51 offen offset:2048 sc1
MM v[148:151],a[204:207],a[116:119],v[148:151]
MM v[180:183],a[200:203],a[120:123],v[180:183]
buffer_load_dwordx4 a[92:95], v30, s[20:23], s51 offen offset:3072 sc1
MM v[180:183],a[204:207],a[124:127],v[180:183]
s_waitcnt vmcnt(33) lgkmcnt(0)
MM v[88:91],a[208:211],a[96:99],v[88:91]
s_barrier
MM v[88:91],a[212:215],a[100:103],v[88:91]
TR a[192:193],v12,0
MM v[120:123],a[208:211],a[104:107],v[120:123]
TR a[194:195],v12,1024
MM v[120:123],a[212:215],a[108:111],v[120:123]
TR a[196:197],v12,8192
MM v[152:155],a[208:211],a[112:115],v[152:155]
TR a[198:199],v12,9216
MM v[152:155],a[212:215],a[116:119],v[152:155]
TR a[200:201],v13,0
MM v[184:187],a[208:211],a[120:123],v[184:187]
TR a[202:203],v13,1024
MM v[184:187],a[212:215],a[124:127],v[184:187]
TR a[204:205],v13,8192
MM v[92:95],a[216:219],a[96:99],v[92:95]
TR a[206:207],v13,9216
MM v[92:95],a[220:223],a[100:103],v[92:95]
TR a[208:209],v14,0
MM v[124:127],a[216:219],a[104:107],v[124:127]
TR a[210:211],v14,1024
MM v[124:127],a[220:223],a[108:111],v[124:127]
MM v[156:159],a[216:219],a[112:115],v[156:159]
TR a[212:213],v14,8192
MM v[156:159],a[220:223],a[116:119],v[156:159]
MM v[188:191],a[216:219],a[120:123],v[188:191]
TR a[214:215],v14,9216
MM v[188:191],a[220:223],a[124:127],v[188:191]
s_waitcnt vmcnt(32) lgkmcnt(10)
MM v[64:67],a[192:195],a[0:3],v[64:67]
s_waitcnt vmcnt(27) lgkmcnt(8)
s_add_u32 m0, s33, 147456
s_mov_b32 s50, 3670016
TR a[216:217],v15,0
MM v[64:67],a[196:199],a[4:7],v[64:67]
buffer_load_dwordx4 v26, s[16:19], s50 offen offset:0 lds
MM v[96:99],a[192:195],a[8:11],v[96:99]
s_waitcnt vmcnt(27)
TR a[218:219],v15,1024
MM v[96:99],a[196:199],a[12:15],v[96:99]
MM v[128:131],a[192:195],a[16:19],v[128:131]
s_waitcnt vmcnt(26)
TR a[220:221],v15,8192
MM v[128:131],a[196:199],a[20:23],v[128:131]
buffer_load_dwordx4 v27, s[16:19], s50 offen offset:1024 lds
MM v[160:163],a[192:195],a[24:27],v[160:163]
s_waitcnt vmcnt(26)
TR a[222:223],v15,9216
MM v[160:163],a[196:199],a[28:31],v[160:163]
s_waitcnt lgkmcnt(10)
MM v[68:71],a[200:203],a[0:3],v[68:71]
s_waitcnt lgkmcnt(8)
TR a[192:193],v16,0
MM v[68:71],a[204:207],a[4:7],v[68:71]
buffer_load_dwordx4 v28, s[16:19], s50 offen offset:2048 lds
MM v[100:103],a[200:203],a[8:11],v[100:103]
TR a[194:195],v16,1024
MM v[100:103],a[204:207],a[12:15],v[100:103]
MM v[132:135],a[200:203],a[16:19],v[132:135]
TR a[196:197],v16,8192
MM v[132:135],a[204:207],a[20:23],v[132:135]
MM v[164:167],a[200:203],a[24:27],v[164:167]
TR a[198:199],v16,9216
MM v[164:167],a[204:207],a[28:31],v[164:167]
s_waitcnt lgkmcnt(10)
buffer_load_dwordx4 v29, s[16:19], s50 offen offset:3072 lds
MM v[72:75],a[208:211],a[0:3],v[72:75]
s_waitcnt lgkmcnt(8)
TR a[200:201],v17,0
MM v[72:75],a[212:215],a[4:7],v[72:75]
MM v[104:107],a[208:211],a[8:11],v[104:107]
s_add_u32 s51, s47, 1835008
TR a[202:203],v17,1024
MM v[104:107],a[212:215],a[12:15],v[104:107]
buffer_load_dwordx4 a[96:99], v30, s[20:23], s51 offen offset:0 sc1
MM v[136:139],a[208:211],a[16:19],v[136:139]
TR a[204:205],v17,8192
MM v[136:139],a[212:215],a[20:23],v[136:139]
MM v[168:171],a[208:211],a[24:27],v[168:171]
TR a[206:207],v17,9216
MM v[168:171],a[212:215],a[28:31],v[168:171]
s_waitcnt lgkmcnt(10)
MM v[76:79],a[216:219],a[0:3],v[76:79]
s_waitcnt lgkmcnt(8)
TR a[208:209],v18,0
MM v[76:79],a[220:223],a[4:7],v[76:79]
buffer_load_dwordx4 a[104:107], v30, s[20:23], s51 offen offset:1024 sc1
MM v[108:111],a[216:219],a[8:11],v[108:111]
TR a[210:211],v18,1024
MM v[108:111],a[220:223],a[12:15],v[108:111]
MM v[140:143],a[216:219],a[16:19],v[140:143]
TR a[212:213],v18,8192
MM v[140:143],a[220:223],a[20:23],v[140:143]
buffer_load_dwordx4 a[112:115], v30, s[20:23], s51 offen offset:2048 sc1
MM v[172:175],a[216:219],a[24:27],v[172:175]
TR a[214:215],v18,9216
MM v[172:175],a[220:223],a[28:31],v[172:175]
s_waitcnt lgkmcnt(10)
MM v[80:83],a[192:195],a[0:3],v[80:83]
s_waitcnt lgkmcnt(8)
TR a[216:217],v19,0
MM v[80:83],a[196:199],a[4:7],v[80:83]
buffer_load_dwordx4 a[120:123], v30, s[20:23], s51 offen offset:3072 sc1
MM v[112:115],a[192:195],a[8:11],v[112:115]
TR a[218:219],v19,1024
MM v[112:115],a[196:199],a[12:15],v[112:115]
MM v[144:147],a[192:195],a[16:19],v[144:147]
TR a[220:221],v19,8192
MM v[144:147],a[196:199],a[20:23],v[144:147]
MM v[176:179],a[192:195],a[24:27],v[176:179]
s_add_u32 s51, s47, 1966080
TR a[222:223],v19,9216
MM v[176:179],a[196:199],a[28:31],v[176:179]
s_waitcnt lgkmcnt(10)
buffer_load_dwordx4 a[100:103], v30, s[20:23], s51 offen offset:0 sc1
MM v[84:87],a[200:203],a[0:3],v[84:87]
s_waitcnt lgkmcnt(8)
MM v[84:87],a[204:207],a[4:7],v[84:87]
buffer_load_dwordx4 a[108:111], v30, s[20:23], s51 offen offset:1024 sc1
MM v[116:119],a[200:203],a[8:11],v[116:119]
MM v[116:119],a[204:207],a[12:15],v[116:119]
MM v[148:151],a[200:203],a[16:19],v[148:151]
buffer_load_dwordx4 a[116:119], v30, s[20:23], s51 offen offset:2048 sc1
MM v[148:151],a[204:207],a[20:23],v[148:151]
MM v[180:183],a[200:203],a[24:27],v[180:183]
buffer_load_dwordx4 a[124:127], v30, s[20:23], s51 offen offset:3072 sc1
MM v[180:183],a[204:207],a[28:31],v[180:183]
s_waitcnt vmcnt(32) lgkmcnt(0)
MM v[88:91],a[208:211],a[0:3],v[88:91]
s_barrier
MM v[88:91],a[212:215],a[4:7],v[88:91]
TR a[192:193],v12,16384
MM v[120:123],a[208:211],a[8:11],v[120:123]
TR a[194:195],v12,17408
MM v[120:123],a[212:215],a[12:15],v[120:123]
TR a[196:197],v12,24576
MM v[152:155],a[208:211],a[16:19],v[152:155]
TR a[198:199],v12,25600
MM v[152:155],a[212:215],a[20:23],v[152:155]
TR a[200:201],v13,16384
MM v[184:187],a[208:211],a[24:27],v[184:187]
TR a[202:203],v13,17408
MM v[184:187],a[212:215],a[28:31],v[184:187]
TR a[204:205],v13,24576
MM v[92:95],a[216:219],a[0:3],v[92:95]
TR a[206:207],v13,25600
MM v[92:95],a[220:223],a[4:7],v[92:95]
TR a[208:209],v14,16384
MM v[124:127],a[216:219],a[8:11],v[124:127]
TR a[210:211],v14,17408
MM v[124:127],a[220:223],a[12:15],v[124:127]
MM v[156:159],a[216:219],a[16:19],v[156:159]
TR a[212:213],v14,24576
MM v[156:159],a[220:223],a[20:23],v[156:159]
MM v[188:191],a[216:219],a[24:27],v[188:191]
TR a[214:215],v14,25600
MM v[188:191],a[220:223],a[28:31],v[188:191]
s_waitcnt vmcnt(31) lgkmcnt(10)
MM v[64:67],a[192:195],a[32:35],v[64:67]
s_waitcnt vmcnt(27) lgkmcnt(8)
s_add_u32 m0, s33, 98304
s_mov_b32 s50, 4194304
TR a[216:217],v15,16384
MM v[64:67],a[196:199],a[36:39],v[64:67]
buffer_load_dwordx4 v26, s[16:19], s50 offen offset:0 lds
MM v[96:99],a[192:195],a[40:43],v[96:99]
s_waitcnt vmcnt(27)
TR a[218:219],v15,17408
MM v[96:99],a[196:199],a[44:47],v[96:99]
MM v[128:131],a[192:195],a[48:51],v[128:131]
s_waitcnt vmcnt(26)
TR a[220:221],v15,24576
MM v[128:131],a[196:199],a[52:55],v[128:131]
buffer_load_dwordx4 v27, s[16:19], s50 offen offset:1024 lds
MM v[160:163],a[192:195],a[56:59],v[160:163]
s_waitcnt vmcnt(26)
TR a[222:223],v15,25600
MM v[160:163],a[196:199],a[60:63],v[160:163]
s_waitcnt lgkmcnt(10)
MM v[68:71],a[200:203],a[32:35],v[68:71]
s_waitcnt lgkmcnt(8)
TR a[192:193],v16,16384
MM v[68:71],a[204:207],a[36:39],v[68:71]
buffer_load_dwordx4 v28, s[16:19], s50 offen offset:2048 lds
MM v[100:103],a[200:203],a[40:43],v[100:103]
TR a[194:195],v16,17408
MM v[100:103],a[204:207],a[44:47],v[100:103]
MM v[132:135],a[200:203],a[48:51],v[132:135]
TR a[196:197],v16,24576
MM v[132:135],a[204:207],a[52:55],v[132:135]
MM v[164:167],a[200:203],a[56:59],v[164:167]
TR a[198:199],v16,25600
MM v[164:167],a[204:207],a[60:63],v[164:167]
s_waitcnt lgkmcnt(10)
buffer_load_dwordx4 v29, s[16:19], s50 offen offset:3072 lds
MM v[72:75],a[208:211],a[32:35],v[72:75]
s_waitcnt lgkmcnt(8)
TR a[200:201],v17,16384
MM v[72:75],a[212:215],a[36:39],v[72:75]
MM v[104:107],a[208:211],a[40:43],v[104:107]
s_add_u32 s51, s47, 2097152
TR a[202:203],v17,17408
MM v[104:107],a[212:215],a[44:47],v[104:107]
buffer_load_dwordx4 a[0:3], v30, s[20:23], s51 offen offset:0 sc1
MM v[136:139],a[208:211],a[48:51],v[136:139]
TR a[204:205],v17,24576
MM v[136:139],a[212:215],a[52:55],v[136:139]
MM v[168:171],a[208:211],a[56:59],v[168:171]
TR a[206:207],v17,25600
MM v[168:171],a[212:215],a[60:63],v[168:171]
s_waitcnt lgkmcnt(10)
MM v[76:79],a[216:219],a[32:35],v[76:79]
s_waitcnt lgkmcnt(8)
TR a[208:209],v18,16384
MM v[76:79],a[220:223],a[36:39],v[76:79]
buffer_load_dwordx4 a[8:11], v30, s[20:23], s51 offen offset:1024 sc1
MM v[108:111],a[216:219],a[40:43],v[108:111]
TR a[210:211],v18,17408
MM v[108:111],a[220:223],a[44:47],v[108:111]
MM v[140:143],a[216:219],a[48:51],v[140:143]
TR a[212:213],v18,24576
MM v[140:143],a[220:223],a[52:55],v[140:143]
buffer_load_dwordx4 a[16:19], v30, s[20:23], s51 offen offset:2048 sc1
MM v[172:175],a[216:219],a[56:59],v[172:175]
TR a[214:215],v18,25600
MM v[172:175],a[220:223],a[60:63],v[172:175]
s_waitcnt lgkmcnt(10)
MM v[80:83],a[192:195],a[32:35],v[80:83]
s_waitcnt lgkmcnt(8)
TR a[216:217],v19,16384
MM v[80:83],a[196:199],a[36:39],v[80:83]
buffer_load_dwordx4 a[24:27], v30, s[20:23], s51 offen offset:3072 sc1
MM v[112:115],a[192:195],a[40:43],v[112:115]
TR a[218:219],v19,17408
MM v[112:115],a[196:199],a[44:47],v[112:115]
MM v[144:147],a[192:195],a[48:51],v[144:147]
TR a[220:221],v19,24576
MM v[144:147],a[196:199],a[52:55],v[144:147]
MM v[176:179],a[192:195],a[56:59],v[176:179]
s_add_u32 s51, s47, 2228224
TR a[222:223],v19,25600
MM v[176:179],a[196:199],a[60:63],v[176:179]
s_waitcnt lgkmcnt(10)
buffer_load_dwordx4 a[4:7], v30, s[20:23], s51 offen offset:0 sc1
MM v[84:87],a[200:203],a[32:35],v[84:87]
s_waitcnt lgkmcnt(8)
MM v[84:87],a[204:207],a[36:39],v[84:87]
buffer_load_dwordx4 a[12:15], v30, s[20:23], s51 offen offset:1024 sc1
MM v[116:119],a[200:203],a[40:43],v[116:119]
MM v[116:119],a[204:207],a[44:47],v[116:119]
MM v[148:151],a[200:203],a[48:51],v[148:151]
buffer_load_dwordx4 a[20:23], v30, s[20:23], s51 offen offset:2048 sc1
MM v[148:151],a[204:207],a[52:55],v[148:151]
MM v[180:183],a[200:203],a[56:59],v[180:183]
buffer_load_dwordx4 a[28:31], v30, s[20:23], s51 offen offset:3072 sc1
MM v[180:183],a[204:207],a[60:63],v[180:183]
s_waitcnt vmcnt(32) lgkmcnt(0)
MM v[88:91],a[208:211],a[32:35],v[88:91]
s_barrier
MM v[88:91],a[212:215],a[36:39],v[88:91]
TR a[192:193],v12,32768
MM v[120:123],a[208:211],a[40:43],v[120:123]
TR a[194:195],v12,33792
MM v[120:123],a[212:215],a[44:47],v[120:123]
TR a[196:197],v12,40960
MM v[152:155],a[208:211],a[48:51],v[152:155]
TR a[198:199],v12,41984
MM v[152:155],a[212:215],a[52:55],v[152:155]
TR a[200:201],v13,32768
MM v[184:187],a[208:211],a[56:59],v[184:187]
TR a[202:203],v13,33792
MM v[184:187],a[212:215],a[60:63],v[184:187]
TR a[204:205],v13,40960
MM v[92:95],a[216:219],a[32:35],v[92:95]
TR a[206:207],v13,41984
MM v[92:95],a[220:223],a[36:39],v[92:95]
TR a[208:209],v14,32768
MM v[124:127],a[216:219],a[40:43],v[124:127]
TR a[210:211],v14,33792
MM v[124:127],a[220:223],a[44:47],v[124:127]
MM v[156:159],a[216:219],a[48:51],v[156:159]
TR a[212:213],v14,40960
MM v[156:159],a[220:223],a[52:55],v[156:159]
MM v[188:191],a[216:219],a[56:59],v[188:191]
TR a[214:215],v14,41984
MM v[188:191],a[220:223],a[60:63],v[188:191]
s_waitcnt vmcnt(31) lgkmcnt(10)
MM v[64:67],a[192:195],a[64:67],v[64:67]
s_waitcnt vmcnt(27) lgkmcnt(8)
s_add_u32 s37, s37, 2097152
TR a[216:217],v15,32768
MM v[64:67],a[196:199],a[68:71],v[64:67]
buffer_load_dword v32, v7, s[16:19], s37 offen
MM v[96:99],a[192:195],a[72:75],v[96:99]
s_waitcnt vmcnt(27)
TR a[218:219],v15,33792
MM v[96:99],a[196:199],a[76:79],v[96:99]
MM v[128:131],a[192:195],a[80:83],v[128:131]
s_waitcnt vmcnt(26)
s_add_u32 m0, s33, 114688
s_mov_b32 s50, 4718592
TR a[220:221],v15,40960
MM v[128:131],a[196:199],a[84:87],v[128:131]
buffer_load_dwordx4 v26, s[16:19], s50 offen offset:0 lds
MM v[160:163],a[192:195],a[88:91],v[160:163]
s_waitcnt vmcnt(26)
TR a[222:223],v15,41984
MM v[160:163],a[196:199],a[92:95],v[160:163]
s_waitcnt lgkmcnt(10)
MM v[68:71],a[200:203],a[64:67],v[68:71]
s_waitcnt lgkmcnt(8)
TR a[192:193],v16,32768
MM v[68:71],a[204:207],a[68:71],v[68:71]
buffer_load_dwordx4 v27, s[16:19], s50 offen offset:1024 lds
MM v[100:103],a[200:203],a[72:75],v[100:103]
TR a[194:195],v16,33792
MM v[100:103],a[204:207],a[76:79],v[100:103]
MM v[132:135],a[200:203],a[80:83],v[132:135]
TR a[196:197],v16,40960
MM v[132:135],a[204:207],a[84:87],v[132:135]
buffer_load_dwordx4 v28, s[16:19], s50 offen offset:2048 lds
MM v[164:167],a[200:203],a[88:91],v[164:167]
TR a[198:199],v16,41984
MM v[164:167],a[204:207],a[92:95],v[164:167]
s_waitcnt lgkmcnt(10)
MM v[72:75],a[208:211],a[64:67],v[72:75]
s_waitcnt lgkmcnt(8)
TR a[200:201],v17,32768
MM v[72:75],a[212:215],a[68:71],v[72:75]
buffer_load_dwordx4 v29, s[16:19], s50 offen offset:3072 lds
MM v[104:107],a[208:211],a[72:75],v[104:107]
TR a[202:203],v17,33792
MM v[104:107],a[212:215],a[76:79],v[104:107]
MM v[136:139],a[208:211],a[80:83],v[136:139]
TR a[204:205],v17,40960
MM v[136:139],a[212:215],a[84:87],v[136:139]
MM v[168:171],a[208:211],a[88:91],v[168:171]
s_add_u32 s51, s47, 2359296
TR a[206:207],v17,41984
MM v[168:171],a[212:215],a[92:95],v[168:171]
s_waitcnt lgkmcnt(10)
buffer_load_dwordx4 a[32:35], v30, s[20:23], s51 offen offset:0 sc1
MM v[76:79],a[216:219],a[64:67],v[76:79]
s_waitcnt lgkmcnt(8)
TR a[208:209],v18,32768
MM v[76:79],a[220:223],a[68:71],v[76:79]
MM v[108:111],a[216:219],a[72:75],v[108:111]
TR a[210:211],v18,33792
MM v[108:111],a[220:223],a[76:79],v[108:111]
buffer_load_dwordx4 a[40:43], v30, s[20:23], s51 offen offset:1024 sc1
MM v[140:143],a[216:219],a[80:83],v[140:143]
TR a[212:213],v18,40960
MM v[140:143],a[220:223],a[84:87],v[140:143]
MM v[172:175],a[216:219],a[88:91],v[172:175]
TR a[214:215],v18,41984
MM v[172:175],a[220:223],a[92:95],v[172:175]
s_waitcnt lgkmcnt(10)
buffer_load_dwordx4 a[48:51], v30, s[20:23], s51 offen offset:2048 sc1
MM v[80:83],a[192:195],a[64:67],v[80:83]
s_waitcnt lgkmcnt(8)
TR a[216:217],v19,32768
MM v[80:83],a[196:199],a[68:71],v[80:83]
MM v[112:115],a[192:195],a[72:75],v[112:115]
TR a[218:219],v19,33792
MM v[112:115],a[196:199],a[76:79],v[112:115]
buffer_load_dwordx4 a[56:59], v30, s[20:23], s51 offen offset:3072 sc1
MM v[144:147],a[192:195],a[80:83],v[144:147]
TR a[220:221],v19,40960
MM v[144:147],a[196:199],a[84:87],v[144:147]
MM v[176:179],a[192:195],a[88:91],v[176:179]
TR a[222:223],v19,41984
MM v[176:179],a[196:199],a[92:95],v[176:179]
s_waitcnt lgkmcnt(10)
s_add_u32 s51, s47, 2490368
MM v[84:87],a[200:203],a[64:67],v[84:87]
s_waitcnt lgkmcnt(8)
buffer_load_dwordx4 a[36:39], v30, s[20:23], s51 offen offset:0 sc1
MM v[84:87],a[204:207],a[68:71],v[84:87]
MM v[116:119],a[200:203],a[72:75],v[116:119]
buffer_load_dwordx4 a[44:47], v30, s[20:23], s51 offen offset:1024 sc1
MM v[116:119],a[204:207],a[76:79],v[116:119]
MM v[148:151],a[200:203],a[80:83],v[148:151]
buffer_load_dwordx4 a[52:55], v30, s[20:23], s51 offen offset:2048 sc1
MM v[148:151],a[204:207],a[84:87],v[148:151]
MM v[180:183],a[200:203],a[88:91],v[180:183]
buffer_load_dwordx4 a[60:63], v30, s[20:23], s51 offen offset:3072 sc1
MM v[180:183],a[204:207],a[92:95],v[180:183]
s_waitcnt vmcnt(33) lgkmcnt(0)
MM v[88:91],a[208:211],a[64:67],v[88:91]
s_barrier
MM v[88:91],a[212:215],a[68:71],v[88:91]
TR a[192:193],v12,49152
MM v[120:123],a[208:211],a[72:75],v[120:123]
TR a[194:195],v12,50176
MM v[120:123],a[212:215],a[76:79],v[120:123]
TR a[196:197],v12,57344
MM v[152:155],a[208:211],a[80:83],v[152:155]
TR a[198:199],v12,58368
MM v[152:155],a[212:215],a[84:87],v[152:155]
TR a[200:201],v13,49152
MM v[184:187],a[208:211],a[88:91],v[184:187]
TR a[202:203],v13,50176
MM v[184:187],a[212:215],a[92:95],v[184:187]
TR a[204:205],v13,57344
MM v[92:95],a[216:219],a[64:67],v[92:95]
TR a[206:207],v13,58368
MM v[92:95],a[220:223],a[68:71],v[92:95]
TR a[208:209],v14,49152
MM v[124:127],a[216:219],a[72:75],v[124:127]
TR a[210:211],v14,50176
MM v[124:127],a[220:223],a[76:79],v[124:127]
MM v[156:159],a[216:219],a[80:83],v[156:159]
TR a[212:213],v14,57344
MM v[156:159],a[220:223],a[84:87],v[156:159]
MM v[188:191],a[216:219],a[88:91],v[188:191]
TR a[214:215],v14,58368
MM v[188:191],a[220:223],a[92:95],v[188:191]
s_waitcnt vmcnt(32) lgkmcnt(10)
MM v[64:67],a[192:195],a[96:99],v[64:67]
s_waitcnt vmcnt(28) lgkmcnt(8)
s_add_u32 m0, s33, 131072
s_mov_b32 s50, 5242880
TR a[216:217],v15,49152
MM v[64:67],a[196:199],a[100:103],v[64:67]
buffer_load_dwordx4 v26, s[16:19], s50 offen offset:0 lds
MM v[96:99],a[192:195],a[104:107],v[96:99]
s_waitcnt vmcnt(28)
TR a[218:219],v15,50176
MM v[96:99],a[196:199],a[108:111],v[96:99]
MM v[128:131],a[192:195],a[112:115],v[128:131]
s_waitcnt vmcnt(27)
TR a[220:221],v15,57344
MM v[128:131],a[196:199],a[116:119],v[128:131]
buffer_load_dwordx4 v27, s[16:19], s50 offen offset:1024 lds
MM v[160:163],a[192:195],a[120:123],v[160:163]
s_waitcnt vmcnt(27)
TR a[222:223],v15,58368
MM v[160:163],a[196:199],a[124:127],v[160:163]
s_waitcnt lgkmcnt(10)
MM v[68:71],a[200:203],a[96:99],v[68:71]
s_waitcnt lgkmcnt(8)
TR a[192:193],v16,49152
MM v[68:71],a[204:207],a[100:103],v[68:71]
buffer_load_dwordx4 v28, s[16:19], s50 offen offset:2048 lds
MM v[100:103],a[200:203],a[104:107],v[100:103]
TR a[194:195],v16,50176
MM v[100:103],a[204:207],a[108:111],v[100:103]
MM v[132:135],a[200:203],a[112:115],v[132:135]
TR a[196:197],v16,57344
MM v[132:135],a[204:207],a[116:119],v[132:135]
MM v[164:167],a[200:203],a[120:123],v[164:167]
TR a[198:199],v16,58368
MM v[164:167],a[204:207],a[124:127],v[164:167]
s_waitcnt lgkmcnt(10)
buffer_load_dwordx4 v29, s[16:19], s50 offen offset:3072 lds
MM v[72:75],a[208:211],a[96:99],v[72:75]
s_waitcnt lgkmcnt(8)
TR a[200:201],v17,49152
MM v[72:75],a[212:215],a[100:103],v[72:75]
MM v[104:107],a[208:211],a[104:107],v[104:107]
s_add_u32 s51, s47, 2621440
TR a[202:203],v17,50176
MM v[104:107],a[212:215],a[108:111],v[104:107]
buffer_load_dwordx4 a[64:67], v30, s[20:23], s51 offen offset:0 sc1
MM v[136:139],a[208:211],a[112:115],v[136:139]
TR a[204:205],v17,57344
MM v[136:139],a[212:215],a[116:119],v[136:139]
MM v[168:171],a[208:211],a[120:123],v[168:171]
TR a[206:207],v17,58368
MM v[168:171],a[212:215],a[124:127],v[168:171]
s_waitcnt lgkmcnt(10)
MM v[76:79],a[216:219],a[96:99],v[76:79]
s_waitcnt lgkmcnt(8)
TR a[208:209],v18,49152
MM v[76:79],a[220:223],a[100:103],v[76:79]
buffer_load_dwordx4 a[72:75], v30, s[20:23], s51 offen offset:1024 sc1
MM v[108:111],a[216:219],a[104:107],v[108:111]
TR a[210:211],v18,50176
MM v[108:111],a[220:223],a[108:111],v[108:111]
MM v[140:143],a[216:219],a[112:115],v[140:143]
TR a[212:213],v18,57344
MM v[140:143],a[220:223],a[116:119],v[140:143]
buffer_load_dwordx4 a[80:83], v30, s[20:23], s51 offen offset:2048 sc1
MM v[172:175],a[216:219],a[120:123],v[172:175]
TR a[214:215],v18,58368
MM v[172:175],a[220:223],a[124:127],v[172:175]
s_waitcnt lgkmcnt(10)
MM v[80:83],a[192:195],a[96:99],v[80:83]
s_waitcnt lgkmcnt(8)
TR a[216:217],v19,49152
MM v[80:83],a[196:199],a[100:103],v[80:83]
buffer_load_dwordx4 a[88:91], v30, s[20:23], s51 offen offset:3072 sc1
MM v[112:115],a[192:195],a[104:107],v[112:115]
TR a[218:219],v19,50176
MM v[112:115],a[196:199],a[108:111],v[112:115]
MM v[144:147],a[192:195],a[112:115],v[144:147]
TR a[220:221],v19,57344
MM v[144:147],a[196:199],a[116:119],v[144:147]
MM v[176:179],a[192:195],a[120:123],v[176:179]
s_add_u32 s51, s47, 2752512
TR a[222:223],v19,58368
MM v[176:179],a[196:199],a[124:127],v[176:179]
s_waitcnt lgkmcnt(10)
buffer_load_dwordx4 a[68:71], v30, s[20:23], s51 offen offset:0 sc1
MM v[84:87],a[200:203],a[96:99],v[84:87]
s_waitcnt lgkmcnt(8)
MM v[84:87],a[204:207],a[100:103],v[84:87]
buffer_load_dwordx4 a[76:79], v30, s[20:23], s51 offen offset:1024 sc1
MM v[116:119],a[200:203],a[104:107],v[116:119]
MM v[116:119],a[204:207],a[108:111],v[116:119]
MM v[148:151],a[200:203],a[112:115],v[148:151]
buffer_load_dwordx4 a[84:87], v30, s[20:23], s51 offen offset:2048 sc1
MM v[148:151],a[204:207],a[116:119],v[148:151]
MM v[180:183],a[200:203],a[120:123],v[180:183]
buffer_load_dwordx4 a[92:95], v30, s[20:23], s51 offen offset:3072 sc1
MM v[180:183],a[204:207],a[124:127],v[180:183]
s_waitcnt vmcnt(33) lgkmcnt(0)
MM v[88:91],a[208:211],a[96:99],v[88:91]
s_barrier
MM v[88:91],a[212:215],a[100:103],v[88:91]
TR a[192:193],v12,0
MM v[120:123],a[208:211],a[104:107],v[120:123]
TR a[194:195],v12,1024
MM v[120:123],a[212:215],a[108:111],v[120:123]
TR a[196:197],v12,8192
MM v[152:155],a[208:211],a[112:115],v[152:155]
TR a[198:199],v12,9216
MM v[152:155],a[212:215],a[116:119],v[152:155]
TR a[200:201],v13,0
MM v[184:187],a[208:211],a[120:123],v[184:187]
TR a[202:203],v13,1024
MM v[184:187],a[212:215],a[124:127],v[184:187]
TR a[204:205],v13,8192
MM v[92:95],a[216:219],a[96:99],v[92:95]
TR a[206:207],v13,9216
MM v[92:95],a[220:223],a[100:103],v[92:95]
TR a[208:209],v14,0
MM v[124:127],a[216:219],a[104:107],v[124:127]
TR a[210:211],v14,1024
MM v[124:127],a[220:223],a[108:111],v[124:127]
MM v[156:159],a[216:219],a[112:115],v[156:159]
TR a[212:213],v14,8192
MM v[156:159],a[220:223],a[116:119],v[156:159]
MM v[188:191],a[216:219],a[120:123],v[188:191]
TR a[214:215],v14,9216
MM v[188:191],a[220:223],a[124:127],v[188:191]
s_waitcnt vmcnt(32) lgkmcnt(10)
MM v[64:67],a[192:195],a[0:3],v[64:67]
s_waitcnt vmcnt(28) lgkmcnt(8)
s_add_u32 m0, s33, 147456
s_mov_b32 s50, 5767168
TR a[216:217],v15,0
MM v[64:67],a[196:199],a[4:7],v[64:67]
buffer_load_dwordx4 v26, s[16:19], s50 offen offset:0 lds
MM v[96:99],a[192:195],a[8:11],v[96:99]
s_waitcnt vmcnt(28)
TR a[218:219],v15,1024
MM v[96:99],a[196:199],a[12:15],v[96:99]
MM v[128:131],a[192:195],a[16:19],v[128:131]
s_waitcnt vmcnt(27)
TR a[220:221],v15,8192
MM v[128:131],a[196:199],a[20:23],v[128:131]
buffer_load_dwordx4 v27, s[16:19], s50 offen offset:1024 lds
MM v[160:163],a[192:195],a[24:27],v[160:163]
s_waitcnt vmcnt(27)
TR a[222:223],v15,9216
MM v[160:163],a[196:199],a[28:31],v[160:163]
s_waitcnt lgkmcnt(10)
MM v[68:71],a[200:203],a[0:3],v[68:71]
s_waitcnt lgkmcnt(8)
TR a[192:193],v16,0
MM v[68:71],a[204:207],a[4:7],v[68:71]
buffer_load_dwordx4 v28, s[16:19], s50 offen offset:2048 lds
MM v[100:103],a[200:203],a[8:11],v[100:103]
TR a[194:195],v16,1024
MM v[100:103],a[204:207],a[12:15],v[100:103]
MM v[132:135],a[200:203],a[16:19],v[132:135]
TR a[196:197],v16,8192
MM v[132:135],a[204:207],a[20:23],v[132:135]
MM v[164:167],a[200:203],a[24:27],v[164:167]
TR a[198:199],v16,9216
MM v[164:167],a[204:207],a[28:31],v[164:167]
s_waitcnt lgkmcnt(10)
buffer_load_dwordx4 v29, s[16:19], s50 offen offset:3072 lds
MM v[72:75],a[208:211],a[0:3],v[72:75]
s_waitcnt lgkmcnt(8)
TR a[200:201],v17,0
MM v[72:75],a[212:215],a[4:7],v[72:75]
MM v[104:107],a[208:211],a[8:11],v[104:107]
s_add_u32 s51, s47, 2883584
TR a[202:203],v17,1024
MM v[104:107],a[212:215],a[12:15],v[104:107]
buffer_load_dwordx4 a[96:99], v30, s[20:23], s51 offen offset:0 sc1
MM v[136:139],a[208:211],a[16:19],v[136:139]
TR a[204:205],v17,8192
MM v[136:139],a[212:215],a[20:23],v[136:139]
MM v[168:171],a[208:211],a[24:27],v[168:171]
TR a[206:207],v17,9216
MM v[168:171],a[212:215],a[28:31],v[168:171]
s_waitcnt lgkmcnt(10)
MM v[76:79],a[216:219],a[0:3],v[76:79]
s_waitcnt lgkmcnt(8)
TR a[208:209],v18,0
MM v[76:79],a[220:223],a[4:7],v[76:79]
buffer_load_dwordx4 a[104:107], v30, s[20:23], s51 offen offset:1024 sc1
MM v[108:111],a[216:219],a[8:11],v[108:111]
TR a[210:211],v18,1024
MM v[108:111],a[220:223],a[12:15],v[108:111]
MM v[140:143],a[216:219],a[16:19],v[140:143]
TR a[212:213],v18,8192
MM v[140:143],a[220:223],a[20:23],v[140:143]
buffer_load_dwordx4 a[112:115], v30, s[20:23], s51 offen offset:2048 sc1
MM v[172:175],a[216:219],a[24:27],v[172:175]
TR a[214:215],v18,9216
MM v[172:175],a[220:223],a[28:31],v[172:175]
s_waitcnt lgkmcnt(10)
MM v[80:83],a[192:195],a[0:3],v[80:83]
s_waitcnt lgkmcnt(8)
TR a[216:217],v19,0
MM v[80:83],a[196:199],a[4:7],v[80:83]
buffer_load_dwordx4 a[120:123], v30, s[20:23], s51 offen offset:3072 sc1
MM v[112:115],a[192:195],a[8:11],v[112:115]
TR a[218:219],v19,1024
MM v[112:115],a[196:199],a[12:15],v[112:115]
MM v[144:147],a[192:195],a[16:19],v[144:147]
TR a[220:221],v19,8192
MM v[144:147],a[196:199],a[20:23],v[144:147]
MM v[176:179],a[192:195],a[24:27],v[176:179]
s_add_u32 s51, s47, 3014656
TR a[222:223],v19,9216
MM v[176:179],a[196:199],a[28:31],v[176:179]
s_waitcnt lgkmcnt(10)
buffer_load_dwordx4 a[100:103], v30, s[20:23], s51 offen offset:0 sc1
MM v[84:87],a[200:203],a[0:3],v[84:87]
s_waitcnt lgkmcnt(8)
MM v[84:87],a[204:207],a[4:7],v[84:87]
buffer_load_dwordx4 a[108:111], v30, s[20:23], s51 offen offset:1024 sc1
MM v[116:119],a[200:203],a[8:11],v[116:119]
MM v[116:119],a[204:207],a[12:15],v[116:119]
MM v[148:151],a[200:203],a[16:19],v[148:151]
buffer_load_dwordx4 a[116:119], v30, s[20:23], s51 offen offset:2048 sc1
MM v[148:151],a[204:207],a[20:23],v[148:151]
MM v[180:183],a[200:203],a[24:27],v[180:183]
buffer_load_dwordx4 a[124:127], v30, s[20:23], s51 offen offset:3072 sc1
MM v[180:183],a[204:207],a[28:31],v[180:183]
s_waitcnt vmcnt(32) lgkmcnt(0)
MM v[88:91],a[208:211],a[0:3],v[88:91]
s_barrier
MM v[88:91],a[212:215],a[4:7],v[88:91]
TR a[192:193],v12,16384
MM v[120:123],a[208:211],a[8:11],v[120:123]
TR a[194:195],v12,17408
MM v[120:123],a[212:215],a[12:15],v[120:123]
TR a[196:197],v12,24576
MM v[152:155],a[208:211],a[16:19],v[152:155]
TR a[198:199],v12,25600
MM v[152:155],a[212:215],a[20:23],v[152:155]
TR a[200:201],v13,16384
MM v[184:187],a[208:211],a[24:27],v[184:187]
TR a[202:203],v13,17408
MM v[184:187],a[212:215],a[28:31],v[184:187]
TR a[204:205],v13,24576
MM v[92:95],a[216:219],a[0:3],v[92:95]
TR a[206:207],v13,25600
MM v[92:95],a[220:223],a[4:7],v[92:95]
TR a[208:209],v14,16384
MM v[124:127],a[216:219],a[8:11],v[124:127]
TR a[210:211],v14,17408
MM v[124:127],a[220:223],a[12:15],v[124:127]
MM v[156:159],a[216:219],a[16:19],v[156:159]
TR a[212:213],v14,24576
MM v[156:159],a[220:223],a[20:23],v[156:159]
MM v[188:191],a[216:219],a[24:27],v[188:191]
TR a[214:215],v14,25600
MM v[188:191],a[220:223],a[28:31],v[188:191]
s_waitcnt vmcnt(31) lgkmcnt(10)
MM v[64:67],a[192:195],a[32:35],v[64:67]
s_waitcnt vmcnt(27) lgkmcnt(8)
s_add_u32 m0, s33, 98304
s_mov_b32 s50, 6291456
TR a[216:217],v15,16384
MM v[64:67],a[196:199],a[36:39],v[64:67]
buffer_load_dwordx4 v26, s[16:19], s50 offen offset:0 lds
MM v[96:99],a[192:195],a[40:43],v[96:99]
s_waitcnt vmcnt(27)
TR a[218:219],v15,17408
MM v[96:99],a[196:199],a[44:47],v[96:99]
MM v[128:131],a[192:195],a[48:51],v[128:131]
s_waitcnt vmcnt(26)
TR a[220:221],v15,24576
MM v[128:131],a[196:199],a[52:55],v[128:131]
buffer_load_dwordx4 v27, s[16:19], s50 offen offset:1024 lds
MM v[160:163],a[192:195],a[56:59],v[160:163]
s_waitcnt vmcnt(26)
TR a[222:223],v15,25600
MM v[160:163],a[196:199],a[60:63],v[160:163]
s_waitcnt lgkmcnt(10)
MM v[68:71],a[200:203],a[32:35],v[68:71]
s_waitcnt lgkmcnt(8)
TR a[192:193],v16,16384
MM v[68:71],a[204:207],a[36:39],v[68:71]
buffer_load_dwordx4 v28, s[16:19], s50 offen offset:2048 lds
MM v[100:103],a[200:203],a[40:43],v[100:103]
TR a[194:195],v16,17408
MM v[100:103],a[204:207],a[44:47],v[100:103]
MM v[132:135],a[200:203],a[48:51],v[132:135]
TR a[196:197],v16,24576
MM v[132:135],a[204:207],a[52:55],v[132:135]
MM v[164:167],a[200:203],a[56:59],v[164:167]
TR a[198:199],v16,25600
MM v[164:167],a[204:207],a[60:63],v[164:167]
s_waitcnt lgkmcnt(10)
buffer_load_dwordx4 v29, s[16:19], s50 offen offset:3072 lds
MM v[72:75],a[208:211],a[32:35],v[72:75]
s_waitcnt lgkmcnt(8)
TR a[200:201],v17,16384
MM v[72:75],a[212:215],a[36:39],v[72:75]
MM v[104:107],a[208:211],a[40:43],v[104:107]
s_add_u32 s51, s47, 3145728
TR a[202:203],v17,17408
MM v[104:107],a[212:215],a[44:47],v[104:107]
buffer_load_dwordx4 a[0:3], v30, s[20:23], s51 offen offset:0 sc1
MM v[136:139],a[208:211],a[48:51],v[136:139]
TR a[204:205],v17,24576
MM v[136:139],a[212:215],a[52:55],v[136:139]
MM v[168:171],a[208:211],a[56:59],v[168:171]
TR a[206:207],v17,25600
MM v[168:171],a[212:215],a[60:63],v[168:171]
s_waitcnt lgkmcnt(10)
MM v[76:79],a[216:219],a[32:35],v[76:79]
s_waitcnt lgkmcnt(8)
TR a[208:209],v18,16384
MM v[76:79],a[220:223],a[36:39],v[76:79]
buffer_load_dwordx4 a[8:11], v30, s[20:23], s51 offen offset:1024 sc1
MM v[108:111],a[216:219],a[40:43],v[108:111]
TR a[210:211],v18,17408
MM v[108:111],a[220:223],a[44:47],v[108:111]
MM v[140:143],a[216:219],a[48:51],v[140:143]
TR a[212:213],v18,24576
MM v[140:143],a[220:223],a[52:55],v[140:143]
buffer_load_dwordx4 a[16:19], v30, s[20:23], s51 offen offset:2048 sc1
MM v[172:175],a[216:219],a[56:59],v[172:175]
TR a[214:215],v18,25600
MM v[172:175],a[220:223],a[60:63],v[172:175]
s_waitcnt lgkmcnt(10)
MM v[80:83],a[192:195],a[32:35],v[80:83]
s_waitcnt lgkmcnt(8)
TR a[216:217],v19,16384
MM v[80:83],a[196:199],a[36:39],v[80:83]
buffer_load_dwordx4 a[24:27], v30, s[20:23], s51 offen offset:3072 sc1
MM v[112:115],a[192:195],a[40:43],v[112:115]
TR a[218:219],v19,17408
MM v[112:115],a[196:199],a[44:47],v[112:115]
MM v[144:147],a[192:195],a[48:51],v[144:147]
TR a[220:221],v19,24576
MM v[144:147],a[196:199],a[52:55],v[144:147]
MM v[176:179],a[192:195],a[56:59],v[176:179]
s_add_u32 s51, s47, 3276800
TR a[222:223],v19,25600
MM v[176:179],a[196:199],a[60:63],v[176:179]
s_waitcnt lgkmcnt(10)
buffer_load_dwordx4 a[4:7], v30, s[20:23], s51 offen offset:0 sc1
MM v[84:87],a[200:203],a[32:35],v[84:87]
s_waitcnt lgkmcnt(8)
MM v[84:87],a[204:207],a[36:39],v[84:87]
buffer_load_dwordx4 a[12:15], v30, s[20:23], s51 offen offset:1024 sc1
MM v[116:119],a[200:203],a[40:43],v[116:119]
MM v[116:119],a[204:207],a[44:47],v[116:119]
MM v[148:151],a[200:203],a[48:51],v[148:151]
buffer_load_dwordx4 a[20:23], v30, s[20:23], s51 offen offset:2048 sc1
MM v[148:151],a[204:207],a[52:55],v[148:151]
MM v[180:183],a[200:203],a[56:59],v[180:183]
buffer_load_dwordx4 a[28:31], v30, s[20:23], s51 offen offset:3072 sc1
MM v[180:183],a[204:207],a[60:63],v[180:183]
s_waitcnt vmcnt(32) lgkmcnt(0)
MM v[88:91],a[208:211],a[32:35],v[88:91]
s_barrier
MM v[88:91],a[212:215],a[36:39],v[88:91]
TR a[192:193],v12,32768
MM v[120:123],a[208:211],a[40:43],v[120:123]
TR a[194:195],v12,33792
MM v[120:123],a[212:215],a[44:47],v[120:123]
TR a[196:197],v12,40960
MM v[152:155],a[208:211],a[48:51],v[152:155]
TR a[198:199],v12,41984
MM v[152:155],a[212:215],a[52:55],v[152:155]
TR a[200:201],v13,32768
MM v[184:187],a[208:211],a[56:59],v[184:187]
TR a[202:203],v13,33792
MM v[184:187],a[212:215],a[60:63],v[184:187]
TR a[204:205],v13,40960
MM v[92:95],a[216:219],a[32:35],v[92:95]
TR a[206:207],v13,41984
MM v[92:95],a[220:223],a[36:39],v[92:95]
TR a[208:209],v14,32768
MM v[124:127],a[216:219],a[40:43],v[124:127]
TR a[210:211],v14,33792
MM v[124:127],a[220:223],a[44:47],v[124:127]
MM v[156:159],a[216:219],a[48:51],v[156:159]
TR a[212:213],v14,40960
MM v[156:159],a[220:223],a[52:55],v[156:159]
MM v[188:191],a[216:219],a[56:59],v[188:191]
TR a[214:215],v14,41984
MM v[188:191],a[220:223],a[60:63],v[188:191]
s_waitcnt vmcnt(31) lgkmcnt(10)
MM v[64:67],a[192:195],a[64:67],v[64:67]
s_waitcnt vmcnt(27) lgkmcnt(8)
s_add_u32 m0, s33, 114688
s_mov_b32 s50, 6815744
TR a[216:217],v15,32768
MM v[64:67],a[196:199],a[68:71],v[64:67]
buffer_load_dwordx4 v26, s[16:19], s50 offen offset:0 lds
MM v[96:99],a[192:195],a[72:75],v[96:99]
s_waitcnt vmcnt(27)
TR a[218:219],v15,33792
MM v[96:99],a[196:199],a[76:79],v[96:99]
MM v[128:131],a[192:195],a[80:83],v[128:131]
s_waitcnt vmcnt(26)
TR a[220:221],v15,40960
MM v[128:131],a[196:199],a[84:87],v[128:131]
buffer_load_dwordx4 v27, s[16:19], s50 offen offset:1024 lds
MM v[160:163],a[192:195],a[88:91],v[160:163]
s_waitcnt vmcnt(26)
TR a[222:223],v15,41984
MM v[160:163],a[196:199],a[92:95],v[160:163]
s_waitcnt lgkmcnt(10)
MM v[68:71],a[200:203],a[64:67],v[68:71]
s_waitcnt lgkmcnt(8)
TR a[192:193],v16,32768
MM v[68:71],a[204:207],a[68:71],v[68:71]
buffer_load_dwordx4 v28, s[16:19], s50 offen offset:2048 lds
MM v[100:103],a[200:203],a[72:75],v[100:103]
TR a[194:195],v16,33792
MM v[100:103],a[204:207],a[76:79],v[100:103]
MM v[132:135],a[200:203],a[80:83],v[132:135]
TR a[196:197],v16,40960
MM v[132:135],a[204:207],a[84:87],v[132:135]
MM v[164:167],a[200:203],a[88:91],v[164:167]
TR a[198:199],v16,41984
MM v[164:167],a[204:207],a[92:95],v[164:167]
s_waitcnt lgkmcnt(10)
buffer_load_dwordx4 v29, s[16:19], s50 offen offset:3072 lds
MM v[72:75],a[208:211],a[64:67],v[72:75]
s_waitcnt lgkmcnt(8)
TR a[200:201],v17,32768
MM v[72:75],a[212:215],a[68:71],v[72:75]
MM v[104:107],a[208:211],a[72:75],v[104:107]
s_add_u32 s51, s47, 3407872
TR a[202:203],v17,33792
MM v[104:107],a[212:215],a[76:79],v[104:107]
buffer_load_dwordx4 a[32:35], v30, s[20:23], s51 offen offset:0 sc1
MM v[136:139],a[208:211],a[80:83],v[136:139]
TR a[204:205],v17,40960
MM v[136:139],a[212:215],a[84:87],v[136:139]
MM v[168:171],a[208:211],a[88:91],v[168:171]
TR a[206:207],v17,41984
MM v[168:171],a[212:215],a[92:95],v[168:171]
s_waitcnt lgkmcnt(10)
MM v[76:79],a[216:219],a[64:67],v[76:79]
s_waitcnt lgkmcnt(8)
TR a[208:209],v18,32768
MM v[76:79],a[220:223],a[68:71],v[76:79]
buffer_load_dwordx4 a[40:43], v30, s[20:23], s51 offen offset:1024 sc1
MM v[108:111],a[216:219],a[72:75],v[108:111]
TR a[210:211],v18,33792
MM v[108:111],a[220:223],a[76:79],v[108:111]
MM v[140:143],a[216:219],a[80:83],v[140:143]
TR a[212:213],v18,40960
MM v[140:143],a[220:223],a[84:87],v[140:143]
buffer_load_dwordx4 a[48:51], v30, s[20:23], s51 offen offset:2048 sc1
MM v[172:175],a[216:219],a[88:91],v[172:175]
TR a[214:215],v18,41984
MM v[172:175],a[220:223],a[92:95],v[172:175]
s_waitcnt lgkmcnt(10)
MM v[80:83],a[192:195],a[64:67],v[80:83]
s_waitcnt lgkmcnt(8)
TR a[216:217],v19,32768
MM v[80:83],a[196:199],a[68:71],v[80:83]
buffer_load_dwordx4 a[56:59], v30, s[20:23], s51 offen offset:3072 sc1
MM v[112:115],a[192:195],a[72:75],v[112:115]
TR a[218:219],v19,33792
MM v[112:115],a[196:199],a[76:79],v[112:115]
MM v[144:147],a[192:195],a[80:83],v[144:147]
TR a[220:221],v19,40960
MM v[144:147],a[196:199],a[84:87],v[144:147]
MM v[176:179],a[192:195],a[88:91],v[176:179]
s_add_u32 s51, s47, 3538944
TR a[222:223],v19,41984
MM v[176:179],a[196:199],a[92:95],v[176:179]
s_waitcnt lgkmcnt(10)
buffer_load_dwordx4 a[36:39], v30, s[20:23], s51 offen offset:0 sc1
MM v[84:87],a[200:203],a[64:67],v[84:87]
s_waitcnt lgkmcnt(8)
MM v[84:87],a[204:207],a[68:71],v[84:87]
buffer_load_dwordx4 a[44:47], v30, s[20:23], s51 offen offset:1024 sc1
MM v[116:119],a[200:203],a[72:75],v[116:119]
MM v[116:119],a[204:207],a[76:79],v[116:119]
MM v[148:151],a[200:203],a[80:83],v[148:151]
buffer_load_dwordx4 a[52:55], v30, s[20:23], s51 offen offset:2048 sc1
MM v[148:151],a[204:207],a[84:87],v[148:151]
MM v[180:183],a[200:203],a[88:91],v[180:183]
buffer_load_dwordx4 a[60:63], v30, s[20:23], s51 offen offset:3072 sc1
MM v[180:183],a[204:207],a[92:95],v[180:183]
s_waitcnt vmcnt(32) lgkmcnt(0)
MM v[88:91],a[208:211],a[64:67],v[88:91]
s_barrier
MM v[88:91],a[212:215],a[68:71],v[88:91]
TR a[192:193],v12,49152
MM v[120:123],a[208:211],a[72:75],v[120:123]
TR a[194:195],v12,50176
MM v[120:123],a[212:215],a[76:79],v[120:123]
TR a[196:197],v12,57344
MM v[152:155],a[208:211],a[80:83],v[152:155]
TR a[198:199],v12,58368
MM v[152:155],a[212:215],a[84:87],v[152:155]
TR a[200:201],v13,49152
MM v[184:187],a[208:211],a[88:91],v[184:187]
TR a[202:203],v13,50176
MM v[184:187],a[212:215],a[92:95],v[184:187]
TR a[204:205],v13,57344
MM v[92:95],a[216:219],a[64:67],v[92:95]
TR a[206:207],v13,58368
MM v[92:95],a[220:223],a[68:71],v[92:95]
TR a[208:209],v14,49152
MM v[124:127],a[216:219],a[72:75],v[124:127]
TR a[210:211],v14,50176
MM v[124:127],a[220:223],a[76:79],v[124:127]
MM v[156:159],a[216:219],a[80:83],v[156:159]
TR a[212:213],v14,57344
MM v[156:159],a[220:223],a[84:87],v[156:159]
MM v[188:191],a[216:219],a[88:91],v[188:191]
TR a[214:215],v14,58368
MM v[188:191],a[220:223],a[92:95],v[188:191]
s_waitcnt vmcnt(31) lgkmcnt(10)
MM v[64:67],a[192:195],a[96:99],v[64:67]
s_waitcnt vmcnt(27) lgkmcnt(8)
s_add_u32 m0, s33, 131072
s_mov_b32 s50, 7340032
TR a[216:217],v15,49152
MM v[64:67],a[196:199],a[100:103],v[64:67]
buffer_load_dwordx4 v26, s[16:19], s50 offen offset:0 lds
MM v[96:99],a[192:195],a[104:107],v[96:99]
s_waitcnt vmcnt(27)
TR a[218:219],v15,50176
MM v[96:99],a[196:199],a[108:111],v[96:99]
MM v[128:131],a[192:195],a[112:115],v[128:131]
s_waitcnt vmcnt(26)
TR a[220:221],v15,57344
MM v[128:131],a[196:199],a[116:119],v[128:131]
buffer_load_dwordx4 v27, s[16:19], s50 offen offset:1024 lds
MM v[160:163],a[192:195],a[120:123],v[160:163]
s_waitcnt vmcnt(26)
TR a[222:223],v15,58368
MM v[160:163],a[196:199],a[124:127],v[160:163]
s_waitcnt lgkmcnt(10)
MM v[68:71],a[200:203],a[96:99],v[68:71]
s_waitcnt lgkmcnt(8)
TR a[192:193],v16,49152
MM v[68:71],a[204:207],a[100:103],v[68:71]
buffer_load_dwordx4 v28, s[16:19], s50 offen offset:2048 lds
MM v[100:103],a[200:203],a[104:107],v[100:103]
TR a[194:195],v16,50176
MM v[100:103],a[204:207],a[108:111],v[100:103]
MM v[132:135],a[200:203],a[112:115],v[132:135]
TR a[196:197],v16,57344
MM v[132:135],a[204:207],a[116:119],v[132:135]
MM v[164:167],a[200:203],a[120:123],v[164:167]
TR a[198:199],v16,58368
MM v[164:167],a[204:207],a[124:127],v[164:167]
s_waitcnt lgkmcnt(10)
buffer_load_dwordx4 v29, s[16:19], s50 offen offset:3072 lds
MM v[72:75],a[208:211],a[96:99],v[72:75]
s_waitcnt lgkmcnt(8)
TR a[200:201],v17,49152
MM v[72:75],a[212:215],a[100:103],v[72:75]
MM v[104:107],a[208:211],a[104:107],v[104:107]
s_add_u32 s51, s47, 3670016
TR a[202:203],v17,50176
MM v[104:107],a[212:215],a[108:111],v[104:107]
buffer_load_dwordx4 a[64:67], v30, s[20:23], s51 offen offset:0 sc1
MM v[136:139],a[208:211],a[112:115],v[136:139]
TR a[204:205],v17,57344
MM v[136:139],a[212:215],a[116:119],v[136:139]
MM v[168:171],a[208:211],a[120:123],v[168:171]
TR a[206:207],v17,58368
MM v[168:171],a[212:215],a[124:127],v[168:171]
s_waitcnt lgkmcnt(10)
MM v[76:79],a[216:219],a[96:99],v[76:79]
s_waitcnt lgkmcnt(8)
TR a[208:209],v18,49152
MM v[76:79],a[220:223],a[100:103],v[76:79]
buffer_load_dwordx4 a[72:75], v30, s[20:23], s51 offen offset:1024 sc1
MM v[108:111],a[216:219],a[104:107],v[108:111]
TR a[210:211],v18,50176
MM v[108:111],a[220:223],a[108:111],v[108:111]
MM v[140:143],a[216:219],a[112:115],v[140:143]
TR a[212:213],v18,57344
MM v[140:143],a[220:223],a[116:119],v[140:143]
buffer_load_dwordx4 a[80:83], v30, s[20:23], s51 offen offset:2048 sc1
MM v[172:175],a[216:219],a[120:123],v[172:175]
TR a[214:215],v18,58368
MM v[172:175],a[220:223],a[124:127],v[172:175]
s_waitcnt lgkmcnt(10)
MM v[80:83],a[192:195],a[96:99],v[80:83]
s_waitcnt lgkmcnt(8)
TR a[216:217],v19,49152
MM v[80:83],a[196:199],a[100:103],v[80:83]
buffer_load_dwordx4 a[88:91], v30, s[20:23], s51 offen offset:3072 sc1
MM v[112:115],a[192:195],a[104:107],v[112:115]
TR a[218:219],v19,50176
MM v[112:115],a[196:199],a[108:111],v[112:115]
MM v[144:147],a[192:195],a[112:115],v[144:147]
TR a[220:221],v19,57344
MM v[144:147],a[196:199],a[116:119],v[144:147]
MM v[176:179],a[192:195],a[120:123],v[176:179]
s_add_u32 s51, s47, 3801088
TR a[222:223],v19,58368
MM v[176:179],a[196:199],a[124:127],v[176:179]
s_waitcnt lgkmcnt(10)
buffer_load_dwordx4 a[68:71], v30, s[20:23], s51 offen offset:0 sc1
MM v[84:87],a[200:203],a[96:99],v[84:87]
s_waitcnt lgkmcnt(8)
MM v[84:87],a[204:207],a[100:103],v[84:87]
buffer_load_dwordx4 a[76:79], v30, s[20:23], s51 offen offset:1024 sc1
MM v[116:119],a[200:203],a[104:107],v[116:119]
MM v[116:119],a[204:207],a[108:111],v[116:119]
MM v[148:151],a[200:203],a[112:115],v[148:151]
buffer_load_dwordx4 a[84:87], v30, s[20:23], s51 offen offset:2048 sc1
MM v[148:151],a[204:207],a[116:119],v[148:151]
MM v[180:183],a[200:203],a[120:123],v[180:183]
buffer_load_dwordx4 a[92:95], v30, s[20:23], s51 offen offset:3072 sc1
MM v[180:183],a[204:207],a[124:127],v[180:183]
s_waitcnt vmcnt(32) lgkmcnt(0)
MM v[88:91],a[208:211],a[96:99],v[88:91]
s_barrier
MM v[88:91],a[212:215],a[100:103],v[88:91]
TR a[192:193],v12,0
MM v[120:123],a[208:211],a[104:107],v[120:123]
TR a[194:195],v12,1024
MM v[120:123],a[212:215],a[108:111],v[120:123]
TR a[196:197],v12,8192
MM v[152:155],a[208:211],a[112:115],v[152:155]
TR a[198:199],v12,9216
MM v[152:155],a[212:215],a[116:119],v[152:155]
TR a[200:201],v13,0
MM v[184:187],a[208:211],a[120:123],v[184:187]
TR a[202:203],v13,1024
MM v[184:187],a[212:215],a[124:127],v[184:187]
TR a[204:205],v13,8192
MM v[92:95],a[216:219],a[96:99],v[92:95]
TR a[206:207],v13,9216
MM v[92:95],a[220:223],a[100:103],v[92:95]
TR a[208:209],v14,0
MM v[124:127],a[216:219],a[104:107],v[124:127]
TR a[210:211],v14,1024
MM v[124:127],a[220:223],a[108:111],v[124:127]
MM v[156:159],a[216:219],a[112:115],v[156:159]
TR a[212:213],v14,8192
MM v[156:159],a[220:223],a[116:119],v[156:159]
MM v[188:191],a[216:219],a[120:123],v[188:191]
TR a[214:215],v14,9216
MM v[188:191],a[220:223],a[124:127],v[188:191]
s_waitcnt vmcnt(31) lgkmcnt(10)
MM v[64:67],a[192:195],a[0:3],v[64:67]
s_waitcnt vmcnt(27) lgkmcnt(8)
s_add_u32 m0, s33, 147456
s_mov_b32 s50, 7864320
TR a[216:217],v15,0
MM v[64:67],a[196:199],a[4:7],v[64:67]
buffer_load_dwordx4 v26, s[16:19], s50 offen offset:0 lds
MM v[96:99],a[192:195],a[8:11],v[96:99]
s_waitcnt vmcnt(27)
TR a[218:219],v15,1024
MM v[96:99],a[196:199],a[12:15],v[96:99]
buffer_load_dwordx4 v27, s[16:19], s50 offen offset:1024 lds
MM v[128:131],a[192:195],a[16:19],v[128:131]
s_waitcnt vmcnt(27)
TR a[220:221],v15,8192
MM v[128:131],a[196:199],a[20:23],v[128:131]
MM v[160:163],a[192:195],a[24:27],v[160:163]
s_waitcnt vmcnt(26)
TR a[222:223],v15,9216
MM v[160:163],a[196:199],a[28:31],v[160:163]
s_waitcnt lgkmcnt(10)
buffer_load_dwordx4 v28, s[16:19], s50 offen offset:2048 lds
MM v[68:71],a[200:203],a[0:3],v[68:71]
s_waitcnt lgkmcnt(8)
TR a[192:193],v16,0
MM v[68:71],a[204:207],a[4:7],v[68:71]
MM v[100:103],a[200:203],a[8:11],v[100:103]
TR a[194:195],v16,1024
MM v[100:103],a[204:207],a[12:15],v[100:103]
buffer_load_dwordx4 v29, s[16:19], s50 offen offset:3072 lds
MM v[132:135],a[200:203],a[16:19],v[132:135]
TR a[196:197],v16,8192
MM v[132:135],a[204:207],a[20:23],v[132:135]
MM v[164:167],a[200:203],a[24:27],v[164:167]
s_add_u32 s51, s47, 3932160
TR a[198:199],v16,9216
MM v[164:167],a[204:207],a[28:31],v[164:167]
s_waitcnt lgkmcnt(10)
buffer_load_dwordx4 a[96:99], v30, s[20:23], s51 offen offset:0 sc1
MM v[72:75],a[208:211],a[0:3],v[72:75]
s_waitcnt lgkmcnt(8)
TR a[200:201],v17,0
MM v[72:75],a[212:215],a[4:7],v[72:75]
MM v[104:107],a[208:211],a[8:11],v[104:107]
TR a[202:203],v17,1024
MM v[104:107],a[212:215],a[12:15],v[104:107]
buffer_load_dwordx4 a[104:107], v30, s[20:23], s51 offen offset:1024 sc1
MM v[136:139],a[208:211],a[16:19],v[136:139]
TR a[204:205],v17,8192
MM v[136:139],a[212:215],a[20:23],v[136:139]
buffer_load_dwordx4 a[112:115], v30, s[20:23], s51 offen offset:2048 sc1
MM v[168:171],a[208:211],a[24:27],v[168:171]
TR a[206:207],v17,9216
MM v[168:171],a[212:215],a[28:31],v[168:171]
s_waitcnt lgkmcnt(10)
MM v[76:79],a[216:219],a[0:3],v[76:79]
s_waitcnt lgkmcnt(8)
TR a[208:209],v18,0
MM v[76:79],a[220:223],a[4:7],v[76:79]
buffer_load_dwordx4 a[120:123], v30, s[20:23], s51 offen offset:3072 sc1
MM v[108:111],a[216:219],a[8:11],v[108:111]
TR a[210:211],v18,1024
MM v[108:111],a[220:223],a[12:15],v[108:111]
MM v[140:143],a[216:219],a[16:19],v[140:143]
s_add_u32 s51, s47, 4063232
TR a[212:213],v18,8192
MM v[140:143],a[220:223],a[20:23],v[140:143]
buffer_load_dwordx4 a[100:103], v30, s[20:23], s51 offen offset:0 sc1
MM v[172:175],a[216:219],a[24:27],v[172:175]
TR a[214:215],v18,9216
MM v[172:175],a[220:223],a[28:31],v[172:175]
s_waitcnt lgkmcnt(10)
MM v[80:83],a[192:195],a[0:3],v[80:83]
s_waitcnt lgkmcnt(8)
TR a[216:217],v19,0
MM v[80:83],a[196:199],a[4:7],v[80:83]
buffer_load_dwordx4 a[108:111], v30, s[20:23], s51 offen offset:1024 sc1
MM v[112:115],a[192:195],a[8:11],v[112:115]
TR a[218:219],v19,1024
MM v[112:115],a[196:199],a[12:15],v[112:115]
MM v[144:147],a[192:195],a[16:19],v[144:147]
TR a[220:221],v19,8192
MM v[144:147],a[196:199],a[20:23],v[144:147]
buffer_load_dwordx4 a[116:119], v30, s[20:23], s51 offen offset:2048 sc1
MM v[176:179],a[192:195],a[24:27],v[176:179]
TR a[222:223],v19,9216
MM v[176:179],a[196:199],a[28:31],v[176:179]
s_waitcnt lgkmcnt(10)
buffer_load_dwordx4 a[124:127], v30, s[20:23], s51 offen offset:3072 sc1
MM v[84:87],a[200:203],a[0:3],v[84:87]
s_waitcnt lgkmcnt(8)
s_mov_b32 s52, 0
s_add_u32 m0, s33, 0
MM v[84:87],a[204:207],a[4:7],v[84:87]
buffer_load_dwordx4 v20, s[8:11], s52 offen offset:0 lds
MM v[116:119],a[200:203],a[8:11],v[116:119]
MM v[116:119],a[204:207],a[12:15],v[116:119]
buffer_load_dwordx4 v21, s[8:11], s52 offen offset:1024 lds
MM v[148:151],a[200:203],a[16:19],v[148:151]
MM v[148:151],a[204:207],a[20:23],v[148:151]
buffer_load_dwordx4 v22, s[8:11], s52 offen offset:2048 lds
MM v[180:183],a[200:203],a[24:27],v[180:183]
MM v[180:183],a[204:207],a[28:31],v[180:183]
s_waitcnt vmcnt(35) lgkmcnt(0)
MM v[88:91],a[208:211],a[0:3],v[88:91]
s_barrier
MM v[88:91],a[212:215],a[4:7],v[88:91]
TR a[192:193],v12,16384
MM v[120:123],a[208:211],a[8:11],v[120:123]
TR a[194:195],v12,17408
MM v[120:123],a[212:215],a[12:15],v[120:123]
TR a[196:197],v12,24576
MM v[152:155],a[208:211],a[16:19],v[152:155]
TR a[198:199],v12,25600
MM v[152:155],a[212:215],a[20:23],v[152:155]
TR a[200:201],v13,16384
MM v[184:187],a[208:211],a[24:27],v[184:187]
TR a[202:203],v13,17408
MM v[184:187],a[212:215],a[28:31],v[184:187]
TR a[204:205],v13,24576
MM v[92:95],a[216:219],a[0:3],v[92:95]
TR a[206:207],v13,25600
MM v[92:95],a[220:223],a[4:7],v[92:95]
TR a[208:209],v14,16384
MM v[124:127],a[216:219],a[8:11],v[124:127]
TR a[210:211],v14,17408
MM v[124:127],a[220:223],a[12:15],v[124:127]
buffer_load_dwordx4 v23, s[8:11], s52 offen offset:3072 lds
MM v[156:159],a[216:219],a[16:19],v[156:159]
TR a[212:213],v14,24576
MM v[156:159],a[220:223],a[20:23],v[156:159]
MM v[188:191],a[216:219],a[24:27],v[188:191]
TR a[214:215],v14,25600
MM v[188:191],a[220:223],a[28:31],v[188:191]
s_waitcnt vmcnt(35) lgkmcnt(10)
MM v[64:67],a[192:195],a[32:35],v[64:67]
s_waitcnt vmcnt(31) lgkmcnt(8)
s_mov_b32 s52, 0
s_add_u32 m0, s33, 65536
TR a[216:217],v15,16384
MM v[64:67],a[196:199],a[36:39],v[64:67]
buffer_load_dwordx4 v24, s[12:15], s52 offen offset:0 lds
v_accvgpr_write_b32 a0, 0
MM v[96:99],a[192:195],a[40:43],v[96:99]
s_waitcnt vmcnt(31)
TR a[218:219],v15,17408
MM v[96:99],a[196:199],a[44:47],v[96:99]
buffer_load_dwordx4 v25, s[12:15], s52 offen offset:1024 lds
v_accvgpr_write_b32 a1, 0
MM v[128:131],a[192:195],a[48:51],v[128:131]
s_waitcnt vmcnt(31)
TR a[220:221],v15,24576
MM v[128:131],a[196:199],a[52:55],v[128:131]
v_accvgpr_write_b32 a2, 0
MM v[160:163],a[192:195],a[56:59],v[160:163]
s_waitcnt vmcnt(30)
TR a[222:223],v15,25600
MM v[160:163],a[196:199],a[60:63],v[160:163]
s_waitcnt lgkmcnt(10)
buffer_load_dwordx4 v24, s[12:15], s52 offen offset:2048 lds
v_accvgpr_write_b32 a3, 0
MM v[68:71],a[200:203],a[32:35],v[68:71]
s_waitcnt lgkmcnt(8)
TR a[192:193],v16,16384
MM v[68:71],a[204:207],a[36:39],v[68:71]
v_accvgpr_write_b32 a4, 0
MM v[100:103],a[200:203],a[40:43],v[100:103]
TR a[194:195],v16,17408
MM v[100:103],a[204:207],a[44:47],v[100:103]
buffer_load_dwordx4 v25, s[12:15], s52 offen offset:3072 lds
v_accvgpr_write_b32 a5, 0
MM v[132:135],a[200:203],a[48:51],v[132:135]
TR a[196:197],v16,24576
MM v[132:135],a[204:207],a[52:55],v[132:135]
v_accvgpr_write_b32 a6, 0
MM v[164:167],a[200:203],a[56:59],v[164:167]
s_mov_b32 s52, 16384
s_add_u32 m0, s33, 16384
TR a[198:199],v16,25600
MM v[164:167],a[204:207],a[60:63],v[164:167]
s_waitcnt lgkmcnt(10)
buffer_load_dwordx4 v20, s[8:11], s52 offen offset:0 lds
v_accvgpr_write_b32 a7, 0
MM v[72:75],a[208:211],a[32:35],v[72:75]
s_waitcnt lgkmcnt(8)
TR a[200:201],v17,16384
MM v[72:75],a[212:215],a[36:39],v[72:75]
v_accvgpr_write_b32 a8, 0
MM v[104:107],a[208:211],a[40:43],v[104:107]
TR a[202:203],v17,17408
MM v[104:107],a[212:215],a[44:47],v[104:107]
buffer_load_dwordx4 v21, s[8:11], s52 offen offset:1024 lds
v_accvgpr_write_b32 a9, 0
MM v[136:139],a[208:211],a[48:51],v[136:139]
TR a[204:205],v17,24576
MM v[136:139],a[212:215],a[52:55],v[136:139]
buffer_load_dwordx4 v22, s[8:11], s52 offen offset:2048 lds
v_accvgpr_write_b32 a10, 0
MM v[168:171],a[208:211],a[56:59],v[168:171]
TR a[206:207],v17,25600
MM v[168:171],a[212:215],a[60:63],v[168:171]
s_waitcnt lgkmcnt(10)
v_accvgpr_write_b32 a11, 0
MM v[76:79],a[216:219],a[32:35],v[76:79]
s_waitcnt lgkmcnt(8)
TR a[208:209],v18,16384
MM v[76:79],a[220:223],a[36:39],v[76:79]
buffer_load_dwordx4 v23, s[8:11], s52 offen offset:3072 lds
v_accvgpr_write_b32 a12, 0
MM v[108:111],a[216:219],a[40:43],v[108:111]
TR a[210:211],v18,17408
MM v[108:111],a[220:223],a[44:47],v[108:111]
v_accvgpr_write_b32 a13, 0
MM v[140:143],a[216:219],a[48:51],v[140:143]
s_mov_b32 s52, 16384
s_add_u32 m0, s33, 81920
TR a[212:213],v18,24576
MM v[140:143],a[220:223],a[52:55],v[140:143]
buffer_load_dwordx4 v24, s[12:15], s52 offen offset:0 lds
v_accvgpr_write_b32 a14, 0
MM v[172:175],a[216:219],a[56:59],v[172:175]
TR a[214:215],v18,25600
MM v[172:175],a[220:223],a[60:63],v[172:175]
s_waitcnt lgkmcnt(10)
v_accvgpr_write_b32 a15, 0
MM v[80:83],a[192:195],a[32:35],v[80:83]
s_waitcnt lgkmcnt(8)
TR a[216:217],v19,16384
MM v[80:83],a[196:199],a[36:39],v[80:83]
buffer_load_dwordx4 v25, s[12:15], s52 offen offset:1024 lds
v_accvgpr_write_b32 a16, 0
MM v[112:115],a[192:195],a[40:43],v[112:115]
TR a[218:219],v19,17408
MM v[112:115],a[196:199],a[44:47],v[112:115]
v_accvgpr_write_b32 a17, 0
MM v[144:147],a[192:195],a[48:51],v[144:147]
TR a[220:221],v19,24576
MM v[144:147],a[196:199],a[52:55],v[144:147]
buffer_load_dwordx4 v24, s[12:15], s52 offen offset:2048 lds
v_accvgpr_write_b32 a18, 0
MM v[176:179],a[192:195],a[56:59],v[176:179]
TR a[222:223],v19,25600
MM v[176:179],a[196:199],a[60:63],v[176:179]
s_waitcnt lgkmcnt(10)
buffer_load_dwordx4 v25, s[12:15], s52 offen offset:3072 lds
v_accvgpr_write_b32 a19, 0
MM v[84:87],a[200:203],a[32:35],v[84:87]
s_waitcnt lgkmcnt(8)
s_mov_b32 s52, 32768
s_add_u32 m0, s33, 32768
MM v[84:87],a[204:207],a[36:39],v[84:87]
buffer_load_dwordx4 v20, s[8:11], s52 offen offset:0 lds
v_accvgpr_write_b32 a20, 0
MM v[116:119],a[200:203],a[40:43],v[116:119]
MM v[116:119],a[204:207],a[44:47],v[116:119]
buffer_load_dwordx4 v21, s[8:11], s52 offen offset:1024 lds
v_accvgpr_write_b32 a21, 0
MM v[148:151],a[200:203],a[48:51],v[148:151]
MM v[148:151],a[204:207],a[52:55],v[148:151]
buffer_load_dwordx4 v22, s[8:11], s52 offen offset:2048 lds
v_accvgpr_write_b32 a22, 0
MM v[180:183],a[200:203],a[56:59],v[180:183]
MM v[180:183],a[204:207],a[60:63],v[180:183]
s_waitcnt vmcnt(39) lgkmcnt(0)
v_accvgpr_write_b32 a23, 0
MM v[88:91],a[208:211],a[32:35],v[88:91]
s_barrier
MM v[88:91],a[212:215],a[36:39],v[88:91]
TR a[192:193],v12,32768
v_accvgpr_write_b32 a24, 0
MM v[120:123],a[208:211],a[40:43],v[120:123]
TR a[194:195],v12,33792
MM v[120:123],a[212:215],a[44:47],v[120:123]
TR a[196:197],v12,40960
v_accvgpr_write_b32 a25, 0
MM v[152:155],a[208:211],a[48:51],v[152:155]
TR a[198:199],v12,41984
MM v[152:155],a[212:215],a[52:55],v[152:155]
TR a[200:201],v13,32768
v_accvgpr_write_b32 a26, 0
MM v[184:187],a[208:211],a[56:59],v[184:187]
TR a[202:203],v13,33792
MM v[184:187],a[212:215],a[60:63],v[184:187]
TR a[204:205],v13,40960
v_accvgpr_write_b32 a27, 0
MM v[92:95],a[216:219],a[32:35],v[92:95]
TR a[206:207],v13,41984
MM v[92:95],a[220:223],a[36:39],v[92:95]
TR a[208:209],v14,32768
v_accvgpr_write_b32 a28, 0
MM v[124:127],a[216:219],a[40:43],v[124:127]
TR a[210:211],v14,33792
MM v[124:127],a[220:223],a[44:47],v[124:127]
buffer_load_dwordx4 v23, s[8:11], s52 offen offset:3072 lds
v_accvgpr_write_b32 a29, 0
MM v[156:159],a[216:219],a[48:51],v[156:159]
TR a[212:213],v14,40960
MM v[156:159],a[220:223],a[52:55],v[156:159]
v_accvgpr_write_b32 a30, 0
MM v[188:191],a[216:219],a[56:59],v[188:191]
TR a[214:215],v14,41984
MM v[188:191],a[220:223],a[60:63],v[188:191]
s_waitcnt vmcnt(39) lgkmcnt(10)
v_accvgpr_write_b32 a31, 0
MM v[64:67],a[192:195],a[64:67],v[64:67]
s_waitcnt vmcnt(35) lgkmcnt(8)
s_mov_b32 s52, 32768
s_add_u32 m0, s33, 98304
TR a[216:217],v15,32768
MM v[64:67],a[196:199],a[68:71],v[64:67]
buffer_load_dwordx4 v24, s[12:15], s52 offen offset:0 lds
v_accvgpr_write_b32 a32, 0
MM v[96:99],a[192:195],a[72:75],v[96:99]
s_waitcnt vmcnt(35)
TR a[218:219],v15,33792
MM v[96:99],a[196:199],a[76:79],v[96:99]
v_accvgpr_write_b32 a33, 0
MM v[128:131],a[192:195],a[80:83],v[128:131]
s_waitcnt vmcnt(34)
TR a[220:221],v15,40960
MM v[128:131],a[196:199],a[84:87],v[128:131]
v_accvgpr_write_b32 a34, 0
MM v[160:163],a[192:195],a[88:91],v[160:163]
s_waitcnt vmcnt(33)
TR a[222:223],v15,41984
MM v[160:163],a[196:199],a[92:95],v[160:163]
s_waitcnt lgkmcnt(10)
buffer_load_dwordx4 v25, s[12:15], s52 offen offset:1024 lds
v_accvgpr_write_b32 a35, 0
MM v[68:71],a[200:203],a[64:67],v[68:71]
s_waitcnt lgkmcnt(8)
TR a[192:193],v16,32768
MM v[68:71],a[204:207],a[68:71],v[68:71]
v_accvgpr_write_b32 a36, 0
MM v[100:103],a[200:203],a[72:75],v[100:103]
TR a[194:195],v16,33792
MM v[100:103],a[204:207],a[76:79],v[100:103]
v_accvgpr_write_b32 a37, 0
MM v[132:135],a[200:203],a[80:83],v[132:135]
TR a[196:197],v16,40960
MM v[132:135],a[204:207],a[84:87],v[132:135]
v_accvgpr_write_b32 a38, 0
MM v[164:167],a[200:203],a[88:91],v[164:167]
TR a[198:199],v16,41984
MM v[164:167],a[204:207],a[92:95],v[164:167]
s_waitcnt lgkmcnt(10)
buffer_load_dwordx4 v24, s[12:15], s52 offen offset:2048 lds
v_accvgpr_write_b32 a39, 0
MM v[72:75],a[208:211],a[64:67],v[72:75]
s_waitcnt lgkmcnt(8)
TR a[200:201],v17,32768
MM v[72:75],a[212:215],a[68:71],v[72:75]
v_accvgpr_write_b32 a40, 0
MM v[104:107],a[208:211],a[72:75],v[104:107]
TR a[202:203],v17,33792
MM v[104:107],a[212:215],a[76:79],v[104:107]
v_accvgpr_write_b32 a41, 0
MM v[136:139],a[208:211],a[80:83],v[136:139]
TR a[204:205],v17,40960
MM v[136:139],a[212:215],a[84:87],v[136:139]
buffer_load_dwordx4 v25, s[12:15], s52 offen offset:3072 lds
v_accvgpr_write_b32 a42, 0
MM v[168:171],a[208:211],a[88:91],v[168:171]
TR a[206:207],v17,41984
MM v[168:171],a[212:215],a[92:95],v[168:171]
s_waitcnt lgkmcnt(10)
v_accvgpr_write_b32 a43, 0
MM v[76:79],a[216:219],a[64:67],v[76:79]
s_waitcnt lgkmcnt(8)
TR a[208:209],v18,32768
MM v[76:79],a[220:223],a[68:71],v[76:79]
v_accvgpr_write_b32 a44, 0
MM v[108:111],a[216:219],a[72:75],v[108:111]
TR a[210:211],v18,33792
MM v[108:111],a[220:223],a[76:79],v[108:111]
v_accvgpr_write_b32 a45, 0
MM v[140:143],a[216:219],a[80:83],v[140:143]
s_mov_b32 s52, 49152
s_add_u32 m0, s33, 49152
TR a[212:213],v18,40960
MM v[140:143],a[220:223],a[84:87],v[140:143]
buffer_load_dwordx4 v20, s[8:11], s52 offen offset:0 lds
v_accvgpr_write_b32 a46, 0
MM v[172:175],a[216:219],a[88:91],v[172:175]
TR a[214:215],v18,41984
MM v[172:175],a[220:223],a[92:95],v[172:175]
s_waitcnt lgkmcnt(10)
v_accvgpr_write_b32 a47, 0
MM v[80:83],a[192:195],a[64:67],v[80:83]
s_waitcnt lgkmcnt(8)
TR a[216:217],v19,32768
MM v[80:83],a[196:199],a[68:71],v[80:83]
v_accvgpr_write_b32 a48, 0
MM v[112:115],a[192:195],a[72:75],v[112:115]
TR a[218:219],v19,33792
MM v[112:115],a[196:199],a[76:79],v[112:115]
v_accvgpr_write_b32 a49, 0
MM v[144:147],a[192:195],a[80:83],v[144:147]
TR a[220:221],v19,40960
MM v[144:147],a[196:199],a[84:87],v[144:147]
buffer_load_dwordx4 v21, s[8:11], s52 offen offset:1024 lds
v_accvgpr_write_b32 a50, 0
MM v[176:179],a[192:195],a[88:91],v[176:179]
TR a[222:223],v19,41984
MM v[176:179],a[196:199],a[92:95],v[176:179]
s_waitcnt lgkmcnt(10)
v_accvgpr_write_b32 a51, 0
MM v[84:87],a[200:203],a[64:67],v[84:87]
s_waitcnt lgkmcnt(8)
MM v[84:87],a[204:207],a[68:71],v[84:87]
buffer_load_dwordx4 v22, s[8:11], s52 offen offset:2048 lds
v_accvgpr_write_b32 a52, 0
MM v[116:119],a[200:203],a[72:75],v[116:119]
MM v[116:119],a[204:207],a[76:79],v[116:119]
v_accvgpr_write_b32 a53, 0
MM v[148:151],a[200:203],a[80:83],v[148:151]
MM v[148:151],a[204:207],a[84:87],v[148:151]
buffer_load_dwordx4 v23, s[8:11], s52 offen offset:3072 lds
v_accvgpr_write_b32 a54, 0
MM v[180:183],a[200:203],a[88:91],v[180:183]
MM v[180:183],a[204:207],a[92:95],v[180:183]
s_waitcnt vmcnt(36) lgkmcnt(0)
v_accvgpr_write_b32 a55, 0
MM v[88:91],a[208:211],a[64:67],v[88:91]
s_barrier
MM v[88:91],a[212:215],a[68:71],v[88:91]
TR a[192:193],v12,49152
v_accvgpr_write_b32 a56, 0
MM v[120:123],a[208:211],a[72:75],v[120:123]
TR a[194:195],v12,50176
MM v[120:123],a[212:215],a[76:79],v[120:123]
TR a[196:197],v12,57344
v_accvgpr_write_b32 a57, 0
MM v[152:155],a[208:211],a[80:83],v[152:155]
TR a[198:199],v12,58368
MM v[152:155],a[212:215],a[84:87],v[152:155]
TR a[200:201],v13,49152
v_accvgpr_write_b32 a58, 0
MM v[184:187],a[208:211],a[88:91],v[184:187]
TR a[202:203],v13,50176
MM v[184:187],a[212:215],a[92:95],v[184:187]
TR a[204:205],v13,57344
v_accvgpr_write_b32 a59, 0
MM v[92:95],a[216:219],a[64:67],v[92:95]
TR a[206:207],v13,58368
MM v[92:95],a[220:223],a[68:71],v[92:95]
TR a[208:209],v14,49152
v_accvgpr_write_b32 a60, 0
MM v[124:127],a[216:219],a[72:75],v[124:127]
TR a[210:211],v14,50176
MM v[124:127],a[220:223],a[76:79],v[124:127]
v_accvgpr_write_b32 a61, 0
MM v[156:159],a[216:219],a[80:83],v[156:159]
TR a[212:213],v14,57344
MM v[156:159],a[220:223],a[84:87],v[156:159]
v_accvgpr_write_b32 a62, 0
MM v[188:191],a[216:219],a[88:91],v[188:191]
TR a[214:215],v14,58368
MM v[188:191],a[220:223],a[92:95],v[188:191]
s_waitcnt vmcnt(35) lgkmcnt(10)
v_accvgpr_write_b32 a63, 0
MM v[64:67],a[192:195],a[96:99],v[64:67]
s_waitcnt vmcnt(31) lgkmcnt(8)
TR a[216:217],v15,49152
v_accvgpr_write_b32 a64, 0
v_accvgpr_write_b32 a65, 0
MM v[64:67],a[196:199],a[100:103],v[64:67]
v_accvgpr_write_b32 a66, 0
v_accvgpr_write_b32 a67, 0
MM v[96:99],a[192:195],a[104:107],v[96:99]
s_waitcnt vmcnt(30)
TR a[218:219],v15,50176
v_accvgpr_write_b32 a68, 0
v_accvgpr_write_b32 a69, 0
MM v[96:99],a[196:199],a[108:111],v[96:99]
v_accvgpr_write_b32 a70, 0
v_accvgpr_write_b32 a71, 0
MM v[128:131],a[192:195],a[112:115],v[128:131]
s_waitcnt vmcnt(29)
TR a[220:221],v15,57344
v_accvgpr_write_b32 a72, 0
v_accvgpr_write_b32 a73, 0
MM v[128:131],a[196:199],a[116:119],v[128:131]
v_accvgpr_write_b32 a74, 0
v_accvgpr_write_b32 a75, 0
MM v[160:163],a[192:195],a[120:123],v[160:163]
s_waitcnt vmcnt(28)
TR a[222:223],v15,58368
v_accvgpr_write_b32 a76, 0
v_accvgpr_write_b32 a77, 0
MM v[160:163],a[196:199],a[124:127],v[160:163]
s_waitcnt lgkmcnt(10)
v_accvgpr_write_b32 a78, 0
v_accvgpr_write_b32 a79, 0
MM v[68:71],a[200:203],a[96:99],v[68:71]
s_waitcnt lgkmcnt(8)
TR a[192:193],v16,49152
v_accvgpr_write_b32 a80, 0
v_accvgpr_write_b32 a81, 0
MM v[68:71],a[204:207],a[100:103],v[68:71]
v_accvgpr_write_b32 a82, 0
v_accvgpr_write_b32 a83, 0
MM v[100:103],a[200:203],a[104:107],v[100:103]
TR a[194:195],v16,50176
v_accvgpr_write_b32 a84, 0
v_accvgpr_write_b32 a85, 0
MM v[100:103],a[204:207],a[108:111],v[100:103]
v_accvgpr_write_b32 a86, 0
v_accvgpr_write_b32 a87, 0
MM v[132:135],a[200:203],a[112:115],v[132:135]
TR a[196:197],v16,57344
v_accvgpr_write_b32 a88, 0
v_accvgpr_write_b32 a89, 0
MM v[132:135],a[204:207],a[116:119],v[132:135]
v_accvgpr_write_b32 a90, 0
v_accvgpr_write_b32 a91, 0
MM v[164:167],a[200:203],a[120:123],v[164:167]
TR a[198:199],v16,58368
v_accvgpr_write_b32 a92, 0
v_accvgpr_write_b32 a93, 0
MM v[164:167],a[204:207],a[124:127],v[164:167]
s_waitcnt lgkmcnt(10)
v_accvgpr_write_b32 a94, 0
v_accvgpr_write_b32 a95, 0
MM v[72:75],a[208:211],a[96:99],v[72:75]
s_waitcnt lgkmcnt(8)
TR a[200:201],v17,49152
MM v[72:75],a[212:215],a[100:103],v[72:75]
MM v[104:107],a[208:211],a[104:107],v[104:107]
TR a[202:203],v17,50176
MM v[104:107],a[212:215],a[108:111],v[104:107]
v_cvt_pk_bf16_f32 v192, v64, v65
v_cvt_pk_bf16_f32 v193, v66, v67
MM v[136:139],a[208:211],a[112:115],v[136:139]
TR a[204:205],v17,57344
v_cvt_pk_bf16_f32 v194, v68, v69
v_cvt_pk_bf16_f32 v195, v70, v71
MM v[136:139],a[212:215],a[116:119],v[136:139]
v_cvt_pk_bf16_f32 v208, v96, v97
v_cvt_pk_bf16_f32 v209, v98, v99
MM v[168:171],a[208:211],a[120:123],v[168:171]
TR a[206:207],v17,58368
v_cvt_pk_bf16_f32 v210, v100, v101
v_cvt_pk_bf16_f32 v211, v102, v103
MM v[168:171],a[212:215],a[124:127],v[168:171]
s_waitcnt lgkmcnt(10)
v_cvt_pk_bf16_f32 v224, v128, v129
v_cvt_pk_bf16_f32 v225, v130, v131
MM v[76:79],a[216:219],a[96:99],v[76:79]
s_waitcnt lgkmcnt(8)
TR a[208:209],v18,49152
v_cvt_pk_bf16_f32 v226, v132, v133
v_cvt_pk_bf16_f32 v227, v134, v135
MM v[76:79],a[220:223],a[100:103],v[76:79]
v_cvt_pk_bf16_f32 v240, v160, v161
v_cvt_pk_bf16_f32 v241, v162, v163
MM v[108:111],a[216:219],a[104:107],v[108:111]
TR a[210:211],v18,50176
v_cvt_pk_bf16_f32 v242, v164, v165
v_cvt_pk_bf16_f32 v243, v166, v167
MM v[108:111],a[220:223],a[108:111],v[108:111]
v_permlane16_swap_b32 v192, v194
v_permlane16_swap_b32 v193, v195
MM v[140:143],a[216:219],a[112:115],v[140:143]
TR a[212:213],v18,57344
v_permlane16_swap_b32 v208, v210
v_permlane16_swap_b32 v209, v211
MM v[140:143],a[220:223],a[116:119],v[140:143]
v_permlane16_swap_b32 v224, v226
v_permlane16_swap_b32 v225, v227
MM v[172:175],a[216:219],a[120:123],v[172:175]
TR a[214:215],v18,58368
v_permlane16_swap_b32 v240, v242
v_permlane16_swap_b32 v241, v243
MM v[172:175],a[220:223],a[124:127],v[172:175]
s_waitcnt lgkmcnt(10)
MM v[80:83],a[192:195],a[96:99],v[80:83]
s_waitcnt lgkmcnt(8)
TR a[216:217],v19,49152
MM v[80:83],a[196:199],a[100:103],v[80:83]
MM v[112:115],a[192:195],a[104:107],v[112:115]
TR a[218:219],v19,50176
MM v[112:115],a[196:199],a[108:111],v[112:115]
v_cvt_pk_bf16_f32 v196, v72, v73
v_cvt_pk_bf16_f32 v197, v74, v75
MM v[144:147],a[192:195],a[112:115],v[144:147]
TR a[220:221],v19,57344
v_cvt_pk_bf16_f32 v198, v76, v77
v_cvt_pk_bf16_f32 v199, v78, v79
MM v[144:147],a[196:199],a[116:119],v[144:147]
v_cvt_pk_bf16_f32 v212, v104, v105
v_cvt_pk_bf16_f32 v213, v106, v107
MM v[176:179],a[192:195],a[120:123],v[176:179]
TR a[222:223],v19,58368
v_cvt_pk_bf16_f32 v214, v108, v109
v_cvt_pk_bf16_f32 v215, v110, v111
MM v[176:179],a[196:199],a[124:127],v[176:179]
s_waitcnt lgkmcnt(10)
v_cvt_pk_bf16_f32 v228, v136, v137
v_cvt_pk_bf16_f32 v229, v138, v139
MM v[84:87],a[200:203],a[96:99],v[84:87]
s_waitcnt lgkmcnt(8)
v_cvt_pk_bf16_f32 v230, v140, v141
v_cvt_pk_bf16_f32 v231, v142, v143
MM v[84:87],a[204:207],a[100:103],v[84:87]
v_cvt_pk_bf16_f32 v244, v168, v169
v_cvt_pk_bf16_f32 v245, v170, v171
MM v[116:119],a[200:203],a[104:107],v[116:119]
v_cvt_pk_bf16_f32 v246, v172, v173
v_cvt_pk_bf16_f32 v247, v174, v175
MM v[116:119],a[204:207],a[108:111],v[116:119]
v_permlane16_swap_b32 v196, v198
v_permlane16_swap_b32 v197, v199
MM v[148:151],a[200:203],a[112:115],v[148:151]
v_permlane16_swap_b32 v212, v214
v_permlane16_swap_b32 v213, v215
MM v[148:151],a[204:207],a[116:119],v[148:151]
v_permlane16_swap_b32 v228, v230
v_permlane16_swap_b32 v229, v231
MM v[180:183],a[200:203],a[120:123],v[180:183]
v_permlane16_swap_b32 v244, v246
v_permlane16_swap_b32 v245, v247
MM v[180:183],a[204:207],a[124:127],v[180:183]
s_waitcnt vmcnt(24) lgkmcnt(6)
MM v[88:91],a[208:211],a[96:99],v[88:91]
s_barrier
s_waitcnt lgkmcnt(4)
MM v[88:91],a[212:215],a[100:103],v[88:91]
ds_read_b128 a[128:131], v8 offset:0
MM v[120:123],a[208:211],a[104:107],v[120:123]
MM v[120:123],a[212:215],a[108:111],v[120:123]
ds_read_b128 a[132:135], v9 offset:0
v_cvt_pk_bf16_f32 v200, v80, v81
v_cvt_pk_bf16_f32 v201, v82, v83
MM v[152:155],a[208:211],a[112:115],v[152:155]
v_cvt_pk_bf16_f32 v202, v84, v85
v_cvt_pk_bf16_f32 v203, v86, v87
MM v[152:155],a[212:215],a[116:119],v[152:155]
ds_read_b128 a[136:139], v10 offset:0
v_cvt_pk_bf16_f32 v216, v112, v113
v_cvt_pk_bf16_f32 v217, v114, v115
MM v[184:187],a[208:211],a[120:123],v[184:187]
v_cvt_pk_bf16_f32 v218, v116, v117
v_cvt_pk_bf16_f32 v219, v118, v119
MM v[184:187],a[212:215],a[124:127],v[184:187]
s_waitcnt lgkmcnt(5)
ds_read_b128 a[140:143], v11 offset:0
v_cvt_pk_bf16_f32 v232, v144, v145
v_cvt_pk_bf16_f32 v233, v146, v147
MM v[92:95],a[216:219],a[96:99],v[92:95]
s_waitcnt lgkmcnt(4)
ds_read_b128 a[144:147], v8 offset:4096
v_cvt_pk_bf16_f32 v234, v148, v149
v_cvt_pk_bf16_f32 v235, v150, v151
MM v[92:95],a[220:223],a[100:103],v[92:95]
v_cvt_pk_bf16_f32 v248, v176, v177
v_cvt_pk_bf16_f32 v249, v178, v179
MM v[124:127],a[216:219],a[104:107],v[124:127]
ds_read_b128 a[148:151], v9 offset:4096
v_cvt_pk_bf16_f32 v250, v180, v181
v_cvt_pk_bf16_f32 v251, v182, v183
MM v[124:127],a[220:223],a[108:111],v[124:127]
v_permlane16_swap_b32 v200, v202
v_permlane16_swap_b32 v201, v203
MM v[156:159],a[216:219],a[112:115],v[156:159]
ds_read_b128 a[152:155], v10 offset:4096
v_permlane16_swap_b32 v216, v218
v_permlane16_swap_b32 v217, v219
MM v[156:159],a[220:223],a[116:119],v[156:159]
v_permlane16_swap_b32 v232, v234
v_permlane16_swap_b32 v233, v235
MM v[188:191],a[216:219],a[120:123],v[188:191]
ds_read_b128 a[156:159], v11 offset:4096
v_permlane16_swap_b32 v248, v250
v_permlane16_swap_b32 v249, v251
MM v[188:191],a[220:223],a[124:127],v[188:191]
s_waitcnt lgkmcnt(7)
v_cvt_pk_bf16_f32 v204, v88, v89
v_cvt_pk_bf16_f32 v205, v90, v91
v_cvt_pk_bf16_f32 v206, v92, v93
v_cvt_pk_bf16_f32 v207, v94, v95
v_cvt_pk_bf16_f32 v220, v120, v121
v_cvt_pk_bf16_f32 v221, v122, v123
v_cvt_pk_bf16_f32 v222, v124, v125
v_cvt_pk_bf16_f32 v223, v126, v127
v_cvt_pk_bf16_f32 v236, v152, v153
v_cvt_pk_bf16_f32 v237, v154, v155
v_cvt_pk_bf16_f32 v238, v156, v157
v_cvt_pk_bf16_f32 v239, v158, v159
v_cvt_pk_bf16_f32 v252, v184, v185
v_cvt_pk_bf16_f32 v253, v186, v187
v_cvt_pk_bf16_f32 v254, v188, v189
v_cvt_pk_bf16_f32 v255, v190, v191
v_permlane16_swap_b32 v204, v206
v_permlane16_swap_b32 v205, v207
v_permlane16_swap_b32 v220, v222
v_permlane16_swap_b32 v221, v223
v_permlane16_swap_b32 v236, v238
v_permlane16_swap_b32 v237, v239
v_permlane16_swap_b32 v252, v254
v_permlane16_swap_b32 v253, v255
MM v[64:67],a[128:131],v[192:195],0
s_waitcnt lgkmcnt(6)
v_accvgpr_write_b32 a96, 0
v_accvgpr_write_b32 a97, 0
MM v[64:67],a[132:135],v[196:199],v[64:67]
s_waitcnt lgkmcnt(5)
v_accvgpr_write_b32 a98, 0
v_accvgpr_write_b32 a99, 0
MM v[64:67],a[136:139],v[200:203],v[64:67]
s_waitcnt lgkmcnt(4)
v_accvgpr_write_b32 a100, 0
v_accvgpr_write_b32 a101, 0
MM v[64:67],a[140:143],v[204:207],v[64:67]
v_accvgpr_write_b32 a102, 0
v_accvgpr_write_b32 a103, 0
MM v[72:75],a[128:131],v[208:211],0
v_accvgpr_write_b32 a104, 0
v_accvgpr_write_b32 a105, 0
MM v[72:75],a[132:135],v[212:215],v[72:75]
v_accvgpr_write_b32 a106, 0
v_accvgpr_write_b32 a107, 0
MM v[72:75],a[136:139],v[216:219],v[72:75]
v_accvgpr_write_b32 a108, 0
v_accvgpr_write_b32 a109, 0
MM v[72:75],a[140:143],v[220:223],v[72:75]
v_accvgpr_write_b32 a110, 0
v_accvgpr_write_b32 a111, 0
MM v[80:83],a[128:131],v[224:227],0
v_accvgpr_write_b32 a112, 0
v_accvgpr_write_b32 a113, 0
MM v[80:83],a[132:135],v[228:231],v[80:83]
v_accvgpr_write_b32 a114, 0
v_accvgpr_write_b32 a115, 0
MM v[80:83],a[136:139],v[232:235],v[80:83]
v_accvgpr_write_b32 a116, 0
v_accvgpr_write_b32 a117, 0
MM v[80:83],a[140:143],v[236:239],v[80:83]
v_accvgpr_write_b32 a118, 0
v_accvgpr_write_b32 a119, 0
MM v[88:91],a[128:131],v[240:243],0
v_accvgpr_write_b32 a120, 0
v_accvgpr_write_b32 a121, 0
MM v[88:91],a[132:135],v[244:247],v[88:91]
v_accvgpr_write_b32 a122, 0
v_accvgpr_write_b32 a123, 0
MM v[88:91],a[136:139],v[248:251],v[88:91]
v_accvgpr_write_b32 a124, 0
v_accvgpr_write_b32 a125, 0
MM v[88:91],a[140:143],v[252:255],v[88:91]
s_waitcnt lgkmcnt(3)
v_accvgpr_write_b32 a126, 0
v_accvgpr_write_b32 a127, 0
MM v[68:71],a[144:147],v[192:195],0
s_waitcnt lgkmcnt(2)
ds_read_b128 a[128:131], v8 offset:8192
v_sub_u32 v12, v12, v43
v_sub_u32 v13, v13, v43
MM v[68:71],a[148:151],v[196:199],v[68:71]
s_waitcnt lgkmcnt(2)
v_sub_u32 v14, v14, v43
v_sub_u32 v15, v15, v43
MM v[68:71],a[152:155],v[200:203],v[68:71]
s_waitcnt lgkmcnt(1)
ds_read_b128 a[132:135], v9 offset:8192
v_sub_u32 v16, v16, v43
v_sub_u32 v17, v17, v43
MM v[68:71],a[156:159],v[204:207],v[68:71]
v_sub_u32 v18, v18, v43
v_sub_u32 v19, v19, v43
MM v[76:79],a[144:147],v[208:211],0
ds_read_b128 a[136:139], v10 offset:8192
v_max3_f32 v44, v64, v65, v66
MM v[76:79],a[148:151],v[212:215],v[76:79]
v_max_f32 v44, v44, v67
MM v[76:79],a[152:155],v[216:219],v[76:79]
ds_read_b128 a[140:143], v11 offset:8192
MM v[76:79],a[156:159],v[220:223],v[76:79]
MM v[84:87],a[144:147],v[224:227],0
v_max3_f32 v45, v72, v73, v74
MM v[84:87],a[148:151],v[228:231],v[84:87]
v_max_f32 v45, v45, v75
MM v[84:87],a[152:155],v[232:235],v[84:87]
MM v[84:87],a[156:159],v[236:239],v[84:87]
MM v[92:95],a[144:147],v[240:243],0
v_max3_f32 v46, v80, v81, v82
v_max3_f32 v44, v44, v68, v69
MM v[92:95],a[148:151],v[244:247],v[92:95]
v_max_f32 v46, v46, v83
v_max3_f32 v44, v44, v70, v71
MM v[92:95],a[152:155],v[248:251],v[92:95]
MM v[92:95],a[156:159],v[252:255],v[92:95]
s_waitcnt lgkmcnt(3)
MM v[96:99],a[128:131],v[192:195],0
s_waitcnt lgkmcnt(2)
ds_read_b128 a[144:147], v8 offset:12288
v_max3_f32 v47, v88, v89, v90
v_max3_f32 v45, v45, v76, v77
MM v[96:99],a[132:135],v[196:199],v[96:99]
s_waitcnt lgkmcnt(2)
v_max_f32 v47, v47, v91
v_max3_f32 v45, v45, v78, v79
MM v[96:99],a[136:139],v[200:203],v[96:99]
s_waitcnt lgkmcnt(1)
ds_read_b128 a[148:151], v9 offset:12288
MM v[96:99],a[140:143],v[204:207],v[96:99]
MM v[104:107],a[128:131],v[208:211],0
ds_read_b128 a[152:155], v10 offset:12288
v_max3_f32 v46, v46, v84, v85
MM v[104:107],a[132:135],v[212:215],v[104:107]
v_max3_f32 v46, v46, v86, v87
MM v[104:107],a[136:139],v[216:219],v[104:107]
ds_read_b128 a[156:159], v11 offset:12288
MM v[104:107],a[140:143],v[220:223],v[104:107]
MM v[112:115],a[128:131],v[224:227],0
v_max3_f32 v47, v47, v92, v93
MM v[112:115],a[132:135],v[228:231],v[112:115]
v_max3_f32 v47, v47, v94, v95
MM v[112:115],a[136:139],v[232:235],v[112:115]
MM v[112:115],a[140:143],v[236:239],v[112:115]
MM v[120:123],a[128:131],v[240:243],0
v_max3_f32 v44, v44, v96, v97
MM v[120:123],a[132:135],v[244:247],v[120:123]
v_max3_f32 v44, v44, v98, v99
MM v[120:123],a[136:139],v[248:251],v[120:123]
MM v[120:123],a[140:143],v[252:255],v[120:123]
s_waitcnt lgkmcnt(3)
MM v[100:103],a[144:147],v[192:195],0
s_waitcnt lgkmcnt(2)
v_max3_f32 v45, v45, v104, v105
MM v[100:103],a[148:151],v[196:199],v[100:103]
s_waitcnt lgkmcnt(1)
v_max3_f32 v45, v45, v106, v107
MM v[100:103],a[152:155],v[200:203],v[100:103]
s_waitcnt lgkmcnt(0)
MM v[100:103],a[156:159],v[204:207],v[100:103]
MM v[108:111],a[144:147],v[208:211],0
v_max3_f32 v46, v46, v112, v113
MM v[108:111],a[148:151],v[212:215],v[108:111]
v_max3_f32 v46, v46, v114, v115
MM v[108:111],a[152:155],v[216:219],v[108:111]
MM v[108:111],a[156:159],v[220:223],v[108:111]
s_waitcnt vmcnt(16) lgkmcnt(0)
MM v[116:119],a[144:147],v[224:227],0
s_barrier
v_max3_f32 v47, v47, v120, v121
MM v[116:119],a[148:151],v[228:231],v[116:119]
ds_read_b128 a[128:131], v8 offset:16384
v_max3_f32 v47, v47, v122, v123
MM v[116:119],a[152:155],v[232:235],v[116:119]
ds_read_b128 a[132:135], v9 offset:16384
MM v[116:119],a[156:159],v[236:239],v[116:119]
ds_read_b128 a[136:139], v10 offset:16384
MM v[124:127],a[144:147],v[240:243],0
ds_read_b128 a[140:143], v11 offset:16384
MM v[124:127],a[148:151],v[244:247],v[124:127]
MM v[124:127],a[152:155],v[248:251],v[124:127]
MM v[124:127],a[156:159],v[252:255],v[124:127]
v_max3_f32 v44, v44, v100, v101
v_max3_f32 v44, v44, v102, v103
v_max3_f32 v45, v45, v108, v109
v_max3_f32 v45, v45, v110, v111
v_max3_f32 v46, v46, v116, v117
v_max3_f32 v46, v46, v118, v119
s_nop 1
v_max3_f32 v47, v47, v124, v125
v_max3_f32 v47, v47, v126, v127
v_mov_b32 v2, v44
v_mov_b32 v3, v45
v_mov_b32 v4, v46
v_mov_b32 v5, v47
v_permlane16_swap_b32 v2, v44
v_permlane16_swap_b32 v3, v45
v_permlane16_swap_b32 v4, v46
v_permlane16_swap_b32 v5, v47
v_max_f32 v44, v44, v2
v_max_f32 v45, v45, v3
v_max_f32 v46, v46, v4
v_max_f32 v47, v47, v5
v_mov_b32 v2, v44
v_mov_b32 v3, v45
v_mov_b32 v4, v46
v_mov_b32 v5, v47
v_permlane32_swap_b32 v2, v44
v_permlane32_swap_b32 v3, v45
v_permlane32_swap_b32 v4, v46
v_permlane32_swap_b32 v5, v47
v_max_f32 v44, v44, v2
v_max_f32 v45, v45, v3
v_max_f32 v46, v46, v4
v_max_f32 v47, v47, v5
s_mov_b32 s53, 0x42400000
v_add_f32 v44, s53, v44
v_sub_f32 v48, 0, v44
v_sub_f32 v49, 0, v44
v_sub_f32 v50, 0, v44
v_sub_f32 v51, 0, v44
v_add_f32 v45, s53, v45
v_sub_f32 v52, 0, v45
v_sub_f32 v53, 0, v45
v_sub_f32 v54, 0, v45
v_sub_f32 v55, 0, v45
v_add_f32 v46, s53, v46
v_sub_f32 v56, 0, v46
v_sub_f32 v57, 0, v46
v_sub_f32 v58, 0, v46
v_sub_f32 v59, 0, v46
v_add_f32 v47, s53, v47
v_sub_f32 v60, 0, v47
v_sub_f32 v61, 0, v47
v_sub_f32 v62, 0, v47
v_sub_f32 v63, 0, v47
v_sub_f32 v64, v64, v44
v_sub_f32 v65, v65, v44
v_sub_f32 v66, v66, v44
v_sub_f32 v67, v67, v44
v_sub_f32 v72, v72, v45
v_sub_f32 v73, v73, v45
v_sub_f32 v74, v74, v45
v_sub_f32 v75, v75, v45
v_sub_f32 v80, v80, v46
v_sub_f32 v81, v81, v46
v_sub_f32 v82, v82, v46
v_sub_f32 v83, v83, v46
v_sub_f32 v88, v88, v47
v_sub_f32 v89, v89, v47
v_sub_f32 v90, v90, v47
v_sub_f32 v91, v91, v47
v_sub_f32 v68, v68, v44
v_sub_f32 v69, v69, v44
v_sub_f32 v70, v70, v44
v_sub_f32 v71, v71, v44
v_sub_f32 v76, v76, v45
v_sub_f32 v77, v77, v45
v_sub_f32 v78, v78, v45
v_sub_f32 v79, v79, v45
v_sub_f32 v84, v84, v46
v_sub_f32 v85, v85, v46
v_sub_f32 v86, v86, v46
v_sub_f32 v87, v87, v46
v_sub_f32 v92, v92, v47
v_sub_f32 v93, v93, v47
v_sub_f32 v94, v94, v47
v_sub_f32 v95, v95, v47
v_sub_f32 v96, v96, v44
v_sub_f32 v97, v97, v44
v_sub_f32 v98, v98, v44
v_sub_f32 v99, v99, v44
v_sub_f32 v104, v104, v45
v_sub_f32 v105, v105, v45
v_sub_f32 v106, v106, v45
v_sub_f32 v107, v107, v45
v_sub_f32 v112, v112, v46
v_sub_f32 v113, v113, v46
v_sub_f32 v114, v114, v46
v_sub_f32 v115, v115, v46
v_sub_f32 v120, v120, v47
v_sub_f32 v121, v121, v47
v_sub_f32 v122, v122, v47
v_sub_f32 v123, v123, v47
v_sub_f32 v100, v100, v44
v_sub_f32 v101, v101, v44
v_sub_f32 v102, v102, v44
v_sub_f32 v103, v103, v44
v_sub_f32 v108, v108, v45
v_sub_f32 v109, v109, v45
v_sub_f32 v110, v110, v45
v_sub_f32 v111, v111, v45
v_sub_f32 v116, v116, v46
v_sub_f32 v117, v117, v46
v_sub_f32 v118, v118, v46
v_sub_f32 v119, v119, v46
v_sub_f32 v124, v124, v47
v_sub_f32 v125, v125, v47
v_sub_f32 v126, v126, v47
v_sub_f32 v127, v127, v47
s_mov_b32 s31, 65536
s_mov_b32 s32, 49152
s_mov_b32 s35, 0
s_mov_b32 s34, 0
s_getpc_b64 s[80:81]
L_attn_kernel_tpc:
s_add_u32 s80, s80, L_attn_kernel_tail-L_attn_kernel_tpc
s_addc_u32 s81, s81, 0
s_mov_b32 s82, L_attn_kernel_end-L_attn_kernel_tail
s_and_b32 s37, s30, 1
s_lshl_b32 s37, s37, 13
v_mov_b32 v26, 0x3e803e80
v_mov_b32 v27, 0x3e803e80
v_mov_b32 v28, 0x3e803e80
v_mov_b32 v29, 0x3e803e80
v_exp_f32 v64, v64
v_add_f32 v38, v38, v34
v_add_f32 v39, v39, v35
v_exp_f32 v65, v65
s_nop 0
v_cvt_pk_bf16_f32 v64, v64, v65
v_add_f32 v40, v40, v36
v_exp_f32 v66, v66
v_exp_f32 v67, v67
v_exp_f32 v68, v68
v_cvt_pk_bf16_f32 v65, v66, v67
v_add_f32 v41, v41, v37
v_exp_f32 v69, v69
s_nop 0
v_cvt_pk_bf16_f32 v66, v68, v69
v_exp_f32 v70, v70
v_exp_f32 v71, v71
v_exp_f32 v96, v96
v_cvt_pk_bf16_f32 v67, v70, v71
v_exp_f32 v97, v97
v_exp_f32 v98, v98
v_add_f32 v34, v96, v97
v_cvt_pk_bf16_f32 v96, v96, v97
v_add_f32 v34, v34, v98
v_exp_f32 v99, v99
MM v[68:71],v[26:29],v[64:67],0
v_exp_f32 v100, v100
v_exp_f32 v101, v101
v_add_f32 v34, v34, v99
v_cvt_pk_bf16_f32 v97, v98, v99
v_exp_f32 v102, v102
v_add_f32 v34, v34, v100
v_exp_f32 v103, v103
v_add_f32 v34, v34, v101
v_cvt_pk_bf16_f32 v98, v100, v101
v_exp_f32 v72, v72
v_exp_f32 v73, v73
v_exp_f32 v74, v74
v_add_f32 v34, v34, v102
v_add_f32 v34, v34, v103
v_cvt_pk_bf16_f32 v99, v102, v103
v_add_f32 v34, v34, v68
v_exp_f32 v75, v75
v_cvt_pk_bf16_f32 v72, v72, v73
v_exp_f32 v76, v76
v_exp_f32 v77, v77
v_cvt_pk_bf16_f32 v73, v74, v75
v_cvt_pk_bf16_f32 v74, v76, v77
v_exp_f32 v78, v78
v_exp_f32 v79, v79
v_exp_f32 v104, v104
v_cvt_pk_bf16_f32 v75, v78, v79
v_exp_f32 v105, v105
s_nop 0
v_add_f32 v35, v104, v105
v_exp_f32 v106, v106
v_cvt_pk_bf16_f32 v104, v104, v105
v_exp_f32 v107, v107
v_add_f32 v35, v35, v106
v_exp_f32 v108, v108
MM v[76:79],v[26:29],v[72:75],0
v_exp_f32 v109, v109
v_add_f32 v35, v35, v107
v_exp_f32 v110, v110
v_cvt_pk_bf16_f32 v105, v106, v107
v_exp_f32 v111, v111
v_add_f32 v35, v35, v108
v_exp_f32 v80, v80
v_add_f32 v35, v35, v109
v_exp_f32 v81, v81
v_cvt_pk_bf16_f32 v106, v108, v109
v_add_f32 v35, v35, v110
v_exp_f32 v82, v82
.p2align 6
L_attn_kernel_loop:
s_waitcnt lgkmcnt(3)
MM v[128:131],a[128:131],v[192:195],v[48:51]
s_waitcnt lgkmcnt(2)
v_exp_f32 v83, v83
MM v[128:131],a[132:135],v[196:199],v[128:131]
s_waitcnt lgkmcnt(1)
v_exp_f32 v84, v84
MM v[128:131],a[136:139],v[200:203],v[128:131]
s_waitcnt lgkmcnt(0)
v_add_f32 v35, v35, v111
v_cvt_pk_bf16_f32 v107, v110, v111
MM v[128:131],a[140:143],v[204:207],v[128:131]
v_exp_f32 v85, v85
MM v[136:139],a[128:131],v[208:211],v[52:55]
s_add_u32 m0, s33, 0
v_exp_f32 v86, v86
MM v[136:139],a[132:135],v[212:215],v[136:139]
ds_read_b128 a[144:147], v8 offset:20480
v_add_f32 v35, v35, v76
MM v[136:139],a[136:139],v[216:219],v[136:139]
v_exp_f32 v87, v87
MM v[136:139],a[140:143],v[220:223],v[136:139]
ds_read_b128 a[148:151], v9 offset:20480
v_cvt_pk_bf16_f32 v80, v80, v81
MM v[144:147],a[128:131],v[224:227],v[56:59]
v_exp_f32 v112, v112
MM v[144:147],a[132:135],v[228:231],v[144:147]
ds_read_b128 a[152:155], v10 offset:20480
v_cvt_pk_bf16_f32 v81, v82, v83
MM v[144:147],a[136:139],v[232:235],v[144:147]
ds_read_b128 a[156:159], v11 offset:20480
v_cvt_pk_bf16_f32 v82, v84, v85
MM v[144:147],a[140:143],v[236:239],v[144:147]
v_exp_f32 v113, v113
MM v[152:155],a[128:131],v[240:243],v[60:63]
TR a[160:161],v12,0
v_cvt_pk_bf16_f32 v83, v86, v87
MM v[152:155],a[132:135],v[244:247],v[152:155]
v_exp_f32 v114, v114
MM v[152:155],a[136:139],v[248:251],v[152:155]
v_exp_f32 v115, v115
MM v[152:155],a[140:143],v[252:255],v[152:155]
s_waitcnt lgkmcnt(4)
ds_read_b128 a[128:131], v8 offset:24576
v_add_f32 v36, v112, v113
MM v[132:135],a[144:147],v[192:195],v[48:51]
s_waitcnt lgkmcnt(4)
ds_read_b128 a[132:135], v9 offset:24576
v_cvt_pk_bf16_f32 v112, v112, v113
MM v[132:135],a[148:151],v[196:199],v[132:135]
s_waitcnt lgkmcnt(4)
v_exp_f32 v116, v116
MM v[132:135],a[152:155],v[200:203],v[132:135]
s_waitcnt lgkmcnt(3)
ds_read_b128 a[136:139], v10 offset:24576
v_add_f32 v36, v36, v114
MM v[132:135],a[156:159],v[204:207],v[132:135]
v_exp_f32 v117, v117
MM v[84:87],v[26:29],v[80:83],0
ds_read_b128 a[140:143], v11 offset:24576
v_add_f32 v36, v36, v115
MM v[140:143],a[144:147],v[208:211],v[52:55]
v_exp_f32 v118, v118
MM v[140:143],a[148:151],v[212:215],v[140:143]
v_exp_f32 v119, v119
MM v[140:143],a[152:155],v[216:219],v[140:143]
TR a[162:163],v12,4096
v_cvt_pk_bf16_f32 v113, v114, v115
MM v[140:143],a[156:159],v[220:223],v[140:143]
TR a[164:165],v12,8192
v_add_f32 v36, v36, v116
MM v[148:151],a[144:147],v[224:227],v[56:59]
v_exp_f32 v88, v88
MM v[148:151],a[148:151],v[228:231],v[148:151]
TR a[166:167],v12,12288
v_add_f32 v36, v36, v117
MM v[148:151],a[152:155],v[232:235],v[148:151]
v_exp_f32 v89, v89
MM v[148:151],a[156:159],v[236:239],v[148:151]
v_exp_f32 v90, v90
MM v[156:159],a[144:147],v[240:243],v[60:63]
v_cvt_pk_bf16_f32 v114, v116, v117
v_add_f32 v36, v36, v118
MM v[156:159],a[148:151],v[244:247],v[156:159]
v_exp_f32 v91, v91
MM v[156:159],a[152:155],v[248:251],v[156:159]
v_add_f32 v36, v36, v119
v_cvt_pk_bf16_f32 v115, v118, v119
MM v[156:159],a[156:159],v[252:255],v[156:159]
s_waitcnt lgkmcnt(6)
buffer_load_dwordx4 v20, s[8:11], s31 offen offset:0 lds
MM v[160:163],a[128:131],v[192:195],v[48:51]
s_waitcnt lgkmcnt(5)
v_exp_f32 v92, v92
MM v[160:163],a[132:135],v[196:199],v[160:163]
s_waitcnt lgkmcnt(4)
ds_read_b128 a[144:147], v8 offset:28672
v_add_f32 v36, v36, v84
MM v[160:163],a[136:139],v[200:203],v[160:163]
s_waitcnt lgkmcnt(4)
v_exp_f32 v93, v93
MM v[160:163],a[140:143],v[204:207],v[160:163]
ds_read_b128 a[148:151], v9 offset:28672
v_cvt_pk_bf16_f32 v88, v88, v89
MM v[168:171],a[128:131],v[208:211],v[52:55]
buffer_load_dwordx4 v21, s[8:11], s31 offen offset:1024 lds
MM v[168:171],a[132:135],v[212:215],v[168:171]
v_exp_f32 v94, v94
MM v[168:171],a[136:139],v[216:219],v[168:171]
ds_read_b128 a[152:155], v10 offset:28672
v_cvt_pk_bf16_f32 v89, v90, v91
MM v[168:171],a[140:143],v[220:223],v[168:171]
v_exp_f32 v95, v95
MM v[176:179],a[128:131],v[224:227],v[56:59]
v_exp_f32 v120, v120
MM v[176:179],a[132:135],v[228:231],v[176:179]
ds_read_b128 a[156:159], v11 offset:28672
v_cvt_pk_bf16_f32 v90, v92, v93
MM v[176:179],a[136:139],v[232:235],v[176:179]
v_exp_f32 v121, v121
MM v[176:179],a[140:143],v[236:239],v[176:179]
v_cvt_pk_bf16_f32 v91, v94, v95
v_add_f32 v37, v120, v121
MM v[184:187],a[128:131],v[240:243],v[60:63]
v_exp_f32 v122, v122
MM v[184:187],a[132:135],v[244:247],v[184:187]
v_exp_f32 v123, v123
MM v[184:187],a[136:139],v[248:251],v[184:187]
v_cvt_pk_bf16_f32 v120, v120, v121
v_add_f32 v37, v37, v122
MM v[184:187],a[140:143],v[252:255],v[184:187]
buffer_load_dwordx4 v22, s[8:11], s31 offen offset:2048 lds
MM v[92:95],v[26:29],v[88:91],0
s_waitcnt lgkmcnt(3)
v_exp_f32 v124, v124
MM v[164:167],a[144:147],v[192:195],v[48:51]
s_waitcnt lgkmcnt(2)
v_exp_f32 v125, v125
MM v[164:167],a[148:151],v[196:199],v[164:167]
s_waitcnt lgkmcnt(1)
TR a[168:169],v13,0
v_add_f32 v37, v37, v123
MM v[164:167],a[152:155],v[200:203],v[164:167]
s_waitcnt lgkmcnt(1)
TR a[170:171],v13,4096
v_cvt_pk_bf16_f32 v121, v122, v123
MM v[164:167],a[156:159],v[204:207],v[164:167]
buffer_load_dwordx4 v23, s[8:11], s31 offen offset:3072 lds
MM v[172:175],a[144:147],v[208:211],v[52:55]
s_add_u32 s31, s31, 16384
v_exp_f32 v126, v126
MM v[172:175],a[148:151],v[212:215],v[172:175]
TR a[172:173],v13,8192
v_add_f32 v37, v37, v124
MM v[172:175],a[152:155],v[216:219],v[172:175]
v_exp_f32 v127, v127
MM v[172:175],a[156:159],v[220:223],v[172:175]
TR a[174:175],v13,12288
v_add_f32 v37, v37, v125
MM v[180:183],a[144:147],v[224:227],v[56:59]
buffer_load_dword v32, v31, s[56:59], s54 offen offset:0
MM v[180:183],a[148:151],v[228:231],v[180:183]
v_cvt_pk_bf16_f32 v122, v124, v125
v_add_f32 v37, v37, v126
MM v[180:183],a[152:155],v[232:235],v[180:183]
TR a[176:177],v14,0
v_add_f32 v37, v37, v127
MM v[180:183],a[156:159],v[236:239],v[180:183]
v_cvt_pk_bf16_f32 v123, v126, v127
v_add_f32 v37, v37, v92
MM v[188:191],a[144:147],v[240:243],v[60:63]
TR a[178:179],v14,4096
v_max3_f32 v43, v34, v35, v36
v_max_f32 v43, v43, v37
v_cmp_nge_f32 vcc, s36, v43
MM v[188:191],a[148:151],v[244:247],v[188:191]
s_cbranch_vccnz L_attn_kernel_tr2
L_attn_kernel_tr2r:
v_exp_f32 v128, v128
MM v[188:191],a[152:155],v[248:251],v[188:191]
s_add_u32 s35, s35, 16384
v_add_f32 v38, v38, v34
v_add_f32 v39, v39, v35
MM v[188:191],a[156:159],v[252:255],v[188:191]
s_waitcnt lgkmcnt(8)
v_exp_f32 v129, v129
MM a[0:3],a[160:163],v[64:67],a[0:3]
s_waitcnt lgkmcnt(6)
v_cvt_pk_bf16_f32 v128, v128, v129
v_add_f32 v40, v40, v36
MM a[0:3],a[164:167],v[96:99],a[0:3]
s_waitcnt vmcnt(12)
v_exp_f32 v130, v130
MM a[4:7],a[160:163],v[72:75],a[4:7]
s_barrier
v_exp_f32 v131, v131
MM a[4:7],a[164:167],v[104:107],a[4:7]
s_add_u32 m0, s33, 114688
v_exp_f32 v132, v132
MM a[8:11],a[160:163],v[80:83],a[8:11]
TR a[180:181],v14,8192
v_cvt_pk_bf16_f32 v129, v130, v131
MM a[8:11],a[164:167],v[112:115],a[8:11]
TR a[182:183],v14,12288
v_add_f32 v41, v41, v37
MM a[12:15],a[160:163],v[88:91],a[12:15]
v_exp_f32 v133, v133
MM a[12:15],a[164:167],v[120:123],a[12:15]
s_waitcnt lgkmcnt(6)
TR a[184:185],v15,0
v_cvt_pk_bf16_f32 v130, v132, v133
MM a[16:19],a[168:171],v[64:67],a[16:19]
s_waitcnt lgkmcnt(5)
buffer_load_dwordx4 v24, s[12:15], s32 offen offset:0 lds
MM a[16:19],a[172:175],v[96:99],a[16:19]
v_exp_f32 v134, v134
MM a[20:23],a[168:171],v[72:75],a[20:23]
v_exp_f32 v135, v135
MM a[20:23],a[172:175],v[104:107],a[20:23]
v_exp_f32 v160, v160
MM a[24:27],a[168:171],v[80:83],a[24:27]
TR a[186:187],v15,4096
v_cvt_pk_bf16_f32 v131, v134, v135
MM a[24:27],a[172:175],v[112:115],a[24:27]
buffer_load_dwordx4 v25, s[12:15], s32 offen offset:1024 lds
MM a[28:31],a[168:171],v[88:91],a[28:31]
v_exp_f32 v161, v161
MM a[28:31],a[172:175],v[120:123],a[28:31]
s_waitcnt lgkmcnt(4)
v_exp_f32 v162, v162
MM a[32:35],a[176:179],v[64:67],a[32:35]
s_waitcnt lgkmcnt(2)
TR a[188:189],v15,8192
v_add_f32 v34, v160, v161
MM a[32:35],a[180:183],v[96:99],a[32:35]
TR a[190:191],v15,12288
v_cvt_pk_bf16_f32 v160, v160, v161
MM a[36:39],a[176:179],v[72:75],a[36:39]
TR a[160:161],v16,0
v_add_f32 v34, v34, v162
MM a[36:39],a[180:183],v[104:107],a[36:39]
v_exp_f32 v163, v163
MM v[132:135],v[26:29],v[128:131],0
v_exp_f32 v164, v164
MM a[40:43],a[176:179],v[80:83],a[40:43]
v_exp_f32 v165, v165
MM a[40:43],a[180:183],v[112:115],a[40:43]
TR a[162:163],v16,4096
v_add_f32 v34, v34, v163
MM a[44:47],a[176:179],v[88:91],a[44:47]
TR a[164:165],v16,8192
v_cvt_pk_bf16_f32 v161, v162, v163
MM a[44:47],a[180:183],v[120:123],a[44:47]
s_waitcnt lgkmcnt(5)
v_exp_f32 v166, v166
MM a[48:51],a[184:187],v[64:67],a[48:51]
s_waitcnt lgkmcnt(3)
TR a[166:167],v16,12288
v_add_f32 v34, v34, v164
MM a[48:51],a[188:191],v[96:99],a[48:51]
v_exp_f32 v167, v167
MM a[52:55],a[184:187],v[72:75],a[52:55]
TR a[168:169],v17,0
v_add_f32 v34, v34, v165
MM a[52:55],a[188:191],v[104:107],a[52:55]
TR a[170:171],v17,4096
v_cvt_pk_bf16_f32 v162, v164, v165
MM a[56:59],a[184:187],v[80:83],a[56:59]
v_exp_f32 v136, v136
MM a[56:59],a[188:191],v[112:115],a[56:59]
v_exp_f32 v137, v137
MM a[60:63],a[184:187],v[88:91],a[60:63]
v_exp_f32 v138, v138
MM a[60:63],a[188:191],v[120:123],a[60:63]
s_waitcnt lgkmcnt(4)
TR a[172:173],v17,8192
v_add_f32 v34, v34, v166
MM a[64:67],a[160:163],v[64:67],a[64:67]
s_waitcnt lgkmcnt(3)
v_add_f32 v34, v34, v167
v_cvt_pk_bf16_f32 v163, v166, v167
MM a[64:67],a[164:167],v[96:99],a[64:67]
TR a[174:175],v17,12288
v_add_f32 v34, v34, v132
MM a[68:71],a[160:163],v[72:75],a[68:71]
v_exp_f32 v139, v139
MM a[68:71],a[164:167],v[104:107],a[68:71]
TR a[176:177],v18,0
v_cvt_pk_bf16_f32 v136, v136, v137
MM a[72:75],a[160:163],v[80:83],a[72:75]
v_exp_f32 v140, v140
MM a[72:75],a[164:167],v[112:115],a[72:75]
v_exp_f32 v141, v141
MM a[76:79],a[160:163],v[88:91],a[76:79]
TR a[178:179],v18,4096
v_cvt_pk_bf16_f32 v137, v138, v139
MM a[76:79],a[164:167],v[120:123],a[76:79]
s_waitcnt lgkmcnt(4)
TR a[180:181],v18,8192
v_cvt_pk_bf16_f32 v138, v140, v141
MM a[80:83],a[168:171],v[64:67],a[80:83]
s_waitcnt lgkmcnt(3)
v_exp_f32 v142, v142
MM a[80:83],a[172:175],v[96:99],a[80:83]
TR a[182:183],v18,12288
MM a[84:87],a[168:171],v[72:75],a[84:87]
v_exp_f32 v143, v143
MM a[84:87],a[172:175],v[104:107],a[84:87]
v_exp_f32 v168, v168
MM a[88:91],a[168:171],v[80:83],a[88:91]
TR a[184:185],v19,0
v_cvt_pk_bf16_f32 v139, v142, v143
MM a[88:91],a[172:175],v[112:115],a[88:91]
v_exp_f32 v169, v169
MM a[92:95],a[168:171],v[88:91],a[92:95]
TR a[186:187],v19,4096
v_add_f32 v35, v168, v169
MM a[92:95],a[172:175],v[120:123],a[92:95]
s_waitcnt lgkmcnt(4)
v_exp_f32 v170, v170
MM a[96:99],a[176:179],v[64:67],a[96:99]
s_waitcnt lgkmcnt(2)
TR a[188:189],v19,8192
v_cvt_pk_bf16_f32 v168, v168, v169
MM a[96:99],a[180:183],v[96:99],a[96:99]
v_exp_f32 v171, v171
MM a[100:103],a[176:179],v[72:75],a[100:103]
TR a[190:191],v19,12288
v_add_f32 v35, v35, v170
MM a[100:103],a[180:183],v[104:107],a[100:103]
v_exp_f32 v172, v172
MM v[140:143],v[26:29],v[136:139],0
v_exp_f32 v173, v173
MM a[104:107],a[176:179],v[80:83],a[104:107]
ds_read_b128 a[128:131], v8 offset:32768
v_add_f32 v35, v35, v171
MM a[104:107],a[180:183],v[112:115],a[104:107]
v_exp_f32 v174, v174
MM a[108:111],a[176:179],v[88:91],a[108:111]
ds_read_b128 a[132:135], v9 offset:32768
v_cvt_pk_bf16_f32 v169, v170, v171
MM a[108:111],a[180:183],v[120:123],a[108:111]
s_waitcnt lgkmcnt(4)
v_exp_f32 v175, v175
MM a[112:115],a[184:187],v[64:67],a[112:115]
s_waitcnt lgkmcnt(2)
buffer_load_dwordx4 v24, s[12:15], s32 offen offset:2048 lds
MM a[112:115],a[188:191],v[96:99],a[112:115]
ds_read_b128 a[136:139], v10 offset:32768
v_add_f32 v35, v35, v172
MM a[116:119],a[184:187],v[72:75],a[116:119]
v_exp_f32 v144, v144
MM a[116:119],a[188:191],v[104:107],a[116:119]
ds_read_b128 a[140:143], v11 offset:32768
v_add_f32 v35, v35, v173
MM a[120:123],a[184:187],v[80:83],a[120:123]
v_exp_f32 v145, v145
MM a[120:123],a[188:191],v[112:115],a[120:123]
v_cvt_pk_bf16_f32 v170, v172, v173
v_add_f32 v35, v35, v174
MM a[124:127],a[184:187],v[88:91],a[124:127]
buffer_load_dwordx4 v25, s[12:15], s32 offen offset:3072 lds
MM a[124:127],a[188:191],v[120:123],a[124:127]
s_waitcnt lgkmcnt(3)
s_add_u32 s32, s32, 16384
v_exp_f32 v146, v146
MM v[64:67],a[128:131],v[192:195],v[48:51]
s_waitcnt lgkmcnt(2)
v_exp_f32 v147, v147
MM v[64:67],a[132:135],v[196:199],v[64:67]
s_waitcnt lgkmcnt(1)
v_exp_f32 v148, v148
MM v[64:67],a[136:139],v[200:203],v[64:67]
s_waitcnt lgkmcnt(0)
v_add_f32 v35, v35, v175
v_cvt_pk_bf16_f32 v171, v174, v175
MM v[64:67],a[140:143],v[204:207],v[64:67]
v_exp_f32 v149, v149
MM v[72:75],a[128:131],v[208:211],v[52:55]
s_add_u32 m0, s33, 16384
v_exp_f32 v150, v150
MM v[72:75],a[132:135],v[212:215],v[72:75]
ds_read_b128 a[144:147], v8 offset:36864
v_add_f32 v35, v35, v140
MM v[72:75],a[136:139],v[216:219],v[72:75]
v_exp_f32 v151, v151
MM v[72:75],a[140:143],v[220:223],v[72:75]
ds_read_b128 a[148:151], v9 offset:36864
v_cvt_pk_bf16_f32 v144, v144, v145
MM v[80:83],a[128:131],v[224:227],v[56:59]
v_exp_f32 v176, v176
MM v[80:83],a[132:135],v[228:231],v[80:83]
ds_read_b128 a[152:155], v10 offset:36864
v_cvt_pk_bf16_f32 v145, v146, v147
MM v[80:83],a[136:139],v[232:235],v[80:83]
ds_read_b128 a[156:159], v11 offset:36864
v_cvt_pk_bf16_f32 v146, v148, v149
MM v[80:83],a[140:143],v[236:239],v[80:83]
v_exp_f32 v177, v177
MM v[88:91],a[128:131],v[240:243],v[60:63]
TR a[160:161],v12,16384
v_cvt_pk_bf16_f32 v147, v150, v151
MM v[88:91],a[132:135],v[244:247],v[88:91]
v_exp_f32 v178, v178
MM v[88:91],a[136:139],v[248:251],v[88:91]
v_exp_f32 v179, v179
MM v[88:91],a[140:143],v[252:255],v[88:91]
s_waitcnt lgkmcnt(4)
ds_read_b128 a[128:131], v8 offset:40960
v_add_f32 v36, v176, v177
MM v[68:71],a[144:147],v[192:195],v[48:51]
s_waitcnt lgkmcnt(4)
ds_read_b128 a[132:135], v9 offset:40960
v_cvt_pk_bf16_f32 v176, v176, v177
MM v[68:71],a[148:151],v[196:199],v[68:71]
s_waitcnt lgkmcnt(4)
v_exp_f32 v180, v180
MM v[68:71],a[152:155],v[200:203],v[68:71]
s_waitcnt lgkmcnt(3)
ds_read_b128 a[136:139], v10 offset:40960
v_add_f32 v36, v36, v178
MM v[68:71],a[156:159],v[204:207],v[68:71]
v_exp_f32 v181, v181
MM v[148:151],v[26:29],v[144:147],0
ds_read_b128 a[140:143], v11 offset:40960
v_add_f32 v36, v36, v179
MM v[76:79],a[144:147],v[208:211],v[52:55]
v_exp_f32 v182, v182
MM v[76:79],a[148:151],v[212:215],v[76:79]
v_exp_f32 v183, v183
MM v[76:79],a[152:155],v[216:219],v[76:79]
TR a[162:163],v12,20480
v_cvt_pk_bf16_f32 v177, v178, v179
MM v[76:79],a[156:159],v[220:223],v[76:79]
TR a[164:165],v12,24576
v_add_f32 v36, v36, v180
MM v[84:87],a[144:147],v[224:227],v[56:59]
v_exp_f32 v152, v152
MM v[84:87],a[148:151],v[228:231],v[84:87]
TR a[166:167],v12,28672
v_add_f32 v36, v36, v181
MM v[84:87],a[152:155],v[232:235],v[84:87]
v_exp_f32 v153, v153
MM v[84:87],a[156:159],v[236:239],v[84:87]
v_exp_f32 v154, v154
MM v[92:95],a[144:147],v[240:243],v[60:63]
v_cvt_pk_bf16_f32 v178, v180, v181
v_add_f32 v36, v36, v182
MM v[92:95],a[148:151],v[244:247],v[92:95]
v_exp_f32 v155, v155
MM v[92:95],a[152:155],v[248:251],v[92:95]
v_add_f32 v36, v36, v183
v_cvt_pk_bf16_f32 v179, v182, v183
MM v[92:95],a[156:159],v[252:255],v[92:95]
s_waitcnt lgkmcnt(6)
buffer_load_dwordx4 v20, s[8:11], s31 offen offset:0 lds
MM v[96:99],a[128:131],v[192:195],v[48:51]
s_waitcnt lgkmcnt(5)
v_exp_f32 v156, v156
MM v[96:99],a[132:135],v[196:199],v[96:99]
s_waitcnt lgkmcnt(4)
ds_read_b128 a[144:147], v8 offset:45056
v_add_f32 v36, v36, v148
MM v[96:99],a[136:139],v[200:203],v[96:99]
s_waitcnt lgkmcnt(4)
v_exp_f32 v157, v157
MM v[96:99],a[140:143],v[204:207],v[96:99]
ds_read_b128 a[148:151], v9 offset:45056
v_cvt_pk_bf16_f32 v152, v152, v153
MM v[104:107],a[128:131],v[208:211],v[52:55]
buffer_load_dwordx4 v21, s[8:11], s31 offen offset:1024 lds
MM v[104:107],a[132:135],v[212:215],v[104:107]
v_exp_f32 v158, v158
MM v[104:107],a[136:139],v[216:219],v[104:107]
ds_read_b128 a[152:155], v10 offset:45056
v_cvt_pk_bf16_f32 v153, v154, v155
MM v[104:107],a[140:143],v[220:223],v[104:107]
v_exp_f32 v159, v159
MM v[112:115],a[128:131],v[224:227],v[56:59]
v_exp_f32 v184, v184
MM v[112:115],a[132:135],v[228:231],v[112:115]
ds_read_b128 a[156:159], v11 offset:45056
v_cvt_pk_bf16_f32 v154, v156, v157
MM v[112:115],a[136:139],v[232:235],v[112:115]
v_exp_f32 v185, v185
MM v[112:115],a[140:143],v[236:239],v[112:115]
v_cvt_pk_bf16_f32 v155, v158, v159
v_add_f32 v37, v184, v185
MM v[120:123],a[128:131],v[240:243],v[60:63]
v_exp_f32 v186, v186
MM v[120:123],a[132:135],v[244:247],v[120:123]
v_exp_f32 v187, v187
MM v[120:123],a[136:139],v[248:251],v[120:123]
v_cvt_pk_bf16_f32 v184, v184, v185
v_add_f32 v37, v37, v186
MM v[120:123],a[140:143],v[252:255],v[120:123]
buffer_load_dwordx4 v22, s[8:11], s31 offen offset:2048 lds
MM v[156:159],v[26:29],v[152:155],0
s_waitcnt lgkmcnt(3)
v_exp_f32 v188, v188
MM v[100:103],a[144:147],v[192:195],v[48:51]
s_waitcnt lgkmcnt(2)
v_exp_f32 v189, v189
MM v[100:103],a[148:151],v[196:199],v[100:103]
s_waitcnt lgkmcnt(1)
TR a[168:169],v13,16384
v_add_f32 v37, v37, v187
MM v[100:103],a[152:155],v[200:203],v[100:103]
s_waitcnt lgkmcnt(1)
TR a[170:171],v13,20480
v_cvt_pk_bf16_f32 v185, v186, v187
MM v[100:103],a[156:159],v[204:207],v[100:103]
buffer_load_dwordx4 v23, s[8:11], s31 offen offset:3072 lds
MM v[108:111],a[144:147],v[208:211],v[52:55]
s_add_u32 s31, s31, 16384
v_exp_f32 v190, v190
MM v[108:111],a[148:151],v[212:215],v[108:111]
TR a[172:173],v13,24576
v_add_f32 v37, v37, v188
MM v[108:111],a[152:155],v[216:219],v[108:111]
v_exp_f32 v191, v191
MM v[108:111],a[156:159],v[220:223],v[108:111]
TR a[174:175],v13,28672
v_add_f32 v37, v37, v189
MM v[116:119],a[144:147],v[224:227],v[56:59]
buffer_load_dword v32, v31, s[56:59], s54 offen offset:2048
MM v[116:119],a[148:151],v[228:231],v[116:119]
v_cvt_pk_bf16_f32 v186, v188, v189
v_add_f32 v37, v37, v190
MM v[116:119],a[152:155],v[232:235],v[116:119]
TR a[176:177],v14,16384
v_add_f32 v37, v37, v191
MM v[116:119],a[156:159],v[236:239],v[116:119]
v_cvt_pk_bf16_f32 v187, v190, v191
v_add_f32 v37, v37, v156
MM v[124:127],a[144:147],v[240:243],v[60:63]
TR a[178:179],v14,20480
v_max3_f32 v43, v34, v35, v36
v_max_f32 v43, v43, v37
v_cmp_nge_f32 vcc, s36, v43
MM v[124:127],a[148:151],v[244:247],v[124:127]
s_cbranch_vccnz L_attn_kernel_tr3
L_attn_kernel_tr3r:
v_exp_f32 v64, v64
MM v[124:127],a[152:155],v[248:251],v[124:127]
s_add_u32 s35, s35, 16384
v_add_f32 v38, v38, v34
v_add_f32 v39, v39, v35
MM v[124:127],a[156:159],v[252:255],v[124:127]
s_waitcnt lgkmcnt(8)
v_exp_f32 v65, v65
MM a[0:3],a[160:163],v[128:131],a[0:3]
s_waitcnt lgkmcnt(6)
v_cvt_pk_bf16_f32 v64, v64, v65
v_add_f32 v40, v40, v36
MM a[0:3],a[164:167],v[160:163],a[0:3]
s_waitcnt vmcnt(12)
v_exp_f32 v66, v66
MM a[4:7],a[160:163],v[136:139],a[4:7]
s_barrier
v_exp_f32 v67, v67
MM a[4:7],a[164:167],v[168:171],a[4:7]
s_add_u32 m0, s33, 65536
v_exp_f32 v68, v68
MM a[8:11],a[160:163],v[144:147],a[8:11]
TR a[180:181],v14,24576
v_cvt_pk_bf16_f32 v65, v66, v67
MM a[8:11],a[164:167],v[176:179],a[8:11]
TR a[182:183],v14,28672
v_add_f32 v41, v41, v37
MM a[12:15],a[160:163],v[152:155],a[12:15]
v_exp_f32 v69, v69
MM a[12:15],a[164:167],v[184:187],a[12:15]
s_waitcnt lgkmcnt(6)
TR a[184:185],v15,16384
v_cvt_pk_bf16_f32 v66, v68, v69
MM a[16:19],a[168:171],v[128:131],a[16:19]
s_waitcnt lgkmcnt(5)
buffer_load_dwordx4 v24, s[12:15], s32 offen offset:0 lds
MM a[16:19],a[172:175],v[160:163],a[16:19]
v_exp_f32 v70, v70
MM a[20:23],a[168:171],v[136:139],a[20:23]
v_exp_f32 v71, v71
MM a[20:23],a[172:175],v[168:171],a[20:23]
v_exp_f32 v96, v96
MM a[24:27],a[168:171],v[144:147],a[24:27]
TR a[186:187],v15,20480
v_cvt_pk_bf16_f32 v67, v70, v71
MM a[24:27],a[172:175],v[176:179],a[24:27]
buffer_load_dwordx4 v25, s[12:15], s32 offen offset:1024 lds
MM a[28:31],a[168:171],v[152:155],a[28:31]
s_add_u32 s54, s54, 4096
v_exp_f32 v97, v97
MM a[28:31],a[172:175],v[184:187],a[28:31]
s_waitcnt lgkmcnt(4)
v_exp_f32 v98, v98
MM a[32:35],a[176:179],v[128:131],a[32:35]
s_waitcnt lgkmcnt(2)
TR a[188:189],v15,24576
v_add_f32 v34, v96, v97
MM a[32:35],a[180:183],v[160:163],a[32:35]
TR a[190:191],v15,28672
v_cvt_pk_bf16_f32 v96, v96, v97
MM a[36:39],a[176:179],v[136:139],a[36:39]
TR a[160:161],v16,16384
v_add_f32 v34, v34, v98
MM a[36:39],a[180:183],v[168:171],a[36:39]
v_exp_f32 v99, v99
MM v[68:71],v[26:29],v[64:67],0
v_exp_f32 v100, v100
MM a[40:43],a[176:179],v[144:147],a[40:43]
v_exp_f32 v101, v101
MM a[40:43],a[180:183],v[176:179],a[40:43]
TR a[162:163],v16,20480
v_add_f32 v34, v34, v99
MM a[44:47],a[176:179],v[152:155],a[44:47]
TR a[164:165],v16,24576
v_cvt_pk_bf16_f32 v97, v98, v99
MM a[44:47],a[180:183],v[184:187],a[44:47]
s_waitcnt lgkmcnt(5)
v_exp_f32 v102, v102
MM a[48:51],a[184:187],v[128:131],a[48:51]
s_waitcnt lgkmcnt(3)
TR a[166:167],v16,28672
v_add_f32 v34, v34, v100
MM a[48:51],a[188:191],v[160:163],a[48:51]
v_exp_f32 v103, v103
MM a[52:55],a[184:187],v[136:139],a[52:55]
TR a[168:169],v17,16384
v_add_f32 v34, v34, v101
MM a[52:55],a[188:191],v[168:171],a[52:55]
TR a[170:171],v17,20480
v_cvt_pk_bf16_f32 v98, v100, v101
MM a[56:59],a[184:187],v[144:147],a[56:59]
v_exp_f32 v72, v72
MM a[56:59],a[188:191],v[176:179],a[56:59]
v_exp_f32 v73, v73
MM a[60:63],a[184:187],v[152:155],a[60:63]
v_exp_f32 v74, v74
MM a[60:63],a[188:191],v[184:187],a[60:63]
s_waitcnt lgkmcnt(4)
TR a[172:173],v17,24576
v_add_f32 v34, v34, v102
MM a[64:67],a[160:163],v[128:131],a[64:67]
s_waitcnt lgkmcnt(3)
v_add_f32 v34, v34, v103
v_cvt_pk_bf16_f32 v99, v102, v103
MM a[64:67],a[164:167],v[160:163],a[64:67]
TR a[174:175],v17,28672
v_add_f32 v34, v34, v68
MM a[68:71],a[160:163],v[136:139],a[68:71]
v_exp_f32 v75, v75
MM a[68:71],a[164:167],v[168:171],a[68:71]
TR a[176:177],v18,16384
v_cvt_pk_bf16_f32 v72, v72, v73
MM a[72:75],a[160:163],v[144:147],a[72:75]
v_exp_f32 v76, v76
MM a[72:75],a[164:167],v[176:179],a[72:75]
v_exp_f32 v77, v77
MM a[76:79],a[160:163],v[152:155],a[76:79]
TR a[178:179],v18,20480
v_cvt_pk_bf16_f32 v73, v74, v75
MM a[76:79],a[164:167],v[184:187],a[76:79]
s_waitcnt lgkmcnt(4)
TR a[180:181],v18,24576
v_cvt_pk_bf16_f32 v74, v76, v77
MM a[80:83],a[168:171],v[128:131],a[80:83]
s_waitcnt lgkmcnt(3)
v_exp_f32 v78, v78
MM a[80:83],a[172:175],v[160:163],a[80:83]
TR a[182:183],v18,28672
MM a[84:87],a[168:171],v[136:139],a[84:87]
v_exp_f32 v79, v79
MM a[84:87],a[172:175],v[168:171],a[84:87]
v_exp_f32 v104, v104
MM a[88:91],a[168:171],v[144:147],a[88:91]
TR a[184:185],v19,16384
v_cvt_pk_bf16_f32 v75, v78, v79
MM a[88:91],a[172:175],v[176:179],a[88:91]
v_exp_f32 v105, v105
MM a[92:95],a[168:171],v[152:155],a[92:95]
TR a[186:187],v19,20480
v_add_f32 v35, v104, v105
MM a[92:95],a[172:175],v[184:187],a[92:95]
s_waitcnt lgkmcnt(4)
v_exp_f32 v106, v106
MM a[96:99],a[176:179],v[128:131],a[96:99]
s_waitcnt lgkmcnt(2)
TR a[188:189],v19,24576
v_cvt_pk_bf16_f32 v104, v104, v105
MM a[96:99],a[180:183],v[160:163],a[96:99]
v_exp_f32 v107, v107
MM a[100:103],a[176:179],v[136:139],a[100:103]
TR a[190:191],v19,28672
v_add_f32 v35, v35, v106
MM a[100:103],a[180:183],v[168:171],a[100:103]
v_exp_f32 v108, v108
MM v[76:79],v[26:29],v[72:75],0
v_exp_f32 v109, v109
MM a[104:107],a[176:179],v[144:147],a[104:107]
ds_read_b128 a[128:131], v8 offset:49152
v_add_f32 v35, v35, v107
MM a[104:107],a[180:183],v[176:179],a[104:107]
v_exp_f32 v110, v110
MM a[108:111],a[176:179],v[152:155],a[108:111]
ds_read_b128 a[132:135], v9 offset:49152
v_cvt_pk_bf16_f32 v105, v106, v107
MM a[108:111],a[180:183],v[184:187],a[108:111]
s_waitcnt lgkmcnt(4)
v_exp_f32 v111, v111
MM a[112:115],a[184:187],v[128:131],a[112:115]
s_waitcnt lgkmcnt(2)
buffer_load_dwordx4 v24, s[12:15], s32 offen offset:2048 lds
MM a[112:115],a[188:191],v[160:163],a[112:115]
ds_read_b128 a[136:139], v10 offset:49152
v_add_f32 v35, v35, v108
MM a[116:119],a[184:187],v[136:139],a[116:119]
v_exp_f32 v80, v80
MM a[116:119],a[188:191],v[168:171],a[116:119]
ds_read_b128 a[140:143], v11 offset:49152
v_add_f32 v35, v35, v109
MM a[120:123],a[184:187],v[144:147],a[120:123]
v_exp_f32 v81, v81
MM a[120:123],a[188:191],v[176:179],a[120:123]
v_cvt_pk_bf16_f32 v106, v108, v109
v_add_f32 v35, v35, v110
MM a[124:127],a[184:187],v[152:155],a[124:127]
buffer_load_dwordx4 v25, s[12:15], s32 offen offset:3072 lds
MM a[124:127],a[188:191],v[184:187],a[124:127]
s_waitcnt lgkmcnt(3)
s_add_u32 s32, s32, 16384
v_exp_f32 v82, v82
MM v[128:131],a[128:131],v[192:195],v[48:51]
s_waitcnt lgkmcnt(2)
v_exp_f32 v83, v83
MM v[128:131],a[132:135],v[196:199],v[128:131]
s_waitcnt lgkmcnt(1)
v_exp_f32 v84, v84
MM v[128:131],a[136:139],v[200:203],v[128:131]
s_waitcnt lgkmcnt(0)
v_add_f32 v35, v35, v111
v_cvt_pk_bf16_f32 v107, v110, v111
MM v[128:131],a[140:143],v[204:207],v[128:131]
v_exp_f32 v85, v85
MM v[136:139],a[128:131],v[208:211],v[52:55]
s_add_u32 m0, s33, 32768
v_exp_f32 v86, v86
MM v[136:139],a[132:135],v[212:215],v[136:139]
ds_read_b128 a[144:147], v8 offset:53248
v_add_f32 v35, v35, v76
MM v[136:139],a[136:139],v[216:219],v[136:139]
v_exp_f32 v87, v87
MM v[136:139],a[140:143],v[220:223],v[136:139]
ds_read_b128 a[148:151], v9 offset:53248
v_cvt_pk_bf16_f32 v80, v80, v81
MM v[144:147],a[128:131],v[224:227],v[56:59]
v_exp_f32 v112, v112
MM v[144:147],a[132:135],v[228:231],v[144:147]
ds_read_b128 a[152:155], v10 offset:53248
v_cvt_pk_bf16_f32 v81, v82, v83
MM v[144:147],a[136:139],v[232:235],v[144:147]
ds_read_b128 a[156:159], v11 offset:53248
v_cvt_pk_bf16_f32 v82, v84, v85
MM v[144:147],a[140:143],v[236:239],v[144:147]
v_exp_f32 v113, v113
MM v[152:155],a[128:131],v[240:243],v[60:63]
TR a[160:161],v12,32768
v_cvt_pk_bf16_f32 v83, v86, v87
MM v[152:155],a[132:135],v[244:247],v[152:155]
v_exp_f32 v114, v114
MM v[152:155],a[136:139],v[248:251],v[152:155]
v_exp_f32 v115, v115
MM v[152:155],a[140:143],v[252:255],v[152:155]
s_waitcnt lgkmcnt(4)
ds_read_b128 a[128:131], v8 offset:57344
v_add_f32 v36, v112, v113
MM v[132:135],a[144:147],v[192:195],v[48:51]
s_waitcnt lgkmcnt(4)
ds_read_b128 a[132:135], v9 offset:57344
v_cvt_pk_bf16_f32 v112, v112, v113
MM v[132:135],a[148:151],v[196:199],v[132:135]
s_waitcnt lgkmcnt(4)
v_exp_f32 v116, v116
MM v[132:135],a[152:155],v[200:203],v[132:135]
s_waitcnt lgkmcnt(3)
ds_read_b128 a[136:139], v10 offset:57344
v_add_f32 v36, v36, v114
MM v[132:135],a[156:159],v[204:207],v[132:135]
v_exp_f32 v117, v117
MM v[84:87],v[26:29],v[80:83],0
ds_read_b128 a[140:143], v11 offset:57344
v_add_f32 v36, v36, v115
MM v[140:143],a[144:147],v[208:211],v[52:55]
v_exp_f32 v118, v118
MM v[140:143],a[148:151],v[212:215],v[140:143]
v_exp_f32 v119, v119
MM v[140:143],a[152:155],v[216:219],v[140:143]
TR a[162:163],v12,36864
v_cvt_pk_bf16_f32 v113, v114, v115
MM v[140:143],a[156:159],v[220:223],v[140:143]
TR a[164:165],v12,40960
v_add_f32 v36, v36, v116
MM v[148:151],a[144:147],v[224:227],v[56:59]
v_exp_f32 v88, v88
MM v[148:151],a[148:151],v[228:231],v[148:151]
TR a[166:167],v12,45056
v_add_f32 v36, v36, v117
MM v[148:151],a[152:155],v[232:235],v[148:151]
v_exp_f32 v89, v89
MM v[148:151],a[156:159],v[236:239],v[148:151]
v_exp_f32 v90, v90
MM v[156:159],a[144:147],v[240:243],v[60:63]
v_cvt_pk_bf16_f32 v114, v116, v117
v_add_f32 v36, v36, v118
MM v[156:159],a[148:151],v[244:247],v[156:159]
v_exp_f32 v91, v91
MM v[156:159],a[152:155],v[248:251],v[156:159]
v_add_f32 v36, v36, v119
v_cvt_pk_bf16_f32 v115, v118, v119
MM v[156:159],a[156:159],v[252:255],v[156:159]
s_waitcnt lgkmcnt(6)
buffer_load_dwordx4 v20, s[8:11], s31 offen offset:0 lds
MM v[160:163],a[128:131],v[192:195],v[48:51]
s_waitcnt lgkmcnt(5)
v_exp_f32 v92, v92
MM v[160:163],a[132:135],v[196:199],v[160:163]
s_waitcnt lgkmcnt(4)
ds_read_b128 a[144:147], v8 offset:61440
v_add_f32 v36, v36, v84
MM v[160:163],a[136:139],v[200:203],v[160:163]
s_waitcnt lgkmcnt(4)
v_exp_f32 v93, v93
MM v[160:163],a[140:143],v[204:207],v[160:163]
ds_read_b128 a[148:151], v9 offset:61440
v_cvt_pk_bf16_f32 v88, v88, v89
MM v[168:171],a[128:131],v[208:211],v[52:55]
buffer_load_dwordx4 v21, s[8:11], s31 offen offset:1024 lds
MM v[168:171],a[132:135],v[212:215],v[168:171]
v_exp_f32 v94, v94
MM v[168:171],a[136:139],v[216:219],v[168:171]
ds_read_b128 a[152:155], v10 offset:61440
v_cvt_pk_bf16_f32 v89, v90, v91
MM v[168:171],a[140:143],v[220:223],v[168:171]
v_exp_f32 v95, v95
MM v[176:179],a[128:131],v[224:227],v[56:59]
v_exp_f32 v120, v120
MM v[176:179],a[132:135],v[228:231],v[176:179]
ds_read_b128 a[156:159], v11 offset:61440
v_cvt_pk_bf16_f32 v90, v92, v93
MM v[176:179],a[136:139],v[232:235],v[176:179]
v_exp_f32 v121, v121
MM v[176:179],a[140:143],v[236:239],v[176:179]
v_cvt_pk_bf16_f32 v91, v94, v95
v_add_f32 v37, v120, v121
MM v[184:187],a[128:131],v[240:243],v[60:63]
v_exp_f32 v122, v122
MM v[184:187],a[132:135],v[244:247],v[184:187]
v_exp_f32 v123, v123
MM v[184:187],a[136:139],v[248:251],v[184:187]
v_cvt_pk_bf16_f32 v120, v120, v121
v_add_f32 v37, v37, v122
MM v[184:187],a[140:143],v[252:255],v[184:187]
buffer_load_dwordx4 v22, s[8:11], s31 offen offset:2048 lds
MM v[92:95],v[26:29],v[88:91],0
s_waitcnt lgkmcnt(3)
v_exp_f32 v124, v124
MM v[164:167],a[144:147],v[192:195],v[48:51]
s_waitcnt lgkmcnt(2)
v_exp_f32 v125, v125
MM v[164:167],a[148:151],v[196:199],v[164:167]
s_waitcnt lgkmcnt(1)
TR a[168:169],v13,32768
v_add_f32 v37, v37, v123
MM v[164:167],a[152:155],v[200:203],v[164:167]
s_waitcnt lgkmcnt(1)
TR a[170:171],v13,36864
v_cvt_pk_bf16_f32 v121, v122, v123
MM v[164:167],a[156:159],v[204:207],v[164:167]
buffer_load_dwordx4 v23, s[8:11], s31 offen offset:3072 lds
MM v[172:175],a[144:147],v[208:211],v[52:55]
s_add_u32 s31, s31, 16384
v_exp_f32 v126, v126
MM v[172:175],a[148:151],v[212:215],v[172:175]
TR a[172:173],v13,40960
v_add_f32 v37, v37, v124
MM v[172:175],a[152:155],v[216:219],v[172:175]
v_exp_f32 v127, v127
MM v[172:175],a[156:159],v[220:223],v[172:175]
TR a[174:175],v13,45056
v_add_f32 v37, v37, v125
MM v[180:183],a[144:147],v[224:227],v[56:59]
buffer_load_dword v32, v31, s[56:59], s54 offen offset:0
MM v[180:183],a[148:151],v[228:231],v[180:183]
v_cvt_pk_bf16_f32 v122, v124, v125
v_add_f32 v37, v37, v126
MM v[180:183],a[152:155],v[232:235],v[180:183]
TR a[176:177],v14,32768
v_add_f32 v37, v37, v127
MM v[180:183],a[156:159],v[236:239],v[180:183]
v_cvt_pk_bf16_f32 v123, v126, v127
v_add_f32 v37, v37, v92
MM v[188:191],a[144:147],v[240:243],v[60:63]
TR a[178:179],v14,36864
v_max3_f32 v43, v34, v35, v36
v_max_f32 v43, v43, v37
v_cmp_nge_f32 vcc, s36, v43
MM v[188:191],a[148:151],v[244:247],v[188:191]
s_cbranch_vccnz L_attn_kernel_tr4
L_attn_kernel_tr4r:
v_exp_f32 v128, v128
MM v[188:191],a[152:155],v[248:251],v[188:191]
s_add_u32 s35, s35, 16384
v_add_f32 v38, v38, v34
v_add_f32 v39, v39, v35
MM v[188:191],a[156:159],v[252:255],v[188:191]
s_waitcnt lgkmcnt(8)
v_exp_f32 v129, v129
MM a[0:3],a[160:163],v[64:67],a[0:3]
s_waitcnt lgkmcnt(6)
v_cvt_pk_bf16_f32 v128, v128, v129
v_add_f32 v40, v40, v36
MM a[0:3],a[164:167],v[96:99],a[0:3]
s_waitcnt vmcnt(12)
v_exp_f32 v130, v130
MM a[4:7],a[160:163],v[72:75],a[4:7]
s_barrier
v_exp_f32 v131, v131
MM a[4:7],a[164:167],v[104:107],a[4:7]
s_add_u32 m0, s33, 81920
v_exp_f32 v132, v132
MM a[8:11],a[160:163],v[80:83],a[8:11]
TR a[180:181],v14,40960
v_cvt_pk_bf16_f32 v129, v130, v131
MM a[8:11],a[164:167],v[112:115],a[8:11]
TR a[182:183],v14,45056
v_add_f32 v41, v41, v37
MM a[12:15],a[160:163],v[88:91],a[12:15]
v_exp_f32 v133, v133
MM a[12:15],a[164:167],v[120:123],a[12:15]
s_waitcnt lgkmcnt(6)
TR a[184:185],v15,32768
v_cvt_pk_bf16_f32 v130, v132, v133
MM a[16:19],a[168:171],v[64:67],a[16:19]
s_waitcnt lgkmcnt(5)
buffer_load_dwordx4 v24, s[12:15], s32 offen offset:0 lds
MM a[16:19],a[172:175],v[96:99],a[16:19]
v_exp_f32 v134, v134
MM a[20:23],a[168:171],v[72:75],a[20:23]
v_exp_f32 v135, v135
MM a[20:23],a[172:175],v[104:107],a[20:23]
v_exp_f32 v160, v160
MM a[24:27],a[168:171],v[80:83],a[24:27]
TR a[186:187],v15,36864
v_cvt_pk_bf16_f32 v131, v134, v135
MM a[24:27],a[172:175],v[112:115],a[24:27]
buffer_load_dwordx4 v25, s[12:15], s32 offen offset:1024 lds
MM a[28:31],a[168:171],v[88:91],a[28:31]
v_exp_f32 v161, v161
MM a[28:31],a[172:175],v[120:123],a[28:31]
s_waitcnt lgkmcnt(4)
v_exp_f32 v162, v162
MM a[32:35],a[176:179],v[64:67],a[32:35]
s_waitcnt lgkmcnt(2)
TR a[188:189],v15,40960
v_add_f32 v34, v160, v161
MM a[32:35],a[180:183],v[96:99],a[32:35]
TR a[190:191],v15,45056
v_cvt_pk_bf16_f32 v160, v160, v161
MM a[36:39],a[176:179],v[72:75],a[36:39]
TR a[160:161],v16,32768
v_add_f32 v34, v34, v162
MM a[36:39],a[180:183],v[104:107],a[36:39]
v_exp_f32 v163, v163
MM v[132:135],v[26:29],v[128:131],0
v_exp_f32 v164, v164
MM a[40:43],a[176:179],v[80:83],a[40:43]
v_exp_f32 v165, v165
MM a[40:43],a[180:183],v[112:115],a[40:43]
TR a[162:163],v16,36864
v_add_f32 v34, v34, v163
MM a[44:47],a[176:179],v[88:91],a[44:47]
TR a[164:165],v16,40960
v_cvt_pk_bf16_f32 v161, v162, v163
MM a[44:47],a[180:183],v[120:123],a[44:47]
s_waitcnt lgkmcnt(5)
v_exp_f32 v166, v166
MM a[48:51],a[184:187],v[64:67],a[48:51]
s_waitcnt lgkmcnt(3)
TR a[166:167],v16,45056
v_add_f32 v34, v34, v164
MM a[48:51],a[188:191],v[96:99],a[48:51]
v_exp_f32 v167, v167
MM a[52:55],a[184:187],v[72:75],a[52:55]
TR a[168:169],v17,32768
v_add_f32 v34, v34, v165
MM a[52:55],a[188:191],v[104:107],a[52:55]
TR a[170:171],v17,36864
v_cvt_pk_bf16_f32 v162, v164, v165
MM a[56:59],a[184:187],v[80:83],a[56:59]
v_exp_f32 v136, v136
MM a[56:59],a[188:191],v[112:115],a[56:59]
v_exp_f32 v137, v137
MM a[60:63],a[184:187],v[88:91],a[60:63]
v_exp_f32 v138, v138
MM a[60:63],a[188:191],v[120:123],a[60:63]
s_waitcnt lgkmcnt(4)
TR a[172:173],v17,40960
v_add_f32 v34, v34, v166
MM a[64:67],a[160:163],v[64:67],a[64:67]
s_waitcnt lgkmcnt(3)
v_add_f32 v34, v34, v167
v_cvt_pk_bf16_f32 v163, v166, v167
MM a[64:67],a[164:167],v[96:99],a[64:67]
TR a[174:175],v17,45056
v_add_f32 v34, v34, v132
MM a[68:71],a[160:163],v[72:75],a[68:71]
v_exp_f32 v139, v139
MM a[68:71],a[164:167],v[104:107],a[68:71]
TR a[176:177],v18,32768
v_cvt_pk_bf16_f32 v136, v136, v137
MM a[72:75],a[160:163],v[80:83],a[72:75]
v_exp_f32 v140, v140
MM a[72:75],a[164:167],v[112:115],a[72:75]
v_exp_f32 v141, v141
MM a[76:79],a[160:163],v[88:91],a[76:79]
TR a[178:179],v18,36864
v_cvt_pk_bf16_f32 v137, v138, v139
MM a[76:79],a[164:167],v[120:123],a[76:79]
s_waitcnt lgkmcnt(4)
TR a[180:181],v18,40960
v_cvt_pk_bf16_f32 v138, v140, v141
MM a[80:83],a[168:171],v[64:67],a[80:83]
s_waitcnt lgkmcnt(3)
v_exp_f32 v142, v142
MM a[80:83],a[172:175],v[96:99],a[80:83]
TR a[182:183],v18,45056
MM a[84:87],a[168:171],v[72:75],a[84:87]
v_exp_f32 v143, v143
MM a[84:87],a[172:175],v[104:107],a[84:87]
v_exp_f32 v168, v168
MM a[88:91],a[168:171],v[80:83],a[88:91]
TR a[184:185],v19,32768
v_cvt_pk_bf16_f32 v139, v142, v143
MM a[88:91],a[172:175],v[112:115],a[88:91]
v_exp_f32 v169, v169
MM a[92:95],a[168:171],v[88:91],a[92:95]
TR a[186:187],v19,36864
v_add_f32 v35, v168, v169
MM a[92:95],a[172:175],v[120:123],a[92:95]
s_waitcnt lgkmcnt(4)
v_exp_f32 v170, v170
MM a[96:99],a[176:179],v[64:67],a[96:99]
s_waitcnt lgkmcnt(2)
TR a[188:189],v19,40960
v_cvt_pk_bf16_f32 v168, v168, v169
MM a[96:99],a[180:183],v[96:99],a[96:99]
v_exp_f32 v171, v171
MM a[100:103],a[176:179],v[72:75],a[100:103]
TR a[190:191],v19,45056
v_add_f32 v35, v35, v170
MM a[100:103],a[180:183],v[104:107],a[100:103]
v_exp_f32 v172, v172
MM v[140:143],v[26:29],v[136:139],0
v_exp_f32 v173, v173
MM a[104:107],a[176:179],v[80:83],a[104:107]
ds_read_b128 a[128:131], v8 offset:0
v_add_f32 v35, v35, v171
MM a[104:107],a[180:183],v[112:115],a[104:107]
v_exp_f32 v174, v174
MM a[108:111],a[176:179],v[88:91],a[108:111]
ds_read_b128 a[132:135], v9 offset:0
v_cvt_pk_bf16_f32 v169, v170, v171
MM a[108:111],a[180:183],v[120:123],a[108:111]
s_waitcnt lgkmcnt(4)
v_exp_f32 v175, v175
MM a[112:115],a[184:187],v[64:67],a[112:115]
s_waitcnt lgkmcnt(2)
buffer_load_dwordx4 v24, s[12:15], s32 offen offset:2048 lds
MM a[112:115],a[188:191],v[96:99],a[112:115]
ds_read_b128 a[136:139], v10 offset:0
v_add_f32 v35, v35, v172
MM a[116:119],a[184:187],v[72:75],a[116:119]
v_exp_f32 v144, v144
MM a[116:119],a[188:191],v[104:107],a[116:119]
ds_read_b128 a[140:143], v11 offset:0
v_add_f32 v35, v35, v173
MM a[120:123],a[184:187],v[80:83],a[120:123]
v_exp_f32 v145, v145
MM a[120:123],a[188:191],v[112:115],a[120:123]
v_cvt_pk_bf16_f32 v170, v172, v173
v_add_f32 v35, v35, v174
MM a[124:127],a[184:187],v[88:91],a[124:127]
buffer_load_dwordx4 v25, s[12:15], s32 offen offset:3072 lds
MM a[124:127],a[188:191],v[120:123],a[124:127]
s_waitcnt lgkmcnt(3)
s_add_u32 s32, s32, 16384
v_exp_f32 v146, v146
MM v[64:67],a[128:131],v[192:195],v[48:51]
s_waitcnt lgkmcnt(2)
v_exp_f32 v147, v147
MM v[64:67],a[132:135],v[196:199],v[64:67]
s_waitcnt lgkmcnt(1)
v_exp_f32 v148, v148
MM v[64:67],a[136:139],v[200:203],v[64:67]
s_waitcnt lgkmcnt(0)
v_add_f32 v35, v35, v175
v_cvt_pk_bf16_f32 v171, v174, v175
MM v[64:67],a[140:143],v[204:207],v[64:67]
v_exp_f32 v149, v149
MM v[72:75],a[128:131],v[208:211],v[52:55]
s_add_u32 m0, s33, 49152
v_exp_f32 v150, v150
MM v[72:75],a[132:135],v[212:215],v[72:75]
ds_read_b128 a[144:147], v8 offset:4096
v_add_f32 v35, v35, v140
MM v[72:75],a[136:139],v[216:219],v[72:75]
v_exp_f32 v151, v151
MM v[72:75],a[140:143],v[220:223],v[72:75]
ds_read_b128 a[148:151], v9 offset:4096
v_cvt_pk_bf16_f32 v144, v144, v145
MM v[80:83],a[128:131],v[224:227],v[56:59]
v_exp_f32 v176, v176
MM v[80:83],a[132:135],v[228:231],v[80:83]
ds_read_b128 a[152:155], v10 offset:4096
v_cvt_pk_bf16_f32 v145, v146, v147
MM v[80:83],a[136:139],v[232:235],v[80:83]
ds_read_b128 a[156:159], v11 offset:4096
v_cvt_pk_bf16_f32 v146, v148, v149
MM v[80:83],a[140:143],v[236:239],v[80:83]
v_exp_f32 v177, v177
MM v[88:91],a[128:131],v[240:243],v[60:63]
TR a[160:161],v12,49152
v_cvt_pk_bf16_f32 v147, v150, v151
MM v[88:91],a[132:135],v[244:247],v[88:91]
v_exp_f32 v178, v178
MM v[88:91],a[136:139],v[248:251],v[88:91]
v_exp_f32 v179, v179
MM v[88:91],a[140:143],v[252:255],v[88:91]
s_waitcnt lgkmcnt(4)
ds_read_b128 a[128:131], v8 offset:8192
v_add_f32 v36, v176, v177
MM v[68:71],a[144:147],v[192:195],v[48:51]
s_waitcnt lgkmcnt(4)
ds_read_b128 a[132:135], v9 offset:8192
v_cvt_pk_bf16_f32 v176, v176, v177
MM v[68:71],a[148:151],v[196:199],v[68:71]
s_waitcnt lgkmcnt(4)
v_exp_f32 v180, v180
MM v[68:71],a[152:155],v[200:203],v[68:71]
s_waitcnt lgkmcnt(3)
ds_read_b128 a[136:139], v10 offset:8192
v_add_f32 v36, v36, v178
MM v[68:71],a[156:159],v[204:207],v[68:71]
v_exp_f32 v181, v181
MM v[148:151],v[26:29],v[144:147],0
ds_read_b128 a[140:143], v11 offset:8192
v_add_f32 v36, v36, v179
MM v[76:79],a[144:147],v[208:211],v[52:55]
v_exp_f32 v182, v182
MM v[76:79],a[148:151],v[212:215],v[76:79]
v_exp_f32 v183, v183
MM v[76:79],a[152:155],v[216:219],v[76:79]
TR a[162:163],v12,53248
v_cvt_pk_bf16_f32 v177, v178, v179
MM v[76:79],a[156:159],v[220:223],v[76:79]
TR a[164:165],v12,57344
v_add_f32 v36, v36, v180
MM v[84:87],a[144:147],v[224:227],v[56:59]
v_exp_f32 v152, v152
MM v[84:87],a[148:151],v[228:231],v[84:87]
TR a[166:167],v12,61440
v_add_f32 v36, v36, v181
MM v[84:87],a[152:155],v[232:235],v[84:87]
v_exp_f32 v153, v153
MM v[84:87],a[156:159],v[236:239],v[84:87]
v_exp_f32 v154, v154
MM v[92:95],a[144:147],v[240:243],v[60:63]
v_cvt_pk_bf16_f32 v178, v180, v181
v_add_f32 v36, v36, v182
MM v[92:95],a[148:151],v[244:247],v[92:95]
v_exp_f32 v155, v155
MM v[92:95],a[152:155],v[248:251],v[92:95]
v_add_f32 v36, v36, v183
v_cvt_pk_bf16_f32 v179, v182, v183
MM v[92:95],a[156:159],v[252:255],v[92:95]
s_waitcnt lgkmcnt(6)
buffer_load_dwordx4 v20, s[8:11], s31 offen offset:0 lds
MM v[96:99],a[128:131],v[192:195],v[48:51]
s_waitcnt lgkmcnt(5)
v_exp_f32 v156, v156
MM v[96:99],a[132:135],v[196:199],v[96:99]
s_waitcnt lgkmcnt(4)
ds_read_b128 a[144:147], v8 offset:12288
v_add_f32 v36, v36, v148
MM v[96:99],a[136:139],v[200:203],v[96:99]
s_waitcnt lgkmcnt(4)
v_exp_f32 v157, v157
MM v[96:99],a[140:143],v[204:207],v[96:99]
ds_read_b128 a[148:151], v9 offset:12288
v_cvt_pk_bf16_f32 v152, v152, v153
MM v[104:107],a[128:131],v[208:211],v[52:55]
buffer_load_dwordx4 v21, s[8:11], s31 offen offset:1024 lds
MM v[104:107],a[132:135],v[212:215],v[104:107]
v_exp_f32 v158, v158
MM v[104:107],a[136:139],v[216:219],v[104:107]
ds_read_b128 a[152:155], v10 offset:12288
v_cvt_pk_bf16_f32 v153, v154, v155
MM v[104:107],a[140:143],v[220:223],v[104:107]
v_exp_f32 v159, v159
MM v[112:115],a[128:131],v[224:227],v[56:59]
v_exp_f32 v184, v184
MM v[112:115],a[132:135],v[228:231],v[112:115]
ds_read_b128 a[156:159], v11 offset:12288
v_cvt_pk_bf16_f32 v154, v156, v157
MM v[112:115],a[136:139],v[232:235],v[112:115]
v_exp_f32 v185, v185
MM v[112:115],a[140:143],v[236:239],v[112:115]
v_cvt_pk_bf16_f32 v155, v158, v159
v_add_f32 v37, v184, v185
MM v[120:123],a[128:131],v[240:243],v[60:63]
v_exp_f32 v186, v186
MM v[120:123],a[132:135],v[244:247],v[120:123]
v_exp_f32 v187, v187
MM v[120:123],a[136:139],v[248:251],v[120:123]
v_cvt_pk_bf16_f32 v184, v184, v185
v_add_f32 v37, v37, v186
MM v[120:123],a[140:143],v[252:255],v[120:123]
buffer_load_dwordx4 v22, s[8:11], s31 offen offset:2048 lds
MM v[156:159],v[26:29],v[152:155],0
s_waitcnt lgkmcnt(3)
v_exp_f32 v188, v188
MM v[100:103],a[144:147],v[192:195],v[48:51]
s_waitcnt lgkmcnt(2)
v_exp_f32 v189, v189
MM v[100:103],a[148:151],v[196:199],v[100:103]
s_waitcnt lgkmcnt(1)
TR a[168:169],v13,49152
v_add_f32 v37, v37, v187
MM v[100:103],a[152:155],v[200:203],v[100:103]
s_waitcnt lgkmcnt(1)
TR a[170:171],v13,53248
v_cvt_pk_bf16_f32 v185, v186, v187
MM v[100:103],a[156:159],v[204:207],v[100:103]
buffer_load_dwordx4 v23, s[8:11], s31 offen offset:3072 lds
MM v[108:111],a[144:147],v[208:211],v[52:55]
s_add_u32 s31, s31, 16384
v_exp_f32 v190, v190
MM v[108:111],a[148:151],v[212:215],v[108:111]
TR a[172:173],v13,57344
v_add_f32 v37, v37, v188
MM v[108:111],a[152:155],v[216:219],v[108:111]
v_exp_f32 v191, v191
MM v[108:111],a[156:159],v[220:223],v[108:111]
TR a[174:175],v13,61440
v_add_f32 v37, v37, v189
MM v[116:119],a[144:147],v[224:227],v[56:59]
buffer_load_dword v32, v31, s[56:59], s54 offen offset:2048
MM v[116:119],a[148:151],v[228:231],v[116:119]
v_cvt_pk_bf16_f32 v186, v188, v189
v_add_f32 v37, v37, v190
MM v[116:119],a[152:155],v[232:235],v[116:119]
TR a[176:177],v14,49152
v_add_f32 v37, v37, v191
MM v[116:119],a[156:159],v[236:239],v[116:119]
v_cvt_pk_bf16_f32 v187, v190, v191
v_add_f32 v37, v37, v156
MM v[124:127],a[144:147],v[240:243],v[60:63]
TR a[178:179],v14,53248
v_max3_f32 v43, v34, v35, v36
v_max_f32 v43, v43, v37
v_cmp_nge_f32 vcc, s36, v43
MM v[124:127],a[148:151],v[244:247],v[124:127]
s_cbranch_vccnz L_attn_kernel_tr5
L_attn_kernel_tr5r:
v_exp_f32 v64, v64
MM v[124:127],a[152:155],v[248:251],v[124:127]
s_add_u32 s35, s35, 16384
v_add_f32 v38, v38, v34
v_add_f32 v39, v39, v35
MM v[124:127],a[156:159],v[252:255],v[124:127]
s_waitcnt lgkmcnt(8)
v_exp_f32 v65, v65
MM a[0:3],a[160:163],v[128:131],a[0:3]
s_waitcnt lgkmcnt(6)
v_cvt_pk_bf16_f32 v64, v64, v65
v_add_f32 v40, v40, v36
MM a[0:3],a[164:167],v[160:163],a[0:3]
s_waitcnt vmcnt(12)
v_exp_f32 v66, v66
MM a[4:7],a[160:163],v[136:139],a[4:7]
s_barrier
v_exp_f32 v67, v67
MM a[4:7],a[164:167],v[168:171],a[4:7]
s_add_u32 m0, s33, 98304
v_exp_f32 v68, v68
MM a[8:11],a[160:163],v[144:147],a[8:11]
TR a[180:181],v14,57344
v_cvt_pk_bf16_f32 v65, v66, v67
MM a[8:11],a[164:167],v[176:179],a[8:11]
TR a[182:183],v14,61440
v_add_f32 v41, v41, v37
MM a[12:15],a[160:163],v[152:155],a[12:15]
v_exp_f32 v69, v69
MM a[12:15],a[164:167],v[184:187],a[12:15]
s_waitcnt lgkmcnt(6)
TR a[184:185],v15,49152
v_cvt_pk_bf16_f32 v66, v68, v69
MM a[16:19],a[168:171],v[128:131],a[16:19]
s_waitcnt lgkmcnt(5)
buffer_load_dwordx4 v24, s[12:15], s32 offen offset:0 lds
MM a[16:19],a[172:175],v[160:163],a[16:19]
v_exp_f32 v70, v70
MM a[20:23],a[168:171],v[136:139],a[20:23]
v_exp_f32 v71, v71
MM a[20:23],a[172:175],v[168:171],a[20:23]
v_exp_f32 v96, v96
MM a[24:27],a[168:171],v[144:147],a[24:27]
TR a[186:187],v15,53248
v_cvt_pk_bf16_f32 v67, v70, v71
MM a[24:27],a[172:175],v[176:179],a[24:27]
buffer_load_dwordx4 v25, s[12:15], s32 offen offset:1024 lds
MM a[28:31],a[168:171],v[152:155],a[28:31]
v_exp_f32 v97, v97
MM a[28:31],a[172:175],v[184:187],a[28:31]
s_waitcnt lgkmcnt(4)
v_exp_f32 v98, v98
MM a[32:35],a[176:179],v[128:131],a[32:35]
s_waitcnt lgkmcnt(2)
TR a[188:189],v15,57344
v_add_f32 v34, v96, v97
MM a[32:35],a[180:183],v[160:163],a[32:35]
s_sub_u32 s54, s54, 4096
TR a[190:191],v15,61440
v_cvt_pk_bf16_f32 v96, v96, v97
MM a[36:39],a[176:179],v[136:139],a[36:39]
s_mov_b64 s[56:57], s[84:85]
TR a[160:161],v16,49152
v_add_f32 v34, v34, v98
MM a[36:39],a[180:183],v[168:171],a[36:39]
s_mov_b64 s[84:85], s[86:87]
v_exp_f32 v99, v99
MM v[68:71],v[26:29],v[64:67],0
s_mov_b64 s[86:87], s[88:89]
v_exp_f32 v100, v100
MM a[40:43],a[176:179],v[144:147],a[40:43]
s_mov_b64 s[88:89], s[90:91]
v_exp_f32 v101, v101
MM a[40:43],a[180:183],v[176:179],a[40:43]
s_cmp_lt_u32 s34, 3
TR a[162:163],v16,53248
v_add_f32 v34, v34, v99
MM a[44:47],a[176:179],v[152:155],a[44:47]
s_cselect_b32 s58, 7340032, 0
TR a[164:165],v16,57344
v_cvt_pk_bf16_f32 v97, v98, v99
MM a[44:47],a[180:183],v[184:187],a[44:47]
s_waitcnt lgkmcnt(5)
v_exp_f32 v102, v102
MM a[48:51],a[184:187],v[128:131],a[48:51]
s_waitcnt lgkmcnt(3)
TR a[166:167],v16,61440
v_add_f32 v34, v34, v100
MM a[48:51],a[188:191],v[160:163],a[48:51]
s_cmp_eq_u32 s34, 3
v_exp_f32 v103, v103
MM a[52:55],a[184:187],v[136:139],a[52:55]
s_cselect_b32 s58, 12582912, s58
TR a[168:169],v17,49152
v_add_f32 v34, v34, v101
MM a[52:55],a[188:191],v[168:171],a[52:55]
s_cselect_b32 s54, s55, s54
TR a[170:171],v17,53248
v_cvt_pk_bf16_f32 v98, v100, v101
MM a[56:59],a[184:187],v[144:147],a[56:59]
s_cmp_eq_u32 s34, 5
v_exp_f32 v72, v72
MM a[56:59],a[188:191],v[176:179],a[56:59]
s_cselect_b64 s[56:57], s[80:81], s[56:57]
v_exp_f32 v73, v73
MM a[60:63],a[184:187],v[152:155],a[60:63]
s_cselect_b32 s58, s82, s58
v_exp_f32 v74, v74
MM a[60:63],a[188:191],v[184:187],a[60:63]
s_waitcnt lgkmcnt(4)
TR a[172:173],v17,57344
v_add_f32 v34, v34, v102
MM a[64:67],a[160:163],v[128:131],a[64:67]
s_waitcnt lgkmcnt(3)
v_add_f32 v34, v34, v103
v_cvt_pk_bf16_f32 v99, v102, v103
MM a[64:67],a[164:167],v[160:163],a[64:67]
s_cselect_b32 s54, s37, s54
TR a[174:175],v17,61440
v_add_f32 v34, v34, v68
MM a[68:71],a[160:163],v[136:139],a[68:71]
s_add_u32 s34, s34, 1
v_exp_f32 v75, v75
MM a[68:71],a[164:167],v[168:171],a[68:71]
TR a[176:177],v18,49152
v_cvt_pk_bf16_f32 v72, v72, v73
MM a[72:75],a[160:163],v[144:147],a[72:75]
v_exp_f32 v76, v76
MM a[72:75],a[164:167],v[176:179],a[72:75]
v_exp_f32 v77, v77
MM a[76:79],a[160:163],v[152:155],a[76:79]
TR a[178:179],v18,53248
v_cvt_pk_bf16_f32 v73, v74, v75
MM a[76:79],a[164:167],v[184:187],a[76:79]
s_waitcnt lgkmcnt(4)
TR a[180:181],v18,57344
v_cvt_pk_bf16_f32 v74, v76, v77
MM a[80:83],a[168:171],v[128:131],a[80:83]
s_waitcnt lgkmcnt(3)
v_exp_f32 v78, v78
MM a[80:83],a[172:175],v[160:163],a[80:83]
TR a[182:183],v18,61440
MM a[84:87],a[168:171],v[136:139],a[84:87]
v_exp_f32 v79, v79
MM a[84:87],a[172:175],v[168:171],a[84:87]
v_exp_f32 v104, v104
MM a[88:91],a[168:171],v[144:147],a[88:91]
TR a[184:185],v19,49152
v_cvt_pk_bf16_f32 v75, v78, v79
MM a[88:91],a[172:175],v[176:179],a[88:91]
v_exp_f32 v105, v105
MM a[92:95],a[168:171],v[152:155],a[92:95]
TR a[186:187],v19,53248
v_add_f32 v35, v104, v105
MM a[92:95],a[172:175],v[184:187],a[92:95]
s_waitcnt lgkmcnt(4)
v_exp_f32 v106, v106
MM a[96:99],a[176:179],v[128:131],a[96:99]
s_waitcnt lgkmcnt(2)
TR a[188:189],v19,57344
v_cvt_pk_bf16_f32 v104, v104, v105
MM a[96:99],a[180:183],v[160:163],a[96:99]
v_exp_f32 v107, v107
MM a[100:103],a[176:179],v[136:139],a[100:103]
TR a[190:191],v19,61440
v_add_f32 v35, v35, v106
MM a[100:103],a[180:183],v[168:171],a[100:103]
v_exp_f32 v108, v108
MM v[76:79],v[26:29],v[72:75],0
v_exp_f32 v109, v109
MM a[104:107],a[176:179],v[144:147],a[104:107]
ds_read_b128 a[128:131], v8 offset:16384
v_add_f32 v35, v35, v107
MM a[104:107],a[180:183],v[176:179],a[104:107]
v_exp_f32 v110, v110
MM a[108:111],a[176:179],v[152:155],a[108:111]
ds_read_b128 a[132:135], v9 offset:16384
v_cvt_pk_bf16_f32 v105, v106, v107
MM a[108:111],a[180:183],v[184:187],a[108:111]
s_waitcnt lgkmcnt(4)
v_exp_f32 v111, v111
MM a[112:115],a[184:187],v[128:131],a[112:115]
s_waitcnt lgkmcnt(2)
buffer_load_dwordx4 v24, s[12:15], s32 offen offset:2048 lds
MM a[112:115],a[188:191],v[160:163],a[112:115]
ds_read_b128 a[136:139], v10 offset:16384
v_add_f32 v35, v35, v108
MM a[116:119],a[184:187],v[136:139],a[116:119]
v_exp_f32 v80, v80
MM a[116:119],a[188:191],v[168:171],a[116:119]
ds_read_b128 a[140:143], v11 offset:16384
v_add_f32 v35, v35, v109
MM a[120:123],a[184:187],v[144:147],a[120:123]
v_exp_f32 v81, v81
MM a[120:123],a[188:191],v[176:179],a[120:123]
v_cvt_pk_bf16_f32 v106, v108, v109
v_add_f32 v35, v35, v110
MM a[124:127],a[184:187],v[152:155],a[124:127]
buffer_load_dwordx4 v25, s[12:15], s32 offen offset:3072 lds
MM a[124:127],a[188:191],v[184:187],a[124:127]
s_add_u32 s32, s32, 16384
v_exp_f32 v82, v82
s_cmp_lt_u32 s34, 7
s_cbranch_scc1 L_attn_kernel_loop
L_attn_kernel_tail:
s_waitcnt lgkmcnt(3)
MM v[128:131],a[128:131],v[192:195],v[48:51]
s_waitcnt lgkmcnt(2)
v_exp_f32 v83, v83
MM v[128:131],a[132:135],v[196:199],v[128:131]
s_waitcnt lgkmcnt(1)
v_exp_f32 v84, v84
MM v[128:131],a[136:139],v[200:203],v[128:131]
s_waitcnt lgkmcnt(0)
v_add_f32 v35, v35, v111
v_cvt_pk_bf16_f32 v107, v110, v111
MM v[128:131],a[140:143],v[204:207],v[128:131]
v_exp_f32 v85, v85
MM v[136:139],a[128:131],v[208:211],v[52:55]
s_lshl_b32 m0, s33, 1
v_exp_f32 v86, v86
MM v[136:139],a[132:135],v[212:215],v[136:139]
s_add_u32 m0, m0, 131072
ds_read_b128 a[144:147], v8 offset:20480
v_add_f32 v35, v35, v76
MM v[136:139],a[136:139],v[216:219],v[136:139]
v_exp_f32 v87, v87
MM v[136:139],a[140:143],v[220:223],v[136:139]
ds_read_b128 a[148:151], v9 offset:20480
v_cvt_pk_bf16_f32 v80, v80, v81
MM v[144:147],a[128:131],v[224:227],v[56:59]
v_exp_f32 v112, v112
MM v[144:147],a[132:135],v[228:231],v[144:147]
ds_read_b128 a[152:155], v10 offset:20480
v_cvt_pk_bf16_f32 v81, v82, v83
MM v[144:147],a[136:139],v[232:235],v[144:147]
ds_read_b128 a[156:159], v11 offset:20480
v_cvt_pk_bf16_f32 v82, v84, v85
MM v[144:147],a[140:143],v[236:239],v[144:147]
v_exp_f32 v113, v113
MM v[152:155],a[128:131],v[240:243],v[60:63]
TR a[160:161],v12,0
v_cvt_pk_bf16_f32 v83, v86, v87
MM v[152:155],a[132:135],v[244:247],v[152:155]
v_exp_f32 v114, v114
MM v[152:155],a[136:139],v[248:251],v[152:155]
v_exp_f32 v115, v115
MM v[152:155],a[140:143],v[252:255],v[152:155]
s_waitcnt lgkmcnt(4)
ds_read_b128 a[128:131], v8 offset:24576
v_add_f32 v36, v112, v113
MM v[132:135],a[144:147],v[192:195],v[48:51]
s_waitcnt lgkmcnt(4)
ds_read_b128 a[132:135], v9 offset:24576
v_cvt_pk_bf16_f32 v112, v112, v113
MM v[132:135],a[148:151],v[196:199],v[132:135]
s_waitcnt lgkmcnt(4)
v_exp_f32 v116, v116
MM v[132:135],a[152:155],v[200:203],v[132:135]
s_waitcnt lgkmcnt(3)
ds_read_b128 a[136:139], v10 offset:24576
v_add_f32 v36, v36, v114
MM v[132:135],a[156:159],v[204:207],v[132:135]
v_exp_f32 v117, v117
MM v[84:87],v[26:29],v[80:83],0
ds_read_b128 a[140:143], v11 offset:24576
v_add_f32 v36, v36, v115
MM v[140:143],a[144:147],v[208:211],v[52:55]
v_exp_f32 v118, v118
MM v[140:143],a[148:151],v[212:215],v[140:143]
v_exp_f32 v119, v119
MM v[140:143],a[152:155],v[216:219],v[140:143]
TR a[162:163],v12,4096
v_cvt_pk_bf16_f32 v113, v114, v115
MM v[140:143],a[156:159],v[220:223],v[140:143]
TR a[164:165],v12,8192
v_add_f32 v36, v36, v116
MM v[148:151],a[144:147],v[224:227],v[56:59]
v_exp_f32 v88, v88
MM v[148:151],a[148:151],v[228:231],v[148:151]
TR a[166:167],v12,12288
v_add_f32 v36, v36, v117
MM v[148:151],a[152:155],v[232:235],v[148:151]
v_exp_f32 v89, v89
MM v[148:151],a[156:159],v[236:239],v[148:151]
v_exp_f32 v90, v90
MM v[156:159],a[144:147],v[240:243],v[60:63]
v_cvt_pk_bf16_f32 v114, v116, v117
v_add_f32 v36, v36, v118
MM v[156:159],a[148:151],v[244:247],v[156:159]
v_exp_f32 v91, v91
MM v[156:159],a[152:155],v[248:251],v[156:159]
v_add_f32 v36, v36, v119
v_cvt_pk_bf16_f32 v115, v118, v119
MM v[156:159],a[156:159],v[252:255],v[156:159]
s_waitcnt lgkmcnt(6)
buffer_load_dwordx4 v33, s[4:7], s29 offen offset:0 lds
MM v[160:163],a[128:131],v[192:195],v[48:51]
s_waitcnt lgkmcnt(5)
v_exp_f32 v92, v92
MM v[160:163],a[132:135],v[196:199],v[160:163]
s_waitcnt lgkmcnt(4)
ds_read_b128 a[144:147], v8 offset:28672
v_add_f32 v36, v36, v84
MM v[160:163],a[136:139],v[200:203],v[160:163]
s_waitcnt lgkmcnt(4)
v_exp_f32 v93, v93
MM v[160:163],a[140:143],v[204:207],v[160:163]
s_add_u32 s29, s29, 392192
ds_read_b128 a[148:151], v9 offset:28672
v_cvt_pk_bf16_f32 v88, v88, v89
MM v[168:171],a[128:131],v[208:211],v[52:55]
buffer_load_dwordx4 v33, s[4:7], s29 offen offset:1024 lds
MM v[168:171],a[132:135],v[212:215],v[168:171]
s_add_u32 s29, s29, 392192
v_exp_f32 v94, v94
MM v[168:171],a[136:139],v[216:219],v[168:171]
ds_read_b128 a[152:155], v10 offset:28672
v_cvt_pk_bf16_f32 v89, v90, v91
MM v[168:171],a[140:143],v[220:223],v[168:171]
v_exp_f32 v95, v95
MM v[176:179],a[128:131],v[224:227],v[56:59]
v_exp_f32 v120, v120
MM v[176:179],a[132:135],v[228:231],v[176:179]
ds_read_b128 a[156:159], v11 offset:28672
v_cvt_pk_bf16_f32 v90, v92, v93
MM v[176:179],a[136:139],v[232:235],v[176:179]
v_exp_f32 v121, v121
MM v[176:179],a[140:143],v[236:239],v[176:179]
v_cvt_pk_bf16_f32 v91, v94, v95
v_add_f32 v37, v120, v121
MM v[184:187],a[128:131],v[240:243],v[60:63]
v_exp_f32 v122, v122
MM v[184:187],a[132:135],v[244:247],v[184:187]
v_exp_f32 v123, v123
MM v[184:187],a[136:139],v[248:251],v[184:187]
v_cvt_pk_bf16_f32 v120, v120, v121
v_add_f32 v37, v37, v122
MM v[184:187],a[140:143],v[252:255],v[184:187]
buffer_load_dwordx4 v33, s[4:7], s29 offen offset:2048 lds
MM v[92:95],v[26:29],v[88:91],0
s_waitcnt lgkmcnt(3)
v_exp_f32 v124, v124
MM v[164:167],a[144:147],v[192:195],v[48:51]
s_waitcnt lgkmcnt(2)
v_exp_f32 v125, v125
MM v[164:167],a[148:151],v[196:199],v[164:167]
s_waitcnt lgkmcnt(1)
TR a[168:169],v13,0
v_add_f32 v37, v37, v123
MM v[164:167],a[152:155],v[200:203],v[164:167]
s_waitcnt lgkmcnt(1)
s_add_u32 s29, s29, 392192
TR a[170:171],v13,4096
v_cvt_pk_bf16_f32 v121, v122, v123
MM v[164:167],a[156:159],v[204:207],v[164:167]
buffer_load_dwordx4 v33, s[4:7], s29 offen offset:3072 lds
MM v[172:175],a[144:147],v[208:211],v[52:55]
s_add_u32 s29, s29, 396288
v_exp_f32 v126, v126
MM v[172:175],a[148:151],v[212:215],v[172:175]
TR a[172:173],v13,8192
v_add_f32 v37, v37, v124
MM v[172:175],a[152:155],v[216:219],v[172:175]
v_exp_f32 v127, v127
MM v[172:175],a[156:159],v[220:223],v[172:175]
TR a[174:175],v13,12288
v_add_f32 v37, v37, v125
MM v[180:183],a[144:147],v[224:227],v[56:59]
MM v[180:183],a[148:151],v[228:231],v[180:183]
v_cvt_pk_bf16_f32 v122, v124, v125
v_add_f32 v37, v37, v126
MM v[180:183],a[152:155],v[232:235],v[180:183]
TR a[176:177],v14,0
v_add_f32 v37, v37, v127
MM v[180:183],a[156:159],v[236:239],v[180:183]
v_cvt_pk_bf16_f32 v123, v126, v127
v_add_f32 v37, v37, v92
MM v[188:191],a[144:147],v[240:243],v[60:63]
TR a[178:179],v14,4096
v_max3_f32 v43, v34, v35, v36
v_max_f32 v43, v43, v37
v_cmp_nge_f32 vcc, s36, v43
MM v[188:191],a[148:151],v[244:247],v[188:191]
s_cbranch_vccnz L_attn_kernel_tr6
L_attn_kernel_tr6r:
v_exp_f32 v128, v128
MM v[188:191],a[152:155],v[248:251],v[188:191]
s_add_u32 s35, s35, 16384
v_add_f32 v38, v38, v34
v_add_f32 v39, v39, v35
MM v[188:191],a[156:159],v[252:255],v[188:191]
s_waitcnt lgkmcnt(8)
v_exp_f32 v129, v129
MM a[0:3],a[160:163],v[64:67],a[0:3]
s_waitcnt lgkmcnt(6)
v_cvt_pk_bf16_f32 v128, v128, v129
v_add_f32 v40, v40, v36
MM a[0:3],a[164:167],v[96:99],a[0:3]
s_waitcnt vmcnt(12)
v_exp_f32 v130, v130
MM a[4:7],a[160:163],v[72:75],a[4:7]
s_barrier
v_exp_f32 v131, v131
MM a[4:7],a[164:167],v[104:107],a[4:7]
s_add_u32 m0, s33, 114688
v_exp_f32 v132, v132
MM a[8:11],a[160:163],v[80:83],a[8:11]
TR a[180:181],v14,8192
v_cvt_pk_bf16_f32 v129, v130, v131
MM a[8:11],a[164:167],v[112:115],a[8:11]
TR a[182:183],v14,12288
v_add_f32 v41, v41, v37
MM a[12:15],a[160:163],v[88:91],a[12:15]
v_exp_f32 v133, v133
MM a[12:15],a[164:167],v[120:123],a[12:15]
s_waitcnt lgkmcnt(6)
TR a[184:185],v15,0
v_cvt_pk_bf16_f32 v130, v132, v133
MM a[16:19],a[168:171],v[64:67],a[16:19]
s_waitcnt lgkmcnt(5)
buffer_load_dwordx4 v24, s[12:15], s32 offen offset:0 lds
MM a[16:19],a[172:175],v[96:99],a[16:19]
v_exp_f32 v134, v134
MM a[20:23],a[168:171],v[72:75],a[20:23]
v_exp_f32 v135, v135
MM a[20:23],a[172:175],v[104:107],a[20:23]
v_exp_f32 v160, v160
MM a[24:27],a[168:171],v[80:83],a[24:27]
TR a[186:187],v15,4096
v_cvt_pk_bf16_f32 v131, v134, v135
MM a[24:27],a[172:175],v[112:115],a[24:27]
buffer_load_dwordx4 v25, s[12:15], s32 offen offset:1024 lds
MM a[28:31],a[168:171],v[88:91],a[28:31]
v_exp_f32 v161, v161
MM a[28:31],a[172:175],v[120:123],a[28:31]
s_waitcnt lgkmcnt(4)
v_exp_f32 v162, v162
MM a[32:35],a[176:179],v[64:67],a[32:35]
s_waitcnt lgkmcnt(2)
TR a[188:189],v15,8192
v_add_f32 v34, v160, v161
MM a[32:35],a[180:183],v[96:99],a[32:35]
TR a[190:191],v15,12288
v_cvt_pk_bf16_f32 v160, v160, v161
MM a[36:39],a[176:179],v[72:75],a[36:39]
TR a[160:161],v16,0
v_add_f32 v34, v34, v162
MM a[36:39],a[180:183],v[104:107],a[36:39]
v_exp_f32 v163, v163
MM v[132:135],v[26:29],v[128:131],0
v_exp_f32 v164, v164
MM a[40:43],a[176:179],v[80:83],a[40:43]
v_exp_f32 v165, v165
MM a[40:43],a[180:183],v[112:115],a[40:43]
TR a[162:163],v16,4096
v_add_f32 v34, v34, v163
MM a[44:47],a[176:179],v[88:91],a[44:47]
TR a[164:165],v16,8192
v_cvt_pk_bf16_f32 v161, v162, v163
MM a[44:47],a[180:183],v[120:123],a[44:47]
s_waitcnt lgkmcnt(5)
v_exp_f32 v166, v166
MM a[48:51],a[184:187],v[64:67],a[48:51]
s_waitcnt lgkmcnt(3)
TR a[166:167],v16,12288
v_add_f32 v34, v34, v164
MM a[48:51],a[188:191],v[96:99],a[48:51]
v_exp_f32 v167, v167
MM a[52:55],a[184:187],v[72:75],a[52:55]
TR a[168:169],v17,0
v_add_f32 v34, v34, v165
MM a[52:55],a[188:191],v[104:107],a[52:55]
TR a[170:171],v17,4096
v_cvt_pk_bf16_f32 v162, v164, v165
MM a[56:59],a[184:187],v[80:83],a[56:59]
v_exp_f32 v136, v136
MM a[56:59],a[188:191],v[112:115],a[56:59]
v_exp_f32 v137, v137
MM a[60:63],a[184:187],v[88:91],a[60:63]
v_exp_f32 v138, v138
MM a[60:63],a[188:191],v[120:123],a[60:63]
s_waitcnt lgkmcnt(4)
TR a[172:173],v17,8192
v_add_f32 v34, v34, v166
MM a[64:67],a[160:163],v[64:67],a[64:67]
s_waitcnt lgkmcnt(3)
v_add_f32 v34, v34, v167
v_cvt_pk_bf16_f32 v163, v166, v167
MM a[64:67],a[164:167],v[96:99],a[64:67]
TR a[174:175],v17,12288
v_add_f32 v34, v34, v132
MM a[68:71],a[160:163],v[72:75],a[68:71]
v_exp_f32 v139, v139
MM a[68:71],a[164:167],v[104:107],a[68:71]
TR a[176:177],v18,0
v_cvt_pk_bf16_f32 v136, v136, v137
MM a[72:75],a[160:163],v[80:83],a[72:75]
v_exp_f32 v140, v140
MM a[72:75],a[164:167],v[112:115],a[72:75]
v_exp_f32 v141, v141
MM a[76:79],a[160:163],v[88:91],a[76:79]
TR a[178:179],v18,4096
v_cvt_pk_bf16_f32 v137, v138, v139
MM a[76:79],a[164:167],v[120:123],a[76:79]
s_waitcnt lgkmcnt(4)
TR a[180:181],v18,8192
v_cvt_pk_bf16_f32 v138, v140, v141
MM a[80:83],a[168:171],v[64:67],a[80:83]
s_waitcnt lgkmcnt(3)
v_exp_f32 v142, v142
MM a[80:83],a[172:175],v[96:99],a[80:83]
TR a[182:183],v18,12288
MM a[84:87],a[168:171],v[72:75],a[84:87]
v_exp_f32 v143, v143
MM a[84:87],a[172:175],v[104:107],a[84:87]
v_exp_f32 v168, v168
MM a[88:91],a[168:171],v[80:83],a[88:91]
TR a[184:185],v19,0
v_cvt_pk_bf16_f32 v139, v142, v143
MM a[88:91],a[172:175],v[112:115],a[88:91]
v_exp_f32 v169, v169
MM a[92:95],a[168:171],v[88:91],a[92:95]
TR a[186:187],v19,4096
v_add_f32 v35, v168, v169
MM a[92:95],a[172:175],v[120:123],a[92:95]
s_waitcnt lgkmcnt(4)
v_exp_f32 v170, v170
MM a[96:99],a[176:179],v[64:67],a[96:99]
s_waitcnt lgkmcnt(2)
TR a[188:189],v19,8192
v_cvt_pk_bf16_f32 v168, v168, v169
MM a[96:99],a[180:183],v[96:99],a[96:99]
v_exp_f32 v171, v171
MM a[100:103],a[176:179],v[72:75],a[100:103]
TR a[190:191],v19,12288
v_add_f32 v35, v35, v170
MM a[100:103],a[180:183],v[104:107],a[100:103]
v_exp_f32 v172, v172
MM v[140:143],v[26:29],v[136:139],0
v_exp_f32 v173, v173
MM a[104:107],a[176:179],v[80:83],a[104:107]
ds_read_b128 a[128:131], v8 offset:32768
v_add_f32 v35, v35, v171
MM a[104:107],a[180:183],v[112:115],a[104:107]
v_exp_f32 v174, v174
MM a[108:111],a[176:179],v[88:91],a[108:111]
ds_read_b128 a[132:135], v9 offset:32768
v_cvt_pk_bf16_f32 v169, v170, v171
MM a[108:111],a[180:183],v[120:123],a[108:111]
s_waitcnt lgkmcnt(4)
v_exp_f32 v175, v175
MM a[112:115],a[184:187],v[64:67],a[112:115]
s_waitcnt lgkmcnt(2)
buffer_load_dwordx4 v24, s[12:15], s32 offen offset:2048 lds
MM a[112:115],a[188:191],v[96:99],a[112:115]
ds_read_b128 a[136:139], v10 offset:32768
v_add_f32 v35, v35, v172
MM a[116:119],a[184:187],v[72:75],a[116:119]
v_exp_f32 v144, v144
MM a[116:119],a[188:191],v[104:107],a[116:119]
ds_read_b128 a[140:143], v11 offset:32768
v_add_f32 v35, v35, v173
MM a[120:123],a[184:187],v[80:83],a[120:123]
v_exp_f32 v145, v145
MM a[120:123],a[188:191],v[112:115],a[120:123]
v_cvt_pk_bf16_f32 v170, v172, v173
v_add_f32 v35, v35, v174
MM a[124:127],a[184:187],v[88:91],a[124:127]
buffer_load_dwordx4 v25, s[12:15], s32 offen offset:3072 lds
MM a[124:127],a[188:191],v[120:123],a[124:127]
s_waitcnt lgkmcnt(3)
s_add_u32 s32, s32, 16384
v_exp_f32 v146, v146
MM v[64:67],a[128:131],v[192:195],v[48:51]
s_waitcnt lgkmcnt(2)
v_exp_f32 v147, v147
MM v[64:67],a[132:135],v[196:199],v[64:67]
s_waitcnt lgkmcnt(1)
v_exp_f32 v148, v148
MM v[64:67],a[136:139],v[200:203],v[64:67]
s_waitcnt lgkmcnt(0)
v_add_f32 v35, v35, v175
v_cvt_pk_bf16_f32 v171, v174, v175
MM v[64:67],a[140:143],v[204:207],v[64:67]
v_exp_f32 v149, v149
MM v[72:75],a[128:131],v[208:211],v[52:55]
s_lshl_b32 m0, s33, 1
v_exp_f32 v150, v150
MM v[72:75],a[132:135],v[212:215],v[72:75]
s_add_u32 m0, m0, 135168
ds_read_b128 a[144:147], v8 offset:36864
v_add_f32 v35, v35, v140
MM v[72:75],a[136:139],v[216:219],v[72:75]
v_exp_f32 v151, v151
MM v[72:75],a[140:143],v[220:223],v[72:75]
ds_read_b128 a[148:151], v9 offset:36864
v_cvt_pk_bf16_f32 v144, v144, v145
MM v[80:83],a[128:131],v[224:227],v[56:59]
v_exp_f32 v176, v176
MM v[80:83],a[132:135],v[228:231],v[80:83]
ds_read_b128 a[152:155], v10 offset:36864
v_cvt_pk_bf16_f32 v145, v146, v147
MM v[80:83],a[136:139],v[232:235],v[80:83]
ds_read_b128 a[156:159], v11 offset:36864
v_cvt_pk_bf16_f32 v146, v148, v149
MM v[80:83],a[140:143],v[236:239],v[80:83]
v_exp_f32 v177, v177
MM v[88:91],a[128:131],v[240:243],v[60:63]
TR a[160:161],v12,16384
v_cvt_pk_bf16_f32 v147, v150, v151
MM v[88:91],a[132:135],v[244:247],v[88:91]
v_exp_f32 v178, v178
MM v[88:91],a[136:139],v[248:251],v[88:91]
v_exp_f32 v179, v179
MM v[88:91],a[140:143],v[252:255],v[88:91]
s_waitcnt lgkmcnt(4)
ds_read_b128 a[128:131], v8 offset:40960
v_add_f32 v36, v176, v177
MM v[68:71],a[144:147],v[192:195],v[48:51]
s_waitcnt lgkmcnt(4)
ds_read_b128 a[132:135], v9 offset:40960
v_cvt_pk_bf16_f32 v176, v176, v177
MM v[68:71],a[148:151],v[196:199],v[68:71]
s_waitcnt lgkmcnt(4)
v_exp_f32 v180, v180
MM v[68:71],a[152:155],v[200:203],v[68:71]
s_waitcnt lgkmcnt(3)
ds_read_b128 a[136:139], v10 offset:40960
v_add_f32 v36, v36, v178
MM v[68:71],a[156:159],v[204:207],v[68:71]
v_exp_f32 v181, v181
MM v[148:151],v[26:29],v[144:147],0
ds_read_b128 a[140:143], v11 offset:40960
v_add_f32 v36, v36, v179
MM v[76:79],a[144:147],v[208:211],v[52:55]
v_exp_f32 v182, v182
MM v[76:79],a[148:151],v[212:215],v[76:79]
v_exp_f32 v183, v183
MM v[76:79],a[152:155],v[216:219],v[76:79]
TR a[162:163],v12,20480
v_cvt_pk_bf16_f32 v177, v178, v179
MM v[76:79],a[156:159],v[220:223],v[76:79]
TR a[164:165],v12,24576
v_add_f32 v36, v36, v180
MM v[84:87],a[144:147],v[224:227],v[56:59]
v_exp_f32 v152, v152
MM v[84:87],a[148:151],v[228:231],v[84:87]
TR a[166:167],v12,28672
v_add_f32 v36, v36, v181
MM v[84:87],a[152:155],v[232:235],v[84:87]
v_exp_f32 v153, v153
MM v[84:87],a[156:159],v[236:239],v[84:87]
v_exp_f32 v154, v154
MM v[92:95],a[144:147],v[240:243],v[60:63]
v_cvt_pk_bf16_f32 v178, v180, v181
v_add_f32 v36, v36, v182
MM v[92:95],a[148:151],v[244:247],v[92:95]
v_exp_f32 v155, v155
MM v[92:95],a[152:155],v[248:251],v[92:95]
v_add_f32 v36, v36, v183
v_cvt_pk_bf16_f32 v179, v182, v183
MM v[92:95],a[156:159],v[252:255],v[92:95]
s_waitcnt lgkmcnt(6)
buffer_load_dwordx4 v33, s[4:7], s29 offen offset:0 lds
MM v[96:99],a[128:131],v[192:195],v[48:51]
s_waitcnt lgkmcnt(5)
v_exp_f32 v156, v156
MM v[96:99],a[132:135],v[196:199],v[96:99]
s_waitcnt lgkmcnt(4)
ds_read_b128 a[144:147], v8 offset:45056
v_add_f32 v36, v36, v148
MM v[96:99],a[136:139],v[200:203],v[96:99]
s_waitcnt lgkmcnt(4)
v_exp_f32 v157, v157
MM v[96:99],a[140:143],v[204:207],v[96:99]
s_add_u32 s29, s29, 392192
ds_read_b128 a[148:151], v9 offset:45056
v_cvt_pk_bf16_f32 v152, v152, v153
MM v[104:107],a[128:131],v[208:211],v[52:55]
buffer_load_dwordx4 v33, s[4:7], s29 offen offset:1024 lds
MM v[104:107],a[132:135],v[212:215],v[104:107]
s_add_u32 s29, s29, 392192
v_exp_f32 v158, v158
MM v[104:107],a[136:139],v[216:219],v[104:107]
ds_read_b128 a[152:155], v10 offset:45056
v_cvt_pk_bf16_f32 v153, v154, v155
MM v[104:107],a[140:143],v[220:223],v[104:107]
v_exp_f32 v159, v159
MM v[112:115],a[128:131],v[224:227],v[56:59]
v_exp_f32 v184, v184
MM v[112:115],a[132:135],v[228:231],v[112:115]
ds_read_b128 a[156:159], v11 offset:45056
v_cvt_pk_bf16_f32 v154, v156, v157
MM v[112:115],a[136:139],v[232:235],v[112:115]
v_exp_f32 v185, v185
MM v[112:115],a[140:143],v[236:239],v[112:115]
v_cvt_pk_bf16_f32 v155, v158, v159
v_add_f32 v37, v184, v185
MM v[120:123],a[128:131],v[240:243],v[60:63]
v_exp_f32 v186, v186
MM v[120:123],a[132:135],v[244:247],v[120:123]
v_exp_f32 v187, v187
MM v[120:123],a[136:139],v[248:251],v[120:123]
v_cvt_pk_bf16_f32 v184, v184, v185
v_add_f32 v37, v37, v186
MM v[120:123],a[140:143],v[252:255],v[120:123]
buffer_load_dwordx4 v33, s[4:7], s29 offen offset:2048 lds
MM v[156:159],v[26:29],v[152:155],0
s_waitcnt lgkmcnt(3)
v_exp_f32 v188, v188
MM v[100:103],a[144:147],v[192:195],v[48:51]
s_waitcnt lgkmcnt(2)
v_exp_f32 v189, v189
MM v[100:103],a[148:151],v[196:199],v[100:103]
s_waitcnt lgkmcnt(1)
TR a[168:169],v13,16384
v_add_f32 v37, v37, v187
MM v[100:103],a[152:155],v[200:203],v[100:103]
s_waitcnt lgkmcnt(1)
s_add_u32 s29, s29, 392192
TR a[170:171],v13,20480
v_cvt_pk_bf16_f32 v185, v186, v187
MM v[100:103],a[156:159],v[204:207],v[100:103]
buffer_load_dwordx4 v33, s[4:7], s29 offen offset:3072 lds
MM v[108:111],a[144:147],v[208:211],v[52:55]
s_add_u32 s29, s29, 396288
v_exp_f32 v190, v190
MM v[108:111],a[148:151],v[212:215],v[108:111]
TR a[172:173],v13,24576
v_add_f32 v37, v37, v188
MM v[108:111],a[152:155],v[216:219],v[108:111]
v_exp_f32 v191, v191
MM v[108:111],a[156:159],v[220:223],v[108:111]
TR a[174:175],v13,28672
v_add_f32 v37, v37, v189
MM v[116:119],a[144:147],v[224:227],v[56:59]
MM v[116:119],a[148:151],v[228:231],v[116:119]
v_cvt_pk_bf16_f32 v186, v188, v189
v_add_f32 v37, v37, v190
MM v[116:119],a[152:155],v[232:235],v[116:119]
TR a[176:177],v14,16384
v_add_f32 v37, v37, v191
MM v[116:119],a[156:159],v[236:239],v[116:119]
v_cvt_pk_bf16_f32 v187, v190, v191
v_add_f32 v37, v37, v156
MM v[124:127],a[144:147],v[240:243],v[60:63]
TR a[178:179],v14,20480
v_max3_f32 v43, v34, v35, v36
v_max_f32 v43, v43, v37
v_cmp_nge_f32 vcc, s36, v43
MM v[124:127],a[148:151],v[244:247],v[124:127]
s_cbranch_vccnz L_attn_kernel_tr7
L_attn_kernel_tr7r:
v_exp_f32 v64, v64
MM v[124:127],a[152:155],v[248:251],v[124:127]
s_add_u32 s35, s35, 16384
v_add_f32 v38, v38, v34
v_add_f32 v39, v39, v35
MM v[124:127],a[156:159],v[252:255],v[124:127]
s_waitcnt lgkmcnt(8)
v_exp_f32 v65, v65
MM a[0:3],a[160:163],v[128:131],a[0:3]
s_waitcnt lgkmcnt(6)
v_cvt_pk_bf16_f32 v64, v64, v65
v_add_f32 v40, v40, v36
MM a[0:3],a[164:167],v[160:163],a[0:3]
s_waitcnt vmcnt(12)
v_exp_f32 v66, v66
MM a[4:7],a[160:163],v[136:139],a[4:7]
s_barrier
v_exp_f32 v67, v67
MM a[4:7],a[164:167],v[168:171],a[4:7]
v_exp_f32 v68, v68
MM a[8:11],a[160:163],v[144:147],a[8:11]
TR a[180:181],v14,24576
v_cvt_pk_bf16_f32 v65, v66, v67
MM a[8:11],a[164:167],v[176:179],a[8:11]
TR a[182:183],v14,28672
v_add_f32 v41, v41, v37
MM a[12:15],a[160:163],v[152:155],a[12:15]
v_exp_f32 v69, v69
MM a[12:15],a[164:167],v[184:187],a[12:15]
s_waitcnt lgkmcnt(6)
TR a[184:185],v15,16384
v_cvt_pk_bf16_f32 v66, v68, v69
MM a[16:19],a[168:171],v[128:131],a[16:19]
s_waitcnt lgkmcnt(5)
MM a[16:19],a[172:175],v[160:163],a[16:19]
v_exp_f32 v70, v70
MM a[20:23],a[168:171],v[136:139],a[20:23]
v_exp_f32 v71, v71
MM a[20:23],a[172:175],v[168:171],a[20:23]
v_exp_f32 v96, v96
MM a[24:27],a[168:171],v[144:147],a[24:27]
TR a[186:187],v15,20480
v_cvt_pk_bf16_f32 v67, v70, v71
MM a[24:27],a[172:175],v[176:179],a[24:27]
MM a[28:31],a[168:171],v[152:155],a[28:31]
v_exp_f32 v97, v97
MM a[28:31],a[172:175],v[184:187],a[28:31]
s_waitcnt lgkmcnt(4)
v_exp_f32 v98, v98
MM a[32:35],a[176:179],v[128:131],a[32:35]
s_waitcnt lgkmcnt(2)
TR a[188:189],v15,24576
v_add_f32 v34, v96, v97
MM a[32:35],a[180:183],v[160:163],a[32:35]
TR a[190:191],v15,28672
v_cvt_pk_bf16_f32 v96, v96, v97
MM a[36:39],a[176:179],v[136:139],a[36:39]
TR a[160:161],v16,16384
v_add_f32 v34, v34, v98
MM a[36:39],a[180:183],v[168:171],a[36:39]
v_exp_f32 v99, v99
MM v[68:71],v[26:29],v[64:67],0
v_exp_f32 v100, v100
MM a[40:43],a[176:179],v[144:147],a[40:43]
v_exp_f32 v101, v101
MM a[40:43],a[180:183],v[176:179],a[40:43]
TR a[162:163],v16,20480
v_add_f32 v34, v34, v99
MM a[44:47],a[176:179],v[152:155],a[44:47]
TR a[164:165],v16,24576
v_cvt_pk_bf16_f32 v97, v98, v99
MM a[44:47],a[180:183],v[184:187],a[44:47]
s_waitcnt lgkmcnt(5)
v_exp_f32 v102, v102
MM a[48:51],a[184:187],v[128:131],a[48:51]
s_waitcnt lgkmcnt(3)
TR a[166:167],v16,28672
v_add_f32 v34, v34, v100
MM a[48:51],a[188:191],v[160:163],a[48:51]
v_exp_f32 v103, v103
MM a[52:55],a[184:187],v[136:139],a[52:55]
TR a[168:169],v17,16384
v_add_f32 v34, v34, v101
MM a[52:55],a[188:191],v[168:171],a[52:55]
TR a[170:171],v17,20480
v_cvt_pk_bf16_f32 v98, v100, v101
MM a[56:59],a[184:187],v[144:147],a[56:59]
v_exp_f32 v72, v72
MM a[56:59],a[188:191],v[176:179],a[56:59]
v_exp_f32 v73, v73
MM a[60:63],a[184:187],v[152:155],a[60:63]
v_exp_f32 v74, v74
MM a[60:63],a[188:191],v[184:187],a[60:63]
s_waitcnt lgkmcnt(4)
TR a[172:173],v17,24576
v_add_f32 v34, v34, v102
MM a[64:67],a[160:163],v[128:131],a[64:67]
s_waitcnt lgkmcnt(3)
v_add_f32 v34, v34, v103
v_cvt_pk_bf16_f32 v99, v102, v103
MM a[64:67],a[164:167],v[160:163],a[64:67]
TR a[174:175],v17,28672
v_add_f32 v34, v34, v68
MM a[68:71],a[160:163],v[136:139],a[68:71]
v_exp_f32 v75, v75
MM a[68:71],a[164:167],v[168:171],a[68:71]
TR a[176:177],v18,16384
v_cvt_pk_bf16_f32 v72, v72, v73
MM a[72:75],a[160:163],v[144:147],a[72:75]
v_exp_f32 v76, v76
MM a[72:75],a[164:167],v[176:179],a[72:75]
v_exp_f32 v77, v77
MM a[76:79],a[160:163],v[152:155],a[76:79]
TR a[178:179],v18,20480
v_cvt_pk_bf16_f32 v73, v74, v75
MM a[76:79],a[164:167],v[184:187],a[76:79]
s_waitcnt lgkmcnt(4)
TR a[180:181],v18,24576
v_cvt_pk_bf16_f32 v74, v76, v77
MM a[80:83],a[168:171],v[128:131],a[80:83]
s_waitcnt lgkmcnt(3)
v_exp_f32 v78, v78
MM a[80:83],a[172:175],v[160:163],a[80:83]
TR a[182:183],v18,28672
MM a[84:87],a[168:171],v[136:139],a[84:87]
v_exp_f32 v79, v79
MM a[84:87],a[172:175],v[168:171],a[84:87]
v_exp_f32 v104, v104
MM a[88:91],a[168:171],v[144:147],a[88:91]
TR a[184:185],v19,16384
v_cvt_pk_bf16_f32 v75, v78, v79
MM a[88:91],a[172:175],v[176:179],a[88:91]
v_exp_f32 v105, v105
MM a[92:95],a[168:171],v[152:155],a[92:95]
TR a[186:187],v19,20480
v_add_f32 v35, v104, v105
MM a[92:95],a[172:175],v[184:187],a[92:95]
s_waitcnt lgkmcnt(4)
v_exp_f32 v106, v106
MM a[96:99],a[176:179],v[128:131],a[96:99]
s_waitcnt lgkmcnt(2)
TR a[188:189],v19,24576
v_cvt_pk_bf16_f32 v104, v104, v105
MM a[96:99],a[180:183],v[160:163],a[96:99]
v_exp_f32 v107, v107
MM a[100:103],a[176:179],v[136:139],a[100:103]
TR a[190:191],v19,28672
v_add_f32 v35, v35, v106
MM a[100:103],a[180:183],v[168:171],a[100:103]
v_exp_f32 v108, v108
MM v[76:79],v[26:29],v[72:75],0
v_exp_f32 v109, v109
MM a[104:107],a[176:179],v[144:147],a[104:107]
ds_read_b128 a[128:131], v8 offset:49152
v_add_f32 v35, v35, v107
MM a[104:107],a[180:183],v[176:179],a[104:107]
v_exp_f32 v110, v110
MM a[108:111],a[176:179],v[152:155],a[108:111]
ds_read_b128 a[132:135], v9 offset:49152
v_cvt_pk_bf16_f32 v105, v106, v107
MM a[108:111],a[180:183],v[184:187],a[108:111]
s_waitcnt lgkmcnt(4)
v_exp_f32 v111, v111
MM a[112:115],a[184:187],v[128:131],a[112:115]
s_waitcnt lgkmcnt(2)
MM a[112:115],a[188:191],v[160:163],a[112:115]
ds_read_b128 a[136:139], v10 offset:49152
v_add_f32 v35, v35, v108
MM a[116:119],a[184:187],v[136:139],a[116:119]
v_exp_f32 v80, v80
MM a[116:119],a[188:191],v[168:171],a[116:119]
ds_read_b128 a[140:143], v11 offset:49152
v_add_f32 v35, v35, v109
MM a[120:123],a[184:187],v[144:147],a[120:123]
v_exp_f32 v81, v81
MM a[120:123],a[188:191],v[176:179],a[120:123]
v_cvt_pk_bf16_f32 v106, v108, v109
v_add_f32 v35, v35, v110
MM a[124:127],a[184:187],v[152:155],a[124:127]
MM a[124:127],a[188:191],v[184:187],a[124:127]
s_waitcnt lgkmcnt(3)
v_exp_f32 v82, v82
MM v[128:131],a[128:131],v[192:195],v[48:51]
s_waitcnt lgkmcnt(2)
v_exp_f32 v83, v83
MM v[128:131],a[132:135],v[196:199],v[128:131]
s_waitcnt lgkmcnt(1)
v_exp_f32 v84, v84
MM v[128:131],a[136:139],v[200:203],v[128:131]
s_waitcnt lgkmcnt(0)
v_add_f32 v35, v35, v111
v_cvt_pk_bf16_f32 v107, v110, v111
MM v[128:131],a[140:143],v[204:207],v[128:131]
v_exp_f32 v85, v85
MM v[136:139],a[128:131],v[208:211],v[52:55]
v_exp_f32 v86, v86
MM v[136:139],a[132:135],v[212:215],v[136:139]
ds_read_b128 a[144:147], v8 offset:53248
v_add_f32 v35, v35, v76
MM v[136:139],a[136:139],v[216:219],v[136:139]
v_exp_f32 v87, v87
MM v[136:139],a[140:143],v[220:223],v[136:139]
ds_read_b128 a[148:151], v9 offset:53248
v_cvt_pk_bf16_f32 v80, v80, v81
MM v[144:147],a[128:131],v[224:227],v[56:59]
v_exp_f32 v112, v112
MM v[144:147],a[132:135],v[228:231],v[144:147]
ds_read_b128 a[152:155], v10 offset:53248
v_cvt_pk_bf16_f32 v81, v82, v83
MM v[144:147],a[136:139],v[232:235],v[144:147]
ds_read_b128 a[156:159], v11 offset:53248
v_cvt_pk_bf16_f32 v82, v84, v85
MM v[144:147],a[140:143],v[236:239],v[144:147]
v_exp_f32 v113, v113
MM v[152:155],a[128:131],v[240:243],v[60:63]
TR a[160:161],v12,32768
v_cvt_pk_bf16_f32 v83, v86, v87
MM v[152:155],a[132:135],v[244:247],v[152:155]
v_exp_f32 v114, v114
MM v[152:155],a[136:139],v[248:251],v[152:155]
v_exp_f32 v115, v115
MM v[152:155],a[140:143],v[252:255],v[152:155]
s_waitcnt lgkmcnt(4)
ds_read_b128 a[128:131], v8 offset:57344
v_add_f32 v36, v112, v113
MM v[132:135],a[144:147],v[192:195],v[48:51]
s_waitcnt lgkmcnt(4)
ds_read_b128 a[132:135], v9 offset:57344
v_cvt_pk_bf16_f32 v112, v112, v113
MM v[132:135],a[148:151],v[196:199],v[132:135]
s_waitcnt lgkmcnt(4)
v_exp_f32 v116, v116
MM v[132:135],a[152:155],v[200:203],v[132:135]
s_waitcnt lgkmcnt(3)
ds_read_b128 a[136:139], v10 offset:57344
v_add_f32 v36, v36, v114
MM v[132:135],a[156:159],v[204:207],v[132:135]
v_exp_f32 v117, v117
MM v[84:87],v[26:29],v[80:83],0
ds_read_b128 a[140:143], v11 offset:57344
v_add_f32 v36, v36, v115
MM v[140:143],a[144:147],v[208:211],v[52:55]
v_exp_f32 v118, v118
MM v[140:143],a[148:151],v[212:215],v[140:143]
v_exp_f32 v119, v119
MM v[140:143],a[152:155],v[216:219],v[140:143]
TR a[162:163],v12,36864
v_cvt_pk_bf16_f32 v113, v114, v115
MM v[140:143],a[156:159],v[220:223],v[140:143]
TR a[164:165],v12,40960
v_add_f32 v36, v36, v116
MM v[148:151],a[144:147],v[224:227],v[56:59]
v_exp_f32 v88, v88
MM v[148:151],a[148:151],v[228:231],v[148:151]
TR a[166:167],v12,45056
v_add_f32 v36, v36, v117
MM v[148:151],a[152:155],v[232:235],v[148:151]
v_exp_f32 v89, v89
MM v[148:151],a[156:159],v[236:239],v[148:151]
v_exp_f32 v90, v90
MM v[156:159],a[144:147],v[240:243],v[60:63]
v_cvt_pk_bf16_f32 v114, v116, v117
v_add_f32 v36, v36, v118
MM v[156:159],a[148:151],v[244:247],v[156:159]
v_exp_f32 v91, v91
MM v[156:159],a[152:155],v[248:251],v[156:159]
v_add_f32 v36, v36, v119
v_cvt_pk_bf16_f32 v115, v118, v119
MM v[156:159],a[156:159],v[252:255],v[156:159]
s_waitcnt lgkmcnt(6)
MM v[160:163],a[128:131],v[192:195],v[48:51]
s_waitcnt lgkmcnt(5)
v_exp_f32 v92, v92
MM v[160:163],a[132:135],v[196:199],v[160:163]
s_waitcnt lgkmcnt(4)
ds_read_b128 a[144:147], v8 offset:61440
v_add_f32 v36, v36, v84
MM v[160:163],a[136:139],v[200:203],v[160:163]
s_waitcnt lgkmcnt(4)
v_exp_f32 v93, v93
MM v[160:163],a[140:143],v[204:207],v[160:163]
ds_read_b128 a[148:151], v9 offset:61440
v_cvt_pk_bf16_f32 v88, v88, v89
MM v[168:171],a[128:131],v[208:211],v[52:55]
MM v[168:171],a[132:135],v[212:215],v[168:171]
v_exp_f32 v94, v94
MM v[168:171],a[136:139],v[216:219],v[168:171]
ds_read_b128 a[152:155], v10 offset:61440
v_cvt_pk_bf16_f32 v89, v90, v91
MM v[168:171],a[140:143],v[220:223],v[168:171]
v_exp_f32 v95, v95
MM v[176:179],a[128:131],v[224:227],v[56:59]
v_exp_f32 v120, v120
MM v[176:179],a[132:135],v[228:231],v[176:179]
ds_read_b128 a[156:159], v11 offset:61440
v_cvt_pk_bf16_f32 v90, v92, v93
MM v[176:179],a[136:139],v[232:235],v[176:179]
v_exp_f32 v121, v121
MM v[176:179],a[140:143],v[236:239],v[176:179]
v_cvt_pk_bf16_f32 v91, v94, v95
v_add_f32 v37, v120, v121
MM v[184:187],a[128:131],v[240:243],v[60:63]
v_exp_f32 v122, v122
MM v[184:187],a[132:135],v[244:247],v[184:187]
v_exp_f32 v123, v123
MM v[184:187],a[136:139],v[248:251],v[184:187]
v_cvt_pk_bf16_f32 v120, v120, v121
v_add_f32 v37, v37, v122
MM v[184:187],a[140:143],v[252:255],v[184:187]
MM v[92:95],v[26:29],v[88:91],0
s_waitcnt lgkmcnt(3)
v_exp_f32 v124, v124
MM v[164:167],a[144:147],v[192:195],v[48:51]
s_waitcnt lgkmcnt(2)
v_exp_f32 v125, v125
MM v[164:167],a[148:151],v[196:199],v[164:167]
s_waitcnt lgkmcnt(1)
TR a[168:169],v13,32768
v_add_f32 v37, v37, v123
MM v[164:167],a[152:155],v[200:203],v[164:167]
s_waitcnt lgkmcnt(1)
TR a[170:171],v13,36864
v_cvt_pk_bf16_f32 v121, v122, v123
MM v[164:167],a[156:159],v[204:207],v[164:167]
MM v[172:175],a[144:147],v[208:211],v[52:55]
v_exp_f32 v126, v126
MM v[172:175],a[148:151],v[212:215],v[172:175]
TR a[172:173],v13,40960
v_add_f32 v37, v37, v124
MM v[172:175],a[152:155],v[216:219],v[172:175]
v_exp_f32 v127, v127
MM v[172:175],a[156:159],v[220:223],v[172:175]
TR a[174:175],v13,45056
v_add_f32 v37, v37, v125
MM v[180:183],a[144:147],v[224:227],v[56:59]
MM v[180:183],a[148:151],v[228:231],v[180:183]
v_cvt_pk_bf16_f32 v122, v124, v125
v_add_f32 v37, v37, v126
MM v[180:183],a[152:155],v[232:235],v[180:183]
TR a[176:177],v14,32768
v_add_f32 v37, v37, v127
MM v[180:183],a[156:159],v[236:239],v[180:183]
v_cvt_pk_bf16_f32 v123, v126, v127
v_add_f32 v37, v37, v92
MM v[188:191],a[144:147],v[240:243],v[60:63]
TR a[178:179],v14,36864
v_max3_f32 v43, v34, v35, v36
v_max_f32 v43, v43, v37
v_cmp_nge_f32 vcc, s36, v43
MM v[188:191],a[148:151],v[244:247],v[188:191]
s_cbranch_vccnz L_attn_kernel_tr8
L_attn_kernel_tr8r:
v_exp_f32 v128, v128
MM v[188:191],a[152:155],v[248:251],v[188:191]
s_add_u32 s35, s35, 16384
v_add_f32 v38, v38, v34
v_add_f32 v39, v39, v35
MM v[188:191],a[156:159],v[252:255],v[188:191]
s_waitcnt lgkmcnt(8)
v_exp_f32 v129, v129
MM a[0:3],a[160:163],v[64:67],a[0:3]
s_waitcnt lgkmcnt(6)
v_cvt_pk_bf16_f32 v128, v128, v129
v_add_f32 v40, v40, v36
MM a[0:3],a[164:167],v[96:99],a[0:3]
s_waitcnt vmcnt(4)
v_exp_f32 v130, v130
MM a[4:7],a[160:163],v[72:75],a[4:7]
s_barrier
v_exp_f32 v131, v131
MM a[4:7],a[164:167],v[104:107],a[4:7]
v_exp_f32 v132, v132
MM a[8:11],a[160:163],v[80:83],a[8:11]
TR a[180:181],v14,40960
v_cvt_pk_bf16_f32 v129, v130, v131
MM a[8:11],a[164:167],v[112:115],a[8:11]
TR a[182:183],v14,45056
v_add_f32 v41, v41, v37
MM a[12:15],a[160:163],v[88:91],a[12:15]
v_exp_f32 v133, v133
MM a[12:15],a[164:167],v[120:123],a[12:15]
s_waitcnt lgkmcnt(6)
TR a[184:185],v15,32768
v_cvt_pk_bf16_f32 v130, v132, v133
MM a[16:19],a[168:171],v[64:67],a[16:19]
s_waitcnt lgkmcnt(5)
MM a[16:19],a[172:175],v[96:99],a[16:19]
v_exp_f32 v134, v134
MM a[20:23],a[168:171],v[72:75],a[20:23]
v_exp_f32 v135, v135
MM a[20:23],a[172:175],v[104:107],a[20:23]
v_exp_f32 v160, v160
MM a[24:27],a[168:171],v[80:83],a[24:27]
TR a[186:187],v15,36864
v_cvt_pk_bf16_f32 v131, v134, v135
MM a[24:27],a[172:175],v[112:115],a[24:27]
MM a[28:31],a[168:171],v[88:91],a[28:31]
v_exp_f32 v161, v161
MM a[28:31],a[172:175],v[120:123],a[28:31]
s_waitcnt lgkmcnt(4)
v_exp_f32 v162, v162
MM a[32:35],a[176:179],v[64:67],a[32:35]
s_waitcnt lgkmcnt(2)
TR a[188:189],v15,40960
v_add_f32 v34, v160, v161
MM a[32:35],a[180:183],v[96:99],a[32:35]
TR a[190:191],v15,45056
v_cvt_pk_bf16_f32 v160, v160, v161
MM a[36:39],a[176:179],v[72:75],a[36:39]
TR a[160:161],v16,32768
v_add_f32 v34, v34, v162
MM a[36:39],a[180:183],v[104:107],a[36:39]
v_exp_f32 v163, v163
MM v[132:135],v[26:29],v[128:131],0
v_exp_f32 v164, v164
MM a[40:43],a[176:179],v[80:83],a[40:43]
v_exp_f32 v165, v165
MM a[40:43],a[180:183],v[112:115],a[40:43]
TR a[162:163],v16,36864
v_add_f32 v34, v34, v163
MM a[44:47],a[176:179],v[88:91],a[44:47]
TR a[164:165],v16,40960
v_cvt_pk_bf16_f32 v161, v162, v163
MM a[44:47],a[180:183],v[120:123],a[44:47]
s_waitcnt lgkmcnt(5)
v_exp_f32 v166, v166
MM a[48:51],a[184:187],v[64:67],a[48:51]
s_waitcnt lgkmcnt(3)
TR a[166:167],v16,45056
v_add_f32 v34, v34, v164
MM a[48:51],a[188:191],v[96:99],a[48:51]
v_exp_f32 v167, v167
MM a[52:55],a[184:187],v[72:75],a[52:55]
TR a[168:169],v17,32768
v_add_f32 v34, v34, v165
MM a[52:55],a[188:191],v[104:107],a[52:55]
TR a[170:171],v17,36864
v_cvt_pk_bf16_f32 v162, v164, v165
MM a[56:59],a[184:187],v[80:83],a[56:59]
v_exp_f32 v136, v136
MM a[56:59],a[188:191],v[112:115],a[56:59]
v_exp_f32 v137, v137
MM a[60:63],a[184:187],v[88:91],a[60:63]
v_exp_f32 v138, v138
MM a[60:63],a[188:191],v[120:123],a[60:63]
s_waitcnt lgkmcnt(4)
TR a[172:173],v17,40960
v_add_f32 v34, v34, v166
MM a[64:67],a[160:163],v[64:67],a[64:67]
s_waitcnt lgkmcnt(3)
v_add_f32 v34, v34, v167
v_cvt_pk_bf16_f32 v163, v166, v167
MM a[64:67],a[164:167],v[96:99],a[64:67]
TR a[174:175],v17,45056
v_add_f32 v34, v34, v132
MM a[68:71],a[160:163],v[72:75],a[68:71]
v_exp_f32 v139, v139
MM a[68:71],a[164:167],v[104:107],a[68:71]
TR a[176:177],v18,32768
v_cvt_pk_bf16_f32 v136, v136, v137
MM a[72:75],a[160:163],v[80:83],a[72:75]
v_exp_f32 v140, v140
MM a[72:75],a[164:167],v[112:115],a[72:75]
v_exp_f32 v141, v141
MM a[76:79],a[160:163],v[88:91],a[76:79]
TR a[178:179],v18,36864
v_cvt_pk_bf16_f32 v137, v138, v139
MM a[76:79],a[164:167],v[120:123],a[76:79]
s_waitcnt lgkmcnt(4)
TR a[180:181],v18,40960
v_cvt_pk_bf16_f32 v138, v140, v141
MM a[80:83],a[168:171],v[64:67],a[80:83]
s_waitcnt lgkmcnt(3)
v_exp_f32 v142, v142
MM a[80:83],a[172:175],v[96:99],a[80:83]
TR a[182:183],v18,45056
MM a[84:87],a[168:171],v[72:75],a[84:87]
v_exp_f32 v143, v143
MM a[84:87],a[172:175],v[104:107],a[84:87]
v_exp_f32 v168, v168
MM a[88:91],a[168:171],v[80:83],a[88:91]
TR a[184:185],v19,32768
v_cvt_pk_bf16_f32 v139, v142, v143
MM a[88:91],a[172:175],v[112:115],a[88:91]
v_exp_f32 v169, v169
MM a[92:95],a[168:171],v[88:91],a[92:95]
TR a[186:187],v19,36864
v_add_f32 v35, v168, v169
MM a[92:95],a[172:175],v[120:123],a[92:95]
s_waitcnt lgkmcnt(4)
v_exp_f32 v170, v170
MM a[96:99],a[176:179],v[64:67],a[96:99]
s_waitcnt lgkmcnt(2)
TR a[188:189],v19,40960
v_cvt_pk_bf16_f32 v168, v168, v169
MM a[96:99],a[180:183],v[96:99],a[96:99]
v_exp_f32 v171, v171
MM a[100:103],a[176:179],v[72:75],a[100:103]
TR a[190:191],v19,45056
v_add_f32 v35, v35, v170
MM a[100:103],a[180:183],v[104:107],a[100:103]
v_exp_f32 v172, v172
MM v[140:143],v[26:29],v[136:139],0
v_exp_f32 v173, v173
MM a[104:107],a[176:179],v[80:83],a[104:107]
ds_read_b128 a[128:131], v8 offset:0
v_add_f32 v35, v35, v171
MM a[104:107],a[180:183],v[112:115],a[104:107]
v_exp_f32 v174, v174
MM a[108:111],a[176:179],v[88:91],a[108:111]
ds_read_b128 a[132:135], v9 offset:0
v_cvt_pk_bf16_f32 v169, v170, v171
MM a[108:111],a[180:183],v[120:123],a[108:111]
s_waitcnt lgkmcnt(4)
v_exp_f32 v175, v175
MM a[112:115],a[184:187],v[64:67],a[112:115]
s_waitcnt lgkmcnt(2)
MM a[112:115],a[188:191],v[96:99],a[112:115]
ds_read_b128 a[136:139], v10 offset:0
v_add_f32 v35, v35, v172
MM a[116:119],a[184:187],v[72:75],a[116:119]
v_exp_f32 v144, v144
MM a[116:119],a[188:191],v[104:107],a[116:119]
ds_read_b128 a[140:143], v11 offset:0
v_add_f32 v35, v35, v173
MM a[120:123],a[184:187],v[80:83],a[120:123]
v_exp_f32 v145, v145
MM a[120:123],a[188:191],v[112:115],a[120:123]
v_cvt_pk_bf16_f32 v170, v172, v173
v_add_f32 v35, v35, v174
MM a[124:127],a[184:187],v[88:91],a[124:127]
MM a[124:127],a[188:191],v[120:123],a[124:127]
v_exp_f32 v146, v146
v_exp_f32 v147, v147
v_exp_f32 v148, v148
v_add_f32 v35, v35, v175
v_cvt_pk_bf16_f32 v171, v174, v175
v_exp_f32 v149, v149
v_exp_f32 v150, v150
v_add_f32 v35, v35, v140
v_exp_f32 v151, v151
v_cvt_pk_bf16_f32 v144, v144, v145
v_exp_f32 v176, v176
v_cvt_pk_bf16_f32 v145, v146, v147
v_cvt_pk_bf16_f32 v146, v148, v149
v_exp_f32 v177, v177
TR a[160:161],v12,49152
v_cvt_pk_bf16_f32 v147, v150, v151
v_exp_f32 v178, v178
v_exp_f32 v179, v179
v_add_f32 v36, v176, v177
v_cvt_pk_bf16_f32 v176, v176, v177
v_exp_f32 v180, v180
v_add_f32 v36, v36, v178
v_exp_f32 v181, v181
MM v[148:151],v[26:29],v[144:147],0
v_add_f32 v36, v36, v179
v_exp_f32 v182, v182
v_exp_f32 v183, v183
TR a[162:163],v12,53248
v_cvt_pk_bf16_f32 v177, v178, v179
TR a[164:165],v12,57344
v_add_f32 v36, v36, v180
v_exp_f32 v152, v152
TR a[166:167],v12,61440
v_add_f32 v36, v36, v181
v_exp_f32 v153, v153
v_exp_f32 v154, v154
v_cvt_pk_bf16_f32 v178, v180, v181
v_add_f32 v36, v36, v182
v_exp_f32 v155, v155
v_add_f32 v36, v36, v183
v_cvt_pk_bf16_f32 v179, v182, v183
v_exp_f32 v156, v156
v_add_f32 v36, v36, v148
v_exp_f32 v157, v157
v_cvt_pk_bf16_f32 v152, v152, v153
v_exp_f32 v158, v158
v_cvt_pk_bf16_f32 v153, v154, v155
v_exp_f32 v159, v159
v_exp_f32 v184, v184
v_cvt_pk_bf16_f32 v154, v156, v157
v_exp_f32 v185, v185
v_cvt_pk_bf16_f32 v155, v158, v159
v_add_f32 v37, v184, v185
v_exp_f32 v186, v186
v_exp_f32 v187, v187
v_cvt_pk_bf16_f32 v184, v184, v185
v_add_f32 v37, v37, v186
MM v[156:159],v[26:29],v[152:155],0
v_exp_f32 v188, v188
v_exp_f32 v189, v189
TR a[168:169],v13,49152
v_add_f32 v37, v37, v187
TR a[170:171],v13,53248
v_cvt_pk_bf16_f32 v185, v186, v187
v_exp_f32 v190, v190
TR a[172:173],v13,57344
v_add_f32 v37, v37, v188
v_exp_f32 v191, v191
TR a[174:175],v13,61440
v_add_f32 v37, v37, v189
v_cvt_pk_bf16_f32 v186, v188, v189
v_add_f32 v37, v37, v190
TR a[176:177],v14,49152
v_add_f32 v37, v37, v191
v_cvt_pk_bf16_f32 v187, v190, v191
v_add_f32 v37, v37, v156
TR a[178:179],v14,53248
v_max3_f32 v43, v34, v35, v36
v_max_f32 v43, v43, v37
v_cmp_nge_f32 vcc, s36, v43
s_cbranch_vccnz L_attn_kernel_tr9
L_attn_kernel_tr9r:
s_add_u32 s35, s35, 16384
s_add_u32 s20, s44, 0
s_addc_u32 s21, s45, 0
s_mov_b32 s22, 65536
s_lshl_b32 s50, s30, 9
s_add_u32 s50, s50, 32768
v_and_b32 v42, 0x30, v1
s_waitcnt vmcnt(0)
v_lshlrev_b32 v43, 4, v42
v_and_b32 v33, 15, v1
v_lshl_add_u32 v43, v33, 3, v43
s_lshl_b32 s51, s33, 1
s_add_u32 s51, s51, 131072
v_add_u32 v43, s51, v43
s_waitcnt lgkmcnt(8)
MM a[0:3],a[160:163],v[128:131],a[0:3]
s_waitcnt lgkmcnt(6)
buffer_load_dwordx4 a[192:195], v42, s[20:23], s50 offen offset:0
v_add_f32 v38, v38, v34
v_add_f32 v39, v39, v35
MM a[0:3],a[164:167],v[160:163],a[0:3]
v_add_f32 v40, v40, v36
v_add_f32 v41, v41, v37
MM a[4:7],a[160:163],v[136:139],a[4:7]
buffer_load_dwordx4 a[196:199], v42, s[20:23], s50 offen offset:64
v_mov_b32 v2, v38
v_mov_b32 v3, v39
MM a[4:7],a[164:167],v[168:171],a[4:7]
v_mov_b32 v4, v40
v_mov_b32 v5, v41
MM a[8:11],a[160:163],v[144:147],a[8:11]
TR a[180:181],v14,57344
buffer_load_dwordx4 a[200:203], v42, s[20:23], s50 offen offset:128
v_permlane16_swap_b32 v2, v38
v_permlane16_swap_b32 v3, v39
MM a[8:11],a[164:167],v[176:179],a[8:11]
TR a[182:183],v14,61440
v_permlane16_swap_b32 v4, v40
v_permlane16_swap_b32 v5, v41
MM a[12:15],a[160:163],v[152:155],a[12:15]
buffer_load_dwordx4 a[204:207], v42, s[20:23], s50 offen offset:192
v_add_f32 v38, v38, v2
v_add_f32 v39, v39, v3
MM a[12:15],a[164:167],v[184:187],a[12:15]
s_waitcnt lgkmcnt(6)
TR a[184:185],v15,49152
v_add_f32 v40, v40, v4
v_add_f32 v41, v41, v5
MM a[16:19],a[168:171],v[128:131],a[16:19]
s_waitcnt lgkmcnt(5)
buffer_load_dwordx4 a[208:211], v42, s[20:23], s50 offen offset:256
v_mov_b32 v2, v38
v_mov_b32 v3, v39
MM a[16:19],a[172:175],v[160:163],a[16:19]
v_mov_b32 v4, v40
v_mov_b32 v5, v41
MM a[20:23],a[168:171],v[136:139],a[20:23]
buffer_load_dwordx4 a[212:215], v42, s[20:23], s50 offen offset:320
v_permlane32_swap_b32 v2, v38
v_permlane32_swap_b32 v3, v39
MM a[20:23],a[172:175],v[168:171],a[20:23]
v_permlane32_swap_b32 v4, v40
v_permlane32_swap_b32 v5, v41
MM a[24:27],a[168:171],v[144:147],a[24:27]
TR a[186:187],v15,53248
buffer_load_dwordx4 a[216:219], v42, s[20:23], s50 offen offset:384
v_add_f32 v38, v38, v2
v_add_f32 v39, v39, v3
MM a[24:27],a[172:175],v[176:179],a[24:27]
v_add_f32 v40, v40, v4
v_add_f32 v41, v41, v5
MM a[28:31],a[168:171],v[152:155],a[28:31]
buffer_load_dwordx4 a[220:223], v42, s[20:23], s50 offen offset:448
v_rcp_f32 v38, v38
v_rcp_f32 v39, v39
MM a[28:31],a[172:175],v[184:187],a[28:31]
s_waitcnt lgkmcnt(4)
v_rcp_f32 v40, v40
v_rcp_f32 v41, v41
MM a[32:35],a[176:179],v[128:131],a[32:35]
s_waitcnt lgkmcnt(2)
TR a[188:189],v15,57344
MM a[32:35],a[180:183],v[160:163],a[32:35]
TR a[190:191],v15,61440
MM a[36:39],a[176:179],v[136:139],a[36:39]
TR a[160:161],v16,49152
s_add_u32 s49, s48, 0
v_accvgpr_read_b32 v64, a0
v_accvgpr_read_b32 v65, a1
v_accvgpr_read_b32 v66, a2
v_accvgpr_read_b32 v67, a3
v_accvgpr_read_b32 v68, a16
MM a[36:39],a[180:183],v[168:171],a[36:39]
v_accvgpr_read_b32 v69, a17
v_accvgpr_read_b32 v70, a18
v_accvgpr_read_b32 v71, a19
v_mul_f32 v64, v64, v38
v_mul_f32 v65, v65, v38
v_mul_f32 v66, v66, v38
v_mul_f32 v67, v67, v38
v_mul_f32 v68, v68, v38
v_mul_f32 v69, v69, v38
v_mul_f32 v70, v70, v38
MM a[40:43],a[176:179],v[144:147],a[40:43]
v_mul_f32 v71, v71, v38
v_cvt_pk_bf16_f32 v64, v64, v65
v_cvt_pk_bf16_f32 v65, v66, v67
v_cvt_pk_bf16_f32 v66, v68, v69
v_cvt_pk_bf16_f32 v67, v70, v71
buffer_store_dwordx4 v[64:67], v30, s[24:27], s49 offen offset:0 sc1
MM a[40:43],a[180:183],v[176:179],a[40:43]
TR a[162:163],v16,53248
v_accvgpr_read_b32 v72, a4
v_accvgpr_read_b32 v73, a5
v_accvgpr_read_b32 v74, a6
v_accvgpr_read_b32 v75, a7
v_accvgpr_read_b32 v76, a20
MM a[44:47],a[176:179],v[152:155],a[44:47]
TR a[164:165],v16,57344
v_accvgpr_read_b32 v77, a21
v_accvgpr_read_b32 v78, a22
v_accvgpr_read_b32 v79, a23
v_mul_f32 v72, v72, v39
v_mul_f32 v73, v73, v39
MM a[44:47],a[180:183],v[184:187],a[44:47]
s_waitcnt lgkmcnt(5)
v_mul_f32 v74, v74, v39
v_mul_f32 v75, v75, v39
v_mul_f32 v76, v76, v39
v_mul_f32 v77, v77, v39
v_mul_f32 v78, v78, v39
v_mul_f32 v79, v79, v39
MM a[48:51],a[184:187],v[128:131],a[48:51]
s_waitcnt lgkmcnt(3)
TR a[166:167],v16,61440
v_cvt_pk_bf16_f32 v72, v72, v73
v_cvt_pk_bf16_f32 v73, v74, v75
v_cvt_pk_bf16_f32 v74, v76, v77
v_cvt_pk_bf16_f32 v75, v78, v79
buffer_store_dwordx4 v[72:75], v30, s[24:27], s49 offen offset:1024 sc1
MM a[48:51],a[188:191],v[160:163],a[48:51]
v_accvgpr_read_b32 v80, a8
v_accvgpr_read_b32 v81, a9
v_accvgpr_read_b32 v82, a10
v_accvgpr_read_b32 v83, a11
v_accvgpr_read_b32 v84, a24
MM a[52:55],a[184:187],v[136:139],a[52:55]
TR a[168:169],v17,49152
v_accvgpr_read_b32 v85, a25
v_accvgpr_read_b32 v86, a26
v_accvgpr_read_b32 v87, a27
v_mul_f32 v80, v80, v40
v_mul_f32 v81, v81, v40
v_mul_f32 v82, v82, v40
MM a[52:55],a[188:191],v[168:171],a[52:55]
TR a[170:171],v17,53248
v_mul_f32 v83, v83, v40
v_mul_f32 v84, v84, v40
v_mul_f32 v85, v85, v40
v_mul_f32 v86, v86, v40
v_mul_f32 v87, v87, v40
MM a[56:59],a[184:187],v[144:147],a[56:59]
v_cvt_pk_bf16_f32 v80, v80, v81
v_cvt_pk_bf16_f32 v81, v82, v83
v_cvt_pk_bf16_f32 v82, v84, v85
v_cvt_pk_bf16_f32 v83, v86, v87
buffer_store_dwordx4 v[80:83], v30, s[24:27], s49 offen offset:2048 sc1
MM a[56:59],a[188:191],v[176:179],a[56:59]
v_accvgpr_read_b32 v88, a12
v_accvgpr_read_b32 v89, a13
v_accvgpr_read_b32 v90, a14
v_accvgpr_read_b32 v91, a15
v_accvgpr_read_b32 v92, a28
v_accvgpr_read_b32 v93, a29
MM a[60:63],a[184:187],v[152:155],a[60:63]
v_accvgpr_read_b32 v94, a30
v_accvgpr_read_b32 v95, a31
v_mul_f32 v88, v88, v41
v_mul_f32 v89, v89, v41
v_mul_f32 v90, v90, v41
MM a[60:63],a[188:191],v[184:187],a[60:63]
s_waitcnt lgkmcnt(4)
TR a[172:173],v17,57344
v_mul_f32 v91, v91, v41
v_mul_f32 v92, v92, v41
v_mul_f32 v93, v93, v41
v_mul_f32 v94, v94, v41
v_mul_f32 v95, v95, v41
MM a[64:67],a[160:163],v[128:131],a[64:67]
s_waitcnt lgkmcnt(3)
v_cvt_pk_bf16_f32 v88, v88, v89
v_cvt_pk_bf16_f32 v89, v90, v91
v_cvt_pk_bf16_f32 v90, v92, v93
v_cvt_pk_bf16_f32 v91, v94, v95
buffer_store_dwordx4 v[88:91], v30, s[24:27], s49 offen offset:3072 sc1
MM a[64:67],a[164:167],v[160:163],a[64:67]
TR a[174:175],v17,61440
MM a[68:71],a[160:163],v[136:139],a[68:71]
s_add_u32 s49, s48, 131072
v_accvgpr_read_b32 v96, a32
v_accvgpr_read_b32 v97, a33
v_accvgpr_read_b32 v98, a34
v_accvgpr_read_b32 v99, a35
v_accvgpr_read_b32 v100, a48
MM a[68:71],a[164:167],v[168:171],a[68:71]
TR a[176:177],v18,49152
v_accvgpr_read_b32 v101, a49
v_accvgpr_read_b32 v102, a50
v_accvgpr_read_b32 v103, a51
v_mul_f32 v96, v96, v38
v_mul_f32 v97, v97, v38
MM a[72:75],a[160:163],v[144:147],a[72:75]
v_mul_f32 v98, v98, v38
v_mul_f32 v99, v99, v38
v_mul_f32 v100, v100, v38
v_mul_f32 v101, v101, v38
v_mul_f32 v102, v102, v38
MM a[72:75],a[164:167],v[176:179],a[72:75]
v_mul_f32 v103, v103, v38
v_cvt_pk_bf16_f32 v96, v96, v97
v_cvt_pk_bf16_f32 v97, v98, v99
v_cvt_pk_bf16_f32 v98, v100, v101
v_cvt_pk_bf16_f32 v99, v102, v103
buffer_store_dwordx4 v[96:99], v30, s[24:27], s49 offen offset:0 sc1
MM a[76:79],a[160:163],v[152:155],a[76:79]
TR a[178:179],v18,53248
v_accvgpr_read_b32 v104, a36
v_accvgpr_read_b32 v105, a37
v_accvgpr_read_b32 v106, a38
v_accvgpr_read_b32 v107, a39
v_accvgpr_read_b32 v108, a52
MM a[76:79],a[164:167],v[184:187],a[76:79]
s_waitcnt lgkmcnt(4)
TR a[180:181],v18,57344
v_accvgpr_read_b32 v109, a53
v_accvgpr_read_b32 v110, a54
v_accvgpr_read_b32 v111, a55
v_mul_f32 v104, v104, v39
v_mul_f32 v105, v105, v39
MM a[80:83],a[168:171],v[128:131],a[80:83]
s_waitcnt lgkmcnt(3)
v_mul_f32 v106, v106, v39
v_mul_f32 v107, v107, v39
v_mul_f32 v108, v108, v39
v_mul_f32 v109, v109, v39
v_mul_f32 v110, v110, v39
v_mul_f32 v111, v111, v39
MM a[80:83],a[172:175],v[160:163],a[80:83]
TR a[182:183],v18,61440
v_cvt_pk_bf16_f32 v104, v104, v105
v_cvt_pk_bf16_f32 v105, v106, v107
v_cvt_pk_bf16_f32 v106, v108, v109
v_cvt_pk_bf16_f32 v107, v110, v111
buffer_store_dwordx4 v[104:107], v30, s[24:27], s49 offen offset:1024 sc1
MM a[84:87],a[168:171],v[136:139],a[84:87]
v_accvgpr_read_b32 v112, a40
v_accvgpr_read_b32 v113, a41
v_accvgpr_read_b32 v114, a42
v_accvgpr_read_b32 v115, a43
v_accvgpr_read_b32 v116, a56
MM a[84:87],a[172:175],v[168:171],a[84:87]
v_accvgpr_read_b32 v117, a57
v_accvgpr_read_b32 v118, a58
v_accvgpr_read_b32 v119, a59
v_mul_f32 v112, v112, v40
v_mul_f32 v113, v113, v40
v_mul_f32 v114, v114, v40
MM a[88:91],a[168:171],v[144:147],a[88:91]
TR a[184:185],v19,49152
v_mul_f32 v115, v115, v40
v_mul_f32 v116, v116, v40
v_mul_f32 v117, v117, v40
v_mul_f32 v118, v118, v40
v_mul_f32 v119, v119, v40
MM a[88:91],a[172:175],v[176:179],a[88:91]
v_cvt_pk_bf16_f32 v112, v112, v113
v_cvt_pk_bf16_f32 v113, v114, v115
v_cvt_pk_bf16_f32 v114, v116, v117
v_cvt_pk_bf16_f32 v115, v118, v119
buffer_store_dwordx4 v[112:115], v30, s[24:27], s49 offen offset:2048 sc1
MM a[92:95],a[168:171],v[152:155],a[92:95]
TR a[186:187],v19,53248
v_accvgpr_read_b32 v120, a44
v_accvgpr_read_b32 v121, a45
v_accvgpr_read_b32 v122, a46
v_accvgpr_read_b32 v123, a47
v_accvgpr_read_b32 v124, a60
v_accvgpr_read_b32 v125, a61
MM a[92:95],a[172:175],v[184:187],a[92:95]
s_waitcnt lgkmcnt(4)
TR a[224:225],v43,0
v_accvgpr_read_b32 v126, a62
v_accvgpr_read_b32 v127, a63
v_mul_f32 v120, v120, v41
v_mul_f32 v121, v121, v41
v_mul_f32 v122, v122, v41
MM a[96:99],a[176:179],v[128:131],a[96:99]
s_waitcnt lgkmcnt(3)
TR a[188:189],v19,57344
TR a[226:227],v43,128
v_mul_f32 v123, v123, v41
v_mul_f32 v124, v124, v41
v_mul_f32 v125, v125, v41
v_mul_f32 v126, v126, v41
v_mul_f32 v127, v127, v41
MM a[96:99],a[180:183],v[160:163],a[96:99]
TR a[228:229],v43,1024
v_cvt_pk_bf16_f32 v120, v120, v121
v_cvt_pk_bf16_f32 v121, v122, v123
v_cvt_pk_bf16_f32 v122, v124, v125
v_cvt_pk_bf16_f32 v123, v126, v127
buffer_store_dwordx4 v[120:123], v30, s[24:27], s49 offen offset:3072 sc1
MM a[100:103],a[176:179],v[136:139],a[100:103]
TR a[190:191],v19,61440
TR a[230:231],v43,1152
s_add_u32 s49, s48, 262144
v_accvgpr_read_b32 v192, a64
v_accvgpr_read_b32 v193, a65
v_accvgpr_read_b32 v194, a66
v_accvgpr_read_b32 v195, a67
v_accvgpr_read_b32 v196, a80
MM a[100:103],a[180:183],v[168:171],a[100:103]
TR a[232:233],v43,2048
v_accvgpr_read_b32 v197, a81
v_accvgpr_read_b32 v198, a82
v_accvgpr_read_b32 v199, a83
v_mul_f32 v192, v192, v38
v_mul_f32 v193, v193, v38
v_mul_f32 v194, v194, v38
TR a[234:235],v43,2176
v_mul_f32 v195, v195, v38
v_mul_f32 v196, v196, v38
v_mul_f32 v197, v197, v38
v_mul_f32 v198, v198, v38
v_mul_f32 v199, v199, v38
MM a[104:107],a[176:179],v[144:147],a[104:107]
TR a[236:237],v43,3072
v_cvt_pk_bf16_f32 v192, v192, v193
v_cvt_pk_bf16_f32 v193, v194, v195
v_cvt_pk_bf16_f32 v194, v196, v197
v_cvt_pk_bf16_f32 v195, v198, v199
buffer_store_dwordx4 v[192:195], v30, s[24:27], s49 offen offset:0 sc1
v_accvgpr_read_b32 v200, a68
MM a[104:107],a[180:183],v[176:179],a[104:107]
TR a[238:239],v43,3200
v_accvgpr_read_b32 v201, a69
v_accvgpr_read_b32 v202, a70
v_accvgpr_read_b32 v203, a71
v_accvgpr_read_b32 v204, a84
v_accvgpr_read_b32 v205, a85
v_accvgpr_read_b32 v206, a86
MM a[108:111],a[176:179],v[152:155],a[108:111]
TR a[240:241],v43,4096
v_accvgpr_read_b32 v207, a87
v_mul_f32 v200, v200, v39
v_mul_f32 v201, v201, v39
v_mul_f32 v202, v202, v39
v_mul_f32 v203, v203, v39
MM a[108:111],a[180:183],v[184:187],a[108:111]
s_waitcnt lgkmcnt(11)
TR a[242:243],v43,4224
v_mul_f32 v204, v204, v39
v_mul_f32 v205, v205, v39
v_mul_f32 v206, v206, v39
v_mul_f32 v207, v207, v39
v_cvt_pk_bf16_f32 v200, v200, v201
v_cvt_pk_bf16_f32 v201, v202, v203
MM a[112:115],a[184:187],v[128:131],a[112:115]
s_waitcnt lgkmcnt(7)
TR a[244:245],v43,5120
v_cvt_pk_bf16_f32 v202, v204, v205
v_cvt_pk_bf16_f32 v203, v206, v207
buffer_store_dwordx4 v[200:203], v30, s[24:27], s49 offen offset:1024 sc1
v_accvgpr_read_b32 v208, a72
v_accvgpr_read_b32 v209, a73
v_accvgpr_read_b32 v210, a74
MM a[112:115],a[188:191],v[160:163],a[112:115]
TR a[246:247],v43,5248
v_accvgpr_read_b32 v211, a75
v_accvgpr_read_b32 v212, a88
v_accvgpr_read_b32 v213, a89
v_accvgpr_read_b32 v214, a90
v_accvgpr_read_b32 v215, a91
MM a[116:119],a[184:187],v[136:139],a[116:119]
TR a[248:249],v43,6144
v_mul_f32 v208, v208, v40
v_mul_f32 v209, v209, v40
v_mul_f32 v210, v210, v40
v_mul_f32 v211, v211, v40
v_mul_f32 v212, v212, v40
v_mul_f32 v213, v213, v40
MM a[116:119],a[188:191],v[168:171],a[116:119]
TR a[250:251],v43,6272
v_mul_f32 v214, v214, v40
v_mul_f32 v215, v215, v40
v_cvt_pk_bf16_f32 v208, v208, v209
v_cvt_pk_bf16_f32 v209, v210, v211
v_cvt_pk_bf16_f32 v210, v212, v213
v_cvt_pk_bf16_f32 v211, v214, v215
MM a[120:123],a[184:187],v[144:147],a[120:123]
TR a[252:253],v43,7168
buffer_store_dwordx4 v[208:211], v30, s[24:27], s49 offen offset:2048 sc1
v_accvgpr_read_b32 v216, a76
v_accvgpr_read_b32 v217, a77
v_accvgpr_read_b32 v218, a78
v_accvgpr_read_b32 v219, a79
MM a[120:123],a[188:191],v[176:179],a[120:123]
TR a[254:255],v43,7296
v_accvgpr_read_b32 v220, a92
v_accvgpr_read_b32 v221, a93
v_accvgpr_read_b32 v222, a94
v_accvgpr_read_b32 v223, a95
v_mul_f32 v216, v216, v41
v_mul_f32 v217, v217, v41
MM a[124:127],a[184:187],v[152:155],a[124:127]
v_mul_f32 v218, v218, v41
v_mul_f32 v219, v219, v41
v_mul_f32 v220, v220, v41
v_mul_f32 v221, v221, v41
v_mul_f32 v222, v222, v41
v_mul_f32 v223, v223, v41
MM a[124:127],a[188:191],v[184:187],a[124:127]
s_waitcnt vmcnt(18)
v_cvt_pk_bf16_f32 v216, v216, v217
v_cvt_pk_bf16_f32 v217, v218, v219
v_cvt_pk_bf16_f32 v218, v220, v221
v_cvt_pk_bf16_f32 v219, v222, v223
buffer_store_dwordx4 v[216:219], v30, s[24:27], s49 offen offset:3072 sc1
MM v[44:47],a[224:227],a[192:195],0
s_waitcnt vmcnt(18) lgkmcnt(12)
MM v[44:47],a[228:231],a[196:199],v[44:47]
s_waitcnt vmcnt(17) lgkmcnt(10)
MM v[44:47],a[232:235],a[200:203],v[44:47]
s_waitcnt vmcnt(16) lgkmcnt(8)
MM v[44:47],a[236:239],a[204:207],v[44:47]
s_waitcnt vmcnt(15) lgkmcnt(6)
MM v[44:47],a[240:243],a[208:211],v[44:47]
s_waitcnt vmcnt(14) lgkmcnt(4)
MM v[44:47],a[244:247],a[212:215],v[44:47]
s_waitcnt vmcnt(13) lgkmcnt(2)
MM v[44:47],a[248:251],a[216:219],v[44:47]
s_waitcnt vmcnt(12) lgkmcnt(0)
MM v[44:47],a[252:255],a[220:223],v[44:47]
s_add_u32 s49, s48, 393216
v_accvgpr_read_b32 v224, a96
v_accvgpr_read_b32 v225, a97
v_accvgpr_read_b32 v226, a98
v_accvgpr_read_b32 v227, a99
v_accvgpr_read_b32 v228, a112
v_accvgpr_read_b32 v229, a113
v_accvgpr_read_b32 v230, a114
v_accvgpr_read_b32 v231, a115
v_mul_f32 v224, v224, v38
v_mul_f32 v225, v225, v38
v_mul_f32 v226, v226, v38
v_mul_f32 v227, v227, v38
v_mul_f32 v228, v228, v38
v_mul_f32 v229, v229, v38
v_mul_f32 v230, v230, v38
v_mul_f32 v231, v231, v38
v_cvt_pk_bf16_f32 v224, v224, v225
v_cvt_pk_bf16_f32 v225, v226, v227
v_cvt_pk_bf16_f32 v226, v228, v229
v_cvt_pk_bf16_f32 v227, v230, v231
buffer_store_dwordx4 v[224:227], v30, s[24:27], s49 offen offset:0 sc1
v_accvgpr_read_b32 v232, a100
v_accvgpr_read_b32 v233, a101
v_accvgpr_read_b32 v234, a102
v_accvgpr_read_b32 v235, a103
v_accvgpr_read_b32 v236, a116
v_accvgpr_read_b32 v237, a117
v_accvgpr_read_b32 v238, a118
v_accvgpr_read_b32 v239, a119
v_mul_f32 v232, v232, v39
v_mul_f32 v233, v233, v39
v_mul_f32 v234, v234, v39
v_mul_f32 v235, v235, v39
v_mul_f32 v236, v236, v39
v_mul_f32 v237, v237, v39
v_mul_f32 v238, v238, v39
v_mul_f32 v239, v239, v39
v_cvt_pk_bf16_f32 v232, v232, v233
v_cvt_pk_bf16_f32 v233, v234, v235
v_cvt_pk_bf16_f32 v234, v236, v237
v_cvt_pk_bf16_f32 v235, v238, v239
buffer_store_dwordx4 v[232:235], v30, s[24:27], s49 offen offset:1024 sc1
v_accvgpr_read_b32 v240, a104
v_accvgpr_read_b32 v241, a105
v_accvgpr_read_b32 v242, a106
v_accvgpr_read_b32 v243, a107
v_accvgpr_read_b32 v244, a120
v_accvgpr_read_b32 v245, a121
v_accvgpr_read_b32 v246, a122
v_accvgpr_read_b32 v247, a123
v_mul_f32 v240, v240, v40
v_mul_f32 v241, v241, v40
v_mul_f32 v242, v242, v40
v_mul_f32 v243, v243, v40
v_mul_f32 v244, v244, v40
v_mul_f32 v245, v245, v40
v_mul_f32 v246, v246, v40
v_mul_f32 v247, v247, v40
v_cvt_pk_bf16_f32 v240, v240, v241
v_cvt_pk_bf16_f32 v241, v242, v243
v_cvt_pk_bf16_f32 v242, v244, v245
v_cvt_pk_bf16_f32 v243, v246, v247
buffer_store_dwordx4 v[240:243], v30, s[24:27], s49 offen offset:2048 sc1
v_accvgpr_read_b32 v248, a108
v_accvgpr_read_b32 v249, a109
v_accvgpr_read_b32 v250, a110
v_accvgpr_read_b32 v251, a111
v_accvgpr_read_b32 v252, a124
v_accvgpr_read_b32 v253, a125
v_accvgpr_read_b32 v254, a126
v_accvgpr_read_b32 v255, a127
v_mul_f32 v248, v248, v41
v_mul_f32 v249, v249, v41
v_mul_f32 v250, v250, v41
v_mul_f32 v251, v251, v41
v_mul_f32 v252, v252, v41
v_mul_f32 v253, v253, v41
v_mul_f32 v254, v254, v41
v_mul_f32 v255, v255, v41
v_cvt_pk_bf16_f32 v248, v248, v249
v_cvt_pk_bf16_f32 v249, v250, v251
v_cvt_pk_bf16_f32 v250, v252, v253
v_cvt_pk_bf16_f32 v251, v254, v255
buffer_store_dwordx4 v[248:251], v30, s[24:27], s49 offen offset:3072 sc1
v_lshlrev_b32 v2, 6, v1
s_lshl_b32 s51, s30, 6
v_add_u32 v3, s51, v42
ds_write_b128 v3, v[44:47]
s_waitcnt lgkmcnt(0)
s_barrier
s_cmp_lg_u32 s30, 0
s_cbranch_scc1 L_attn_kernel_fin
v_lshlrev_b32 v2, 2, v33
ds_read_b32 v4, v2 offset:0
ds_read_b32 v5, v2 offset:64
ds_read_b32 v6, v2 offset:128
ds_read_b32 v7, v2 offset:192
s_waitcnt lgkmcnt(2)
v_add_f32 v4, v4, v5
s_waitcnt lgkmcnt(0)
v_add_f32 v6, v6, v7
v_add_f32 v4, v4, v6
v_cvt_pk_bf16_f32 v4, v4, v4
v_and_b32 v4, 0xffff0000, v4
s_lshr_b32 s29, s28, 6
s_cmp_eq_u32 s29, 2
s_cselect_b32 s29, 1.0, 0
v_add_f32 v4, s29, v4
v_cvt_pk_bf16_f32 v4, v4, v4
v_and_b32 v4, 0xffff0000, v4
s_lshl_b32 s29, s28, 6
s_add_u32 s29, s29, 8192
buffer_store_dword v4, v2, s[20:23], s29 offen sc1
L_attn_kernel_fin:
s_lshl_b32 s3, s41, 5
s_add_u32 s3, s3, s40
s_lshl_b32 s3, s3, 2
s_add_u32 s3, s3, 63111168
s_lshl_b32 s79, s28, 2
s_add_u32 s79, s79, 63114240
s_branch L_oproj_kernel_entry
L_attn_kernel_end:
s_endpgm
L_attn_kernel_tr2:
s_call_b64 s[38:39], L_attn_kernel_slow0
s_branch L_attn_kernel_tr2r
L_attn_kernel_tr3:
s_call_b64 s[38:39], L_attn_kernel_slow1
s_branch L_attn_kernel_tr3r
L_attn_kernel_tr4:
s_call_b64 s[38:39], L_attn_kernel_slow0
s_branch L_attn_kernel_tr4r
L_attn_kernel_tr5:
s_call_b64 s[38:39], L_attn_kernel_slow1
s_branch L_attn_kernel_tr5r
L_attn_kernel_tr6:
s_call_b64 s[38:39], L_attn_kernel_slow0
s_branch L_attn_kernel_tr6r
L_attn_kernel_tr7:
s_call_b64 s[38:39], L_attn_kernel_slow1
s_branch L_attn_kernel_tr7r
L_attn_kernel_tr8:
s_call_b64 s[38:39], L_attn_kernel_slow0
s_branch L_attn_kernel_tr8r
L_attn_kernel_tr9:
s_call_b64 s[38:39], L_attn_kernel_slow1
s_branch L_attn_kernel_tr9r
L_attn_kernel_slow0:
s_add_u32 s52, s35, 0
buffer_load_dwordx4 a[192:195], v42, s[8:11], s52 offen offset:0
buffer_load_dwordx4 a[196:199], v42, s[8:11], s52 offen offset:64
buffer_load_dwordx4 a[200:203], v42, s[8:11], s52 offen offset:128
buffer_load_dwordx4 a[204:207], v42, s[8:11], s52 offen offset:192
s_add_u32 s52, s35, 4096
buffer_load_dwordx4 a[208:211], v42, s[8:11], s52 offen offset:0
buffer_load_dwordx4 a[212:215], v42, s[8:11], s52 offen offset:64
buffer_load_dwordx4 a[216:219], v42, s[8:11], s52 offen offset:128
buffer_load_dwordx4 a[220:223], v42, s[8:11], s52 offen offset:192
s_add_u32 s52, s35, 8192
buffer_load_dwordx4 a[224:227], v42, s[8:11], s52 offen offset:0
buffer_load_dwordx4 a[228:231], v42, s[8:11], s52 offen offset:64
buffer_load_dwordx4 a[232:235], v42, s[8:11], s52 offen offset:128
buffer_load_dwordx4 a[236:239], v42, s[8:11], s52 offen offset:192
s_add_u32 s52, s35, 12288
buffer_load_dwordx4 a[240:243], v42, s[8:11], s52 offen offset:0
buffer_load_dwordx4 a[244:247], v42, s[8:11], s52 offen offset:64
buffer_load_dwordx4 a[248:251], v42, s[8:11], s52 offen offset:128
buffer_load_dwordx4 a[252:255], v42, s[8:11], s52 offen offset:192
s_waitcnt vmcnt(0)
MM v[64:67],a[192:195],v[192:195],v[48:51]
MM v[64:67],a[196:199],v[196:199],v[64:67]
MM v[64:67],a[200:203],v[200:203],v[64:67]
MM v[64:67],a[204:207],v[204:207],v[64:67]
MM v[72:75],a[192:195],v[208:211],v[52:55]
MM v[72:75],a[196:199],v[212:215],v[72:75]
MM v[72:75],a[200:203],v[216:219],v[72:75]
MM v[72:75],a[204:207],v[220:223],v[72:75]
MM v[80:83],a[192:195],v[224:227],v[56:59]
MM v[80:83],a[196:199],v[228:231],v[80:83]
MM v[80:83],a[200:203],v[232:235],v[80:83]
MM v[80:83],a[204:207],v[236:239],v[80:83]
MM v[88:91],a[192:195],v[240:243],v[60:63]
MM v[88:91],a[196:199],v[244:247],v[88:91]
MM v[88:91],a[200:203],v[248:251],v[88:91]
MM v[88:91],a[204:207],v[252:255],v[88:91]
MM v[68:71],a[208:211],v[192:195],v[48:51]
MM v[68:71],a[212:215],v[196:199],v[68:71]
MM v[68:71],a[216:219],v[200:203],v[68:71]
MM v[68:71],a[220:223],v[204:207],v[68:71]
MM v[76:79],a[208:211],v[208:211],v[52:55]
MM v[76:79],a[212:215],v[212:215],v[76:79]
MM v[76:79],a[216:219],v[216:219],v[76:79]
MM v[76:79],a[220:223],v[220:223],v[76:79]
MM v[84:87],a[208:211],v[224:227],v[56:59]
MM v[84:87],a[212:215],v[228:231],v[84:87]
MM v[84:87],a[216:219],v[232:235],v[84:87]
MM v[84:87],a[220:223],v[236:239],v[84:87]
MM v[92:95],a[208:211],v[240:243],v[60:63]
MM v[92:95],a[212:215],v[244:247],v[92:95]
MM v[92:95],a[216:219],v[248:251],v[92:95]
MM v[92:95],a[220:223],v[252:255],v[92:95]
MM v[96:99],a[224:227],v[192:195],v[48:51]
MM v[96:99],a[228:231],v[196:199],v[96:99]
MM v[96:99],a[232:235],v[200:203],v[96:99]
MM v[96:99],a[236:239],v[204:207],v[96:99]
MM v[104:107],a[224:227],v[208:211],v[52:55]
MM v[104:107],a[228:231],v[212:215],v[104:107]
MM v[104:107],a[232:235],v[216:219],v[104:107]
MM v[104:107],a[236:239],v[220:223],v[104:107]
MM v[112:115],a[224:227],v[224:227],v[56:59]
MM v[112:115],a[228:231],v[228:231],v[112:115]
MM v[112:115],a[232:235],v[232:235],v[112:115]
MM v[112:115],a[236:239],v[236:239],v[112:115]
MM v[120:123],a[224:227],v[240:243],v[60:63]
MM v[120:123],a[228:231],v[244:247],v[120:123]
MM v[120:123],a[232:235],v[248:251],v[120:123]
MM v[120:123],a[236:239],v[252:255],v[120:123]
MM v[100:103],a[240:243],v[192:195],v[48:51]
MM v[100:103],a[244:247],v[196:199],v[100:103]
MM v[100:103],a[248:251],v[200:203],v[100:103]
MM v[100:103],a[252:255],v[204:207],v[100:103]
MM v[108:111],a[240:243],v[208:211],v[52:55]
MM v[108:111],a[244:247],v[212:215],v[108:111]
MM v[108:111],a[248:251],v[216:219],v[108:111]
MM v[108:111],a[252:255],v[220:223],v[108:111]
MM v[116:119],a[240:243],v[224:227],v[56:59]
MM v[116:119],a[244:247],v[228:231],v[116:119]
MM v[116:119],a[248:251],v[232:235],v[116:119]
MM v[116:119],a[252:255],v[236:239],v[116:119]
MM v[124:127],a[240:243],v[240:243],v[60:63]
MM v[124:127],a[244:247],v[244:247],v[124:127]
MM v[124:127],a[248:251],v[248:251],v[124:127]
MM v[124:127],a[252:255],v[252:255],v[124:127]
v_max3_f32 v44, v64, v65, v66
v_max3_f32 v44, v44, v67, v68
v_max3_f32 v44, v44, v69, v70
v_max3_f32 v44, v44, v71, v96
v_max3_f32 v44, v44, v97, v98
v_max3_f32 v44, v44, v99, v100
v_max3_f32 v44, v44, v101, v102
v_max_f32 v44, v44, v103
v_max3_f32 v45, v72, v73, v74
v_max3_f32 v45, v45, v75, v76
v_max3_f32 v45, v45, v77, v78
v_max3_f32 v45, v45, v79, v104
v_max3_f32 v45, v45, v105, v106
v_max3_f32 v45, v45, v107, v108
v_max3_f32 v45, v45, v109, v110
v_max_f32 v45, v45, v111
v_max3_f32 v46, v80, v81, v82
v_max3_f32 v46, v46, v83, v84
v_max3_f32 v46, v46, v85, v86
v_max3_f32 v46, v46, v87, v112
v_max3_f32 v46, v46, v113, v114
v_max3_f32 v46, v46, v115, v116
v_max3_f32 v46, v46, v117, v118
v_max_f32 v46, v46, v119
v_max3_f32 v47, v88, v89, v90
v_max3_f32 v47, v47, v91, v92
v_max3_f32 v47, v47, v93, v94
v_max3_f32 v47, v47, v95, v120
v_max3_f32 v47, v47, v121, v122
v_max3_f32 v47, v47, v123, v124
v_max3_f32 v47, v47, v125, v126
v_max_f32 v47, v47, v127
v_mov_b32 v2, v44
v_mov_b32 v3, v45
v_mov_b32 v4, v46
v_mov_b32 v5, v47
v_permlane16_swap_b32 v2, v44
v_permlane16_swap_b32 v3, v45
v_permlane16_swap_b32 v4, v46
v_permlane16_swap_b32 v5, v47
v_max_f32 v44, v44, v2
v_max_f32 v45, v45, v3
v_max_f32 v46, v46, v4
v_max_f32 v47, v47, v5
v_mov_b32 v2, v44
v_mov_b32 v3, v45
v_mov_b32 v4, v46
v_mov_b32 v5, v47
v_permlane32_swap_b32 v2, v44
v_permlane32_swap_b32 v3, v45
v_permlane32_swap_b32 v4, v46
v_permlane32_swap_b32 v5, v47
v_max_f32 v44, v44, v2
v_max_f32 v45, v45, v3
v_max_f32 v46, v46, v4
v_max_f32 v47, v47, v5
s_mov_b32 s53, 0x42400000
v_add_f32 v44, s53, v44
v_max_f32 v44, 0, v44
v_sub_f32 v2, 0, v44
v_exp_f32 v2, v2
v_sub_f32 v48, v48, v44
v_sub_f32 v49, v49, v44
v_sub_f32 v50, v50, v44
v_sub_f32 v51, v51, v44
v_mul_f32 v38, v38, v2
v_add_f32 v45, s53, v45
v_max_f32 v45, 0, v45
v_sub_f32 v3, 0, v45
v_exp_f32 v3, v3
v_sub_f32 v52, v52, v45
v_sub_f32 v53, v53, v45
v_sub_f32 v54, v54, v45
v_sub_f32 v55, v55, v45
v_mul_f32 v39, v39, v3
v_add_f32 v46, s53, v46
v_max_f32 v46, 0, v46
v_sub_f32 v4, 0, v46
v_exp_f32 v4, v4
v_sub_f32 v56, v56, v46
v_sub_f32 v57, v57, v46
v_sub_f32 v58, v58, v46
v_sub_f32 v59, v59, v46
v_mul_f32 v40, v40, v4
v_add_f32 v47, s53, v47
v_max_f32 v47, 0, v47
v_sub_f32 v5, 0, v47
v_exp_f32 v5, v5
v_sub_f32 v60, v60, v47
v_sub_f32 v61, v61, v47
v_sub_f32 v62, v62, v47
v_sub_f32 v63, v63, v47
v_mul_f32 v41, v41, v5
v_sub_f32 v64, v64, v44
v_sub_f32 v65, v65, v44
v_sub_f32 v66, v66, v44
v_sub_f32 v67, v67, v44
v_sub_f32 v72, v72, v45
v_sub_f32 v73, v73, v45
v_sub_f32 v74, v74, v45
v_sub_f32 v75, v75, v45
v_sub_f32 v80, v80, v46
v_sub_f32 v81, v81, v46
v_sub_f32 v82, v82, v46
v_sub_f32 v83, v83, v46
v_sub_f32 v88, v88, v47
v_sub_f32 v89, v89, v47
v_sub_f32 v90, v90, v47
v_sub_f32 v91, v91, v47
v_sub_f32 v68, v68, v44
v_sub_f32 v69, v69, v44
v_sub_f32 v70, v70, v44
v_sub_f32 v71, v71, v44
v_sub_f32 v76, v76, v45
v_sub_f32 v77, v77, v45
v_sub_f32 v78, v78, v45
v_sub_f32 v79, v79, v45
v_sub_f32 v84, v84, v46
v_sub_f32 v85, v85, v46
v_sub_f32 v86, v86, v46
v_sub_f32 v87, v87, v46
v_sub_f32 v92, v92, v47
v_sub_f32 v93, v93, v47
v_sub_f32 v94, v94, v47
v_sub_f32 v95, v95, v47
v_sub_f32 v96, v96, v44
v_sub_f32 v97, v97, v44
v_sub_f32 v98, v98, v44
v_sub_f32 v99, v99, v44
v_sub_f32 v104, v104, v45
v_sub_f32 v105, v105, v45
v_sub_f32 v106, v106, v45
v_sub_f32 v107, v107, v45
v_sub_f32 v112, v112, v46
v_sub_f32 v113, v113, v46
v_sub_f32 v114, v114, v46
v_sub_f32 v115, v115, v46
v_sub_f32 v120, v120, v47
v_sub_f32 v121, v121, v47
v_sub_f32 v122, v122, v47
v_sub_f32 v123, v123, v47
v_sub_f32 v100, v100, v44
v_sub_f32 v101, v101, v44
v_sub_f32 v102, v102, v44
v_sub_f32 v103, v103, v44
v_sub_f32 v108, v108, v45
v_sub_f32 v109, v109, v45
v_sub_f32 v110, v110, v45
v_sub_f32 v111, v111, v45
v_sub_f32 v116, v116, v46
v_sub_f32 v117, v117, v46
v_sub_f32 v118, v118, v46
v_sub_f32 v119, v119, v46
v_sub_f32 v124, v124, v47
v_sub_f32 v125, v125, v47
v_sub_f32 v126, v126, v47
v_sub_f32 v127, v127, v47
v_sub_f32 v128, v128, v44
v_sub_f32 v129, v129, v44
v_sub_f32 v130, v130, v44
v_sub_f32 v131, v131, v44
v_sub_f32 v136, v136, v45
v_sub_f32 v137, v137, v45
v_sub_f32 v138, v138, v45
v_sub_f32 v139, v139, v45
v_sub_f32 v144, v144, v46
v_sub_f32 v145, v145, v46
v_sub_f32 v146, v146, v46
v_sub_f32 v147, v147, v46
v_sub_f32 v152, v152, v47
v_sub_f32 v153, v153, v47
v_sub_f32 v154, v154, v47
v_sub_f32 v155, v155, v47
v_sub_f32 v132, v132, v44
v_sub_f32 v133, v133, v44
v_sub_f32 v134, v134, v44
v_sub_f32 v135, v135, v44
v_sub_f32 v140, v140, v45
v_sub_f32 v141, v141, v45
v_sub_f32 v142, v142, v45
v_sub_f32 v143, v143, v45
v_sub_f32 v148, v148, v46
v_sub_f32 v149, v149, v46
v_sub_f32 v150, v150, v46
v_sub_f32 v151, v151, v46
v_sub_f32 v156, v156, v47
v_sub_f32 v157, v157, v47
v_sub_f32 v158, v158, v47
v_sub_f32 v159, v159, v47
v_sub_f32 v160, v160, v44
v_sub_f32 v161, v161, v44
v_sub_f32 v162, v162, v44
v_sub_f32 v163, v163, v44
v_sub_f32 v168, v168, v45
v_sub_f32 v169, v169, v45
v_sub_f32 v170, v170, v45
v_sub_f32 v171, v171, v45
v_sub_f32 v176, v176, v46
v_sub_f32 v177, v177, v46
v_sub_f32 v178, v178, v46
v_sub_f32 v179, v179, v46
v_sub_f32 v184, v184, v47
v_sub_f32 v185, v185, v47
v_sub_f32 v186, v186, v47
v_sub_f32 v187, v187, v47
v_sub_f32 v164, v164, v44
v_sub_f32 v165, v165, v44
v_sub_f32 v166, v166, v44
v_sub_f32 v167, v167, v44
v_sub_f32 v172, v172, v45
v_sub_f32 v173, v173, v45
v_sub_f32 v174, v174, v45
v_sub_f32 v175, v175, v45
v_sub_f32 v180, v180, v46
v_sub_f32 v181, v181, v46
v_sub_f32 v182, v182, v46
v_sub_f32 v183, v183, v46
v_sub_f32 v188, v188, v47
v_sub_f32 v189, v189, v47
v_sub_f32 v190, v190, v47
v_sub_f32 v191, v191, v47
v_accvgpr_read_b32 v6, a0
v_mul_f32 v6, v6, v2
v_accvgpr_write_b32 a0, v6
v_accvgpr_read_b32 v6, a1
v_mul_f32 v6, v6, v2
v_accvgpr_write_b32 a1, v6
v_accvgpr_read_b32 v6, a2
v_mul_f32 v6, v6, v2
v_accvgpr_write_b32 a2, v6
v_accvgpr_read_b32 v6, a3
v_mul_f32 v6, v6, v2
v_accvgpr_write_b32 a3, v6
v_accvgpr_read_b32 v6, a4
v_mul_f32 v6, v6, v3
v_accvgpr_write_b32 a4, v6
v_accvgpr_read_b32 v6, a5
v_mul_f32 v6, v6, v3
v_accvgpr_write_b32 a5, v6
v_accvgpr_read_b32 v6, a6
v_mul_f32 v6, v6, v3
v_accvgpr_write_b32 a6, v6
v_accvgpr_read_b32 v6, a7
v_mul_f32 v6, v6, v3
v_accvgpr_write_b32 a7, v6
v_accvgpr_read_b32 v6, a8
v_mul_f32 v6, v6, v4
v_accvgpr_write_b32 a8, v6
v_accvgpr_read_b32 v6, a9
v_mul_f32 v6, v6, v4
v_accvgpr_write_b32 a9, v6
v_accvgpr_read_b32 v6, a10
v_mul_f32 v6, v6, v4
v_accvgpr_write_b32 a10, v6
v_accvgpr_read_b32 v6, a11
v_mul_f32 v6, v6, v4
v_accvgpr_write_b32 a11, v6
v_accvgpr_read_b32 v6, a12
v_mul_f32 v6, v6, v5
v_accvgpr_write_b32 a12, v6
v_accvgpr_read_b32 v6, a13
v_mul_f32 v6, v6, v5
v_accvgpr_write_b32 a13, v6
v_accvgpr_read_b32 v6, a14
v_mul_f32 v6, v6, v5
v_accvgpr_write_b32 a14, v6
v_accvgpr_read_b32 v6, a15
v_mul_f32 v6, v6, v5
v_accvgpr_write_b32 a15, v6
v_accvgpr_read_b32 v6, a16
v_mul_f32 v6, v6, v2
v_accvgpr_write_b32 a16, v6
v_accvgpr_read_b32 v6, a17
v_mul_f32 v6, v6, v2
v_accvgpr_write_b32 a17, v6
v_accvgpr_read_b32 v6, a18
v_mul_f32 v6, v6, v2
v_accvgpr_write_b32 a18, v6
v_accvgpr_read_b32 v6, a19
v_mul_f32 v6, v6, v2
v_accvgpr_write_b32 a19, v6
v_accvgpr_read_b32 v6, a20
v_mul_f32 v6, v6, v3
v_accvgpr_write_b32 a20, v6
v_accvgpr_read_b32 v6, a21
v_mul_f32 v6, v6, v3
v_accvgpr_write_b32 a21, v6
v_accvgpr_read_b32 v6, a22
v_mul_f32 v6, v6, v3
v_accvgpr_write_b32 a22, v6
v_accvgpr_read_b32 v6, a23
v_mul_f32 v6, v6, v3
v_accvgpr_write_b32 a23, v6
v_accvgpr_read_b32 v6, a24
v_mul_f32 v6, v6, v4
v_accvgpr_write_b32 a24, v6
v_accvgpr_read_b32 v6, a25
v_mul_f32 v6, v6, v4
v_accvgpr_write_b32 a25, v6
v_accvgpr_read_b32 v6, a26
v_mul_f32 v6, v6, v4
v_accvgpr_write_b32 a26, v6
v_accvgpr_read_b32 v6, a27
v_mul_f32 v6, v6, v4
v_accvgpr_write_b32 a27, v6
v_accvgpr_read_b32 v6, a28
v_mul_f32 v6, v6, v5
v_accvgpr_write_b32 a28, v6
v_accvgpr_read_b32 v6, a29
v_mul_f32 v6, v6, v5
v_accvgpr_write_b32 a29, v6
v_accvgpr_read_b32 v6, a30
v_mul_f32 v6, v6, v5
v_accvgpr_write_b32 a30, v6
v_accvgpr_read_b32 v6, a31
v_mul_f32 v6, v6, v5
v_accvgpr_write_b32 a31, v6
v_accvgpr_read_b32 v6, a32
v_mul_f32 v6, v6, v2
v_accvgpr_write_b32 a32, v6
v_accvgpr_read_b32 v6, a33
v_mul_f32 v6, v6, v2
v_accvgpr_write_b32 a33, v6
v_accvgpr_read_b32 v6, a34
v_mul_f32 v6, v6, v2
v_accvgpr_write_b32 a34, v6
v_accvgpr_read_b32 v6, a35
v_mul_f32 v6, v6, v2
v_accvgpr_write_b32 a35, v6
v_accvgpr_read_b32 v6, a36
v_mul_f32 v6, v6, v3
v_accvgpr_write_b32 a36, v6
v_accvgpr_read_b32 v6, a37
v_mul_f32 v6, v6, v3
v_accvgpr_write_b32 a37, v6
v_accvgpr_read_b32 v6, a38
v_mul_f32 v6, v6, v3
v_accvgpr_write_b32 a38, v6
v_accvgpr_read_b32 v6, a39
v_mul_f32 v6, v6, v3
v_accvgpr_write_b32 a39, v6
v_accvgpr_read_b32 v6, a40
v_mul_f32 v6, v6, v4
v_accvgpr_write_b32 a40, v6
v_accvgpr_read_b32 v6, a41
v_mul_f32 v6, v6, v4
v_accvgpr_write_b32 a41, v6
v_accvgpr_read_b32 v6, a42
v_mul_f32 v6, v6, v4
v_accvgpr_write_b32 a42, v6
v_accvgpr_read_b32 v6, a43
v_mul_f32 v6, v6, v4
v_accvgpr_write_b32 a43, v6
v_accvgpr_read_b32 v6, a44
v_mul_f32 v6, v6, v5
v_accvgpr_write_b32 a44, v6
v_accvgpr_read_b32 v6, a45
v_mul_f32 v6, v6, v5
v_accvgpr_write_b32 a45, v6
v_accvgpr_read_b32 v6, a46
v_mul_f32 v6, v6, v5
v_accvgpr_write_b32 a46, v6
v_accvgpr_read_b32 v6, a47
v_mul_f32 v6, v6, v5
v_accvgpr_write_b32 a47, v6
v_accvgpr_read_b32 v6, a48
v_mul_f32 v6, v6, v2
v_accvgpr_write_b32 a48, v6
v_accvgpr_read_b32 v6, a49
v_mul_f32 v6, v6, v2
v_accvgpr_write_b32 a49, v6
v_accvgpr_read_b32 v6, a50
v_mul_f32 v6, v6, v2
v_accvgpr_write_b32 a50, v6
v_accvgpr_read_b32 v6, a51
v_mul_f32 v6, v6, v2
v_accvgpr_write_b32 a51, v6
v_accvgpr_read_b32 v6, a52
v_mul_f32 v6, v6, v3
v_accvgpr_write_b32 a52, v6
v_accvgpr_read_b32 v6, a53
v_mul_f32 v6, v6, v3
v_accvgpr_write_b32 a53, v6
v_accvgpr_read_b32 v6, a54
v_mul_f32 v6, v6, v3
v_accvgpr_write_b32 a54, v6
v_accvgpr_read_b32 v6, a55
v_mul_f32 v6, v6, v3
v_accvgpr_write_b32 a55, v6
v_accvgpr_read_b32 v6, a56
v_mul_f32 v6, v6, v4
v_accvgpr_write_b32 a56, v6
v_accvgpr_read_b32 v6, a57
v_mul_f32 v6, v6, v4
v_accvgpr_write_b32 a57, v6
v_accvgpr_read_b32 v6, a58
v_mul_f32 v6, v6, v4
v_accvgpr_write_b32 a58, v6
v_accvgpr_read_b32 v6, a59
v_mul_f32 v6, v6, v4
v_accvgpr_write_b32 a59, v6
v_accvgpr_read_b32 v6, a60
v_mul_f32 v6, v6, v5
v_accvgpr_write_b32 a60, v6
v_accvgpr_read_b32 v6, a61
v_mul_f32 v6, v6, v5
v_accvgpr_write_b32 a61, v6
v_accvgpr_read_b32 v6, a62
v_mul_f32 v6, v6, v5
v_accvgpr_write_b32 a62, v6
v_accvgpr_read_b32 v6, a63
v_mul_f32 v6, v6, v5
v_accvgpr_write_b32 a63, v6
v_accvgpr_read_b32 v6, a64
v_mul_f32 v6, v6, v2
v_accvgpr_write_b32 a64, v6
v_accvgpr_read_b32 v6, a65
v_mul_f32 v6, v6, v2
v_accvgpr_write_b32 a65, v6
v_accvgpr_read_b32 v6, a66
v_mul_f32 v6, v6, v2
v_accvgpr_write_b32 a66, v6
v_accvgpr_read_b32 v6, a67
v_mul_f32 v6, v6, v2
v_accvgpr_write_b32 a67, v6
v_accvgpr_read_b32 v6, a68
v_mul_f32 v6, v6, v3
v_accvgpr_write_b32 a68, v6
v_accvgpr_read_b32 v6, a69
v_mul_f32 v6, v6, v3
v_accvgpr_write_b32 a69, v6
v_accvgpr_read_b32 v6, a70
v_mul_f32 v6, v6, v3
v_accvgpr_write_b32 a70, v6
v_accvgpr_read_b32 v6, a71
v_mul_f32 v6, v6, v3
v_accvgpr_write_b32 a71, v6
v_accvgpr_read_b32 v6, a72
v_mul_f32 v6, v6, v4
v_accvgpr_write_b32 a72, v6
v_accvgpr_read_b32 v6, a73
v_mul_f32 v6, v6, v4
v_accvgpr_write_b32 a73, v6
v_accvgpr_read_b32 v6, a74
v_mul_f32 v6, v6, v4
v_accvgpr_write_b32 a74, v6
v_accvgpr_read_b32 v6, a75
v_mul_f32 v6, v6, v4
v_accvgpr_write_b32 a75, v6
v_accvgpr_read_b32 v6, a76
v_mul_f32 v6, v6, v5
v_accvgpr_write_b32 a76, v6
v_accvgpr_read_b32 v6, a77
v_mul_f32 v6, v6, v5
v_accvgpr_write_b32 a77, v6
v_accvgpr_read_b32 v6, a78
v_mul_f32 v6, v6, v5
v_accvgpr_write_b32 a78, v6
v_accvgpr_read_b32 v6, a79
v_mul_f32 v6, v6, v5
v_accvgpr_write_b32 a79, v6
v_accvgpr_read_b32 v6, a80
v_mul_f32 v6, v6, v2
v_accvgpr_write_b32 a80, v6
v_accvgpr_read_b32 v6, a81
v_mul_f32 v6, v6, v2
v_accvgpr_write_b32 a81, v6
v_accvgpr_read_b32 v6, a82
v_mul_f32 v6, v6, v2
v_accvgpr_write_b32 a82, v6
v_accvgpr_read_b32 v6, a83
v_mul_f32 v6, v6, v2
v_accvgpr_write_b32 a83, v6
v_accvgpr_read_b32 v6, a84
v_mul_f32 v6, v6, v3
v_accvgpr_write_b32 a84, v6
v_accvgpr_read_b32 v6, a85
v_mul_f32 v6, v6, v3
v_accvgpr_write_b32 a85, v6
v_accvgpr_read_b32 v6, a86
v_mul_f32 v6, v6, v3
v_accvgpr_write_b32 a86, v6
v_accvgpr_read_b32 v6, a87
v_mul_f32 v6, v6, v3
v_accvgpr_write_b32 a87, v6
v_accvgpr_read_b32 v6, a88
v_mul_f32 v6, v6, v4
v_accvgpr_write_b32 a88, v6
v_accvgpr_read_b32 v6, a89
v_mul_f32 v6, v6, v4
v_accvgpr_write_b32 a89, v6
v_accvgpr_read_b32 v6, a90
v_mul_f32 v6, v6, v4
v_accvgpr_write_b32 a90, v6
v_accvgpr_read_b32 v6, a91
v_mul_f32 v6, v6, v4
v_accvgpr_write_b32 a91, v6
v_accvgpr_read_b32 v6, a92
v_mul_f32 v6, v6, v5
v_accvgpr_write_b32 a92, v6
v_accvgpr_read_b32 v6, a93
v_mul_f32 v6, v6, v5
v_accvgpr_write_b32 a93, v6
v_accvgpr_read_b32 v6, a94
v_mul_f32 v6, v6, v5
v_accvgpr_write_b32 a94, v6
v_accvgpr_read_b32 v6, a95
v_mul_f32 v6, v6, v5
v_accvgpr_write_b32 a95, v6
v_accvgpr_read_b32 v6, a96
v_mul_f32 v6, v6, v2
v_accvgpr_write_b32 a96, v6
v_accvgpr_read_b32 v6, a97
v_mul_f32 v6, v6, v2
v_accvgpr_write_b32 a97, v6
v_accvgpr_read_b32 v6, a98
v_mul_f32 v6, v6, v2
v_accvgpr_write_b32 a98, v6
v_accvgpr_read_b32 v6, a99
v_mul_f32 v6, v6, v2
v_accvgpr_write_b32 a99, v6
v_accvgpr_read_b32 v6, a100
v_mul_f32 v6, v6, v3
v_accvgpr_write_b32 a100, v6
v_accvgpr_read_b32 v6, a101
v_mul_f32 v6, v6, v3
v_accvgpr_write_b32 a101, v6
v_accvgpr_read_b32 v6, a102
v_mul_f32 v6, v6, v3
v_accvgpr_write_b32 a102, v6
v_accvgpr_read_b32 v6, a103
v_mul_f32 v6, v6, v3
v_accvgpr_write_b32 a103, v6
v_accvgpr_read_b32 v6, a104
v_mul_f32 v6, v6, v4
v_accvgpr_write_b32 a104, v6
v_accvgpr_read_b32 v6, a105
v_mul_f32 v6, v6, v4
v_accvgpr_write_b32 a105, v6
v_accvgpr_read_b32 v6, a106
v_mul_f32 v6, v6, v4
v_accvgpr_write_b32 a106, v6
v_accvgpr_read_b32 v6, a107
v_mul_f32 v6, v6, v4
v_accvgpr_write_b32 a107, v6
v_accvgpr_read_b32 v6, a108
v_mul_f32 v6, v6, v5
v_accvgpr_write_b32 a108, v6
v_accvgpr_read_b32 v6, a109
v_mul_f32 v6, v6, v5
v_accvgpr_write_b32 a109, v6
v_accvgpr_read_b32 v6, a110
v_mul_f32 v6, v6, v5
v_accvgpr_write_b32 a110, v6
v_accvgpr_read_b32 v6, a111
v_mul_f32 v6, v6, v5
v_accvgpr_write_b32 a111, v6
v_accvgpr_read_b32 v6, a112
v_mul_f32 v6, v6, v2
v_accvgpr_write_b32 a112, v6
v_accvgpr_read_b32 v6, a113
v_mul_f32 v6, v6, v2
v_accvgpr_write_b32 a113, v6
v_accvgpr_read_b32 v6, a114
v_mul_f32 v6, v6, v2
v_accvgpr_write_b32 a114, v6
v_accvgpr_read_b32 v6, a115
v_mul_f32 v6, v6, v2
v_accvgpr_write_b32 a115, v6
v_accvgpr_read_b32 v6, a116
v_mul_f32 v6, v6, v3
v_accvgpr_write_b32 a116, v6
v_accvgpr_read_b32 v6, a117
v_mul_f32 v6, v6, v3
v_accvgpr_write_b32 a117, v6
v_accvgpr_read_b32 v6, a118
v_mul_f32 v6, v6, v3
v_accvgpr_write_b32 a118, v6
v_accvgpr_read_b32 v6, a119
v_mul_f32 v6, v6, v3
v_accvgpr_write_b32 a119, v6
v_accvgpr_read_b32 v6, a120
v_mul_f32 v6, v6, v4
v_accvgpr_write_b32 a120, v6
v_accvgpr_read_b32 v6, a121
v_mul_f32 v6, v6, v4
v_accvgpr_write_b32 a121, v6
v_accvgpr_read_b32 v6, a122
v_mul_f32 v6, v6, v4
v_accvgpr_write_b32 a122, v6
v_accvgpr_read_b32 v6, a123
v_mul_f32 v6, v6, v4
v_accvgpr_write_b32 a123, v6
v_accvgpr_read_b32 v6, a124
v_mul_f32 v6, v6, v5
v_accvgpr_write_b32 a124, v6
v_accvgpr_read_b32 v6, a125
v_mul_f32 v6, v6, v5
v_accvgpr_write_b32 a125, v6
v_accvgpr_read_b32 v6, a126
v_mul_f32 v6, v6, v5
v_accvgpr_write_b32 a126, v6
v_accvgpr_read_b32 v6, a127
v_mul_f32 v6, v6, v5
v_accvgpr_write_b32 a127, v6
v_mov_b32 v34, 0
v_mov_b32 v35, 0
v_mov_b32 v36, 0
v_mov_b32 v37, 0
v_exp_f32 v64, v64
s_nop 0
v_add_f32 v34, v34, v64
v_exp_f32 v65, v65
s_nop 0
v_add_f32 v34, v34, v65
v_cvt_pk_bf16_f32 v64, v64, v65
v_exp_f32 v66, v66
s_nop 0
v_add_f32 v34, v34, v66
v_exp_f32 v67, v67
s_nop 0
v_add_f32 v34, v34, v67
v_cvt_pk_bf16_f32 v65, v66, v67
v_exp_f32 v68, v68
s_nop 0
v_add_f32 v34, v34, v68
v_exp_f32 v69, v69
s_nop 0
v_add_f32 v34, v34, v69
v_cvt_pk_bf16_f32 v66, v68, v69
v_exp_f32 v70, v70
s_nop 0
v_add_f32 v34, v34, v70
v_exp_f32 v71, v71
s_nop 0
v_add_f32 v34, v34, v71
v_cvt_pk_bf16_f32 v67, v70, v71
v_exp_f32 v72, v72
s_nop 0
v_add_f32 v35, v35, v72
v_exp_f32 v73, v73
s_nop 0
v_add_f32 v35, v35, v73
v_cvt_pk_bf16_f32 v72, v72, v73
v_exp_f32 v74, v74
s_nop 0
v_add_f32 v35, v35, v74
v_exp_f32 v75, v75
s_nop 0
v_add_f32 v35, v35, v75
v_cvt_pk_bf16_f32 v73, v74, v75
v_exp_f32 v76, v76
s_nop 0
v_add_f32 v35, v35, v76
v_exp_f32 v77, v77
s_nop 0
v_add_f32 v35, v35, v77
v_cvt_pk_bf16_f32 v74, v76, v77
v_exp_f32 v78, v78
s_nop 0
v_add_f32 v35, v35, v78
v_exp_f32 v79, v79
s_nop 0
v_add_f32 v35, v35, v79
v_cvt_pk_bf16_f32 v75, v78, v79
v_exp_f32 v80, v80
s_nop 0
v_add_f32 v36, v36, v80
v_exp_f32 v81, v81
s_nop 0
v_add_f32 v36, v36, v81
v_cvt_pk_bf16_f32 v80, v80, v81
v_exp_f32 v82, v82
s_nop 0
v_add_f32 v36, v36, v82
v_exp_f32 v83, v83
s_nop 0
v_add_f32 v36, v36, v83
v_cvt_pk_bf16_f32 v81, v82, v83
v_exp_f32 v84, v84
s_nop 0
v_add_f32 v36, v36, v84
v_exp_f32 v85, v85
s_nop 0
v_add_f32 v36, v36, v85
v_cvt_pk_bf16_f32 v82, v84, v85
v_exp_f32 v86, v86
s_nop 0
v_add_f32 v36, v36, v86
v_exp_f32 v87, v87
s_nop 0
v_add_f32 v36, v36, v87
v_cvt_pk_bf16_f32 v83, v86, v87
v_exp_f32 v88, v88
s_nop 0
v_add_f32 v37, v37, v88
v_exp_f32 v89, v89
s_nop 0
v_add_f32 v37, v37, v89
v_cvt_pk_bf16_f32 v88, v88, v89
v_exp_f32 v90, v90
s_nop 0
v_add_f32 v37, v37, v90
v_exp_f32 v91, v91
s_nop 0
v_add_f32 v37, v37, v91
v_cvt_pk_bf16_f32 v89, v90, v91
v_exp_f32 v92, v92
s_nop 0
v_add_f32 v37, v37, v92
v_exp_f32 v93, v93
s_nop 0
v_add_f32 v37, v37, v93
v_cvt_pk_bf16_f32 v90, v92, v93
v_exp_f32 v94, v94
s_nop 0
v_add_f32 v37, v37, v94
v_exp_f32 v95, v95
s_nop 0
v_add_f32 v37, v37, v95
v_cvt_pk_bf16_f32 v91, v94, v95
v_exp_f32 v96, v96
s_nop 0
v_add_f32 v34, v34, v96
v_exp_f32 v97, v97
s_nop 0
v_add_f32 v34, v34, v97
v_cvt_pk_bf16_f32 v96, v96, v97
v_exp_f32 v98, v98
s_nop 0
v_add_f32 v34, v34, v98
v_exp_f32 v99, v99
s_nop 0
v_add_f32 v34, v34, v99
v_cvt_pk_bf16_f32 v97, v98, v99
v_exp_f32 v100, v100
s_nop 0
v_add_f32 v34, v34, v100
v_exp_f32 v101, v101
s_nop 0
v_add_f32 v34, v34, v101
v_cvt_pk_bf16_f32 v98, v100, v101
v_exp_f32 v102, v102
s_nop 0
v_add_f32 v34, v34, v102
v_exp_f32 v103, v103
s_nop 0
v_add_f32 v34, v34, v103
v_cvt_pk_bf16_f32 v99, v102, v103
v_exp_f32 v104, v104
s_nop 0
v_add_f32 v35, v35, v104
v_exp_f32 v105, v105
s_nop 0
v_add_f32 v35, v35, v105
v_cvt_pk_bf16_f32 v104, v104, v105
v_exp_f32 v106, v106
s_nop 0
v_add_f32 v35, v35, v106
v_exp_f32 v107, v107
s_nop 0
v_add_f32 v35, v35, v107
v_cvt_pk_bf16_f32 v105, v106, v107
v_exp_f32 v108, v108
s_nop 0
v_add_f32 v35, v35, v108
v_exp_f32 v109, v109
s_nop 0
v_add_f32 v35, v35, v109
v_cvt_pk_bf16_f32 v106, v108, v109
v_exp_f32 v110, v110
s_nop 0
v_add_f32 v35, v35, v110
v_exp_f32 v111, v111
s_nop 0
v_add_f32 v35, v35, v111
v_cvt_pk_bf16_f32 v107, v110, v111
v_exp_f32 v112, v112
s_nop 0
v_add_f32 v36, v36, v112
v_exp_f32 v113, v113
s_nop 0
v_add_f32 v36, v36, v113
v_cvt_pk_bf16_f32 v112, v112, v113
v_exp_f32 v114, v114
s_nop 0
v_add_f32 v36, v36, v114
v_exp_f32 v115, v115
s_nop 0
v_add_f32 v36, v36, v115
v_cvt_pk_bf16_f32 v113, v114, v115
v_exp_f32 v116, v116
s_nop 0
v_add_f32 v36, v36, v116
v_exp_f32 v117, v117
s_nop 0
v_add_f32 v36, v36, v117
v_cvt_pk_bf16_f32 v114, v116, v117
v_exp_f32 v118, v118
s_nop 0
v_add_f32 v36, v36, v118
v_exp_f32 v119, v119
s_nop 0
v_add_f32 v36, v36, v119
v_cvt_pk_bf16_f32 v115, v118, v119
v_exp_f32 v120, v120
s_nop 0
v_add_f32 v37, v37, v120
v_exp_f32 v121, v121
s_nop 0
v_add_f32 v37, v37, v121
v_cvt_pk_bf16_f32 v120, v120, v121
v_exp_f32 v122, v122
s_nop 0
v_add_f32 v37, v37, v122
v_exp_f32 v123, v123
s_nop 0
v_add_f32 v37, v37, v123
v_cvt_pk_bf16_f32 v121, v122, v123
v_exp_f32 v124, v124
s_nop 0
v_add_f32 v37, v37, v124
v_exp_f32 v125, v125
s_nop 0
v_add_f32 v37, v37, v125
v_cvt_pk_bf16_f32 v122, v124, v125
v_exp_f32 v126, v126
s_nop 0
v_add_f32 v37, v37, v126
v_exp_f32 v127, v127
s_nop 0
v_add_f32 v37, v37, v127
v_cvt_pk_bf16_f32 v123, v126, v127
s_setpc_b64 s[38:39]
L_attn_kernel_slow1:
s_add_u32 s52, s35, 0
buffer_load_dwordx4 a[192:195], v42, s[8:11], s52 offen offset:0
buffer_load_dwordx4 a[196:199], v42, s[8:11], s52 offen offset:64
buffer_load_dwordx4 a[200:203], v42, s[8:11], s52 offen offset:128
buffer_load_dwordx4 a[204:207], v42, s[8:11], s52 offen offset:192
s_add_u32 s52, s35, 4096
buffer_load_dwordx4 a[208:211], v42, s[8:11], s52 offen offset:0
buffer_load_dwordx4 a[212:215], v42, s[8:11], s52 offen offset:64
buffer_load_dwordx4 a[216:219], v42, s[8:11], s52 offen offset:128
buffer_load_dwordx4 a[220:223], v42, s[8:11], s52 offen offset:192
s_add_u32 s52, s35, 8192
buffer_load_dwordx4 a[224:227], v42, s[8:11], s52 offen offset:0
buffer_load_dwordx4 a[228:231], v42, s[8:11], s52 offen offset:64
buffer_load_dwordx4 a[232:235], v42, s[8:11], s52 offen offset:128
buffer_load_dwordx4 a[236:239], v42, s[8:11], s52 offen offset:192
s_add_u32 s52, s35, 12288
buffer_load_dwordx4 a[240:243], v42, s[8:11], s52 offen offset:0
buffer_load_dwordx4 a[244:247], v42, s[8:11], s52 offen offset:64
buffer_load_dwordx4 a[248:251], v42, s[8:11], s52 offen offset:128
buffer_load_dwordx4 a[252:255], v42, s[8:11], s52 offen offset:192
s_waitcnt vmcnt(0)
MM v[128:131],a[192:195],v[192:195],v[48:51]
MM v[128:131],a[196:199],v[196:199],v[128:131]
MM v[128:131],a[200:203],v[200:203],v[128:131]
MM v[128:131],a[204:207],v[204:207],v[128:131]
MM v[136:139],a[192:195],v[208:211],v[52:55]
MM v[136:139],a[196:199],v[212:215],v[136:139]
MM v[136:139],a[200:203],v[216:219],v[136:139]
MM v[136:139],a[204:207],v[220:223],v[136:139]
MM v[144:147],a[192:195],v[224:227],v[56:59]
MM v[144:147],a[196:199],v[228:231],v[144:147]
MM v[144:147],a[200:203],v[232:235],v[144:147]
MM v[144:147],a[204:207],v[236:239],v[144:147]
MM v[152:155],a[192:195],v[240:243],v[60:63]
MM v[152:155],a[196:199],v[244:247],v[152:155]
MM v[152:155],a[200:203],v[248:251],v[152:155]
MM v[152:155],a[204:207],v[252:255],v[152:155]
MM v[132:135],a[208:211],v[192:195],v[48:51]
MM v[132:135],a[212:215],v[196:199],v[132:135]
MM v[132:135],a[216:219],v[200:203],v[132:135]
MM v[132:135],a[220:223],v[204:207],v[132:135]
MM v[140:143],a[208:211],v[208:211],v[52:55]
MM v[140:143],a[212:215],v[212:215],v[140:143]
MM v[140:143],a[216:219],v[216:219],v[140:143]
MM v[140:143],a[220:223],v[220:223],v[140:143]
MM v[148:151],a[208:211],v[224:227],v[56:59]
MM v[148:151],a[212:215],v[228:231],v[148:151]
MM v[148:151],a[216:219],v[232:235],v[148:151]
MM v[148:151],a[220:223],v[236:239],v[148:151]
MM v[156:159],a[208:211],v[240:243],v[60:63]
MM v[156:159],a[212:215],v[244:247],v[156:159]
MM v[156:159],a[216:219],v[248:251],v[156:159]
MM v[156:159],a[220:223],v[252:255],v[156:159]
MM v[160:163],a[224:227],v[192:195],v[48:51]
MM v[160:163],a[228:231],v[196:199],v[160:163]
MM v[160:163],a[232:235],v[200:203],v[160:163]
MM v[160:163],a[236:239],v[204:207],v[160:163]
MM v[168:171],a[224:227],v[208:211],v[52:55]
MM v[168:171],a[228:231],v[212:215],v[168:171]
MM v[168:171],a[232:235],v[216:219],v[168:171]
MM v[168:171],a[236:239],v[220:223],v[168:171]
MM v[176:179],a[224:227],v[224:227],v[56:59]
MM v[176:179],a[228:231],v[228:231],v[176:179]
MM v[176:179],a[232:235],v[232:235],v[176:179]
MM v[176:179],a[236:239],v[236:239],v[176:179]
MM v[184:187],a[224:227],v[240:243],v[60:63]
MM v[184:187],a[228:231],v[244:247],v[184:187]
MM v[184:187],a[232:235],v[248:251],v[184:187]
MM v[184:187],a[236:239],v[252:255],v[184:187]
MM v[164:167],a[240:243],v[192:195],v[48:51]
MM v[164:167],a[244:247],v[196:199],v[164:167]
MM v[164:167],a[248:251],v[200:203],v[164:167]
MM v[164:167],a[252:255],v[204:207],v[164:167]
MM v[172:175],a[240:243],v[208:211],v[52:55]
MM v[172:175],a[244:247],v[212:215],v[172:175]
MM v[172:175],a[248:251],v[216:219],v[172:175]
MM v[172:175],a[252:255],v[220:223],v[172:175]
MM v[180:183],a[240:243],v[224:227],v[56:59]
MM v[180:183],a[244:247],v[228:231],v[180:183]
MM v[180:183],a[248:251],v[232:235],v[180:183]
MM v[180:183],a[252:255],v[236:239],v[180:183]
MM v[188:191],a[240:243],v[240:243],v[60:63]
MM v[188:191],a[244:247],v[244:247],v[188:191]
MM v[188:191],a[248:251],v[248:251],v[188:191]
MM v[188:191],a[252:255],v[252:255],v[188:191]
v_max3_f32 v44, v128, v129, v130
v_max3_f32 v44, v44, v131, v132
v_max3_f32 v44, v44, v133, v134
v_max3_f32 v44, v44, v135, v160
v_max3_f32 v44, v44, v161, v162
v_max3_f32 v44, v44, v163, v164
v_max3_f32 v44, v44, v165, v166
v_max_f32 v44, v44, v167
v_max3_f32 v45, v136, v137, v138
v_max3_f32 v45, v45, v139, v140
v_max3_f32 v45, v45, v141, v142
v_max3_f32 v45, v45, v143, v168
v_max3_f32 v45, v45, v169, v170
v_max3_f32 v45, v45, v171, v172
v_max3_f32 v45, v45, v173, v174
v_max_f32 v45, v45, v175
v_max3_f32 v46, v144, v145, v146
v_max3_f32 v46, v46, v147, v148
v_max3_f32 v46, v46, v149, v150
v_max3_f32 v46, v46, v151, v176
v_max3_f32 v46, v46, v177, v178
v_max3_f32 v46, v46, v179, v180
v_max3_f32 v46, v46, v181, v182
v_max_f32 v46, v46, v183
v_max3_f32 v47, v152, v153, v154
v_max3_f32 v47, v47, v155, v156
v_max3_f32 v47, v47, v157, v158
v_max3_f32 v47, v47, v159, v184
v_max3_f32 v47, v47, v185, v186
v_max3_f32 v47, v47, v187, v188
v_max3_f32 v47, v47, v189, v190
v_max_f32 v47, v47, v191
v_mov_b32 v2, v44
v_mov_b32 v3, v45
v_mov_b32 v4, v46
v_mov_b32 v5, v47
v_permlane16_swap_b32 v2, v44
v_permlane16_swap_b32 v3, v45
v_permlane16_swap_b32 v4, v46
v_permlane16_swap_b32 v5, v47
v_max_f32 v44, v44, v2
v_max_f32 v45, v45, v3
v_max_f32 v46, v46, v4
v_max_f32 v47, v47, v5
v_mov_b32 v2, v44
v_mov_b32 v3, v45
v_mov_b32 v4, v46
v_mov_b32 v5, v47
v_permlane32_swap_b32 v2, v44
v_permlane32_swap_b32 v3, v45
v_permlane32_swap_b32 v4, v46
v_permlane32_swap_b32 v5, v47
v_max_f32 v44, v44, v2
v_max_f32 v45, v45, v3
v_max_f32 v46, v46, v4
v_max_f32 v47, v47, v5
s_mov_b32 s53, 0x42400000
v_add_f32 v44, s53, v44
v_max_f32 v44, 0, v44
v_sub_f32 v2, 0, v44
v_exp_f32 v2, v2
v_sub_f32 v48, v48, v44
v_sub_f32 v49, v49, v44
v_sub_f32 v50, v50, v44
v_sub_f32 v51, v51, v44
v_mul_f32 v38, v38, v2
v_add_f32 v45, s53, v45
v_max_f32 v45, 0, v45
v_sub_f32 v3, 0, v45
v_exp_f32 v3, v3
v_sub_f32 v52, v52, v45
v_sub_f32 v53, v53, v45
v_sub_f32 v54, v54, v45
v_sub_f32 v55, v55, v45
v_mul_f32 v39, v39, v3
v_add_f32 v46, s53, v46
v_max_f32 v46, 0, v46
v_sub_f32 v4, 0, v46
v_exp_f32 v4, v4
v_sub_f32 v56, v56, v46
v_sub_f32 v57, v57, v46
v_sub_f32 v58, v58, v46
v_sub_f32 v59, v59, v46
v_mul_f32 v40, v40, v4
v_add_f32 v47, s53, v47
v_max_f32 v47, 0, v47
v_sub_f32 v5, 0, v47
v_exp_f32 v5, v5
v_sub_f32 v60, v60, v47
v_sub_f32 v61, v61, v47
v_sub_f32 v62, v62, v47
v_sub_f32 v63, v63, v47
v_mul_f32 v41, v41, v5
v_sub_f32 v128, v128, v44
v_sub_f32 v129, v129, v44
v_sub_f32 v130, v130, v44
v_sub_f32 v131, v131, v44
v_sub_f32 v136, v136, v45
v_sub_f32 v137, v137, v45
v_sub_f32 v138, v138, v45
v_sub_f32 v139, v139, v45
v_sub_f32 v144, v144, v46
v_sub_f32 v145, v145, v46
v_sub_f32 v146, v146, v46
v_sub_f32 v147, v147, v46
v_sub_f32 v152, v152, v47
v_sub_f32 v153, v153, v47
v_sub_f32 v154, v154, v47
v_sub_f32 v155, v155, v47
v_sub_f32 v132, v132, v44
v_sub_f32 v133, v133, v44
v_sub_f32 v134, v134, v44
v_sub_f32 v135, v135, v44
v_sub_f32 v140, v140, v45
v_sub_f32 v141, v141, v45
v_sub_f32 v142, v142, v45
v_sub_f32 v143, v143, v45
v_sub_f32 v148, v148, v46
v_sub_f32 v149, v149, v46
v_sub_f32 v150, v150, v46
v_sub_f32 v151, v151, v46
v_sub_f32 v156, v156, v47
v_sub_f32 v157, v157, v47
v_sub_f32 v158, v158, v47
v_sub_f32 v159, v159, v47
v_sub_f32 v160, v160, v44
v_sub_f32 v161, v161, v44
v_sub_f32 v162, v162, v44
v_sub_f32 v163, v163, v44
v_sub_f32 v168, v168, v45
v_sub_f32 v169, v169, v45
v_sub_f32 v170, v170, v45
v_sub_f32 v171, v171, v45
v_sub_f32 v176, v176, v46
v_sub_f32 v177, v177, v46
v_sub_f32 v178, v178, v46
v_sub_f32 v179, v179, v46
v_sub_f32 v184, v184, v47
v_sub_f32 v185, v185, v47
v_sub_f32 v186, v186, v47
v_sub_f32 v187, v187, v47
v_sub_f32 v164, v164, v44
v_sub_f32 v165, v165, v44
v_sub_f32 v166, v166, v44
v_sub_f32 v167, v167, v44
v_sub_f32 v172, v172, v45
v_sub_f32 v173, v173, v45
v_sub_f32 v174, v174, v45
v_sub_f32 v175, v175, v45
v_sub_f32 v180, v180, v46
v_sub_f32 v181, v181, v46
v_sub_f32 v182, v182, v46
v_sub_f32 v183, v183, v46
v_sub_f32 v188, v188, v47
v_sub_f32 v189, v189, v47
v_sub_f32 v190, v190, v47
v_sub_f32 v191, v191, v47
v_sub_f32 v64, v64, v44
v_sub_f32 v65, v65, v44
v_sub_f32 v66, v66, v44
v_sub_f32 v67, v67, v44
v_sub_f32 v72, v72, v45
v_sub_f32 v73, v73, v45
v_sub_f32 v74, v74, v45
v_sub_f32 v75, v75, v45
v_sub_f32 v80, v80, v46
v_sub_f32 v81, v81, v46
v_sub_f32 v82, v82, v46
v_sub_f32 v83, v83, v46
v_sub_f32 v88, v88, v47
v_sub_f32 v89, v89, v47
v_sub_f32 v90, v90, v47
v_sub_f32 v91, v91, v47
v_sub_f32 v68, v68, v44
v_sub_f32 v69, v69, v44
v_sub_f32 v70, v70, v44
v_sub_f32 v71, v71, v44
v_sub_f32 v76, v76, v45
v_sub_f32 v77, v77, v45
v_sub_f32 v78, v78, v45
v_sub_f32 v79, v79, v45
v_sub_f32 v84, v84, v46
v_sub_f32 v85, v85, v46
v_sub_f32 v86, v86, v46
v_sub_f32 v87, v87, v46
v_sub_f32 v92, v92, v47
v_sub_f32 v93, v93, v47
v_sub_f32 v94, v94, v47
v_sub_f32 v95, v95, v47
v_sub_f32 v96, v96, v44
v_sub_f32 v97, v97, v44
v_sub_f32 v98, v98, v44
v_sub_f32 v99, v99, v44
v_sub_f32 v104, v104, v45
v_sub_f32 v105, v105, v45
v_sub_f32 v106, v106, v45
v_sub_f32 v107, v107, v45
v_sub_f32 v112, v112, v46
v_sub_f32 v113, v113, v46
v_sub_f32 v114, v114, v46
v_sub_f32 v115, v115, v46
v_sub_f32 v120, v120, v47
v_sub_f32 v121, v121, v47
v_sub_f32 v122, v122, v47
v_sub_f32 v123, v123, v47
v_sub_f32 v100, v100, v44
v_sub_f32 v101, v101, v44
v_sub_f32 v102, v102, v44
v_sub_f32 v103, v103, v44
v_sub_f32 v108, v108, v45
v_sub_f32 v109, v109, v45
v_sub_f32 v110, v110, v45
v_sub_f32 v111, v111, v45
v_sub_f32 v116, v116, v46
v_sub_f32 v117, v117, v46
v_sub_f32 v118, v118, v46
v_sub_f32 v119, v119, v46
v_sub_f32 v124, v124, v47
v_sub_f32 v125, v125, v47
v_sub_f32 v126, v126, v47
v_sub_f32 v127, v127, v47
v_accvgpr_read_b32 v6, a0
v_mul_f32 v6, v6, v2
v_accvgpr_write_b32 a0, v6
v_accvgpr_read_b32 v6, a1
v_mul_f32 v6, v6, v2
v_accvgpr_write_b32 a1, v6
v_accvgpr_read_b32 v6, a2
v_mul_f32 v6, v6, v2
v_accvgpr_write_b32 a2, v6
v_accvgpr_read_b32 v6, a3
v_mul_f32 v6, v6, v2
v_accvgpr_write_b32 a3, v6
v_accvgpr_read_b32 v6, a4
v_mul_f32 v6, v6, v3
v_accvgpr_write_b32 a4, v6
v_accvgpr_read_b32 v6, a5
v_mul_f32 v6, v6, v3
v_accvgpr_write_b32 a5, v6
v_accvgpr_read_b32 v6, a6
v_mul_f32 v6, v6, v3
v_accvgpr_write_b32 a6, v6
v_accvgpr_read_b32 v6, a7
v_mul_f32 v6, v6, v3
v_accvgpr_write_b32 a7, v6
v_accvgpr_read_b32 v6, a8
v_mul_f32 v6, v6, v4
v_accvgpr_write_b32 a8, v6
v_accvgpr_read_b32 v6, a9
v_mul_f32 v6, v6, v4
v_accvgpr_write_b32 a9, v6
v_accvgpr_read_b32 v6, a10
v_mul_f32 v6, v6, v4
v_accvgpr_write_b32 a10, v6
v_accvgpr_read_b32 v6, a11
v_mul_f32 v6, v6, v4
v_accvgpr_write_b32 a11, v6
v_accvgpr_read_b32 v6, a12
v_mul_f32 v6, v6, v5
v_accvgpr_write_b32 a12, v6
v_accvgpr_read_b32 v6, a13
v_mul_f32 v6, v6, v5
v_accvgpr_write_b32 a13, v6
v_accvgpr_read_b32 v6, a14
v_mul_f32 v6, v6, v5
v_accvgpr_write_b32 a14, v6
v_accvgpr_read_b32 v6, a15
v_mul_f32 v6, v6, v5
v_accvgpr_write_b32 a15, v6
v_accvgpr_read_b32 v6, a16
v_mul_f32 v6, v6, v2
v_accvgpr_write_b32 a16, v6
v_accvgpr_read_b32 v6, a17
v_mul_f32 v6, v6, v2
v_accvgpr_write_b32 a17, v6
v_accvgpr_read_b32 v6, a18
v_mul_f32 v6, v6, v2
v_accvgpr_write_b32 a18, v6
v_accvgpr_read_b32 v6, a19
v_mul_f32 v6, v6, v2
v_accvgpr_write_b32 a19, v6
v_accvgpr_read_b32 v6, a20
v_mul_f32 v6, v6, v3
v_accvgpr_write_b32 a20, v6
v_accvgpr_read_b32 v6, a21
v_mul_f32 v6, v6, v3
v_accvgpr_write_b32 a21, v6
v_accvgpr_read_b32 v6, a22
v_mul_f32 v6, v6, v3
v_accvgpr_write_b32 a22, v6
v_accvgpr_read_b32 v6, a23
v_mul_f32 v6, v6, v3
v_accvgpr_write_b32 a23, v6
v_accvgpr_read_b32 v6, a24
v_mul_f32 v6, v6, v4
v_accvgpr_write_b32 a24, v6
v_accvgpr_read_b32 v6, a25
v_mul_f32 v6, v6, v4
v_accvgpr_write_b32 a25, v6
v_accvgpr_read_b32 v6, a26
v_mul_f32 v6, v6, v4
v_accvgpr_write_b32 a26, v6
v_accvgpr_read_b32 v6, a27
v_mul_f32 v6, v6, v4
v_accvgpr_write_b32 a27, v6
v_accvgpr_read_b32 v6, a28
v_mul_f32 v6, v6, v5
v_accvgpr_write_b32 a28, v6
v_accvgpr_read_b32 v6, a29
v_mul_f32 v6, v6, v5
v_accvgpr_write_b32 a29, v6
v_accvgpr_read_b32 v6, a30
v_mul_f32 v6, v6, v5
v_accvgpr_write_b32 a30, v6
v_accvgpr_read_b32 v6, a31
v_mul_f32 v6, v6, v5
v_accvgpr_write_b32 a31, v6
v_accvgpr_read_b32 v6, a32
v_mul_f32 v6, v6, v2
v_accvgpr_write_b32 a32, v6
v_accvgpr_read_b32 v6, a33
v_mul_f32 v6, v6, v2
v_accvgpr_write_b32 a33, v6
v_accvgpr_read_b32 v6, a34
v_mul_f32 v6, v6, v2
v_accvgpr_write_b32 a34, v6
v_accvgpr_read_b32 v6, a35
v_mul_f32 v6, v6, v2
v_accvgpr_write_b32 a35, v6
v_accvgpr_read_b32 v6, a36
v_mul_f32 v6, v6, v3
v_accvgpr_write_b32 a36, v6
v_accvgpr_read_b32 v6, a37
v_mul_f32 v6, v6, v3
v_accvgpr_write_b32 a37, v6
v_accvgpr_read_b32 v6, a38
v_mul_f32 v6, v6, v3
v_accvgpr_write_b32 a38, v6
v_accvgpr_read_b32 v6, a39
v_mul_f32 v6, v6, v3
v_accvgpr_write_b32 a39, v6
v_accvgpr_read_b32 v6, a40
v_mul_f32 v6, v6, v4
v_accvgpr_write_b32 a40, v6
v_accvgpr_read_b32 v6, a41
v_mul_f32 v6, v6, v4
v_accvgpr_write_b32 a41, v6
v_accvgpr_read_b32 v6, a42
v_mul_f32 v6, v6, v4
v_accvgpr_write_b32 a42, v6
v_accvgpr_read_b32 v6, a43
v_mul_f32 v6, v6, v4
v_accvgpr_write_b32 a43, v6
v_accvgpr_read_b32 v6, a44
v_mul_f32 v6, v6, v5
v_accvgpr_write_b32 a44, v6
v_accvgpr_read_b32 v6, a45
v_mul_f32 v6, v6, v5
v_accvgpr_write_b32 a45, v6
v_accvgpr_read_b32 v6, a46
v_mul_f32 v6, v6, v5
v_accvgpr_write_b32 a46, v6
v_accvgpr_read_b32 v6, a47
v_mul_f32 v6, v6, v5
v_accvgpr_write_b32 a47, v6
v_accvgpr_read_b32 v6, a48
v_mul_f32 v6, v6, v2
v_accvgpr_write_b32 a48, v6
v_accvgpr_read_b32 v6, a49
v_mul_f32 v6, v6, v2
v_accvgpr_write_b32 a49, v6
v_accvgpr_read_b32 v6, a50
v_mul_f32 v6, v6, v2
v_accvgpr_write_b32 a50, v6
v_accvgpr_read_b32 v6, a51
v_mul_f32 v6, v6, v2
v_accvgpr_write_b32 a51, v6
v_accvgpr_read_b32 v6, a52
v_mul_f32 v6, v6, v3
v_accvgpr_write_b32 a52, v6
v_accvgpr_read_b32 v6, a53
v_mul_f32 v6, v6, v3
v_accvgpr_write_b32 a53, v6
v_accvgpr_read_b32 v6, a54
v_mul_f32 v6, v6, v3
v_accvgpr_write_b32 a54, v6
v_accvgpr_read_b32 v6, a55
v_mul_f32 v6, v6, v3
v_accvgpr_write_b32 a55, v6
v_accvgpr_read_b32 v6, a56
v_mul_f32 v6, v6, v4
v_accvgpr_write_b32 a56, v6
v_accvgpr_read_b32 v6, a57
v_mul_f32 v6, v6, v4
v_accvgpr_write_b32 a57, v6
v_accvgpr_read_b32 v6, a58
v_mul_f32 v6, v6, v4
v_accvgpr_write_b32 a58, v6
v_accvgpr_read_b32 v6, a59
v_mul_f32 v6, v6, v4
v_accvgpr_write_b32 a59, v6
v_accvgpr_read_b32 v6, a60
v_mul_f32 v6, v6, v5
v_accvgpr_write_b32 a60, v6
v_accvgpr_read_b32 v6, a61
v_mul_f32 v6, v6, v5
v_accvgpr_write_b32 a61, v6
v_accvgpr_read_b32 v6, a62
v_mul_f32 v6, v6, v5
v_accvgpr_write_b32 a62, v6
v_accvgpr_read_b32 v6, a63
v_mul_f32 v6, v6, v5
v_accvgpr_write_b32 a63, v6
v_accvgpr_read_b32 v6, a64
v_mul_f32 v6, v6, v2
v_accvgpr_write_b32 a64, v6
v_accvgpr_read_b32 v6, a65
v_mul_f32 v6, v6, v2
v_accvgpr_write_b32 a65, v6
v_accvgpr_read_b32 v6, a66
v_mul_f32 v6, v6, v2
v_accvgpr_write_b32 a66, v6
v_accvgpr_read_b32 v6, a67
v_mul_f32 v6, v6, v2
v_accvgpr_write_b32 a67, v6
v_accvgpr_read_b32 v6, a68
v_mul_f32 v6, v6, v3
v_accvgpr_write_b32 a68, v6
v_accvgpr_read_b32 v6, a69
v_mul_f32 v6, v6, v3
v_accvgpr_write_b32 a69, v6
v_accvgpr_read_b32 v6, a70
v_mul_f32 v6, v6, v3
v_accvgpr_write_b32 a70, v6
v_accvgpr_read_b32 v6, a71
v_mul_f32 v6, v6, v3
v_accvgpr_write_b32 a71, v6
v_accvgpr_read_b32 v6, a72
v_mul_f32 v6, v6, v4
v_accvgpr_write_b32 a72, v6
v_accvgpr_read_b32 v6, a73
v_mul_f32 v6, v6, v4
v_accvgpr_write_b32 a73, v6
v_accvgpr_read_b32 v6, a74
v_mul_f32 v6, v6, v4
v_accvgpr_write_b32 a74, v6
v_accvgpr_read_b32 v6, a75
v_mul_f32 v6, v6, v4
v_accvgpr_write_b32 a75, v6
v_accvgpr_read_b32 v6, a76
v_mul_f32 v6, v6, v5
v_accvgpr_write_b32 a76, v6
v_accvgpr_read_b32 v6, a77
v_mul_f32 v6, v6, v5
v_accvgpr_write_b32 a77, v6
v_accvgpr_read_b32 v6, a78
v_mul_f32 v6, v6, v5
v_accvgpr_write_b32 a78, v6
v_accvgpr_read_b32 v6, a79
v_mul_f32 v6, v6, v5
v_accvgpr_write_b32 a79, v6
v_accvgpr_read_b32 v6, a80
v_mul_f32 v6, v6, v2
v_accvgpr_write_b32 a80, v6
v_accvgpr_read_b32 v6, a81
v_mul_f32 v6, v6, v2
v_accvgpr_write_b32 a81, v6
v_accvgpr_read_b32 v6, a82
v_mul_f32 v6, v6, v2
v_accvgpr_write_b32 a82, v6
v_accvgpr_read_b32 v6, a83
v_mul_f32 v6, v6, v2
v_accvgpr_write_b32 a83, v6
v_accvgpr_read_b32 v6, a84
v_mul_f32 v6, v6, v3
v_accvgpr_write_b32 a84, v6
v_accvgpr_read_b32 v6, a85
v_mul_f32 v6, v6, v3
v_accvgpr_write_b32 a85, v6
v_accvgpr_read_b32 v6, a86
v_mul_f32 v6, v6, v3
v_accvgpr_write_b32 a86, v6
v_accvgpr_read_b32 v6, a87
v_mul_f32 v6, v6, v3
v_accvgpr_write_b32 a87, v6
v_accvgpr_read_b32 v6, a88
v_mul_f32 v6, v6, v4
v_accvgpr_write_b32 a88, v6
v_accvgpr_read_b32 v6, a89
v_mul_f32 v6, v6, v4
v_accvgpr_write_b32 a89, v6
v_accvgpr_read_b32 v6, a90
v_mul_f32 v6, v6, v4
v_accvgpr_write_b32 a90, v6
v_accvgpr_read_b32 v6, a91
v_mul_f32 v6, v6, v4
v_accvgpr_write_b32 a91, v6
v_accvgpr_read_b32 v6, a92
v_mul_f32 v6, v6, v5
v_accvgpr_write_b32 a92, v6
v_accvgpr_read_b32 v6, a93
v_mul_f32 v6, v6, v5
v_accvgpr_write_b32 a93, v6
v_accvgpr_read_b32 v6, a94
v_mul_f32 v6, v6, v5
v_accvgpr_write_b32 a94, v6
v_accvgpr_read_b32 v6, a95
v_mul_f32 v6, v6, v5
v_accvgpr_write_b32 a95, v6
v_accvgpr_read_b32 v6, a96
v_mul_f32 v6, v6, v2
v_accvgpr_write_b32 a96, v6
v_accvgpr_read_b32 v6, a97
v_mul_f32 v6, v6, v2
v_accvgpr_write_b32 a97, v6
v_accvgpr_read_b32 v6, a98
v_mul_f32 v6, v6, v2
v_accvgpr_write_b32 a98, v6
v_accvgpr_read_b32 v6, a99
v_mul_f32 v6, v6, v2
v_accvgpr_write_b32 a99, v6
v_accvgpr_read_b32 v6, a100
v_mul_f32 v6, v6, v3
v_accvgpr_write_b32 a100, v6
v_accvgpr_read_b32 v6, a101
v_mul_f32 v6, v6, v3
v_accvgpr_write_b32 a101, v6
v_accvgpr_read_b32 v6, a102
v_mul_f32 v6, v6, v3
v_accvgpr_write_b32 a102, v6
v_accvgpr_read_b32 v6, a103
v_mul_f32 v6, v6, v3
v_accvgpr_write_b32 a103, v6
v_accvgpr_read_b32 v6, a104
v_mul_f32 v6, v6, v4
v_accvgpr_write_b32 a104, v6
v_accvgpr_read_b32 v6, a105
v_mul_f32 v6, v6, v4
v_accvgpr_write_b32 a105, v6
v_accvgpr_read_b32 v6, a106
v_mul_f32 v6, v6, v4
v_accvgpr_write_b32 a106, v6
v_accvgpr_read_b32 v6, a107
v_mul_f32 v6, v6, v4
v_accvgpr_write_b32 a107, v6
v_accvgpr_read_b32 v6, a108
v_mul_f32 v6, v6, v5
v_accvgpr_write_b32 a108, v6
v_accvgpr_read_b32 v6, a109
v_mul_f32 v6, v6, v5
v_accvgpr_write_b32 a109, v6
v_accvgpr_read_b32 v6, a110
v_mul_f32 v6, v6, v5
v_accvgpr_write_b32 a110, v6
v_accvgpr_read_b32 v6, a111
v_mul_f32 v6, v6, v5
v_accvgpr_write_b32 a111, v6
v_accvgpr_read_b32 v6, a112
v_mul_f32 v6, v6, v2
v_accvgpr_write_b32 a112, v6
v_accvgpr_read_b32 v6, a113
v_mul_f32 v6, v6, v2
v_accvgpr_write_b32 a113, v6
v_accvgpr_read_b32 v6, a114
v_mul_f32 v6, v6, v2
v_accvgpr_write_b32 a114, v6
v_accvgpr_read_b32 v6, a115
v_mul_f32 v6, v6, v2
v_accvgpr_write_b32 a115, v6
v_accvgpr_read_b32 v6, a116
v_mul_f32 v6, v6, v3
v_accvgpr_write_b32 a116, v6
v_accvgpr_read_b32 v6, a117
v_mul_f32 v6, v6, v3
v_accvgpr_write_b32 a117, v6
v_accvgpr_read_b32 v6, a118
v_mul_f32 v6, v6, v3
v_accvgpr_write_b32 a118, v6
v_accvgpr_read_b32 v6, a119
v_mul_f32 v6, v6, v3
v_accvgpr_write_b32 a119, v6
v_accvgpr_read_b32 v6, a120
v_mul_f32 v6, v6, v4
v_accvgpr_write_b32 a120, v6
v_accvgpr_read_b32 v6, a121
v_mul_f32 v6, v6, v4
v_accvgpr_write_b32 a121, v6
v_accvgpr_read_b32 v6, a122
v_mul_f32 v6, v6, v4
v_accvgpr_write_b32 a122, v6
v_accvgpr_read_b32 v6, a123
v_mul_f32 v6, v6, v4
v_accvgpr_write_b32 a123, v6
v_accvgpr_read_b32 v6, a124
v_mul_f32 v6, v6, v5
v_accvgpr_write_b32 a124, v6
v_accvgpr_read_b32 v6, a125
v_mul_f32 v6, v6, v5
v_accvgpr_write_b32 a125, v6
v_accvgpr_read_b32 v6, a126
v_mul_f32 v6, v6, v5
v_accvgpr_write_b32 a126, v6
v_accvgpr_read_b32 v6, a127
v_mul_f32 v6, v6, v5
v_accvgpr_write_b32 a127, v6
v_mov_b32 v34, 0
v_mov_b32 v35, 0
v_mov_b32 v36, 0
v_mov_b32 v37, 0
v_exp_f32 v128, v128
s_nop 0
v_add_f32 v34, v34, v128
v_exp_f32 v129, v129
s_nop 0
v_add_f32 v34, v34, v129
v_cvt_pk_bf16_f32 v128, v128, v129
v_exp_f32 v130, v130
s_nop 0
v_add_f32 v34, v34, v130
v_exp_f32 v131, v131
s_nop 0
v_add_f32 v34, v34, v131
v_cvt_pk_bf16_f32 v129, v130, v131
v_exp_f32 v132, v132
s_nop 0
v_add_f32 v34, v34, v132
v_exp_f32 v133, v133
s_nop 0
v_add_f32 v34, v34, v133
v_cvt_pk_bf16_f32 v130, v132, v133
v_exp_f32 v134, v134
s_nop 0
v_add_f32 v34, v34, v134
v_exp_f32 v135, v135
s_nop 0
v_add_f32 v34, v34, v135
v_cvt_pk_bf16_f32 v131, v134, v135
v_exp_f32 v136, v136
s_nop 0
v_add_f32 v35, v35, v136
v_exp_f32 v137, v137
s_nop 0
v_add_f32 v35, v35, v137
v_cvt_pk_bf16_f32 v136, v136, v137
v_exp_f32 v138, v138
s_nop 0
v_add_f32 v35, v35, v138
v_exp_f32 v139, v139
s_nop 0
v_add_f32 v35, v35, v139
v_cvt_pk_bf16_f32 v137, v138, v139
v_exp_f32 v140, v140
s_nop 0
v_add_f32 v35, v35, v140
v_exp_f32 v141, v141
s_nop 0
v_add_f32 v35, v35, v141
v_cvt_pk_bf16_f32 v138, v140, v141
v_exp_f32 v142, v142
s_nop 0
v_add_f32 v35, v35, v142
v_exp_f32 v143, v143
s_nop 0
v_add_f32 v35, v35, v143
v_cvt_pk_bf16_f32 v139, v142, v143
v_exp_f32 v144, v144
s_nop 0
v_add_f32 v36, v36, v144
v_exp_f32 v145, v145
s_nop 0
v_add_f32 v36, v36, v145
v_cvt_pk_bf16_f32 v144, v144, v145
v_exp_f32 v146, v146
s_nop 0
v_add_f32 v36, v36, v146
v_exp_f32 v147, v147
s_nop 0
v_add_f32 v36, v36, v147
v_cvt_pk_bf16_f32 v145, v146, v147
v_exp_f32 v148, v148
s_nop 0
v_add_f32 v36, v36, v148
v_exp_f32 v149, v149
s_nop 0
v_add_f32 v36, v36, v149
v_cvt_pk_bf16_f32 v146, v148, v149
v_exp_f32 v150, v150
s_nop 0
v_add_f32 v36, v36, v150
v_exp_f32 v151, v151
s_nop 0
v_add_f32 v36, v36, v151
v_cvt_pk_bf16_f32 v147, v150, v151
v_exp_f32 v152, v152
s_nop 0
v_add_f32 v37, v37, v152
v_exp_f32 v153, v153
s_nop 0
v_add_f32 v37, v37, v153
v_cvt_pk_bf16_f32 v152, v152, v153
v_exp_f32 v154, v154
s_nop 0
v_add_f32 v37, v37, v154
v_exp_f32 v155, v155
s_nop 0
v_add_f32 v37, v37, v155
v_cvt_pk_bf16_f32 v153, v154, v155
v_exp_f32 v156, v156
s_nop 0
v_add_f32 v37, v37, v156
v_exp_f32 v157, v157
s_nop 0
v_add_f32 v37, v37, v157
v_cvt_pk_bf16_f32 v154, v156, v157
v_exp_f32 v158, v158
s_nop 0
v_add_f32 v37, v37, v158
v_exp_f32 v159, v159
s_nop 0
v_add_f32 v37, v37, v159
v_cvt_pk_bf16_f32 v155, v158, v159
v_exp_f32 v160, v160
s_nop 0
v_add_f32 v34, v34, v160
v_exp_f32 v161, v161
s_nop 0
v_add_f32 v34, v34, v161
v_cvt_pk_bf16_f32 v160, v160, v161
v_exp_f32 v162, v162
s_nop 0
v_add_f32 v34, v34, v162
v_exp_f32 v163, v163
s_nop 0
v_add_f32 v34, v34, v163
v_cvt_pk_bf16_f32 v161, v162, v163
v_exp_f32 v164, v164
s_nop 0
v_add_f32 v34, v34, v164
v_exp_f32 v165, v165
s_nop 0
v_add_f32 v34, v34, v165
v_cvt_pk_bf16_f32 v162, v164, v165
v_exp_f32 v166, v166
s_nop 0
v_add_f32 v34, v34, v166
v_exp_f32 v167, v167
s_nop 0
v_add_f32 v34, v34, v167
v_cvt_pk_bf16_f32 v163, v166, v167
v_exp_f32 v168, v168
s_nop 0
v_add_f32 v35, v35, v168
v_exp_f32 v169, v169
s_nop 0
v_add_f32 v35, v35, v169
v_cvt_pk_bf16_f32 v168, v168, v169
v_exp_f32 v170, v170
s_nop 0
v_add_f32 v35, v35, v170
v_exp_f32 v171, v171
s_nop 0
v_add_f32 v35, v35, v171
v_cvt_pk_bf16_f32 v169, v170, v171
v_exp_f32 v172, v172
s_nop 0
v_add_f32 v35, v35, v172
v_exp_f32 v173, v173
s_nop 0
v_add_f32 v35, v35, v173
v_cvt_pk_bf16_f32 v170, v172, v173
v_exp_f32 v174, v174
s_nop 0
v_add_f32 v35, v35, v174
v_exp_f32 v175, v175
s_nop 0
v_add_f32 v35, v35, v175
v_cvt_pk_bf16_f32 v171, v174, v175
v_exp_f32 v176, v176
s_nop 0
v_add_f32 v36, v36, v176
v_exp_f32 v177, v177
s_nop 0
v_add_f32 v36, v36, v177
v_cvt_pk_bf16_f32 v176, v176, v177
v_exp_f32 v178, v178
s_nop 0
v_add_f32 v36, v36, v178
v_exp_f32 v179, v179
s_nop 0
v_add_f32 v36, v36, v179
v_cvt_pk_bf16_f32 v177, v178, v179
v_exp_f32 v180, v180
s_nop 0
v_add_f32 v36, v36, v180
v_exp_f32 v181, v181
s_nop 0
v_add_f32 v36, v36, v181
v_cvt_pk_bf16_f32 v178, v180, v181
v_exp_f32 v182, v182
s_nop 0
v_add_f32 v36, v36, v182
v_exp_f32 v183, v183
s_nop 0
v_add_f32 v36, v36, v183
v_cvt_pk_bf16_f32 v179, v182, v183
v_exp_f32 v184, v184
s_nop 0
v_add_f32 v37, v37, v184
v_exp_f32 v185, v185
s_nop 0
v_add_f32 v37, v37, v185
v_cvt_pk_bf16_f32 v184, v184, v185
v_exp_f32 v186, v186
s_nop 0
v_add_f32 v37, v37, v186
v_exp_f32 v187, v187
s_nop 0
v_add_f32 v37, v37, v187
v_cvt_pk_bf16_f32 v185, v186, v187
v_exp_f32 v188, v188
s_nop 0
v_add_f32 v37, v37, v188
v_exp_f32 v189, v189
s_nop 0
v_add_f32 v37, v37, v189
v_cvt_pk_bf16_f32 v186, v188, v189
v_exp_f32 v190, v190
s_nop 0
v_add_f32 v37, v37, v190
v_exp_f32 v191, v191
s_nop 0
v_add_f32 v37, v37, v191
v_cvt_pk_bf16_f32 v187, v190, v191
s_setpc_b64 s[38:39]
L_attn_kernel_codeend:
L_oproj_kernel_entry:
s_load_dwordx2 s[4:5], s[0:1], 32
s_load_dwordx2 s[44:45], s[0:1], 104
s_load_dwordx2 s[6:7], s[0:1], 0
s_load_dwordx2 s[28:29], s[0:1], 104
v_lshrrev_b32 v2, 6, v0
v_and_b32 v1, 63, v0
v_readfirstlane_b32 s30, v2
v_and_b32 v2, 15, v1
v_lshrrev_b32 v3, 4, v1
s_getpc_b64 s[92:93]
L_oproj_kernel_pc1:
s_mov_b32 s94, L_oproj_kernel_codeend-L_oproj_kernel_pc1
s_mov_b32 s95, 0x00020000
s_lshr_b32 s59, s2, 3
s_lshl_b32 s59, s59, 2
s_add_u32 s59, s59, s30
s_and_b32 s59, s59, 31
s_lshl_b32 s59, s59, 9
v_lshlrev_b32 v39, 7, v1
v_cmp_gt_u32 vcc, 4, v1
v_mov_b32 v6, 0x40000000
s_nop 0
v_cndmask_b32 v39, v6, v39, vcc
buffer_load_dword v38, v39, s[92:95], s59 offen
s_and_b32 s39, s2, 1
s_bfe_u32 s42, s2, 0x10002
s_lshl_b32 s42, s42, 3
s_bfe_u32 s43, s2, 0x30003
s_add_u32 s42, s42, s43
s_bfe_u32 s43, s2, 0x10001
s_lshl_b32 s43, s43, 2
s_lshr_b32 s46, s2, 6
s_add_u32 s43, s43, s46
s_lshl_b32 s43, s43, 1
s_lshl_b32 s46, s43, 7
s_mul_i32 s40, s39, 1
s_add_u32 s43, s43, s40
s_mul_i32 s40, s39, 4194304
s_add_u32 s40, s40, s46
s_lshl_b32 s33, s30, 13
s_lshl_b32 s47, s30, 16
v_lshlrev_b32 v4, 11, v3
v_add_u32 v4, s47, v4
v_add_u32 v5, 0, v3
v_lshlrev_b32 v5, 1, v5
v_xor_b32 v5, v5, v2
v_lshl_add_u32 v5, v5, 4, v4
v_add_u32 v8, 0, v5
v_add_u32 v5, 4, v3
v_lshlrev_b32 v5, 1, v5
v_xor_b32 v5, v5, v2
v_lshl_add_u32 v5, v5, 4, v4
v_add_u32 v9, 7168, v5
v_add_u32 v5, 0, v3
v_lshlrev_b32 v5, 1, v5
v_xor_b32 v5, v5, v2
v_lshl_add_u32 v5, v5, 4, v4
v_add_u32 v10, 14336, v5
v_add_u32 v5, 4, v3
v_lshlrev_b32 v5, 1, v5
v_xor_b32 v5, v5, v2
v_lshl_add_u32 v5, v5, 4, v4
v_add_u32 v11, 21504, v5
v_lshlrev_b32 v12, 4, v1
s_lshl_b32 s47, s42, 2
s_add_u32 s47, s47, s30
s_lshl_b32 s32, s47, 11
s_mul_i32 s41, s39, 8388608
s_add_u32 s32, s32, s41
s_sub_u32 s35, s32, 131072
s_mov_b32 s31, 4294737920
s_waitcnt lgkmcnt(0)
s_add_u32 s8, s4, s40
s_addc_u32 s9, s5, 0
s_mov_b32 s10, 4192512
s_mov_b32 s11, 0x00020000
s_add_u32 s16, s44, 8388608
s_addc_u32 s17, s45, 0
s_mov_b32 s18, 16777216
s_mov_b32 s19, 0x00020000
s_mov_b32 s24, s44
s_mov_b32 s25, s45
s_mov_b32 s26, 67108864
s_mov_b32 s27, 0x00020000
v_mov_b32 v36, 0
v_mov_b32 v37, 1
s_waitcnt vmcnt(0) lgkmcnt(0)
s_barrier
s_cmp_lg_u32 s30, 0
s_cbranch_scc1 L_oproj_kernel_pub2
buffer_store_dword v37, v36, s[24:27], s3 offen sc1
buffer_store_dword v37, v36, s[24:27], s79 offen sc1
L_oproj_kernel_pub2:
s_add_u32 m0, s33, 0
s_add_u32 s31, s31, 229376
buffer_load_dwordx4 v8, s[8:11], s31 offen offset:0  lds
buffer_load_dwordx4 v9, s[8:11], s31 offen offset:1024  lds
buffer_load_dwordx4 v10, s[8:11], s31 offen offset:2048  lds
buffer_load_dwordx4 v11, s[8:11], s31 offen offset:3072  lds
s_add_u32 m0, s33, 4096
s_add_u32 s31, s31, 32768
buffer_load_dwordx4 v8, s[8:11], s31 offen offset:0  lds
buffer_load_dwordx4 v9, s[8:11], s31 offen offset:1024  lds
buffer_load_dwordx4 v10, s[8:11], s31 offen offset:2048  lds
buffer_load_dwordx4 v11, s[8:11], s31 offen offset:3072  lds
s_add_u32 m0, s33, 32768
s_add_u32 s31, s31, 229376
buffer_load_dwordx4 v8, s[8:11], s31 offen offset:0  lds
buffer_load_dwordx4 v9, s[8:11], s31 offen offset:1024  lds
buffer_load_dwordx4 v10, s[8:11], s31 offen offset:2048  lds
buffer_load_dwordx4 v11, s[8:11], s31 offen offset:3072  lds
s_add_u32 m0, s33, 36864
s_add_u32 s31, s31, 32768
buffer_load_dwordx4 v8, s[8:11], s31 offen offset:0  lds
buffer_load_dwordx4 v9, s[8:11], s31 offen offset:1024  lds
buffer_load_dwordx4 v10, s[8:11], s31 offen offset:2048  lds
buffer_load_dwordx4 v11, s[8:11], s31 offen offset:3072  lds
s_mov_b32 s12, s6
s_mov_b32 s13, s7
s_mov_b32 s14, 4194304
s_mov_b32 s15, 0x00020000
s_add_u32 s20, s28, 25165824
s_addc_u32 s21, s29, 0
s_mov_b32 s22, 4194304
s_mov_b32 s23, 0x00020000
v_lshrrev_b32 v4, 2, v2
v_lshl_add_u32 v4, v3, 2, v4
v_and_b32 v5, 7, v4
v_lshlrev_b32 v5, 1, v5
v_bfe_u32 v6, v2, 1, 1
v_xor_b32 v5, v5, v6
s_lshl_b32 s48, s39, 3
v_xor_b32 v5, s48, v5
v_lshlrev_b32 v4, 8, v4
v_and_b32 v6, 1, v2
v_lshl_add_u32 v4, v6, 3, v4
v_xor_b32 v6, 0, v5
v_lshl_add_u32 v16, v6, 4, v4
v_add_u32 v24, 0x10000, v16
v_xor_b32 v6, 2, v5
v_lshl_add_u32 v17, v6, 4, v4
v_add_u32 v25, 0x10000, v17
v_xor_b32 v6, 4, v5
v_lshl_add_u32 v18, v6, 4, v4
v_add_u32 v26, 0x10000, v18
v_xor_b32 v6, 6, v5
v_lshl_add_u32 v19, v6, 4, v4
v_add_u32 v27, 0x10000, v19
v_xor_b32 v6, 8, v5
v_lshl_add_u32 v20, v6, 4, v4
v_add_u32 v28, 0x10000, v20
v_xor_b32 v6, 10, v5
v_lshl_add_u32 v21, v6, 4, v4
v_add_u32 v29, 0x10000, v21
v_xor_b32 v6, 12, v5
v_lshl_add_u32 v22, v6, 4, v4
v_add_u32 v30, 0x10000, v22
v_xor_b32 v6, 14, v5
v_lshl_add_u32 v23, v6, 4, v4
v_add_u32 v31, 0x10000, v23
s_mul_i32 s48, s30, 8704
s_movk_i32 s49, 272
v_mul_lo_u32 v32, v2, s49
v_lshl_add_u32 v32, v3, 4, v32
v_add_u32 v32, s48, v32
v_lshrrev_b32 v4, 3, v1
v_and_b32 v5, 7, v1
v_mul_lo_u32 v33, v4, s49
v_lshl_add_u32 v33, v5, 5, v33
v_add_u32 v33, s48, v33
v_lshlrev_b32 v34, 11, v4
v_lshl_add_u32 v34, v5, 4, v34
v_lshlrev_b32 v35, 5, v5
s_lshl_b32 s50, s47, 16
s_lshl_b32 s51, s43, 7
s_add_u32 s50, s50, s51
s_lshl_b32 s51, s43, 8
s_add_u32 s51, s51, 8192
s_lshl_b32 s53, s2, 2
s_add_u32 s53, s53, s30
s_xor_b32 s54, s53, 4
s_lshl_b32 s55, s53, 10
s_add_u32 s55, s55, 50331648
s_lshl_b32 s56, s54, 10
s_add_u32 s56, s56, 50331648
s_lshl_b32 s57, s53, 6
s_add_u32 s57, s57, 62914560
s_lshl_b32 s58, s54, 6
s_add_u32 s58, s58, 62914560
v_mov_b32 v36, 0
v_mov_b32 v37, 1
v_lshl_add_u32 v240, v5, 3, v4
v_lshlrev_b32 v240, 3, v240
v_cmp_gt_u32 vcc, 4, v5
v_mov_b32 v6, 0x40000000
s_nop 0
v_cndmask_b32 v240, v6, v240, vcc
v_cmp_eq_u32 s[86:87], 1, v5
v_cmp_eq_u32 s[88:89], 2, v5
v_cmp_eq_u32 s[90:91], 3, v5
v_lshlrev_b32 v241, 4, v2
v_add_u32 v241, s48, v241
v_lshlrev_b32 v243, 3, v4
v_add_u32 v243, s48, v243
v_lshrrev_b32 v6, 2, v4
v_lshlrev_b32 v242, 17, v6
v_and_b32 v6, 3, v4
v_lshl_add_u32 v242, v6, 8, v242
v_lshl_add_u32 v242, v5, 4, v242
v_xor_b32 v6, v4, v5
v_lshl_add_u32 v244, v5, 3, v6
v_lshlrev_b32 v244, 4, v244
v_add_u32 v244, s48, v244
v_lshl_add_u32 v245, v4, 3, v6
v_lshlrev_b32 v245, 4, v245
v_add_u32 v245, s48, v245
s_lshl_b32 s36, s47, 12
s_add_u32 s36, s36, 63963136
s_mov_b32 s37, s43
s_lshl_b32 s38, s37, 18
s_lshl_b32 s37, s37, 8
s_add_u32 s37, s37, s36
s_lshl_b32 s34, s47, 11
s_add_u32 s38, s38, s34
s_add_u32 s38, s38, 29360128
v_mov_b64 v[128:129], 0
v_mov_b64 v[130:131], 0
v_mov_b64 v[132:133], 0
v_mov_b64 v[134:135], 0
v_mov_b64 v[136:137], 0
v_mov_b64 v[138:139], 0
v_mov_b64 v[140:141], 0
v_mov_b64 v[142:143], 0
v_mov_b64 v[144:145], 0
v_mov_b64 v[146:147], 0
v_mov_b64 v[148:149], 0
v_mov_b64 v[150:151], 0
v_mov_b64 v[152:153], 0
v_mov_b64 v[154:155], 0
v_mov_b64 v[156:157], 0
v_mov_b64 v[158:159], 0
v_mov_b64 v[160:161], 0
v_mov_b64 v[162:163], 0
v_mov_b64 v[164:165], 0
v_mov_b64 v[166:167], 0
v_mov_b64 v[168:169], 0
v_mov_b64 v[170:171], 0
v_mov_b64 v[172:173], 0
v_mov_b64 v[174:175], 0
v_mov_b64 v[176:177], 0
v_mov_b64 v[178:179], 0
v_mov_b64 v[180:181], 0
v_mov_b64 v[182:183], 0
v_mov_b64 v[184:185], 0
v_mov_b64 v[186:187], 0
v_mov_b64 v[188:189], 0
v_mov_b64 v[190:191], 0
s_mov_b32 s34, 0
s_mov_b32 s80, s4
s_mov_b32 s81, s5
s_mov_b32 s82, 8388608
s_mov_b32 s83, 0x00020000
s_lshr_b32 s84, s2, 3
s_lshl_b32 s84, s84, 2
s_add_u32 s84, s84, s30
s_lshl_b32 s84, s84, 11
s_mul_i32 s85, s39, 4194304
s_add_u32 s84, s84, s85
s_bfe_u32 s85, s2, 0x10001
s_lshl_b32 s85, s85, 10
s_add_u32 s84, s84, s85
s_add_u32 s84, s84, 524288
v_lshlrev_b32 v7, 7, v1
v_cmp_gt_u32 vcc, 8, v1
v_mov_b32 v6, 0x40000000
s_nop 0
v_cndmask_b32 v7, v6, v7, vcc
buffer_load_dword v38, v7, s[80:83], s84 offen
s_add_u32 s84, s84, 262144
buffer_load_dword v38, v7, s[80:83], s84 offen
s_add_u32 s84, s84, 262144
s_lshr_b32 s52, s42, 1
s_lshl_b32 s52, s52, 7
s_lshl_b32 s49, s39, 6
s_add_u32 s52, s52, s49
v_lshlrev_b32 v41, 2, v2
v_add_u32 v41, s52, v41
v_lshrrev_b32 v42, 2, v2
v_lshlrev_b32 v42, 6, v42
v_and_b32 v43, 3, v2
v_add_u32 v42, v42, v43
s_lshl_b32 s49, s43, 2
v_add_u32 v42, s49, v42
v_lshlrev_b32 v42, 2, v42
v_add_u32 v42, 3072, v42
v_and_b32 v43, 1, v3
v_cmp_eq_u32 vcc, 0, v43
s_nop 1
v_cndmask_b32 v41, v42, v41, vcc
s_mov_b32 s52, 63111168
s_cmp_lg_u32 s30, 0
s_cbranch_scc1 L_oproj_kernel_pd4
s_mov_b32 s49, 0
L_oproj_kernel_pw3:
buffer_load_dword v40, v41, s[24:27], s52 offen sc1
s_waitcnt vmcnt(0)
v_cmp_ne_u32 vcc, 1, v40
s_cbranch_vccz L_oproj_kernel_pd4
s_sleep 3
s_add_u32 s49, s49, 1
s_cmp_lt_u32 s49, 0x40000
s_cbranch_scc1 L_oproj_kernel_pw3
L_oproj_kernel_pd4:
s_waitcnt vmcnt(0)
s_barrier
TR v[64:65],v20,0
TR v[66:67],v20,4096
TR v[68:69],v20,8192
TR v[70:71],v20,12288
TR v[72:73],v20,16384
TR v[74:75],v20,20480
TR v[76:77],v20,24576
TR v[78:79],v20,28672
TR v[80:81],v21,0
TR v[82:83],v21,4096
TR v[84:85],v21,8192
TR v[86:87],v21,12288
TR v[88:89],v21,16384
TR v[90:91],v21,20480
TR v[92:93],v21,24576
TR v[94:95],v21,28672
s_add_u32 s35, s35, 131072
buffer_load_dwordx4 a[0:3], v12, s[16:19], s35 offen offset:0 sc1
buffer_load_dwordx4 a[16:19], v12, s[16:19], s35 offen offset:1024 sc1
s_add_u32 s35, s35, 131072
buffer_load_dwordx4 a[4:7], v12, s[16:19], s35 offen offset:0 sc1
buffer_load_dwordx4 a[20:23], v12, s[16:19], s35 offen offset:1024 sc1
s_add_u32 s35, s35, 131072
buffer_load_dwordx4 a[8:11], v12, s[16:19], s35 offen offset:0 sc1
buffer_load_dwordx4 a[24:27], v12, s[16:19], s35 offen offset:1024 sc1
s_add_u32 s35, s35, 131072
buffer_load_dwordx4 a[12:15], v12, s[16:19], s35 offen offset:0 sc1
buffer_load_dwordx4 a[28:31], v12, s[16:19], s35 offen offset:1024 sc1
s_add_u32 s35, s35, 131072
buffer_load_dwordx4 a[32:35], v12, s[16:19], s35 offen offset:0 sc1
buffer_load_dwordx4 a[48:51], v12, s[16:19], s35 offen offset:1024 sc1
s_add_u32 s35, s35, 131072
buffer_load_dwordx4 a[36:39], v12, s[16:19], s35 offen offset:0 sc1
buffer_load_dwordx4 a[52:55], v12, s[16:19], s35 offen offset:1024 sc1
s_add_u32 s35, s35, 131072
buffer_load_dwordx4 a[40:43], v12, s[16:19], s35 offen offset:0 sc1
buffer_load_dwordx4 a[56:59], v12, s[16:19], s35 offen offset:1024 sc1
s_add_u32 s35, s35, 131072
buffer_load_dwordx4 a[44:47], v12, s[16:19], s35 offen offset:0 sc1
buffer_load_dwordx4 a[60:63], v12, s[16:19], s35 offen offset:1024 sc1
.p2align 6
L_oproj_kernel_loop:
s_waitcnt vmcnt(15) lgkmcnt(14)
MM v[160:163],v[64:67],a[0:3],v[160:163]
s_waitcnt vmcnt(13) lgkmcnt(12)
s_add_u32 m0, s33, 65536
s_add_u32 s31, s31, 229376
TR v[96:97],v22,0
MM v[160:163],v[68:71],a[4:7],v[160:163]
s_waitcnt vmcnt(11) lgkmcnt(11)
TR v[98:99],v22,4096
buffer_load_dwordx4 v8, s[8:11], s31 offen offset:0  lds
MM v[160:163],v[72:75],a[8:11],v[160:163]
s_waitcnt vmcnt(10) lgkmcnt(10)
TR v[100:101],v22,8192
MM v[160:163],v[76:79],a[12:15],v[160:163]
TR v[102:103],v22,12288
buffer_load_dword v38, v7, s[80:83], s84 offen
MM v[164:167],v[64:67],a[16:19],v[164:167]
TR v[104:105],v22,16384
MM v[164:167],v[68:71],a[20:23],v[164:167]
TR v[106:107],v22,20480
buffer_load_dwordx4 v9, s[8:11], s31 offen offset:1024  lds
MM v[164:167],v[72:75],a[24:27],v[164:167]
s_waitcnt vmcnt(11)
s_add_u32 s84, s84, 262144
TR v[108:109],v22,24576
MM v[164:167],v[76:79],a[28:31],v[164:167]
s_waitcnt lgkmcnt(13)
TR v[110:111],v22,28672
MM v[168:171],v[80:83],a[0:3],v[168:171]
s_waitcnt lgkmcnt(12)
TR v[112:113],v23,0
MM v[168:171],v[84:87],a[4:7],v[168:171]
s_waitcnt lgkmcnt(11)
TR v[114:115],v23,4096
buffer_load_dwordx4 v10, s[8:11], s31 offen offset:2048  lds
MM v[168:171],v[88:91],a[8:11],v[168:171]
s_waitcnt lgkmcnt(10)
TR v[116:117],v23,8192
MM v[168:171],v[92:95],a[12:15],v[168:171]
TR v[118:119],v23,12288
MM v[172:175],v[80:83],a[16:19],v[172:175]
TR v[120:121],v23,16384
MM v[172:175],v[84:87],a[20:23],v[172:175]
TR v[122:123],v23,20480
buffer_load_dwordx4 v11, s[8:11], s31 offen offset:3072  lds
MM v[172:175],v[88:91],a[24:27],v[172:175]
TR v[124:125],v23,24576
MM v[172:175],v[92:95],a[28:31],v[172:175]
s_waitcnt lgkmcnt(13)
TR v[126:127],v23,28672
MM v[176:179],v[96:99],a[0:3],v[176:179]
s_waitcnt lgkmcnt(12)
s_add_u32 m0, s33, 69632
s_add_u32 s31, s31, 32768
TR v[64:65],v16,0
MM v[176:179],v[100:103],a[4:7],v[176:179]
s_waitcnt lgkmcnt(11)
TR v[66:67],v16,4096
buffer_load_dwordx4 v8, s[8:11], s31 offen offset:0  lds
MM v[176:179],v[104:107],a[8:11],v[176:179]
s_waitcnt lgkmcnt(10)
TR v[68:69],v16,8192
MM v[176:179],v[108:111],a[12:15],v[176:179]
TR v[70:71],v16,12288
MM v[180:183],v[96:99],a[16:19],v[180:183]
TR v[72:73],v16,16384
MM v[180:183],v[100:103],a[20:23],v[180:183]
TR v[74:75],v16,20480
buffer_load_dwordx4 v9, s[8:11], s31 offen offset:1024  lds
MM v[180:183],v[104:107],a[24:27],v[180:183]
TR v[76:77],v16,24576
MM v[180:183],v[108:111],a[28:31],v[180:183]
s_waitcnt lgkmcnt(13)
TR v[78:79],v16,28672
MM v[184:187],v[112:115],a[0:3],v[184:187]
s_waitcnt lgkmcnt(12)
TR v[80:81],v17,0
MM v[184:187],v[116:119],a[4:7],v[184:187]
s_waitcnt lgkmcnt(11)
TR v[82:83],v17,4096
buffer_load_dwordx4 v10, s[8:11], s31 offen offset:2048  lds
MM v[184:187],v[120:123],a[8:11],v[184:187]
s_waitcnt lgkmcnt(10)
TR v[84:85],v17,8192
MM v[184:187],v[124:127],a[12:15],v[184:187]
TR v[86:87],v17,12288
MM v[188:191],v[112:115],a[16:19],v[188:191]
TR v[88:89],v17,16384
MM v[188:191],v[116:119],a[20:23],v[188:191]
TR v[90:91],v17,20480
buffer_load_dwordx4 v11, s[8:11], s31 offen offset:3072  lds
MM v[188:191],v[120:123],a[24:27],v[188:191]
TR v[92:93],v17,24576
MM v[188:191],v[124:127],a[28:31],v[188:191]
s_waitcnt lgkmcnt(13)
TR v[94:95],v17,28672
MM v[128:131],v[64:67],a[0:3],v[128:131]
s_waitcnt lgkmcnt(12)
s_add_u32 s35, s35, 131072
TR v[96:97],v18,0
MM v[128:131],v[68:71],a[4:7],v[128:131]
s_waitcnt lgkmcnt(11)
TR v[98:99],v18,4096
buffer_load_dwordx4 a[64:67], v12, s[16:19], s35 offen offset:0 sc1
MM v[128:131],v[72:75],a[8:11],v[128:131]
s_waitcnt lgkmcnt(10)
TR v[100:101],v18,8192
MM v[128:131],v[76:79],a[12:15],v[128:131]
TR v[102:103],v18,12288
MM v[132:135],v[64:67],a[16:19],v[132:135]
TR v[104:105],v18,16384
MM v[132:135],v[68:71],a[20:23],v[132:135]
TR v[106:107],v18,20480
buffer_load_dwordx4 a[80:83], v12, s[16:19], s35 offen offset:1024 sc1
MM v[132:135],v[72:75],a[24:27],v[132:135]
TR v[108:109],v18,24576
MM v[132:135],v[76:79],a[28:31],v[132:135]
s_waitcnt lgkmcnt(13)
TR v[110:111],v18,28672
MM v[136:139],v[80:83],a[0:3],v[136:139]
s_waitcnt lgkmcnt(12)
s_add_u32 s35, s35, 131072
TR v[112:113],v19,0
MM v[136:139],v[84:87],a[4:7],v[136:139]
s_waitcnt lgkmcnt(11)
TR v[114:115],v19,4096
buffer_load_dwordx4 a[68:71], v12, s[16:19], s35 offen offset:0 sc1
MM v[136:139],v[88:91],a[8:11],v[136:139]
s_waitcnt lgkmcnt(10)
TR v[116:117],v19,8192
MM v[136:139],v[92:95],a[12:15],v[136:139]
TR v[118:119],v19,12288
MM v[140:143],v[80:83],a[16:19],v[140:143]
TR v[120:121],v19,16384
MM v[140:143],v[84:87],a[20:23],v[140:143]
TR v[122:123],v19,20480
buffer_load_dwordx4 a[84:87], v12, s[16:19], s35 offen offset:1024 sc1
MM v[140:143],v[88:91],a[24:27],v[140:143]
TR v[124:125],v19,24576
MM v[140:143],v[92:95],a[28:31],v[140:143]
s_waitcnt vmcnt(21) lgkmcnt(13)
TR v[126:127],v19,28672
MM v[144:147],v[96:99],a[0:3],v[144:147]
s_barrier
s_waitcnt lgkmcnt(12)
MM v[144:147],v[100:103],a[4:7],v[144:147]
s_waitcnt lgkmcnt(10)
s_add_u32 s35, s35, 131072
TR v[64:65],v20,32768
MM v[144:147],v[104:107],a[8:11],v[144:147]
s_waitcnt lgkmcnt(9)
TR v[66:67],v20,36864
buffer_load_dwordx4 a[72:75], v12, s[16:19], s35 offen offset:0 sc1
MM v[144:147],v[108:111],a[12:15],v[144:147]
TR v[68:69],v20,40960
MM v[148:151],v[96:99],a[16:19],v[148:151]
TR v[70:71],v20,45056
MM v[148:151],v[100:103],a[20:23],v[148:151]
TR v[72:73],v20,49152
MM v[148:151],v[104:107],a[24:27],v[148:151]
TR v[74:75],v20,53248
buffer_load_dwordx4 a[88:91], v12, s[16:19], s35 offen offset:1024 sc1
MM v[148:151],v[108:111],a[28:31],v[148:151]
s_waitcnt lgkmcnt(12)
TR v[76:77],v20,57344
TR v[78:79],v20,61440
MM v[152:155],v[112:115],a[0:3],v[152:155]
s_waitcnt lgkmcnt(12)
TR v[80:81],v21,32768
MM v[152:155],v[116:119],a[4:7],v[152:155]
s_waitcnt lgkmcnt(11)
s_add_u32 s35, s35, 131072
TR v[82:83],v21,36864
MM v[152:155],v[120:123],a[8:11],v[152:155]
s_waitcnt lgkmcnt(10)
TR v[84:85],v21,40960
buffer_load_dwordx4 a[76:79], v12, s[16:19], s35 offen offset:0 sc1
MM v[152:155],v[124:127],a[12:15],v[152:155]
TR v[86:87],v21,45056
MM v[156:159],v[112:115],a[16:19],v[156:159]
TR v[88:89],v21,49152
MM v[156:159],v[116:119],a[20:23],v[156:159]
TR v[90:91],v21,53248
MM v[156:159],v[120:123],a[24:27],v[156:159]
TR v[92:93],v21,57344
buffer_load_dwordx4 a[92:95], v12, s[16:19], s35 offen offset:1024 sc1
MM v[156:159],v[124:127],a[28:31],v[156:159]
s_waitcnt vmcnt(24) lgkmcnt(13)
TR v[94:95],v21,61440
MM v[160:163],v[64:67],a[32:35],v[160:163]
s_waitcnt vmcnt(22) lgkmcnt(12)
s_add_u32 m0, s33, 98304
s_add_u32 s31, s31, 229376
TR v[96:97],v22,32768
MM v[160:163],v[68:71],a[36:39],v[160:163]
s_waitcnt vmcnt(20) lgkmcnt(11)
TR v[98:99],v22,36864
buffer_load_dwordx4 v8, s[8:11], s31 offen offset:0  lds
MM v[160:163],v[72:75],a[40:43],v[160:163]
s_waitcnt vmcnt(19) lgkmcnt(10)
TR v[100:101],v22,40960
MM v[160:163],v[76:79],a[44:47],v[160:163]
TR v[102:103],v22,45056
buffer_load_dword v38, v7, s[80:83], s84 offen
MM v[164:167],v[64:67],a[48:51],v[164:167]
TR v[104:105],v22,49152
MM v[164:167],v[68:71],a[52:55],v[164:167]
TR v[106:107],v22,53248
buffer_load_dwordx4 v9, s[8:11], s31 offen offset:1024  lds
MM v[164:167],v[72:75],a[56:59],v[164:167]
s_waitcnt vmcnt(20)
s_add_u32 s84, s84, 262144
TR v[108:109],v22,57344
MM v[164:167],v[76:79],a[60:63],v[164:167]
s_waitcnt lgkmcnt(13)
TR v[110:111],v22,61440
MM v[168:171],v[80:83],a[32:35],v[168:171]
s_waitcnt lgkmcnt(12)
TR v[112:113],v23,32768
MM v[168:171],v[84:87],a[36:39],v[168:171]
s_waitcnt lgkmcnt(11)
TR v[114:115],v23,36864
buffer_load_dwordx4 v10, s[8:11], s31 offen offset:2048  lds
MM v[168:171],v[88:91],a[40:43],v[168:171]
s_waitcnt lgkmcnt(10)
TR v[116:117],v23,40960
MM v[168:171],v[92:95],a[44:47],v[168:171]
TR v[118:119],v23,45056
MM v[172:175],v[80:83],a[48:51],v[172:175]
TR v[120:121],v23,49152
MM v[172:175],v[84:87],a[52:55],v[172:175]
TR v[122:123],v23,53248
buffer_load_dwordx4 v11, s[8:11], s31 offen offset:3072  lds
MM v[172:175],v[88:91],a[56:59],v[172:175]
TR v[124:125],v23,57344
MM v[172:175],v[92:95],a[60:63],v[172:175]
s_waitcnt lgkmcnt(13)
TR v[126:127],v23,61440
MM v[176:179],v[96:99],a[32:35],v[176:179]
s_waitcnt lgkmcnt(12)
s_add_u32 m0, s33, 102400
s_add_u32 s31, s31, 32768
TR v[64:65],v16,32768
MM v[176:179],v[100:103],a[36:39],v[176:179]
s_waitcnt lgkmcnt(11)
TR v[66:67],v16,36864
buffer_load_dwordx4 v8, s[8:11], s31 offen offset:0  lds
MM v[176:179],v[104:107],a[40:43],v[176:179]
s_waitcnt lgkmcnt(10)
TR v[68:69],v16,40960
MM v[176:179],v[108:111],a[44:47],v[176:179]
TR v[70:71],v16,45056
MM v[180:183],v[96:99],a[48:51],v[180:183]
TR v[72:73],v16,49152
MM v[180:183],v[100:103],a[52:55],v[180:183]
TR v[74:75],v16,53248
buffer_load_dwordx4 v9, s[8:11], s31 offen offset:1024  lds
MM v[180:183],v[104:107],a[56:59],v[180:183]
TR v[76:77],v16,57344
MM v[180:183],v[108:111],a[60:63],v[180:183]
s_waitcnt lgkmcnt(13)
TR v[78:79],v16,61440
MM v[184:187],v[112:115],a[32:35],v[184:187]
s_waitcnt lgkmcnt(12)
TR v[80:81],v17,32768
MM v[184:187],v[116:119],a[36:39],v[184:187]
s_waitcnt lgkmcnt(11)
TR v[82:83],v17,36864
buffer_load_dwordx4 v10, s[8:11], s31 offen offset:2048  lds
MM v[184:187],v[120:123],a[40:43],v[184:187]
s_waitcnt lgkmcnt(10)
TR v[84:85],v17,40960
MM v[184:187],v[124:127],a[44:47],v[184:187]
TR v[86:87],v17,45056
MM v[188:191],v[112:115],a[48:51],v[188:191]
TR v[88:89],v17,49152
MM v[188:191],v[116:119],a[52:55],v[188:191]
TR v[90:91],v17,53248
buffer_load_dwordx4 v11, s[8:11], s31 offen offset:3072  lds
MM v[188:191],v[120:123],a[56:59],v[188:191]
TR v[92:93],v17,57344
MM v[188:191],v[124:127],a[60:63],v[188:191]
s_waitcnt lgkmcnt(13)
TR v[94:95],v17,61440
MM v[128:131],v[64:67],a[32:35],v[128:131]
s_waitcnt lgkmcnt(12)
s_add_u32 s35, s35, 131072
TR v[96:97],v18,32768
MM v[128:131],v[68:71],a[36:39],v[128:131]
s_waitcnt lgkmcnt(11)
TR v[98:99],v18,36864
buffer_load_dwordx4 a[96:99], v12, s[16:19], s35 offen offset:0 sc1
MM v[128:131],v[72:75],a[40:43],v[128:131]
s_waitcnt lgkmcnt(10)
TR v[100:101],v18,40960
MM v[128:131],v[76:79],a[44:47],v[128:131]
TR v[102:103],v18,45056
MM v[132:135],v[64:67],a[48:51],v[132:135]
TR v[104:105],v18,49152
MM v[132:135],v[68:71],a[52:55],v[132:135]
TR v[106:107],v18,53248
buffer_load_dwordx4 a[112:115], v12, s[16:19], s35 offen offset:1024 sc1
MM v[132:135],v[72:75],a[56:59],v[132:135]
TR v[108:109],v18,57344
MM v[132:135],v[76:79],a[60:63],v[132:135]
s_waitcnt lgkmcnt(13)
TR v[110:111],v18,61440
MM v[136:139],v[80:83],a[32:35],v[136:139]
s_waitcnt lgkmcnt(12)
s_add_u32 s35, s35, 131072
TR v[112:113],v19,32768
MM v[136:139],v[84:87],a[36:39],v[136:139]
s_waitcnt lgkmcnt(11)
TR v[114:115],v19,36864
buffer_load_dwordx4 a[100:103], v12, s[16:19], s35 offen offset:0 sc1
MM v[136:139],v[88:91],a[40:43],v[136:139]
s_waitcnt lgkmcnt(10)
TR v[116:117],v19,40960
MM v[136:139],v[92:95],a[44:47],v[136:139]
TR v[118:119],v19,45056
MM v[140:143],v[80:83],a[48:51],v[140:143]
TR v[120:121],v19,49152
MM v[140:143],v[84:87],a[52:55],v[140:143]
TR v[122:123],v19,53248
buffer_load_dwordx4 a[116:119], v12, s[16:19], s35 offen offset:1024 sc1
MM v[140:143],v[88:91],a[56:59],v[140:143]
TR v[124:125],v19,57344
MM v[140:143],v[92:95],a[60:63],v[140:143]
s_waitcnt vmcnt(21) lgkmcnt(13)
TR v[126:127],v19,61440
MM v[144:147],v[96:99],a[32:35],v[144:147]
s_barrier
s_waitcnt lgkmcnt(12)
MM v[144:147],v[100:103],a[36:39],v[144:147]
s_waitcnt lgkmcnt(10)
s_add_u32 s35, s35, 131072
TR v[64:65],v28,0
MM v[144:147],v[104:107],a[40:43],v[144:147]
s_waitcnt lgkmcnt(9)
TR v[66:67],v28,4096
buffer_load_dwordx4 a[104:107], v12, s[16:19], s35 offen offset:0 sc1
MM v[144:147],v[108:111],a[44:47],v[144:147]
TR v[68:69],v28,8192
MM v[148:151],v[96:99],a[48:51],v[148:151]
TR v[70:71],v28,12288
MM v[148:151],v[100:103],a[52:55],v[148:151]
TR v[72:73],v28,16384
MM v[148:151],v[104:107],a[56:59],v[148:151]
TR v[74:75],v28,20480
buffer_load_dwordx4 a[120:123], v12, s[16:19], s35 offen offset:1024 sc1
MM v[148:151],v[108:111],a[60:63],v[148:151]
s_waitcnt lgkmcnt(12)
TR v[76:77],v28,24576
TR v[78:79],v28,28672
MM v[152:155],v[112:115],a[32:35],v[152:155]
s_waitcnt lgkmcnt(12)
TR v[80:81],v29,0
MM v[152:155],v[116:119],a[36:39],v[152:155]
s_waitcnt lgkmcnt(11)
s_add_u32 s35, s35, 131072
TR v[82:83],v29,4096
MM v[152:155],v[120:123],a[40:43],v[152:155]
s_waitcnt lgkmcnt(10)
TR v[84:85],v29,8192
buffer_load_dwordx4 a[108:111], v12, s[16:19], s35 offen offset:0 sc1
MM v[152:155],v[124:127],a[44:47],v[152:155]
TR v[86:87],v29,12288
MM v[156:159],v[112:115],a[48:51],v[156:159]
TR v[88:89],v29,16384
MM v[156:159],v[116:119],a[52:55],v[156:159]
TR v[90:91],v29,20480
MM v[156:159],v[120:123],a[56:59],v[156:159]
TR v[92:93],v29,24576
buffer_load_dwordx4 a[124:127], v12, s[16:19], s35 offen offset:1024 sc1
MM v[156:159],v[124:127],a[60:63],v[156:159]
s_waitcnt vmcnt(24) lgkmcnt(13)
TR v[94:95],v29,28672
MM v[160:163],v[64:67],a[64:67],v[160:163]
s_waitcnt vmcnt(22) lgkmcnt(12)
s_add_u32 m0, s33, 0
s_add_u32 s31, s31, 229376
TR v[96:97],v30,0
MM v[160:163],v[68:71],a[68:71],v[160:163]
s_waitcnt vmcnt(20) lgkmcnt(11)
TR v[98:99],v30,4096
buffer_load_dwordx4 v8, s[8:11], s31 offen offset:0  lds
MM v[160:163],v[72:75],a[72:75],v[160:163]
s_waitcnt vmcnt(19) lgkmcnt(10)
TR v[100:101],v30,8192
MM v[160:163],v[76:79],a[76:79],v[160:163]
TR v[102:103],v30,12288
buffer_load_dword v38, v7, s[80:83], s84 offen
MM v[164:167],v[64:67],a[80:83],v[164:167]
TR v[104:105],v30,16384
MM v[164:167],v[68:71],a[84:87],v[164:167]
TR v[106:107],v30,20480
buffer_load_dwordx4 v9, s[8:11], s31 offen offset:1024  lds
MM v[164:167],v[72:75],a[88:91],v[164:167]
s_waitcnt vmcnt(20)
s_add_u32 s84, s84, 262144
TR v[108:109],v30,24576
MM v[164:167],v[76:79],a[92:95],v[164:167]
s_waitcnt lgkmcnt(13)
TR v[110:111],v30,28672
MM v[168:171],v[80:83],a[64:67],v[168:171]
s_waitcnt lgkmcnt(12)
TR v[112:113],v31,0
MM v[168:171],v[84:87],a[68:71],v[168:171]
s_waitcnt lgkmcnt(11)
TR v[114:115],v31,4096
buffer_load_dwordx4 v10, s[8:11], s31 offen offset:2048  lds
MM v[168:171],v[88:91],a[72:75],v[168:171]
s_waitcnt lgkmcnt(10)
TR v[116:117],v31,8192
MM v[168:171],v[92:95],a[76:79],v[168:171]
TR v[118:119],v31,12288
MM v[172:175],v[80:83],a[80:83],v[172:175]
TR v[120:121],v31,16384
MM v[172:175],v[84:87],a[84:87],v[172:175]
TR v[122:123],v31,20480
buffer_load_dwordx4 v11, s[8:11], s31 offen offset:3072  lds
MM v[172:175],v[88:91],a[88:91],v[172:175]
TR v[124:125],v31,24576
MM v[172:175],v[92:95],a[92:95],v[172:175]
s_waitcnt lgkmcnt(13)
TR v[126:127],v31,28672
MM v[176:179],v[96:99],a[64:67],v[176:179]
s_waitcnt lgkmcnt(12)
s_add_u32 m0, s33, 4096
s_add_u32 s31, s31, 32768
TR v[64:65],v24,0
MM v[176:179],v[100:103],a[68:71],v[176:179]
s_waitcnt lgkmcnt(11)
TR v[66:67],v24,4096
buffer_load_dwordx4 v8, s[8:11], s31 offen offset:0  lds
MM v[176:179],v[104:107],a[72:75],v[176:179]
s_waitcnt lgkmcnt(10)
TR v[68:69],v24,8192
MM v[176:179],v[108:111],a[76:79],v[176:179]
TR v[70:71],v24,12288
MM v[180:183],v[96:99],a[80:83],v[180:183]
TR v[72:73],v24,16384
MM v[180:183],v[100:103],a[84:87],v[180:183]
TR v[74:75],v24,20480
buffer_load_dwordx4 v9, s[8:11], s31 offen offset:1024  lds
MM v[180:183],v[104:107],a[88:91],v[180:183]
TR v[76:77],v24,24576
MM v[180:183],v[108:111],a[92:95],v[180:183]
s_waitcnt lgkmcnt(13)
TR v[78:79],v24,28672
MM v[184:187],v[112:115],a[64:67],v[184:187]
s_waitcnt lgkmcnt(12)
TR v[80:81],v25,0
MM v[184:187],v[116:119],a[68:71],v[184:187]
s_waitcnt lgkmcnt(11)
TR v[82:83],v25,4096
buffer_load_dwordx4 v10, s[8:11], s31 offen offset:2048  lds
MM v[184:187],v[120:123],a[72:75],v[184:187]
s_waitcnt lgkmcnt(10)
TR v[84:85],v25,8192
MM v[184:187],v[124:127],a[76:79],v[184:187]
TR v[86:87],v25,12288
MM v[188:191],v[112:115],a[80:83],v[188:191]
TR v[88:89],v25,16384
MM v[188:191],v[116:119],a[84:87],v[188:191]
TR v[90:91],v25,20480
buffer_load_dwordx4 v11, s[8:11], s31 offen offset:3072  lds
MM v[188:191],v[120:123],a[88:91],v[188:191]
TR v[92:93],v25,24576
MM v[188:191],v[124:127],a[92:95],v[188:191]
s_waitcnt lgkmcnt(13)
TR v[94:95],v25,28672
MM v[128:131],v[64:67],a[64:67],v[128:131]
s_waitcnt lgkmcnt(12)
s_add_u32 s35, s35, 131072
TR v[96:97],v26,0
buffer_load_dword v38, v39, s[92:95], s59 offen
MM v[128:131],v[68:71],a[68:71],v[128:131]
s_waitcnt lgkmcnt(11)
TR v[98:99],v26,4096
buffer_load_dwordx4 a[0:3], v12, s[16:19], s35 offen offset:0 sc1
MM v[128:131],v[72:75],a[72:75],v[128:131]
s_waitcnt lgkmcnt(10)
TR v[100:101],v26,8192
MM v[128:131],v[76:79],a[76:79],v[128:131]
TR v[102:103],v26,12288
MM v[132:135],v[64:67],a[80:83],v[132:135]
TR v[104:105],v26,16384
MM v[132:135],v[68:71],a[84:87],v[132:135]
TR v[106:107],v26,20480
buffer_load_dwordx4 a[16:19], v12, s[16:19], s35 offen offset:1024 sc1
MM v[132:135],v[72:75],a[88:91],v[132:135]
TR v[108:109],v26,24576
MM v[132:135],v[76:79],a[92:95],v[132:135]
s_waitcnt lgkmcnt(13)
TR v[110:111],v26,28672
MM v[136:139],v[80:83],a[64:67],v[136:139]
s_waitcnt lgkmcnt(12)
s_add_u32 s35, s35, 131072
TR v[112:113],v27,0
MM v[136:139],v[84:87],a[68:71],v[136:139]
s_waitcnt lgkmcnt(11)
TR v[114:115],v27,4096
buffer_load_dwordx4 a[4:7], v12, s[16:19], s35 offen offset:0 sc1
MM v[136:139],v[88:91],a[72:75],v[136:139]
s_waitcnt lgkmcnt(10)
TR v[116:117],v27,8192
MM v[136:139],v[92:95],a[76:79],v[136:139]
TR v[118:119],v27,12288
MM v[140:143],v[80:83],a[80:83],v[140:143]
TR v[120:121],v27,16384
MM v[140:143],v[84:87],a[84:87],v[140:143]
TR v[122:123],v27,20480
buffer_load_dwordx4 a[20:23], v12, s[16:19], s35 offen offset:1024 sc1
MM v[140:143],v[88:91],a[88:91],v[140:143]
TR v[124:125],v27,24576
MM v[140:143],v[92:95],a[92:95],v[140:143]
s_waitcnt vmcnt(22) lgkmcnt(13)
TR v[126:127],v27,28672
MM v[144:147],v[96:99],a[64:67],v[144:147]
s_barrier
s_waitcnt lgkmcnt(12)
MM v[144:147],v[100:103],a[68:71],v[144:147]
s_waitcnt lgkmcnt(10)
s_add_u32 s35, s35, 131072
TR v[64:65],v28,32768
MM v[144:147],v[104:107],a[72:75],v[144:147]
s_waitcnt lgkmcnt(9)
TR v[66:67],v28,36864
buffer_load_dwordx4 a[8:11], v12, s[16:19], s35 offen offset:0 sc1
MM v[144:147],v[108:111],a[76:79],v[144:147]
TR v[68:69],v28,40960
MM v[148:151],v[96:99],a[80:83],v[148:151]
TR v[70:71],v28,45056
MM v[148:151],v[100:103],a[84:87],v[148:151]
TR v[72:73],v28,49152
MM v[148:151],v[104:107],a[88:91],v[148:151]
TR v[74:75],v28,53248
buffer_load_dwordx4 a[24:27], v12, s[16:19], s35 offen offset:1024 sc1
MM v[148:151],v[108:111],a[92:95],v[148:151]
s_waitcnt lgkmcnt(12)
TR v[76:77],v28,57344
TR v[78:79],v28,61440
MM v[152:155],v[112:115],a[64:67],v[152:155]
s_waitcnt lgkmcnt(12)
TR v[80:81],v29,32768
MM v[152:155],v[116:119],a[68:71],v[152:155]
s_waitcnt lgkmcnt(11)
s_add_u32 s35, s35, 131072
TR v[82:83],v29,36864
MM v[152:155],v[120:123],a[72:75],v[152:155]
s_waitcnt lgkmcnt(10)
TR v[84:85],v29,40960
buffer_load_dwordx4 a[12:15], v12, s[16:19], s35 offen offset:0 sc1
MM v[152:155],v[124:127],a[76:79],v[152:155]
TR v[86:87],v29,45056
MM v[156:159],v[112:115],a[80:83],v[156:159]
TR v[88:89],v29,49152
MM v[156:159],v[116:119],a[84:87],v[156:159]
TR v[90:91],v29,53248
MM v[156:159],v[120:123],a[88:91],v[156:159]
TR v[92:93],v29,57344
buffer_load_dwordx4 a[28:31], v12, s[16:19], s35 offen offset:1024 sc1
MM v[156:159],v[124:127],a[92:95],v[156:159]
s_waitcnt vmcnt(25) lgkmcnt(13)
TR v[94:95],v29,61440
MM v[160:163],v[64:67],a[96:99],v[160:163]
s_waitcnt vmcnt(23) lgkmcnt(12)
s_add_u32 m0, s33, 32768
s_add_u32 s31, s31, 229376
TR v[96:97],v30,32768
MM v[160:163],v[68:71],a[100:103],v[160:163]
s_waitcnt vmcnt(21) lgkmcnt(11)
TR v[98:99],v30,36864
buffer_load_dwordx4 v8, s[8:11], s31 offen offset:0  lds
MM v[160:163],v[72:75],a[104:107],v[160:163]
s_waitcnt vmcnt(20) lgkmcnt(10)
TR v[100:101],v30,40960
MM v[160:163],v[76:79],a[108:111],v[160:163]
TR v[102:103],v30,45056
buffer_load_dword v38, v7, s[80:83], s84 offen
MM v[164:167],v[64:67],a[112:115],v[164:167]
TR v[104:105],v30,49152
MM v[164:167],v[68:71],a[116:119],v[164:167]
TR v[106:107],v30,53248
buffer_load_dwordx4 v9, s[8:11], s31 offen offset:1024  lds
MM v[164:167],v[72:75],a[120:123],v[164:167]
s_waitcnt vmcnt(21)
s_add_u32 s84, s84, 262144
TR v[108:109],v30,57344
MM v[164:167],v[76:79],a[124:127],v[164:167]
s_waitcnt lgkmcnt(13)
TR v[110:111],v30,61440
MM v[168:171],v[80:83],a[96:99],v[168:171]
s_waitcnt lgkmcnt(12)
TR v[112:113],v31,32768
MM v[168:171],v[84:87],a[100:103],v[168:171]
s_waitcnt lgkmcnt(11)
TR v[114:115],v31,36864
buffer_load_dwordx4 v10, s[8:11], s31 offen offset:2048  lds
MM v[168:171],v[88:91],a[104:107],v[168:171]
s_waitcnt lgkmcnt(10)
TR v[116:117],v31,40960
MM v[168:171],v[92:95],a[108:111],v[168:171]
TR v[118:119],v31,45056
MM v[172:175],v[80:83],a[112:115],v[172:175]
TR v[120:121],v31,49152
MM v[172:175],v[84:87],a[116:119],v[172:175]
TR v[122:123],v31,53248
buffer_load_dwordx4 v11, s[8:11], s31 offen offset:3072  lds
MM v[172:175],v[88:91],a[120:123],v[172:175]
TR v[124:125],v31,57344
MM v[172:175],v[92:95],a[124:127],v[172:175]
s_waitcnt lgkmcnt(13)
TR v[126:127],v31,61440
MM v[176:179],v[96:99],a[96:99],v[176:179]
s_waitcnt lgkmcnt(12)
s_add_u32 m0, s33, 36864
s_add_u32 s31, s31, 32768
TR v[64:65],v24,32768
MM v[176:179],v[100:103],a[100:103],v[176:179]
s_waitcnt lgkmcnt(11)
TR v[66:67],v24,36864
buffer_load_dwordx4 v8, s[8:11], s31 offen offset:0  lds
MM v[176:179],v[104:107],a[104:107],v[176:179]
s_waitcnt lgkmcnt(10)
TR v[68:69],v24,40960
MM v[176:179],v[108:111],a[108:111],v[176:179]
TR v[70:71],v24,45056
MM v[180:183],v[96:99],a[112:115],v[180:183]
TR v[72:73],v24,49152
MM v[180:183],v[100:103],a[116:119],v[180:183]
TR v[74:75],v24,53248
buffer_load_dwordx4 v9, s[8:11], s31 offen offset:1024  lds
MM v[180:183],v[104:107],a[120:123],v[180:183]
TR v[76:77],v24,57344
MM v[180:183],v[108:111],a[124:127],v[180:183]
s_waitcnt lgkmcnt(13)
TR v[78:79],v24,61440
MM v[184:187],v[112:115],a[96:99],v[184:187]
s_waitcnt lgkmcnt(12)
TR v[80:81],v25,32768
MM v[184:187],v[116:119],a[100:103],v[184:187]
s_waitcnt lgkmcnt(11)
TR v[82:83],v25,36864
buffer_load_dwordx4 v10, s[8:11], s31 offen offset:2048  lds
MM v[184:187],v[120:123],a[104:107],v[184:187]
s_waitcnt lgkmcnt(10)
TR v[84:85],v25,40960
MM v[184:187],v[124:127],a[108:111],v[184:187]
TR v[86:87],v25,45056
MM v[188:191],v[112:115],a[112:115],v[188:191]
TR v[88:89],v25,49152
MM v[188:191],v[116:119],a[116:119],v[188:191]
TR v[90:91],v25,53248
buffer_load_dwordx4 v11, s[8:11], s31 offen offset:3072  lds
MM v[188:191],v[120:123],a[120:123],v[188:191]
TR v[92:93],v25,57344
MM v[188:191],v[124:127],a[124:127],v[188:191]
s_waitcnt lgkmcnt(13)
TR v[94:95],v25,61440
MM v[128:131],v[64:67],a[96:99],v[128:131]
s_waitcnt lgkmcnt(12)
s_add_u32 s35, s35, 131072
TR v[96:97],v26,32768
MM v[128:131],v[68:71],a[100:103],v[128:131]
s_waitcnt lgkmcnt(11)
TR v[98:99],v26,36864
buffer_load_dwordx4 a[32:35], v12, s[16:19], s35 offen offset:0 sc1
MM v[128:131],v[72:75],a[104:107],v[128:131]
s_waitcnt lgkmcnt(10)
TR v[100:101],v26,40960
MM v[128:131],v[76:79],a[108:111],v[128:131]
TR v[102:103],v26,45056
MM v[132:135],v[64:67],a[112:115],v[132:135]
TR v[104:105],v26,49152
MM v[132:135],v[68:71],a[116:119],v[132:135]
TR v[106:107],v26,53248
buffer_load_dwordx4 a[48:51], v12, s[16:19], s35 offen offset:1024 sc1
MM v[132:135],v[72:75],a[120:123],v[132:135]
TR v[108:109],v26,57344
MM v[132:135],v[76:79],a[124:127],v[132:135]
s_waitcnt lgkmcnt(13)
TR v[110:111],v26,61440
MM v[136:139],v[80:83],a[96:99],v[136:139]
s_waitcnt lgkmcnt(12)
s_add_u32 s35, s35, 131072
TR v[112:113],v27,32768
MM v[136:139],v[84:87],a[100:103],v[136:139]
s_waitcnt lgkmcnt(11)
TR v[114:115],v27,36864
buffer_load_dwordx4 a[36:39], v12, s[16:19], s35 offen offset:0 sc1
MM v[136:139],v[88:91],a[104:107],v[136:139]
s_waitcnt lgkmcnt(10)
TR v[116:117],v27,40960
MM v[136:139],v[92:95],a[108:111],v[136:139]
TR v[118:119],v27,45056
MM v[140:143],v[80:83],a[112:115],v[140:143]
TR v[120:121],v27,49152
MM v[140:143],v[84:87],a[116:119],v[140:143]
TR v[122:123],v27,53248
buffer_load_dwordx4 a[52:55], v12, s[16:19], s35 offen offset:1024 sc1
MM v[140:143],v[88:91],a[120:123],v[140:143]
TR v[124:125],v27,57344
MM v[140:143],v[92:95],a[124:127],v[140:143]
s_waitcnt vmcnt(22) lgkmcnt(13)
TR v[126:127],v27,61440
MM v[144:147],v[96:99],a[96:99],v[144:147]
s_barrier
s_waitcnt lgkmcnt(12)
MM v[144:147],v[100:103],a[100:103],v[144:147]
s_waitcnt lgkmcnt(10)
s_add_u32 s35, s35, 131072
TR v[64:65],v20,0
MM v[144:147],v[104:107],a[104:107],v[144:147]
s_waitcnt lgkmcnt(9)
TR v[66:67],v20,4096
buffer_load_dwordx4 a[40:43], v12, s[16:19], s35 offen offset:0 sc1
MM v[144:147],v[108:111],a[108:111],v[144:147]
TR v[68:69],v20,8192
MM v[148:151],v[96:99],a[112:115],v[148:151]
TR v[70:71],v20,12288
MM v[148:151],v[100:103],a[116:119],v[148:151]
TR v[72:73],v20,16384
MM v[148:151],v[104:107],a[120:123],v[148:151]
TR v[74:75],v20,20480
buffer_load_dwordx4 a[56:59], v12, s[16:19], s35 offen offset:1024 sc1
MM v[148:151],v[108:111],a[124:127],v[148:151]
s_waitcnt lgkmcnt(12)
TR v[76:77],v20,24576
TR v[78:79],v20,28672
MM v[152:155],v[112:115],a[96:99],v[152:155]
s_waitcnt lgkmcnt(12)
TR v[80:81],v21,0
MM v[152:155],v[116:119],a[100:103],v[152:155]
s_waitcnt lgkmcnt(11)
s_add_u32 s35, s35, 131072
TR v[82:83],v21,4096
MM v[152:155],v[120:123],a[104:107],v[152:155]
s_waitcnt lgkmcnt(10)
TR v[84:85],v21,8192
buffer_load_dwordx4 a[44:47], v12, s[16:19], s35 offen offset:0 sc1
MM v[152:155],v[124:127],a[108:111],v[152:155]
s_add_u32 s34, s34, 1
TR v[86:87],v21,12288
MM v[156:159],v[112:115],a[112:115],v[156:159]
TR v[88:89],v21,16384
MM v[156:159],v[116:119],a[116:119],v[156:159]
TR v[90:91],v21,20480
MM v[156:159],v[120:123],a[120:123],v[156:159]
TR v[92:93],v21,24576
buffer_load_dwordx4 a[60:63], v12, s[16:19], s35 offen offset:1024 sc1
MM v[156:159],v[124:127],a[124:127],v[156:159]
TR v[94:95],v21,28672
s_cmp_lt_u32 s34, 3
s_cbranch_scc1 L_oproj_kernel_loop
s_waitcnt vmcnt(24) lgkmcnt(14)
MM v[160:163],v[64:67],a[0:3],v[160:163]
s_waitcnt vmcnt(22) lgkmcnt(12)
TR v[96:97],v22,0
MM v[160:163],v[68:71],a[4:7],v[160:163]
s_waitcnt vmcnt(20) lgkmcnt(11)
s_add_u32 m0, s33, 65536
s_add_u32 s31, s31, 229376
TR v[98:99],v22,4096
MM v[160:163],v[72:75],a[8:11],v[160:163]
s_waitcnt vmcnt(18) lgkmcnt(10)
TR v[100:101],v22,8192
buffer_load_dwordx4 v8, s[8:11], s31 offen offset:0  lds
MM v[160:163],v[76:79],a[12:15],v[160:163]
TR v[102:103],v22,12288
MM v[164:167],v[64:67],a[16:19],v[164:167]
TR v[104:105],v22,16384
MM v[164:167],v[68:71],a[20:23],v[164:167]
TR v[106:107],v22,20480
MM v[164:167],v[72:75],a[24:27],v[164:167]
s_waitcnt vmcnt(18)
TR v[108:109],v22,24576
buffer_load_dwordx4 v9, s[8:11], s31 offen offset:1024  lds
MM v[164:167],v[76:79],a[28:31],v[164:167]
s_waitcnt lgkmcnt(13)
TR v[110:111],v22,28672
MM v[168:171],v[80:83],a[0:3],v[168:171]
s_waitcnt lgkmcnt(12)
TR v[112:113],v23,0
MM v[168:171],v[84:87],a[4:7],v[168:171]
s_waitcnt lgkmcnt(11)
TR v[114:115],v23,4096
MM v[168:171],v[88:91],a[8:11],v[168:171]
s_waitcnt lgkmcnt(10)
TR v[116:117],v23,8192
buffer_load_dwordx4 v10, s[8:11], s31 offen offset:2048  lds
MM v[168:171],v[92:95],a[12:15],v[168:171]
TR v[118:119],v23,12288
MM v[172:175],v[80:83],a[16:19],v[172:175]
TR v[120:121],v23,16384
MM v[172:175],v[84:87],a[20:23],v[172:175]
TR v[122:123],v23,20480
MM v[172:175],v[88:91],a[24:27],v[172:175]
TR v[124:125],v23,24576
buffer_load_dwordx4 v11, s[8:11], s31 offen offset:3072  lds
MM v[172:175],v[92:95],a[28:31],v[172:175]
s_waitcnt lgkmcnt(13)
TR v[126:127],v23,28672
MM v[176:179],v[96:99],a[0:3],v[176:179]
s_waitcnt lgkmcnt(12)
s_add_u32 m0, s33, 69632
s_add_u32 s31, s31, 32768
TR v[64:65],v16,0
MM v[176:179],v[100:103],a[4:7],v[176:179]
s_waitcnt lgkmcnt(11)
TR v[66:67],v16,4096
buffer_load_dwordx4 v8, s[8:11], s31 offen offset:0  lds
MM v[176:179],v[104:107],a[8:11],v[176:179]
s_waitcnt lgkmcnt(10)
TR v[68:69],v16,8192
MM v[176:179],v[108:111],a[12:15],v[176:179]
TR v[70:71],v16,12288
MM v[180:183],v[96:99],a[16:19],v[180:183]
TR v[72:73],v16,16384
buffer_load_dwordx4 v9, s[8:11], s31 offen offset:1024  lds
MM v[180:183],v[100:103],a[20:23],v[180:183]
TR v[74:75],v16,20480
MM v[180:183],v[104:107],a[24:27],v[180:183]
TR v[76:77],v16,24576
MM v[180:183],v[108:111],a[28:31],v[180:183]
s_waitcnt lgkmcnt(13)
TR v[78:79],v16,28672
buffer_load_dwordx4 v10, s[8:11], s31 offen offset:2048  lds
MM v[184:187],v[112:115],a[0:3],v[184:187]
s_waitcnt lgkmcnt(12)
TR v[80:81],v17,0
MM v[184:187],v[116:119],a[4:7],v[184:187]
s_waitcnt lgkmcnt(11)
TR v[82:83],v17,4096
MM v[184:187],v[120:123],a[8:11],v[184:187]
s_waitcnt lgkmcnt(10)
TR v[84:85],v17,8192
buffer_load_dwordx4 v11, s[8:11], s31 offen offset:3072  lds
MM v[184:187],v[124:127],a[12:15],v[184:187]
TR v[86:87],v17,12288
MM v[188:191],v[112:115],a[16:19],v[188:191]
s_add_u32 s35, s35, 131072
TR v[88:89],v17,16384
MM v[188:191],v[116:119],a[20:23],v[188:191]
TR v[90:91],v17,20480
buffer_load_dwordx4 a[64:67], v12, s[16:19], s35 offen offset:0 sc1
MM v[188:191],v[120:123],a[24:27],v[188:191]
TR v[92:93],v17,24576
MM v[188:191],v[124:127],a[28:31],v[188:191]
s_waitcnt lgkmcnt(13)
TR v[94:95],v17,28672
MM v[128:131],v[64:67],a[0:3],v[128:131]
s_waitcnt lgkmcnt(12)
TR v[96:97],v18,0
buffer_load_dwordx4 a[80:83], v12, s[16:19], s35 offen offset:1024 sc1
MM v[128:131],v[68:71],a[4:7],v[128:131]
s_waitcnt lgkmcnt(11)
TR v[98:99],v18,4096
MM v[128:131],v[72:75],a[8:11],v[128:131]
s_waitcnt lgkmcnt(10)
s_add_u32 s35, s35, 131072
TR v[100:101],v18,8192
MM v[128:131],v[76:79],a[12:15],v[128:131]
TR v[102:103],v18,12288
buffer_load_dwordx4 a[68:71], v12, s[16:19], s35 offen offset:0 sc1
MM v[132:135],v[64:67],a[16:19],v[132:135]
TR v[104:105],v18,16384
MM v[132:135],v[68:71],a[20:23],v[132:135]
TR v[106:107],v18,20480
MM v[132:135],v[72:75],a[24:27],v[132:135]
TR v[108:109],v18,24576
buffer_load_dwordx4 a[84:87], v12, s[16:19], s35 offen offset:1024 sc1
MM v[132:135],v[76:79],a[28:31],v[132:135]
s_waitcnt lgkmcnt(13)
TR v[110:111],v18,28672
MM v[136:139],v[80:83],a[0:3],v[136:139]
s_waitcnt lgkmcnt(12)
s_add_u32 s35, s35, 131072
TR v[112:113],v19,0
MM v[136:139],v[84:87],a[4:7],v[136:139]
s_waitcnt lgkmcnt(11)
TR v[114:115],v19,4096
buffer_load_dwordx4 a[72:75], v12, s[16:19], s35 offen offset:0 sc1
MM v[136:139],v[88:91],a[8:11],v[136:139]
s_waitcnt lgkmcnt(10)
TR v[116:117],v19,8192
MM v[136:139],v[92:95],a[12:15],v[136:139]
TR v[118:119],v19,12288
MM v[140:143],v[80:83],a[16:19],v[140:143]
TR v[120:121],v19,16384
buffer_load_dwordx4 a[88:91], v12, s[16:19], s35 offen offset:1024 sc1
MM v[140:143],v[84:87],a[20:23],v[140:143]
TR v[122:123],v19,20480
MM v[140:143],v[88:91],a[24:27],v[140:143]
TR v[124:125],v19,24576
MM v[140:143],v[92:95],a[28:31],v[140:143]
s_waitcnt vmcnt(22) lgkmcnt(13)
TR v[126:127],v19,28672
MM v[144:147],v[96:99],a[0:3],v[144:147]
s_barrier
s_add_u32 s35, s35, 131072
s_waitcnt lgkmcnt(12)
MM v[144:147],v[100:103],a[4:7],v[144:147]
s_waitcnt lgkmcnt(10)
TR v[64:65],v20,32768
buffer_load_dwordx4 a[76:79], v12, s[16:19], s35 offen offset:0 sc1
MM v[144:147],v[104:107],a[8:11],v[144:147]
s_waitcnt lgkmcnt(9)
TR v[66:67],v20,36864
MM v[144:147],v[108:111],a[12:15],v[144:147]
TR v[68:69],v20,40960
MM v[148:151],v[96:99],a[16:19],v[148:151]
TR v[70:71],v20,45056
buffer_load_dwordx4 a[92:95], v12, s[16:19], s35 offen offset:1024 sc1
MM v[148:151],v[100:103],a[20:23],v[148:151]
TR v[72:73],v20,49152
MM v[148:151],v[104:107],a[24:27],v[148:151]
s_add_u32 m0, s33, 98304
s_add_u32 s31, s31, 229376
TR v[74:75],v20,53248
MM v[148:151],v[108:111],a[28:31],v[148:151]
s_waitcnt lgkmcnt(12)
TR v[76:77],v20,57344
TR v[78:79],v20,61440
buffer_load_dwordx4 v8, s[8:11], s31 offen offset:0  lds
MM v[152:155],v[112:115],a[0:3],v[152:155]
s_waitcnt lgkmcnt(12)
TR v[80:81],v21,32768
MM v[152:155],v[116:119],a[4:7],v[152:155]
s_waitcnt lgkmcnt(11)
TR v[82:83],v21,36864
MM v[152:155],v[120:123],a[8:11],v[152:155]
s_waitcnt lgkmcnt(10)
TR v[84:85],v21,40960
buffer_load_dwordx4 v9, s[8:11], s31 offen offset:1024  lds
MM v[152:155],v[124:127],a[12:15],v[152:155]
TR v[86:87],v21,45056
MM v[156:159],v[112:115],a[16:19],v[156:159]
TR v[88:89],v21,49152
MM v[156:159],v[116:119],a[20:23],v[156:159]
TR v[90:91],v21,53248
buffer_load_dwordx4 v10, s[8:11], s31 offen offset:2048  lds
MM v[156:159],v[120:123],a[24:27],v[156:159]
TR v[92:93],v21,57344
MM v[156:159],v[124:127],a[28:31],v[156:159]
s_waitcnt vmcnt(26) lgkmcnt(13)
TR v[94:95],v21,61440
MM v[160:163],v[64:67],a[32:35],v[160:163]
s_waitcnt vmcnt(24) lgkmcnt(12)
TR v[96:97],v22,32768
buffer_load_dwordx4 v11, s[8:11], s31 offen offset:3072  lds
MM v[160:163],v[68:71],a[36:39],v[160:163]
s_waitcnt vmcnt(23) lgkmcnt(11)
TR v[98:99],v22,36864
MM v[160:163],v[72:75],a[40:43],v[160:163]
s_waitcnt vmcnt(21) lgkmcnt(10)
s_add_u32 m0, s33, 102400
s_add_u32 s31, s31, 32768
TR v[100:101],v22,40960
MM v[160:163],v[76:79],a[44:47],v[160:163]
TR v[102:103],v22,45056
buffer_load_dwordx4 v8, s[8:11], s31 offen offset:0  lds
MM v[164:167],v[64:67],a[48:51],v[164:167]
TR v[104:105],v22,49152
MM v[164:167],v[68:71],a[52:55],v[164:167]
TR v[106:107],v22,53248
MM v[164:167],v[72:75],a[56:59],v[164:167]
s_waitcnt vmcnt(21)
TR v[108:109],v22,57344
buffer_load_dwordx4 v9, s[8:11], s31 offen offset:1024  lds
MM v[164:167],v[76:79],a[60:63],v[164:167]
s_waitcnt lgkmcnt(13)
TR v[110:111],v22,61440
MM v[168:171],v[80:83],a[32:35],v[168:171]
s_waitcnt lgkmcnt(12)
TR v[112:113],v23,32768
MM v[168:171],v[84:87],a[36:39],v[168:171]
s_waitcnt lgkmcnt(11)
TR v[114:115],v23,36864
buffer_load_dwordx4 v10, s[8:11], s31 offen offset:2048  lds
MM v[168:171],v[88:91],a[40:43],v[168:171]
s_waitcnt lgkmcnt(10)
TR v[116:117],v23,40960
MM v[168:171],v[92:95],a[44:47],v[168:171]
TR v[118:119],v23,45056
MM v[172:175],v[80:83],a[48:51],v[172:175]
TR v[120:121],v23,49152
buffer_load_dwordx4 v11, s[8:11], s31 offen offset:3072  lds
MM v[172:175],v[84:87],a[52:55],v[172:175]
TR v[122:123],v23,53248
MM v[172:175],v[88:91],a[56:59],v[172:175]
TR v[124:125],v23,57344
MM v[172:175],v[92:95],a[60:63],v[172:175]
s_waitcnt vmcnt(16) lgkmcnt(13)
TR v[126:127],v23,61440
MM v[176:179],v[96:99],a[32:35],v[176:179]
s_barrier
s_add_u32 s35, s35, 131072
s_waitcnt lgkmcnt(12)
MM v[176:179],v[100:103],a[36:39],v[176:179]
s_waitcnt lgkmcnt(10)
TR v[64:65],v28,0
buffer_load_dwordx4 a[96:99], v12, s[16:19], s35 offen offset:0 sc1
MM v[176:179],v[104:107],a[40:43],v[176:179]
s_waitcnt lgkmcnt(9)
TR v[66:67],v28,4096
MM v[176:179],v[108:111],a[44:47],v[176:179]
TR v[68:69],v28,8192
MM v[180:183],v[96:99],a[48:51],v[180:183]
TR v[70:71],v28,12288
buffer_load_dwordx4 a[112:115], v12, s[16:19], s35 offen offset:1024 sc1
MM v[180:183],v[100:103],a[52:55],v[180:183]
TR v[72:73],v28,16384
MM v[180:183],v[104:107],a[56:59],v[180:183]
s_add_u32 s35, s35, 131072
TR v[74:75],v28,20480
MM v[180:183],v[108:111],a[60:63],v[180:183]
s_waitcnt lgkmcnt(12)
TR v[76:77],v28,24576
TR v[78:79],v28,28672
buffer_load_dwordx4 a[100:103], v12, s[16:19], s35 offen offset:0 sc1
MM v[184:187],v[112:115],a[32:35],v[184:187]
s_waitcnt lgkmcnt(12)
TR v[80:81],v29,0
MM v[184:187],v[116:119],a[36:39],v[184:187]
s_waitcnt lgkmcnt(11)
TR v[82:83],v29,4096
MM v[184:187],v[120:123],a[40:43],v[184:187]
s_waitcnt lgkmcnt(10)
TR v[84:85],v29,8192
buffer_load_dwordx4 a[116:119], v12, s[16:19], s35 offen offset:1024 sc1
MM v[184:187],v[124:127],a[44:47],v[184:187]
TR v[86:87],v29,12288
MM v[188:191],v[112:115],a[48:51],v[188:191]
s_add_u32 s35, s35, 131072
TR v[88:89],v29,16384
MM v[188:191],v[116:119],a[52:55],v[188:191]
TR v[90:91],v29,20480
buffer_load_dwordx4 a[104:107], v12, s[16:19], s35 offen offset:0 sc1
MM v[188:191],v[120:123],a[56:59],v[188:191]
TR v[92:93],v29,24576
MM v[188:191],v[124:127],a[60:63],v[188:191]
s_waitcnt vmcnt(20) lgkmcnt(13)
TR v[94:95],v29,28672
MM v[160:163],v[64:67],a[64:67],v[160:163]
s_waitcnt vmcnt(18) lgkmcnt(12)
TR v[96:97],v30,0
buffer_load_dwordx4 a[120:123], v12, s[16:19], s35 offen offset:1024 sc1
MM v[160:163],v[68:71],a[68:71],v[160:163]
s_waitcnt vmcnt(17) lgkmcnt(11)
TR v[98:99],v30,4096
MM v[160:163],v[72:75],a[72:75],v[160:163]
s_waitcnt vmcnt(15) lgkmcnt(10)
s_add_u32 s35, s35, 131072
TR v[100:101],v30,8192
MM v[160:163],v[76:79],a[76:79],v[160:163]
TR v[102:103],v30,12288
buffer_load_dwordx4 a[108:111], v12, s[16:19], s35 offen offset:0 sc1
MM v[164:167],v[64:67],a[80:83],v[164:167]
TR v[104:105],v30,16384
MM v[164:167],v[68:71],a[84:87],v[164:167]
TR v[106:107],v30,20480
MM v[164:167],v[72:75],a[88:91],v[164:167]
s_waitcnt vmcnt(15)
TR v[108:109],v30,24576
buffer_load_dwordx4 a[124:127], v12, s[16:19], s35 offen offset:1024 sc1
MM v[164:167],v[76:79],a[92:95],v[164:167]
s_waitcnt lgkmcnt(13)
TR v[110:111],v30,28672
MM v[168:171],v[80:83],a[64:67],v[168:171]
s_waitcnt lgkmcnt(12)
TR v[112:113],v31,0
MM v[168:171],v[84:87],a[68:71],v[168:171]
s_waitcnt lgkmcnt(11)
TR v[114:115],v31,4096
MM v[168:171],v[88:91],a[72:75],v[168:171]
s_waitcnt lgkmcnt(10)
TR v[116:117],v31,8192
MM v[168:171],v[92:95],a[76:79],v[168:171]
TR v[118:119],v31,12288
MM v[172:175],v[80:83],a[80:83],v[172:175]
TR v[120:121],v31,16384
MM v[172:175],v[84:87],a[84:87],v[172:175]
TR v[122:123],v31,20480
MM v[172:175],v[88:91],a[88:91],v[172:175]
TR v[124:125],v31,24576
MM v[172:175],v[92:95],a[92:95],v[172:175]
s_waitcnt vmcnt(8) lgkmcnt(13)
TR v[126:127],v31,28672
MM v[176:179],v[96:99],a[64:67],v[176:179]
s_barrier
s_waitcnt lgkmcnt(12)
MM v[176:179],v[100:103],a[68:71],v[176:179]
s_waitcnt lgkmcnt(10)
TR v[64:65],v28,32768
MM v[176:179],v[104:107],a[72:75],v[176:179]
s_waitcnt lgkmcnt(9)
TR v[66:67],v28,36864
MM v[176:179],v[108:111],a[76:79],v[176:179]
TR v[68:69],v28,40960
MM v[180:183],v[96:99],a[80:83],v[180:183]
TR v[70:71],v28,45056
MM v[180:183],v[100:103],a[84:87],v[180:183]
TR v[72:73],v28,49152
MM v[180:183],v[104:107],a[88:91],v[180:183]
TR v[74:75],v28,53248
MM v[180:183],v[108:111],a[92:95],v[180:183]
s_waitcnt lgkmcnt(12)
TR v[76:77],v28,57344
TR v[78:79],v28,61440
MM v[184:187],v[112:115],a[64:67],v[184:187]
s_waitcnt lgkmcnt(12)
TR v[80:81],v29,32768
MM v[184:187],v[116:119],a[68:71],v[184:187]
s_waitcnt lgkmcnt(11)
TR v[82:83],v29,36864
MM v[184:187],v[120:123],a[72:75],v[184:187]
s_waitcnt lgkmcnt(10)
TR v[84:85],v29,40960
MM v[184:187],v[124:127],a[76:79],v[184:187]
TR v[86:87],v29,45056
MM v[188:191],v[112:115],a[80:83],v[188:191]
TR v[88:89],v29,49152
MM v[188:191],v[116:119],a[84:87],v[188:191]
TR v[90:91],v29,53248
MM v[188:191],v[120:123],a[88:91],v[188:191]
TR v[92:93],v29,57344
MM v[188:191],v[124:127],a[92:95],v[188:191]
s_waitcnt vmcnt(7) lgkmcnt(13)
TR v[94:95],v29,61440
MM v[160:163],v[64:67],a[96:99],v[160:163]
s_waitcnt vmcnt(5) lgkmcnt(12)
TR v[96:97],v30,32768
MM v[160:163],v[68:71],a[100:103],v[160:163]
s_waitcnt vmcnt(3) lgkmcnt(11)
TR v[98:99],v30,36864
MM v[160:163],v[72:75],a[104:107],v[160:163]
s_waitcnt vmcnt(1) lgkmcnt(10)
TR v[100:101],v30,40960
MM v[160:163],v[76:79],a[108:111],v[160:163]
TR v[102:103],v30,45056
MM v[164:167],v[64:67],a[112:115],v[164:167]
TR v[104:105],v30,49152
MM v[164:167],v[68:71],a[116:119],v[164:167]
TR v[106:107],v30,53248
MM v[164:167],v[72:75],a[120:123],v[164:167]
s_waitcnt vmcnt(0)
TR v[108:109],v30,57344
MM v[164:167],v[76:79],a[124:127],v[164:167]
s_waitcnt lgkmcnt(13)
TR v[110:111],v30,61440
MM v[168:171],v[80:83],a[96:99],v[168:171]
s_waitcnt lgkmcnt(12)
TR v[112:113],v31,32768
MM v[168:171],v[84:87],a[100:103],v[168:171]
s_waitcnt lgkmcnt(11)
TR v[114:115],v31,36864
MM v[168:171],v[88:91],a[104:107],v[168:171]
s_waitcnt lgkmcnt(10)
TR v[116:117],v31,40960
s_add_u32 s52, s50, 0
MM v[168:171],v[92:95],a[108:111],v[168:171]
TR v[118:119],v31,45056
buffer_load_dwordx4 v[40:43], v34, s[12:15], s52 offen sc1
MM v[172:175],v[80:83],a[112:115],v[172:175]
TR v[120:121],v31,49152
s_add_u32 s52, s50, 16384
MM v[172:175],v[84:87],a[116:119],v[172:175]
TR v[122:123],v31,53248
buffer_load_dwordx4 v[44:47], v34, s[12:15], s52 offen sc1
MM v[172:175],v[88:91],a[120:123],v[172:175]
TR v[124:125],v31,57344
s_add_u32 s52, s50, 32768
MM v[172:175],v[92:95],a[124:127],v[172:175]
s_waitcnt lgkmcnt(13)
TR v[126:127],v31,61440
buffer_load_dwordx4 v[48:51], v34, s[12:15], s52 offen sc1
MM v[176:179],v[96:99],a[96:99],v[176:179]
s_waitcnt lgkmcnt(12)
TR v[64:65],v16,32768
s_add_u32 s52, s50, 49152
MM v[176:179],v[100:103],a[100:103],v[176:179]
s_waitcnt lgkmcnt(11)
TR v[66:67],v16,36864
buffer_load_dwordx4 v[52:55], v34, s[12:15], s52 offen sc1
MM v[176:179],v[104:107],a[104:107],v[176:179]
s_waitcnt lgkmcnt(10)
TR v[68:69],v16,40960
buffer_load_dwordx4 v[56:59], v35, s[24:27], s51 offen sc1
MM v[176:179],v[108:111],a[108:111],v[176:179]
TR v[70:71],v16,45056
buffer_load_dwordx4 v[60:63], v35, s[24:27], s51 offen offset:16 sc1
MM v[180:183],v[96:99],a[112:115],v[180:183]
TR v[72:73],v16,49152
s_add_u32 s52, s51, 4096
MM v[180:183],v[100:103],a[116:119],v[180:183]
TR v[74:75],v16,53248
buffer_load_dwordx4 v[224:227], v35, s[24:27], s52 offen sc1
MM v[180:183],v[104:107],a[120:123],v[180:183]
TR v[76:77],v16,57344
buffer_load_dwordx4 v[228:231], v35, s[24:27], s52 offen offset:16 sc1
MM v[180:183],v[108:111],a[124:127],v[180:183]
s_waitcnt lgkmcnt(13)
TR v[78:79],v16,61440
s_add_u32 s52, s51, 8192
MM v[184:187],v[112:115],a[96:99],v[184:187]
s_waitcnt lgkmcnt(12)
TR v[80:81],v17,32768
buffer_load_dwordx4 v[232:235], v35, s[24:27], s52 offen sc1
MM v[184:187],v[116:119],a[100:103],v[184:187]
s_waitcnt lgkmcnt(11)
TR v[82:83],v17,36864
buffer_load_dwordx4 v[236:239], v35, s[24:27], s52 offen offset:16 sc1
MM v[184:187],v[120:123],a[104:107],v[184:187]
s_waitcnt lgkmcnt(10)
TR v[84:85],v17,40960
MM v[184:187],v[124:127],a[108:111],v[184:187]
TR v[86:87],v17,45056
MM v[188:191],v[112:115],a[112:115],v[188:191]
TR v[88:89],v17,49152
MM v[188:191],v[116:119],a[116:119],v[188:191]
TR v[90:91],v17,53248
MM v[188:191],v[120:123],a[120:123],v[188:191]
TR v[92:93],v17,57344
MM v[188:191],v[124:127],a[124:127],v[188:191]
s_waitcnt lgkmcnt(13)
TR v[94:95],v17,61440
MM v[128:131],v[64:67],a[32:35],v[128:131]
s_waitcnt lgkmcnt(12)
TR v[96:97],v18,32768
MM v[128:131],v[68:71],a[36:39],v[128:131]
s_waitcnt lgkmcnt(11)
TR v[98:99],v18,36864
MM v[128:131],v[72:75],a[40:43],v[128:131]
s_waitcnt lgkmcnt(10)
TR v[100:101],v18,40960
v_cvt_pk_bf16_f32 v160, v160, v161
MM v[128:131],v[76:79],a[44:47],v[128:131]
TR v[102:103],v18,45056
v_cvt_pk_bf16_f32 v161, v162, v163
MM v[132:135],v[64:67],a[48:51],v[132:135]
TR v[104:105],v18,49152
v_cvt_pk_bf16_f32 v162, v164, v165
MM v[132:135],v[68:71],a[52:55],v[132:135]
TR v[106:107],v18,53248
v_cvt_pk_bf16_f32 v163, v166, v167
MM v[132:135],v[72:75],a[56:59],v[132:135]
TR v[108:109],v18,57344
buffer_store_dwordx4 v[160:163], v12, s[24:27], s55 offen sc1
MM v[132:135],v[76:79],a[60:63],v[132:135]
s_waitcnt lgkmcnt(13)
TR v[110:111],v18,61440
v_cvt_pk_bf16_f32 v168, v168, v169
MM v[136:139],v[80:83],a[32:35],v[136:139]
s_waitcnt lgkmcnt(12)
TR v[112:113],v19,32768
v_cvt_pk_bf16_f32 v169, v170, v171
MM v[136:139],v[84:87],a[36:39],v[136:139]
s_waitcnt lgkmcnt(11)
TR v[114:115],v19,36864
v_cvt_pk_bf16_f32 v170, v172, v173
MM v[136:139],v[88:91],a[40:43],v[136:139]
s_waitcnt lgkmcnt(10)
TR v[116:117],v19,40960
v_cvt_pk_bf16_f32 v171, v174, v175
MM v[136:139],v[92:95],a[44:47],v[136:139]
TR v[118:119],v19,45056
s_add_u32 s55, s55, 1048576
MM v[140:143],v[80:83],a[48:51],v[140:143]
TR v[120:121],v19,49152
buffer_store_dwordx4 v[168:171], v12, s[24:27], s55 offen sc1
MM v[140:143],v[84:87],a[52:55],v[140:143]
TR v[122:123],v19,53248
v_cvt_pk_bf16_f32 v176, v176, v177
MM v[140:143],v[88:91],a[56:59],v[140:143]
TR v[124:125],v19,57344
v_cvt_pk_bf16_f32 v177, v178, v179
MM v[140:143],v[92:95],a[60:63],v[140:143]
s_waitcnt lgkmcnt(13)
TR v[126:127],v19,61440
v_cvt_pk_bf16_f32 v178, v180, v181
MM v[144:147],v[96:99],a[32:35],v[144:147]
s_waitcnt lgkmcnt(12)
TR v[64:65],v24,0
v_cvt_pk_bf16_f32 v179, v182, v183
MM v[144:147],v[100:103],a[36:39],v[144:147]
s_waitcnt lgkmcnt(11)
TR v[66:67],v24,4096
s_add_u32 s55, s55, 1048576
MM v[144:147],v[104:107],a[40:43],v[144:147]
s_waitcnt lgkmcnt(10)
TR v[68:69],v24,8192
buffer_store_dwordx4 v[176:179], v12, s[24:27], s55 offen sc1
MM v[144:147],v[108:111],a[44:47],v[144:147]
TR v[70:71],v24,12288
v_cvt_pk_bf16_f32 v184, v184, v185
MM v[148:151],v[96:99],a[48:51],v[148:151]
TR v[72:73],v24,16384
v_cvt_pk_bf16_f32 v185, v186, v187
MM v[148:151],v[100:103],a[52:55],v[148:151]
TR v[74:75],v24,20480
v_cvt_pk_bf16_f32 v186, v188, v189
MM v[148:151],v[104:107],a[56:59],v[148:151]
TR v[76:77],v24,24576
v_cvt_pk_bf16_f32 v187, v190, v191
MM v[148:151],v[108:111],a[60:63],v[148:151]
s_waitcnt lgkmcnt(13)
TR v[78:79],v24,28672
s_add_u32 s55, s55, 1048576
MM v[152:155],v[112:115],a[32:35],v[152:155]
s_waitcnt lgkmcnt(12)
TR v[80:81],v25,0
buffer_store_dwordx4 v[184:187], v12, s[24:27], s55 offen sc1
MM v[152:155],v[116:119],a[36:39],v[152:155]
s_waitcnt lgkmcnt(11)
TR v[82:83],v25,4096
MM v[152:155],v[120:123],a[40:43],v[152:155]
s_waitcnt lgkmcnt(10)
TR v[84:85],v25,8192
MM v[152:155],v[124:127],a[44:47],v[152:155]
TR v[86:87],v25,12288
MM v[156:159],v[112:115],a[48:51],v[156:159]
TR v[88:89],v25,16384
MM v[156:159],v[116:119],a[52:55],v[156:159]
TR v[90:91],v25,20480
MM v[156:159],v[120:123],a[56:59],v[156:159]
TR v[92:93],v25,24576
MM v[156:159],v[124:127],a[60:63],v[156:159]
s_waitcnt lgkmcnt(13)
TR v[94:95],v25,28672
MM v[128:131],v[64:67],a[64:67],v[128:131]
s_waitcnt lgkmcnt(12)
TR v[96:97],v26,0
MM v[128:131],v[68:71],a[68:71],v[128:131]
s_waitcnt lgkmcnt(11)
TR v[98:99],v26,4096
MM v[128:131],v[72:75],a[72:75],v[128:131]
s_waitcnt lgkmcnt(10)
TR v[100:101],v26,8192
MM v[128:131],v[76:79],a[76:79],v[128:131]
TR v[102:103],v26,12288
MM v[132:135],v[64:67],a[80:83],v[132:135]
TR v[104:105],v26,16384
MM v[132:135],v[68:71],a[84:87],v[132:135]
TR v[106:107],v26,20480
MM v[132:135],v[72:75],a[88:91],v[132:135]
TR v[108:109],v26,24576
MM v[132:135],v[76:79],a[92:95],v[132:135]
s_waitcnt lgkmcnt(13)
TR v[110:111],v26,28672
MM v[136:139],v[80:83],a[64:67],v[136:139]
s_waitcnt lgkmcnt(12)
TR v[112:113],v27,0
MM v[136:139],v[84:87],a[68:71],v[136:139]
s_waitcnt lgkmcnt(11)
TR v[114:115],v27,4096
MM v[136:139],v[88:91],a[72:75],v[136:139]
s_waitcnt lgkmcnt(10)
TR v[116:117],v27,8192
MM v[136:139],v[92:95],a[76:79],v[136:139]
TR v[118:119],v27,12288
MM v[140:143],v[80:83],a[80:83],v[140:143]
TR v[120:121],v27,16384
MM v[140:143],v[84:87],a[84:87],v[140:143]
TR v[122:123],v27,20480
MM v[140:143],v[88:91],a[88:91],v[140:143]
TR v[124:125],v27,24576
MM v[140:143],v[92:95],a[92:95],v[140:143]
s_waitcnt lgkmcnt(13)
TR v[126:127],v27,28672
MM v[144:147],v[96:99],a[64:67],v[144:147]
s_waitcnt lgkmcnt(12)
TR v[64:65],v24,32768
MM v[144:147],v[100:103],a[68:71],v[144:147]
s_waitcnt lgkmcnt(11)
TR v[66:67],v24,36864
MM v[144:147],v[104:107],a[72:75],v[144:147]
s_waitcnt lgkmcnt(10)
TR v[68:69],v24,40960
MM v[144:147],v[108:111],a[76:79],v[144:147]
TR v[70:71],v24,45056
MM v[148:151],v[96:99],a[80:83],v[148:151]
TR v[72:73],v24,49152
MM v[148:151],v[100:103],a[84:87],v[148:151]
TR v[74:75],v24,53248
MM v[148:151],v[104:107],a[88:91],v[148:151]
TR v[76:77],v24,57344
MM v[148:151],v[108:111],a[92:95],v[148:151]
s_waitcnt lgkmcnt(13)
TR v[78:79],v24,61440
MM v[152:155],v[112:115],a[64:67],v[152:155]
s_waitcnt lgkmcnt(12)
TR v[80:81],v25,32768
MM v[152:155],v[116:119],a[68:71],v[152:155]
s_waitcnt lgkmcnt(11)
TR v[82:83],v25,36864
MM v[152:155],v[120:123],a[72:75],v[152:155]
s_waitcnt lgkmcnt(10)
TR v[84:85],v25,40960
MM v[152:155],v[124:127],a[76:79],v[152:155]
TR v[86:87],v25,45056
MM v[156:159],v[112:115],a[80:83],v[156:159]
TR v[88:89],v25,49152
MM v[156:159],v[116:119],a[84:87],v[156:159]
TR v[90:91],v25,53248
MM v[156:159],v[120:123],a[88:91],v[156:159]
TR v[92:93],v25,57344
MM v[156:159],v[124:127],a[92:95],v[156:159]
s_waitcnt lgkmcnt(13)
TR v[94:95],v25,61440
MM v[128:131],v[64:67],a[96:99],v[128:131]
s_waitcnt lgkmcnt(12)
TR v[96:97],v26,32768
MM v[128:131],v[68:71],a[100:103],v[128:131]
s_waitcnt lgkmcnt(11)
TR v[98:99],v26,36864
MM v[128:131],v[72:75],a[104:107],v[128:131]
s_waitcnt lgkmcnt(10)
TR v[100:101],v26,40960
MM v[128:131],v[76:79],a[108:111],v[128:131]
TR v[102:103],v26,45056
MM v[132:135],v[64:67],a[112:115],v[132:135]
TR v[104:105],v26,49152
MM v[132:135],v[68:71],a[116:119],v[132:135]
TR v[106:107],v26,53248
MM v[132:135],v[72:75],a[120:123],v[132:135]
TR v[108:109],v26,57344
MM v[132:135],v[76:79],a[124:127],v[132:135]
s_waitcnt lgkmcnt(13)
TR v[110:111],v26,61440
MM v[136:139],v[80:83],a[96:99],v[136:139]
s_waitcnt lgkmcnt(12)
TR v[112:113],v27,32768
MM v[136:139],v[84:87],a[100:103],v[136:139]
s_waitcnt lgkmcnt(11)
TR v[114:115],v27,36864
MM v[136:139],v[88:91],a[104:107],v[136:139]
s_waitcnt lgkmcnt(10)
TR v[116:117],v27,40960
MM v[136:139],v[92:95],a[108:111],v[136:139]
TR v[118:119],v27,45056
MM v[140:143],v[80:83],a[112:115],v[140:143]
TR v[120:121],v27,49152
MM v[140:143],v[84:87],a[116:119],v[140:143]
TR v[122:123],v27,53248
MM v[140:143],v[88:91],a[120:123],v[140:143]
TR v[124:125],v27,57344
MM v[140:143],v[92:95],a[124:127],v[140:143]
s_waitcnt lgkmcnt(13)
TR v[126:127],v27,61440
MM v[144:147],v[96:99],a[96:99],v[144:147]
s_waitcnt lgkmcnt(12)
MM v[144:147],v[100:103],a[100:103],v[144:147]
s_waitcnt lgkmcnt(10)
MM v[144:147],v[104:107],a[104:107],v[144:147]
s_waitcnt lgkmcnt(8)
MM v[144:147],v[108:111],a[108:111],v[144:147]
MM v[148:151],v[96:99],a[112:115],v[148:151]
MM v[148:151],v[100:103],a[116:119],v[148:151]
MM v[148:151],v[104:107],a[120:123],v[148:151]
MM v[148:151],v[108:111],a[124:127],v[148:151]
s_waitcnt lgkmcnt(6)
MM v[152:155],v[112:115],a[96:99],v[152:155]
s_waitcnt lgkmcnt(4)
MM v[152:155],v[116:119],a[100:103],v[152:155]
s_waitcnt lgkmcnt(2)
MM v[152:155],v[120:123],a[104:107],v[152:155]
s_waitcnt lgkmcnt(0)
MM v[152:155],v[124:127],a[108:111],v[152:155]
MM v[156:159],v[112:115],a[112:115],v[156:159]
MM v[156:159],v[116:119],a[116:119],v[156:159]
MM v[156:159],v[120:123],a[120:123],v[156:159]
MM v[156:159],v[124:127],a[124:127],v[156:159]
s_waitcnt vmcnt(0)
buffer_store_dword v37, v36, s[24:27], s57 offen sc1
s_barrier
s_mov_b32 s59, 0
L_oproj_kernel_poll:
buffer_load_dword v38, v36, s[24:27], s58 offen sc1
s_waitcnt vmcnt(0)
v_cmp_ne_u32 vcc, 1, v38
s_cbranch_vccz L_oproj_kernel_got
s_sleep 2
s_add_u32 s59, s59, 1
s_cmp_lt_u32 s59, 0x40000
s_cbranch_scc1 L_oproj_kernel_poll
L_oproj_kernel_got:
buffer_load_dwordx4 v[192:195], v12, s[24:27], s56 offen sc1
s_add_u32 s56, s56, 1048576
buffer_load_dwordx4 v[196:199], v12, s[24:27], s56 offen sc1
s_add_u32 s56, s56, 1048576
buffer_load_dwordx4 v[200:203], v12, s[24:27], s56 offen sc1
s_add_u32 s56, s56, 1048576
buffer_load_dwordx4 v[204:207], v12, s[24:27], s56 offen sc1
s_waitcnt vmcnt(3)
v_lshlrev_b32 v208, 16, v192
v_and_b32 v209, 0xffff0000, v192
v_pk_add_f32 v[128:129], v[128:129], v[208:209]
v_lshlrev_b32 v210, 16, v193
v_and_b32 v211, 0xffff0000, v193
v_pk_add_f32 v[130:131], v[130:131], v[210:211]
ds_write_b128 v32, v[128:131] offset:0
v_lshlrev_b32 v212, 16, v194
v_and_b32 v213, 0xffff0000, v194
v_pk_add_f32 v[132:133], v[132:133], v[212:213]
v_lshlrev_b32 v214, 16, v195
v_and_b32 v215, 0xffff0000, v195
v_pk_add_f32 v[134:135], v[134:135], v[214:215]
ds_write_b128 v32, v[132:135] offset:4352
s_waitcnt vmcnt(2)
v_lshlrev_b32 v216, 16, v196
v_and_b32 v217, 0xffff0000, v196
v_pk_add_f32 v[136:137], v[136:137], v[216:217]
v_lshlrev_b32 v218, 16, v197
v_and_b32 v219, 0xffff0000, v197
v_pk_add_f32 v[138:139], v[138:139], v[218:219]
ds_write_b128 v32, v[136:139] offset:64
v_lshlrev_b32 v220, 16, v198
v_and_b32 v221, 0xffff0000, v198
v_pk_add_f32 v[140:141], v[140:141], v[220:221]
v_lshlrev_b32 v222, 16, v199
v_and_b32 v223, 0xffff0000, v199
v_pk_add_f32 v[142:143], v[142:143], v[222:223]
ds_write_b128 v32, v[140:143] offset:4416
s_waitcnt vmcnt(1)
v_lshlrev_b32 v208, 16, v200
v_and_b32 v209, 0xffff0000, v200
v_pk_add_f32 v[144:145], v[144:145], v[208:209]
v_lshlrev_b32 v210, 16, v201
v_and_b32 v211, 0xffff0000, v201
v_pk_add_f32 v[146:147], v[146:147], v[210:211]
ds_write_b128 v32, v[144:147] offset:128
v_lshlrev_b32 v212, 16, v202
v_and_b32 v213, 0xffff0000, v202
v_pk_add_f32 v[148:149], v[148:149], v[212:213]
v_lshlrev_b32 v214, 16, v203
v_and_b32 v215, 0xffff0000, v203
v_pk_add_f32 v[150:151], v[150:151], v[214:215]
ds_write_b128 v32, v[148:151] offset:4480
s_waitcnt vmcnt(0)
v_lshlrev_b32 v216, 16, v204
v_and_b32 v217, 0xffff0000, v204
v_pk_add_f32 v[152:153], v[152:153], v[216:217]
v_lshlrev_b32 v218, 16, v205
v_and_b32 v219, 0xffff0000, v205
v_pk_add_f32 v[154:155], v[154:155], v[218:219]
ds_write_b128 v32, v[152:155] offset:192
v_lshlrev_b32 v220, 16, v206
v_and_b32 v221, 0xffff0000, v206
v_pk_add_f32 v[156:157], v[156:157], v[220:221]
v_lshlrev_b32 v222, 16, v207
v_and_b32 v223, 0xffff0000, v207
v_pk_add_f32 v[158:159], v[158:159], v[222:223]
ds_write_b128 v32, v[156:159] offset:4544
s_waitcnt lgkmcnt(0)
ds_read_b128 v[64:67], v33 offset:0
ds_read_b128 v[68:71], v33 offset:16
ds_read_b128 v[72:75], v33 offset:2176
ds_read_b128 v[76:79], v33 offset:2192
ds_read_b128 v[80:83], v33 offset:4352
ds_read_b128 v[84:87], v33 offset:4368
ds_read_b128 v[88:91], v33 offset:6528
ds_read_b128 v[92:95], v33 offset:6544
v_lshlrev_b32 v4, 16, v40
v_and_b32 v5, 0xffff0000, v40
s_waitcnt lgkmcnt(7)
v_pk_fma_f32 v[4:5], v[64:65], v[56:57], v[4:5]
v_cvt_pk_bf16_f32 v40, v4, v5
v_lshlrev_b32 v4, 16, v41
v_and_b32 v5, 0xffff0000, v41
v_pk_fma_f32 v[4:5], v[66:67], v[58:59], v[4:5]
v_cvt_pk_bf16_f32 v41, v4, v5
v_lshlrev_b32 v4, 16, v42
v_and_b32 v5, 0xffff0000, v42
s_waitcnt lgkmcnt(6)
v_pk_fma_f32 v[4:5], v[68:69], v[60:61], v[4:5]
v_cvt_pk_bf16_f32 v42, v4, v5
v_lshlrev_b32 v4, 16, v43
v_and_b32 v5, 0xffff0000, v43
v_pk_fma_f32 v[4:5], v[70:71], v[62:63], v[4:5]
v_cvt_pk_bf16_f32 v43, v4, v5
s_add_u32 s52, s50, 0
buffer_store_dwordx4 v[40:43], v34, s[20:23], s52 offen sc1
v_lshlrev_b32 v4, 16, v44
v_and_b32 v5, 0xffff0000, v44
s_waitcnt lgkmcnt(5)
v_pk_fma_f32 v[4:5], v[72:73], v[56:57], v[4:5]
v_cvt_pk_bf16_f32 v44, v4, v5
v_lshlrev_b32 v4, 16, v45
v_and_b32 v5, 0xffff0000, v45
v_pk_fma_f32 v[4:5], v[74:75], v[58:59], v[4:5]
v_cvt_pk_bf16_f32 v45, v4, v5
v_lshlrev_b32 v4, 16, v46
v_and_b32 v5, 0xffff0000, v46
s_waitcnt lgkmcnt(4)
v_pk_fma_f32 v[4:5], v[76:77], v[60:61], v[4:5]
v_cvt_pk_bf16_f32 v46, v4, v5
v_lshlrev_b32 v4, 16, v47
v_and_b32 v5, 0xffff0000, v47
v_pk_fma_f32 v[4:5], v[78:79], v[62:63], v[4:5]
v_cvt_pk_bf16_f32 v47, v4, v5
s_add_u32 s52, s50, 16384
buffer_store_dwordx4 v[44:47], v34, s[20:23], s52 offen sc1
v_lshlrev_b32 v4, 16, v48
v_and_b32 v5, 0xffff0000, v48
s_waitcnt lgkmcnt(3)
v_pk_fma_f32 v[4:5], v[80:81], v[56:57], v[4:5]
v_cvt_pk_bf16_f32 v48, v4, v5
v_lshlrev_b32 v4, 16, v49
v_and_b32 v5, 0xffff0000, v49
v_pk_fma_f32 v[4:5], v[82:83], v[58:59], v[4:5]
v_cvt_pk_bf16_f32 v49, v4, v5
v_lshlrev_b32 v4, 16, v50
v_and_b32 v5, 0xffff0000, v50
s_waitcnt lgkmcnt(2)
v_pk_fma_f32 v[4:5], v[84:85], v[60:61], v[4:5]
v_cvt_pk_bf16_f32 v50, v4, v5
v_lshlrev_b32 v4, 16, v51
v_and_b32 v5, 0xffff0000, v51
v_pk_fma_f32 v[4:5], v[86:87], v[62:63], v[4:5]
v_cvt_pk_bf16_f32 v51, v4, v5
s_add_u32 s52, s50, 32768
buffer_store_dwordx4 v[48:51], v34, s[20:23], s52 offen sc1
v_lshlrev_b32 v4, 16, v52
v_and_b32 v5, 0xffff0000, v52
s_waitcnt lgkmcnt(1)
v_pk_fma_f32 v[4:5], v[88:89], v[56:57], v[4:5]
v_cvt_pk_bf16_f32 v52, v4, v5
v_lshlrev_b32 v4, 16, v53
v_and_b32 v5, 0xffff0000, v53
v_pk_fma_f32 v[4:5], v[90:91], v[58:59], v[4:5]
v_cvt_pk_bf16_f32 v53, v4, v5
v_lshlrev_b32 v4, 16, v54
v_and_b32 v5, 0xffff0000, v54
s_waitcnt lgkmcnt(0)
v_pk_fma_f32 v[4:5], v[92:93], v[60:61], v[4:5]
v_cvt_pk_bf16_f32 v54, v4, v5
v_lshlrev_b32 v4, 16, v55
v_and_b32 v5, 0xffff0000, v55
v_pk_fma_f32 v[4:5], v[94:95], v[62:63], v[4:5]
v_cvt_pk_bf16_f32 v55, v4, v5
s_add_u32 s52, s50, 49152
buffer_store_dwordx4 v[52:55], v34, s[20:23], s52 offen sc1
v_lshlrev_b32 v64, 16, v40
v_and_b32 v65, 0xffff0000, v40
v_lshlrev_b32 v66, 16, v41
v_and_b32 v67, 0xffff0000, v41
v_lshlrev_b32 v68, 16, v42
v_and_b32 v69, 0xffff0000, v42
v_lshlrev_b32 v70, 16, v43
v_and_b32 v71, 0xffff0000, v43
v_lshlrev_b32 v72, 16, v44
v_and_b32 v73, 0xffff0000, v44
v_lshlrev_b32 v74, 16, v45
v_and_b32 v75, 0xffff0000, v45
v_lshlrev_b32 v76, 16, v46
v_and_b32 v77, 0xffff0000, v46
v_lshlrev_b32 v78, 16, v47
v_and_b32 v79, 0xffff0000, v47
v_lshlrev_b32 v80, 16, v48
v_and_b32 v81, 0xffff0000, v48
v_lshlrev_b32 v82, 16, v49
v_and_b32 v83, 0xffff0000, v49
v_lshlrev_b32 v84, 16, v50
v_and_b32 v85, 0xffff0000, v50
v_lshlrev_b32 v86, 16, v51
v_and_b32 v87, 0xffff0000, v51
v_lshlrev_b32 v88, 16, v52
v_and_b32 v89, 0xffff0000, v52
v_lshlrev_b32 v90, 16, v53
v_and_b32 v91, 0xffff0000, v53
v_lshlrev_b32 v92, 16, v54
v_and_b32 v93, 0xffff0000, v54
v_lshlrev_b32 v94, 16, v55
v_and_b32 v95, 0xffff0000, v55
v_pk_add_f32 v[128:129], v[64:65], v[66:67]
v_pk_add_f32 v[130:131], v[72:73], v[74:75]
v_pk_add_f32 v[132:133], v[80:81], v[82:83]
v_pk_add_f32 v[134:135], v[88:89], v[90:91]
v_pk_add_f32 v[128:129], v[128:129], v[68:69]
v_pk_add_f32 v[130:131], v[130:131], v[76:77]
v_pk_add_f32 v[132:133], v[132:133], v[84:85]
v_pk_add_f32 v[134:135], v[134:135], v[92:93]
v_pk_add_f32 v[128:129], v[128:129], v[70:71]
v_pk_add_f32 v[130:131], v[130:131], v[78:79]
v_pk_add_f32 v[132:133], v[132:133], v[86:87]
v_pk_add_f32 v[134:135], v[134:135], v[94:95]
v_add_f32 v128, v128, v129
v_add_f32 v130, v130, v131
v_add_f32 v132, v132, v133
v_add_f32 v134, v134, v135
v_add_f32_dpp v128, v128, v128 quad_perm:[1,0,3,2] row_mask:0xf bank_mask:0xf
v_add_f32_dpp v130, v130, v130 quad_perm:[1,0,3,2] row_mask:0xf bank_mask:0xf
v_add_f32_dpp v132, v132, v132 quad_perm:[1,0,3,2] row_mask:0xf bank_mask:0xf
v_add_f32_dpp v134, v134, v134 quad_perm:[1,0,3,2] row_mask:0xf bank_mask:0xf
v_add_f32_dpp v128, v128, v128 quad_perm:[2,3,0,1] row_mask:0xf bank_mask:0xf
v_add_f32_dpp v130, v130, v130 quad_perm:[2,3,0,1] row_mask:0xf bank_mask:0xf
v_add_f32_dpp v132, v132, v132 quad_perm:[2,3,0,1] row_mask:0xf bank_mask:0xf
v_add_f32_dpp v134, v134, v134 quad_perm:[2,3,0,1] row_mask:0xf bank_mask:0xf
v_add_f32_dpp v128, v128, v128 row_half_mirror row_mask:0xf bank_mask:0xf
v_add_f32_dpp v130, v130, v130 row_half_mirror row_mask:0xf bank_mask:0xf
v_add_f32_dpp v132, v132, v132 row_half_mirror row_mask:0xf bank_mask:0xf
v_add_f32_dpp v134, v134, v134 row_half_mirror row_mask:0xf bank_mask:0xf
v_mul_f32 v128, 0x3c800000, v128
v_mul_f32 v130, 0x3c800000, v130
v_mul_f32 v132, 0x3c800000, v132
v_mul_f32 v134, 0x3c800000, v134
v_pk_add_f32 v[96:97], v[64:65], v[128:129] op_sel_hi:[1,0] neg_lo:[0,1] neg_hi:[0,1]
v_pk_add_f32 v[98:99], v[66:67], v[128:129] op_sel_hi:[1,0] neg_lo:[0,1] neg_hi:[0,1]
v_pk_add_f32 v[100:101], v[68:69], v[128:129] op_sel_hi:[1,0] neg_lo:[0,1] neg_hi:[0,1]
v_pk_add_f32 v[102:103], v[70:71], v[128:129] op_sel_hi:[1,0] neg_lo:[0,1] neg_hi:[0,1]
v_pk_add_f32 v[104:105], v[72:73], v[130:131] op_sel_hi:[1,0] neg_lo:[0,1] neg_hi:[0,1]
v_pk_add_f32 v[106:107], v[74:75], v[130:131] op_sel_hi:[1,0] neg_lo:[0,1] neg_hi:[0,1]
v_pk_add_f32 v[108:109], v[76:77], v[130:131] op_sel_hi:[1,0] neg_lo:[0,1] neg_hi:[0,1]
v_pk_add_f32 v[110:111], v[78:79], v[130:131] op_sel_hi:[1,0] neg_lo:[0,1] neg_hi:[0,1]
v_pk_add_f32 v[112:113], v[80:81], v[132:133] op_sel_hi:[1,0] neg_lo:[0,1] neg_hi:[0,1]
v_pk_add_f32 v[114:115], v[82:83], v[132:133] op_sel_hi:[1,0] neg_lo:[0,1] neg_hi:[0,1]
v_pk_add_f32 v[116:117], v[84:85], v[132:133] op_sel_hi:[1,0] neg_lo:[0,1] neg_hi:[0,1]
v_pk_add_f32 v[118:119], v[86:87], v[132:133] op_sel_hi:[1,0] neg_lo:[0,1] neg_hi:[0,1]
v_pk_add_f32 v[120:121], v[88:89], v[134:135] op_sel_hi:[1,0] neg_lo:[0,1] neg_hi:[0,1]
v_pk_add_f32 v[122:123], v[90:91], v[134:135] op_sel_hi:[1,0] neg_lo:[0,1] neg_hi:[0,1]
v_pk_add_f32 v[124:125], v[92:93], v[134:135] op_sel_hi:[1,0] neg_lo:[0,1] neg_hi:[0,1]
v_pk_add_f32 v[126:127], v[94:95], v[134:135] op_sel_hi:[1,0] neg_lo:[0,1] neg_hi:[0,1]
v_pk_mul_f32 v[136:137], v[96:97], v[96:97]
v_pk_mul_f32 v[138:139], v[104:105], v[104:105]
v_pk_mul_f32 v[140:141], v[112:113], v[112:113]
v_pk_mul_f32 v[142:143], v[120:121], v[120:121]
v_pk_fma_f32 v[136:137], v[98:99], v[98:99], v[136:137]
v_pk_fma_f32 v[138:139], v[106:107], v[106:107], v[138:139]
v_pk_fma_f32 v[140:141], v[114:115], v[114:115], v[140:141]
v_pk_fma_f32 v[142:143], v[122:123], v[122:123], v[142:143]
v_pk_fma_f32 v[136:137], v[100:101], v[100:101], v[136:137]
v_pk_fma_f32 v[138:139], v[108:109], v[108:109], v[138:139]
v_pk_fma_f32 v[140:141], v[116:117], v[116:117], v[140:141]
v_pk_fma_f32 v[142:143], v[124:125], v[124:125], v[142:143]
v_pk_fma_f32 v[136:137], v[102:103], v[102:103], v[136:137]
v_pk_fma_f32 v[138:139], v[110:111], v[110:111], v[138:139]
v_pk_fma_f32 v[140:141], v[118:119], v[118:119], v[140:141]
v_pk_fma_f32 v[142:143], v[126:127], v[126:127], v[142:143]
v_add_f32 v129, v136, v137
v_add_f32 v131, v138, v139
v_add_f32 v133, v140, v141
v_add_f32 v135, v142, v143
v_add_f32_dpp v129, v129, v129 quad_perm:[1,0,3,2] row_mask:0xf bank_mask:0xf
v_add_f32_dpp v131, v131, v131 quad_perm:[1,0,3,2] row_mask:0xf bank_mask:0xf
v_add_f32_dpp v133, v133, v133 quad_perm:[1,0,3,2] row_mask:0xf bank_mask:0xf
v_add_f32_dpp v135, v135, v135 quad_perm:[1,0,3,2] row_mask:0xf bank_mask:0xf
v_add_f32_dpp v129, v129, v129 quad_perm:[2,3,0,1] row_mask:0xf bank_mask:0xf
v_add_f32_dpp v131, v131, v131 quad_perm:[2,3,0,1] row_mask:0xf bank_mask:0xf
v_add_f32_dpp v133, v133, v133 quad_perm:[2,3,0,1] row_mask:0xf bank_mask:0xf
v_add_f32_dpp v135, v135, v135 quad_perm:[2,3,0,1] row_mask:0xf bank_mask:0xf
v_add_f32_dpp v129, v129, v129 row_half_mirror row_mask:0xf bank_mask:0xf
v_add_f32_dpp v131, v131, v131 row_half_mirror row_mask:0xf bank_mask:0xf
v_add_f32_dpp v133, v133, v133 row_half_mirror row_mask:0xf bank_mask:0xf
v_add_f32_dpp v135, v135, v135 row_half_mirror row_mask:0xf bank_mask:0xf
v_cndmask_b32 v128, v128, v130, s[86:87]
v_cndmask_b32 v129, v129, v131, s[86:87]
v_cndmask_b32 v128, v128, v132, s[88:89]
v_cndmask_b32 v129, v129, v133, s[88:89]
v_cndmask_b32 v128, v128, v134, s[90:91]
v_cndmask_b32 v129, v129, v135, s[90:91]
buffer_store_dwordx2 v[128:129], v240, s[24:27], s37 offen sc1
s_mov_b32 s59, 0
L_oproj_kernel_poll2:
s_sleep 8
buffer_load_dwordx4 v[144:147], v12, s[24:27], s36 offen offset:0 sc1
buffer_load_dwordx4 v[148:151], v12, s[24:27], s36 offen offset:1024 sc1
buffer_load_dwordx4 v[152:155], v12, s[24:27], s36 offen offset:2048 sc1
buffer_load_dwordx4 v[156:159], v12, s[24:27], s36 offen offset:3072 sc1
s_waitcnt vmcnt(0)
v_min3_f32 v6, v145, v147, v149
v_min3_f32 v6, v6, v151, v153
v_min3_f32 v6, v6, v155, v157
v_min_f32 v6, v6, v159
v_cmp_eq_f32 vcc, -1.0, v6
s_cbranch_vccz L_oproj_kernel_got2
s_add_u32 s59, s59, 1
s_cmp_lt_u32 s59, 0x40000
s_cbranch_scc1 L_oproj_kernel_poll2
L_oproj_kernel_got2:
v_add_f32 v160, v144, v148
v_add_f32 v164, v152, v156
v_add_f32 v161, v145, v149
v_add_f32 v165, v153, v157
v_add_f32 v162, v146, v150
v_add_f32 v166, v154, v158
v_add_f32 v163, v147, v151
v_add_f32 v167, v155, v159
v_add_f32 v160, v160, v164
v_add_f32 v161, v161, v165
v_add_f32 v162, v162, v166
v_add_f32 v163, v163, v167
v_mov_b32 v164, v160
v_mov_b32 v165, v162
s_nop 0
v_permlane16_swap_b32 v164, v160
v_permlane16_swap_b32 v165, v162
v_add_f32 v160, v160, v164
v_add_f32 v162, v162, v165
v_mov_b32 v164, v160
v_mov_b32 v165, v162
s_nop 0
v_permlane32_swap_b32 v164, v160
v_permlane32_swap_b32 v165, v162
v_add_f32 v160, v160, v164
v_add_f32 v162, v162, v165
v_mul_f32 v160, 0x3d800000, v160
v_mul_f32 v162, 0x3d800000, v162
s_mov_b32 s34, 0x42800000
v_sub_f32 v144, v144, v160
v_sub_f32 v148, v148, v160
v_sub_f32 v152, v152, v160
v_sub_f32 v156, v156, v160
v_mul_f32 v164, v144, v144
v_fmac_f32 v164, v148, v148
v_fmac_f32 v164, v152, v152
v_fmac_f32 v164, v156, v156
v_fmac_f32 v161, s34, v164
v_sub_f32 v146, v146, v162
v_sub_f32 v150, v150, v162
v_sub_f32 v154, v154, v162
v_sub_f32 v158, v158, v162
v_mul_f32 v166, v146, v146
v_fmac_f32 v166, v150, v150
v_fmac_f32 v166, v154, v154
v_fmac_f32 v166, v158, v158
v_fmac_f32 v163, s34, v166
v_mov_b32 v164, v161
v_mov_b32 v165, v163
s_nop 0
v_permlane16_swap_b32 v164, v161
v_permlane16_swap_b32 v165, v163
v_add_f32 v161, v161, v164
v_add_f32 v163, v163, v165
v_mov_b32 v164, v161
v_mov_b32 v165, v163
s_nop 0
v_permlane32_swap_b32 v164, v161
v_permlane32_swap_b32 v165, v163
v_add_f32 v161, v161, v164
v_add_f32 v163, v163, v165
s_mov_b32 s34, 0x3a800000
v_mov_b32 v6, 0x3727c5ac
v_fma_f32 v161, v161, s34, v6
v_fma_f32 v163, v163, s34, v6
v_rsq_f32 v161, v161
v_rsq_f32 v163, v163
ds_write_b128 v241, v[160:163]
s_waitcnt lgkmcnt(0)
ds_read_b64 v[128:129], v243 offset:0
ds_read_b64 v[130:131], v243 offset:64
ds_read_b64 v[132:133], v243 offset:128
ds_read_b64 v[134:135], v243 offset:192
s_waitcnt lgkmcnt(3)
v_pk_add_f32 v[64:65], v[64:65], v[128:129] op_sel_hi:[1,0] neg_lo:[0,1] neg_hi:[0,1]
v_pk_add_f32 v[66:67], v[66:67], v[128:129] op_sel_hi:[1,0] neg_lo:[0,1] neg_hi:[0,1]
v_pk_add_f32 v[68:69], v[68:69], v[128:129] op_sel_hi:[1,0] neg_lo:[0,1] neg_hi:[0,1]
v_pk_add_f32 v[70:71], v[70:71], v[128:129] op_sel_hi:[1,0] neg_lo:[0,1] neg_hi:[0,1]
v_pk_mul_f32 v[64:65], v[64:65], v[128:129] op_sel:[0,1] op_sel_hi:[1,1]
v_pk_mul_f32 v[66:67], v[66:67], v[128:129] op_sel:[0,1] op_sel_hi:[1,1]
v_pk_mul_f32 v[68:69], v[68:69], v[128:129] op_sel:[0,1] op_sel_hi:[1,1]
v_pk_mul_f32 v[70:71], v[70:71], v[128:129] op_sel:[0,1] op_sel_hi:[1,1]
v_pk_fma_f32 v[64:65], v[64:65], v[232:233], v[224:225]
v_pk_fma_f32 v[66:67], v[66:67], v[234:235], v[226:227]
v_pk_fma_f32 v[68:69], v[68:69], v[236:237], v[228:229]
v_pk_fma_f32 v[70:71], v[70:71], v[238:239], v[230:231]
v_cvt_pk_bf16_f32 v96, v64, v65
v_cvt_pk_bf16_f32 v97, v66, v67
v_cvt_pk_bf16_f32 v98, v68, v69
v_cvt_pk_bf16_f32 v99, v70, v71
ds_write_b128 v244, v[96:99] offset:1024
ds_read_b128 v[100:103], v245 offset:1024
s_waitcnt lgkmcnt(4)
v_pk_add_f32 v[72:73], v[72:73], v[130:131] op_sel_hi:[1,0] neg_lo:[0,1] neg_hi:[0,1]
v_pk_add_f32 v[74:75], v[74:75], v[130:131] op_sel_hi:[1,0] neg_lo:[0,1] neg_hi:[0,1]
v_pk_add_f32 v[76:77], v[76:77], v[130:131] op_sel_hi:[1,0] neg_lo:[0,1] neg_hi:[0,1]
v_pk_add_f32 v[78:79], v[78:79], v[130:131] op_sel_hi:[1,0] neg_lo:[0,1] neg_hi:[0,1]
v_pk_mul_f32 v[72:73], v[72:73], v[130:131] op_sel:[0,1] op_sel_hi:[1,1]
v_pk_mul_f32 v[74:75], v[74:75], v[130:131] op_sel:[0,1] op_sel_hi:[1,1]
v_pk_mul_f32 v[76:77], v[76:77], v[130:131] op_sel:[0,1] op_sel_hi:[1,1]
v_pk_mul_f32 v[78:79], v[78:79], v[130:131] op_sel:[0,1] op_sel_hi:[1,1]
v_pk_fma_f32 v[72:73], v[72:73], v[232:233], v[224:225]
v_pk_fma_f32 v[74:75], v[74:75], v[234:235], v[226:227]
v_pk_fma_f32 v[76:77], v[76:77], v[236:237], v[228:229]
v_pk_fma_f32 v[78:79], v[78:79], v[238:239], v[230:231]
v_cvt_pk_bf16_f32 v104, v72, v73
v_cvt_pk_bf16_f32 v105, v74, v75
v_cvt_pk_bf16_f32 v106, v76, v77
v_cvt_pk_bf16_f32 v107, v78, v79
ds_write_b128 v244, v[104:107] offset:2048
ds_read_b128 v[108:111], v245 offset:2048
s_waitcnt lgkmcnt(5)
v_pk_add_f32 v[80:81], v[80:81], v[132:133] op_sel_hi:[1,0] neg_lo:[0,1] neg_hi:[0,1]
v_pk_add_f32 v[82:83], v[82:83], v[132:133] op_sel_hi:[1,0] neg_lo:[0,1] neg_hi:[0,1]
v_pk_add_f32 v[84:85], v[84:85], v[132:133] op_sel_hi:[1,0] neg_lo:[0,1] neg_hi:[0,1]
v_pk_add_f32 v[86:87], v[86:87], v[132:133] op_sel_hi:[1,0] neg_lo:[0,1] neg_hi:[0,1]
v_pk_mul_f32 v[80:81], v[80:81], v[132:133] op_sel:[0,1] op_sel_hi:[1,1]
v_pk_mul_f32 v[82:83], v[82:83], v[132:133] op_sel:[0,1] op_sel_hi:[1,1]
v_pk_mul_f32 v[84:85], v[84:85], v[132:133] op_sel:[0,1] op_sel_hi:[1,1]
v_pk_mul_f32 v[86:87], v[86:87], v[132:133] op_sel:[0,1] op_sel_hi:[1,1]
v_pk_fma_f32 v[80:81], v[80:81], v[232:233], v[224:225]
v_pk_fma_f32 v[82:83], v[82:83], v[234:235], v[226:227]
v_pk_fma_f32 v[84:85], v[84:85], v[236:237], v[228:229]
v_pk_fma_f32 v[86:87], v[86:87], v[238:239], v[230:231]
v_cvt_pk_bf16_f32 v112, v80, v81
v_cvt_pk_bf16_f32 v113, v82, v83
v_cvt_pk_bf16_f32 v114, v84, v85
v_cvt_pk_bf16_f32 v115, v86, v87
ds_write_b128 v244, v[112:115] offset:3072
ds_read_b128 v[116:119], v245 offset:3072
s_waitcnt lgkmcnt(6)
v_pk_add_f32 v[88:89], v[88:89], v[134:135] op_sel_hi:[1,0] neg_lo:[0,1] neg_hi:[0,1]
v_pk_add_f32 v[90:91], v[90:91], v[134:135] op_sel_hi:[1,0] neg_lo:[0,1] neg_hi:[0,1]
v_pk_add_f32 v[92:93], v[92:93], v[134:135] op_sel_hi:[1,0] neg_lo:[0,1] neg_hi:[0,1]
v_pk_add_f32 v[94:95], v[94:95], v[134:135] op_sel_hi:[1,0] neg_lo:[0,1] neg_hi:[0,1]
v_pk_mul_f32 v[88:89], v[88:89], v[134:135] op_sel:[0,1] op_sel_hi:[1,1]
v_pk_mul_f32 v[90:91], v[90:91], v[134:135] op_sel:[0,1] op_sel_hi:[1,1]
v_pk_mul_f32 v[92:93], v[92:93], v[134:135] op_sel:[0,1] op_sel_hi:[1,1]
v_pk_mul_f32 v[94:95], v[94:95], v[134:135] op_sel:[0,1] op_sel_hi:[1,1]
v_pk_fma_f32 v[88:89], v[88:89], v[232:233], v[224:225]
v_pk_fma_f32 v[90:91], v[90:91], v[234:235], v[226:227]
v_pk_fma_f32 v[92:93], v[92:93], v[236:237], v[228:229]
v_pk_fma_f32 v[94:95], v[94:95], v[238:239], v[230:231]
v_cvt_pk_bf16_f32 v120, v88, v89
v_cvt_pk_bf16_f32 v121, v90, v91
v_cvt_pk_bf16_f32 v122, v92, v93
v_cvt_pk_bf16_f32 v123, v94, v95
ds_write_b128 v244, v[120:123] offset:4096
ds_read_b128 v[124:127], v245 offset:4096
s_waitcnt lgkmcnt(6)
buffer_store_dwordx4 v[100:103], v242, s[24:27], s38 offen offset:0 sc1
s_waitcnt lgkmcnt(4)
buffer_store_dwordx4 v[108:111], v242, s[24:27], s38 offen offset:128 sc1
s_waitcnt lgkmcnt(2)
buffer_store_dwordx4 v[116:119], v242, s[24:27], s38 offen offset:1024 sc1
s_waitcnt lgkmcnt(0)
buffer_store_dwordx4 v[124:127], v242, s[24:27], s38 offen offset:1152 sc1
s_lshl_b32 s3, s42, 4
s_add_u32 s3, s3, s43
s_lshl_b32 s3, s3, 2
s_add_u32 s3, s3, 63112192
s_branch L_gateup_kernel_entry
L_oproj_kernel_end:
s_endpgm
L_oproj_kernel_codeend:
L_gateup_kernel_entry:
s_load_dwordx4 s[4:7], s[0:1], 48
s_load_dwordx2 s[44:45], s[0:1], 104
v_lshrrev_b32 v2, 6, v0
v_and_b32 v1, 63, v0
v_readfirstlane_b32 s30, v2
v_and_b32 v2, 15, v1
v_lshrrev_b32 v3, 4, v1
s_getpc_b64 s[88:89]
L_gateup_kernel_pc1:
s_mov_b32 s90, L_gateup_kernel_codeend-L_gateup_kernel_pc1
s_mov_b32 s91, 0x00020000
s_lshr_b32 s59, s2, 3
s_lshl_b32 s59, s59, 2
s_add_u32 s59, s59, s30
s_and_b32 s59, s59, 31
s_lshl_b32 s59, s59, 9
v_lshlrev_b32 v60, 7, v1
v_cmp_gt_u32 vcc, 4, v1
v_mov_b32 v6, 0x40000000
s_nop 0
v_cndmask_b32 v60, v6, v60, vcc
buffer_load_dword v61, v60, s[88:91], s59 offen
s_and_b32 s40, s2, 7
s_lshr_b32 s41, s2, 3
s_and_b32 s42, s40, 1
s_lshl_b32 s42, s42, 2
s_and_b32 s43, s41, 3
s_add_u32 s42, s42, s43
s_lshr_b32 s43, s40, 1
s_lshl_b32 s43, s43, 3
s_lshr_b32 s46, s41, 2
s_add_u32 s43, s43, s46
s_mul_i32 s46, s43, 224
s_and_b32 s39, s43, 1
s_lshl_b32 s33, s30, 12
s_mul_i32 s47, s30, 114688
s_movk_i32 s48, 7168
v_mul_lo_u32 v4, v3, s48
v_mov_b32 v7, 0x40000000
v_add_u32 v4, s47, v4
v_add_u32 v5, 0, v3
v_lshlrev_b32 v5, 1, v5
v_xor_b32 v5, v5, v2
v_cmp_gt_u32 vcc, 14, v5
v_lshl_add_u32 v5, v5, 4, v4
v_add_u32 v5, 0, v5
v_cndmask_b32 v8, v7, v5, vcc
v_add_u32 v5, 0, v3
v_lshlrev_b32 v5, 1, v5
v_xor_b32 v5, v5, v2
v_cmp_gt_u32 vcc, 14, v5
v_lshl_add_u32 v5, v5, 4, v4
v_add_u32 v5, 27648, v5
v_cndmask_b32 v9, v7, v5, vcc
v_add_u32 v5, 4, v3
v_lshlrev_b32 v5, 1, v5
v_xor_b32 v5, v5, v2
v_cmp_gt_u32 vcc, 14, v5
v_lshl_add_u32 v5, v5, 4, v4
v_add_u32 v5, 55296, v5
v_cndmask_b32 v10, v7, v5, vcc
v_add_u32 v5, 4, v3
v_lshlrev_b32 v5, 1, v5
v_xor_b32 v5, v5, v2
v_cmp_gt_u32 vcc, 14, v5
v_lshl_add_u32 v5, v5, 4, v4
v_add_u32 v5, 82944, v5
v_cndmask_b32 v11, v7, v5, vcc
v_lshlrev_b32 v12, 4, v1
s_waitcnt lgkmcnt(0)
s_add_u32 s8, s4, s46
s_addc_u32 s9, s5, 0
s_mov_b32 s10, 7333088
s_mov_b32 s11, 0x00020000
s_add_u32 s12, s6, s46
s_addc_u32 s13, s7, 0
s_mov_b32 s14, 7333088
s_mov_b32 s15, 0x00020000
s_add_u32 s16, s44, 29360128
s_addc_u32 s17, s45, 0
s_mov_b32 s18, 4194304
s_mov_b32 s19, 0x00020000
s_add_u32 s20, s44, 33554432
s_addc_u32 s21, s45, 0
s_mov_b32 s22, 14680064
s_mov_b32 s23, 0x00020000
s_lshl_b32 s47, s42, 2
s_add_u32 s47, s47, s30
s_lshl_b32 s47, s47, 12
s_mov_b32 s31, 0
s_mov_b32 s32, s47
s_mov_b32 s24, s44
s_mov_b32 s25, s45
s_mov_b32 s26, 67108864
s_mov_b32 s27, 0x00020000
v_mov_b32 v36, 0
v_mov_b32 v37, 1
s_waitcnt vmcnt(0) lgkmcnt(0)
s_barrier
s_cmp_lg_u32 s30, 0
s_cbranch_scc1 L_gateup_kernel_pub2
buffer_store_dword v37, v36, s[24:27], s3 offen sc1
L_gateup_kernel_pub2:
s_add_u32 m0, s33, 0
s_nop 0
buffer_load_dwordx4 v8, s[8:11], s31 offen offset:0 lds
v_lshrrev_b32 v4, 2, v2
v_and_b32 v5, 1, v3
v_lshl_or_b32 v5, v5, 2, v4
v_lshlrev_b32 v5, 1, v5
v_bfe_u32 v6, v2, 1, 1
v_xor_b32 v5, v5, v6
v_lshl_add_u32 v4, v3, 3, v4
v_lshlrev_b32 v4, 8, v4
v_and_b32 v6, 1, v2
v_lshl_add_u32 v4, v6, 3, v4
s_mul_i32 s50, s39, 2
s_add_u32 s50, s50, 0
v_xor_b32 v6, s50, v5
v_lshl_add_u32 v16, v6, 4, v4
buffer_load_dwordx4 v9, s[8:11], s31 offen offset:1024 lds
v_add_u32 v23, 0x10000, v16
s_mul_i32 s50, s39, 2
s_add_u32 s50, s50, 2
v_xor_b32 v6, s50, v5
v_lshl_add_u32 v17, v6, 4, v4
v_add_u32 v24, 0x10000, v17
s_mul_i32 s50, s39, 2
s_add_u32 s50, s50, 4
v_xor_b32 v6, s50, v5
v_lshl_add_u32 v18, v6, 4, v4
v_add_u32 v25, 0x10000, v18
s_mul_i32 s50, s39, 2
s_add_u32 s50, s50, 6
v_xor_b32 v6, s50, v5
buffer_load_dwordx4 v10, s[8:11], s31 offen offset:2048 lds
v_lshl_add_u32 v19, v6, 4, v4
v_add_u32 v26, 0x10000, v19
s_mul_i32 s50, s39, 2
s_add_u32 s50, s50, 8
v_xor_b32 v6, s50, v5
v_lshl_add_u32 v20, v6, 4, v4
v_add_u32 v27, 0x10000, v20
s_mul_i32 s50, s39, 2
s_add_u32 s50, s50, 10
v_xor_b32 v6, s50, v5
v_lshl_add_u32 v21, v6, 4, v4
v_add_u32 v28, 0x10000, v21
s_mul_i32 s50, s39, -12
s_add_u32 s50, s50, 12
buffer_load_dwordx4 v11, s[8:11], s31 offen offset:3072 lds
v_xor_b32 v6, s50, v5
v_lshl_add_u32 v22, v6, 4, v4
v_add_u32 v29, 0x10000, v22
v_mov_b64 v[128:129], 0
v_mov_b64 v[130:131], 0
v_mov_b64 v[132:133], 0
v_mov_b64 v[134:135], 0
v_mov_b64 v[136:137], 0
v_mov_b64 v[138:139], 0
v_mov_b64 v[140:141], 0
v_mov_b64 v[142:143], 0
v_mov_b64 v[144:145], 0
v_mov_b64 v[146:147], 0
v_mov_b64 v[148:149], 0
s_add_u32 m0, s33, 65536
s_nop 0
buffer_load_dwordx4 v8, s[12:15], s31 offen offset:0 lds
v_mov_b64 v[150:151], 0
v_mov_b64 v[152:153], 0
v_mov_b64 v[154:155], 0
v_mov_b64 v[156:157], 0
v_mov_b64 v[158:159], 0
v_mov_b64 v[160:161], 0
v_mov_b64 v[162:163], 0
v_mov_b64 v[164:165], 0
v_mov_b64 v[166:167], 0
v_mov_b64 v[168:169], 0
v_mov_b64 v[170:171], 0
v_mov_b64 v[172:173], 0
v_mov_b64 v[174:175], 0
v_mov_b64 v[176:177], 0
buffer_load_dwordx4 v9, s[12:15], s31 offen offset:1024 lds
v_mov_b64 v[178:179], 0
v_mov_b64 v[180:181], 0
v_mov_b64 v[182:183], 0
v_mov_b64 v[184:185], 0
v_mov_b64 v[186:187], 0
v_mov_b64 v[188:189], 0
v_mov_b64 v[190:191], 0
v_mov_b64 v[192:193], 0
v_mov_b64 v[194:195], 0
v_mov_b64 v[196:197], 0
v_mov_b64 v[198:199], 0
v_mov_b64 v[200:201], 0
v_mov_b64 v[202:203], 0
v_mov_b64 v[204:205], 0
buffer_load_dwordx4 v10, s[12:15], s31 offen offset:2048 lds
v_mov_b64 v[206:207], 0
v_mov_b64 v[208:209], 0
v_mov_b64 v[210:211], 0
v_mov_b64 v[212:213], 0
v_mov_b64 v[214:215], 0
v_mov_b64 v[216:217], 0
v_mov_b64 v[218:219], 0
v_mov_b64 v[220:221], 0
v_mov_b64 v[222:223], 0
v_mov_b64 v[224:225], 0
v_mov_b64 v[226:227], 0
v_mov_b64 v[228:229], 0
v_mov_b64 v[230:231], 0
v_mov_b64 v[232:233], 0
buffer_load_dwordx4 v11, s[12:15], s31 offen offset:3072 lds
v_mov_b64 v[234:235], 0
v_mov_b64 v[236:237], 0
v_mov_b64 v[238:239], 0
v_accvgpr_write_b32 a0, 0
v_accvgpr_write_b32 a1, 0
v_accvgpr_write_b32 a2, 0
v_accvgpr_write_b32 a3, 0
v_accvgpr_write_b32 a4, 0
v_accvgpr_write_b32 a5, 0
v_accvgpr_write_b32 a6, 0
v_accvgpr_write_b32 a7, 0
v_accvgpr_write_b32 a8, 0
v_accvgpr_write_b32 a9, 0
v_accvgpr_write_b32 a10, 0
s_add_u32 s31, s31, 458752
s_add_u32 m0, s33, 16384
s_nop 0
buffer_load_dwordx4 v8, s[8:11], s31 offen offset:0 lds
v_accvgpr_write_b32 a11, 0
v_accvgpr_write_b32 a12, 0
v_accvgpr_write_b32 a13, 0
v_accvgpr_write_b32 a14, 0
v_accvgpr_write_b32 a15, 0
v_accvgpr_write_b32 a16, 0
v_accvgpr_write_b32 a17, 0
v_accvgpr_write_b32 a18, 0
v_accvgpr_write_b32 a19, 0
v_accvgpr_write_b32 a20, 0
v_accvgpr_write_b32 a21, 0
v_accvgpr_write_b32 a22, 0
v_accvgpr_write_b32 a23, 0
v_accvgpr_write_b32 a24, 0
buffer_load_dwordx4 v9, s[8:11], s31 offen offset:1024 lds
v_accvgpr_write_b32 a25, 0
v_accvgpr_write_b32 a26, 0
v_accvgpr_write_b32 a27, 0
v_accvgpr_write_b32 a28, 0
v_accvgpr_write_b32 a29, 0
v_accvgpr_write_b32 a30, 0
v_accvgpr_write_b32 a31, 0
v_accvgpr_write_b32 a32, 0
v_accvgpr_write_b32 a33, 0
v_accvgpr_write_b32 a34, 0
v_accvgpr_write_b32 a35, 0
v_accvgpr_write_b32 a36, 0
v_accvgpr_write_b32 a37, 0
v_accvgpr_write_b32 a38, 0
buffer_load_dwordx4 v10, s[8:11], s31 offen offset:2048 lds
v_accvgpr_write_b32 a39, 0
v_accvgpr_write_b32 a40, 0
v_accvgpr_write_b32 a41, 0
v_accvgpr_write_b32 a42, 0
v_accvgpr_write_b32 a43, 0
v_accvgpr_write_b32 a44, 0
v_accvgpr_write_b32 a45, 0
v_accvgpr_write_b32 a46, 0
v_accvgpr_write_b32 a47, 0
v_accvgpr_write_b32 a48, 0
v_accvgpr_write_b32 a49, 0
v_accvgpr_write_b32 a50, 0
v_accvgpr_write_b32 a51, 0
v_accvgpr_write_b32 a52, 0
buffer_load_dwordx4 v11, s[8:11], s31 offen offset:3072 lds
v_accvgpr_write_b32 a53, 0
v_accvgpr_write_b32 a54, 0
v_accvgpr_write_b32 a55, 0
v_accvgpr_write_b32 a56, 0
v_accvgpr_write_b32 a57, 0
v_accvgpr_write_b32 a58, 0
v_accvgpr_write_b32 a59, 0
v_accvgpr_write_b32 a60, 0
v_accvgpr_write_b32 a61, 0
v_accvgpr_write_b32 a62, 0
v_accvgpr_write_b32 a63, 0
v_accvgpr_write_b32 a64, 0
v_accvgpr_write_b32 a65, 0
v_accvgpr_write_b32 a66, 0
s_add_u32 m0, s33, 81920
s_nop 0
buffer_load_dwordx4 v8, s[12:15], s31 offen offset:0 lds
v_accvgpr_write_b32 a67, 0
v_accvgpr_write_b32 a68, 0
v_accvgpr_write_b32 a69, 0
v_accvgpr_write_b32 a70, 0
v_accvgpr_write_b32 a71, 0
v_accvgpr_write_b32 a72, 0
v_accvgpr_write_b32 a73, 0
v_accvgpr_write_b32 a74, 0
v_accvgpr_write_b32 a75, 0
v_accvgpr_write_b32 a76, 0
v_accvgpr_write_b32 a77, 0
v_accvgpr_write_b32 a78, 0
v_accvgpr_write_b32 a79, 0
v_accvgpr_write_b32 a80, 0
buffer_load_dwordx4 v9, s[12:15], s31 offen offset:1024 lds
v_accvgpr_write_b32 a81, 0
v_accvgpr_write_b32 a82, 0
v_accvgpr_write_b32 a83, 0
v_accvgpr_write_b32 a84, 0
v_accvgpr_write_b32 a85, 0
v_accvgpr_write_b32 a86, 0
v_accvgpr_write_b32 a87, 0
v_accvgpr_write_b32 a88, 0
v_accvgpr_write_b32 a89, 0
v_accvgpr_write_b32 a90, 0
v_accvgpr_write_b32 a91, 0
v_accvgpr_write_b32 a92, 0
v_accvgpr_write_b32 a93, 0
v_accvgpr_write_b32 a94, 0
buffer_load_dwordx4 v10, s[12:15], s31 offen offset:2048 lds
v_accvgpr_write_b32 a95, 0
v_accvgpr_write_b32 a96, 0
v_accvgpr_write_b32 a97, 0
v_accvgpr_write_b32 a98, 0
v_accvgpr_write_b32 a99, 0
v_accvgpr_write_b32 a100, 0
v_accvgpr_write_b32 a101, 0
v_accvgpr_write_b32 a102, 0
v_accvgpr_write_b32 a103, 0
v_accvgpr_write_b32 a104, 0
v_accvgpr_write_b32 a105, 0
v_accvgpr_write_b32 a106, 0
v_accvgpr_write_b32 a107, 0
v_accvgpr_write_b32 a108, 0
buffer_load_dwordx4 v11, s[12:15], s31 offen offset:3072 lds
v_accvgpr_write_b32 a109, 0
v_accvgpr_write_b32 a110, 0
v_accvgpr_write_b32 a111, 0
s_lshl_b32 s59, s41, 2
s_add_u32 s59, s59, s30
s_and_b32 s59, s59, 31
s_lshl_b32 s59, s59, 9
v_lshlrev_b32 v60, 7, v1
v_cmp_gt_u32 vcc, 4, v1
s_nop 1
v_cndmask_b32 v60, v7, v60, vcc
s_add_u32 s31, s31, 458752
s_lshl_b32 s52, s42, 7
s_add_u32 s52, s52, 63112192
v_and_b32 v41, 31, v1
v_lshlrev_b32 v41, 2, v41
s_cmp_lg_u32 s30, 0
s_cbranch_scc1 L_gateup_kernel_pd4
s_mov_b32 s53, 0
L_gateup_kernel_pw3:
buffer_load_dword v40, v41, s[24:27], s52 offen sc1
s_waitcnt vmcnt(0)
v_cmp_ne_u32 vcc, 1, v40
s_cbranch_vccz L_gateup_kernel_pd4
s_sleep 3
s_add_u32 s53, s53, 1
s_cmp_lt_u32 s53, 0x40000
s_cbranch_scc1 L_gateup_kernel_pw3
L_gateup_kernel_pd4:
s_waitcnt vmcnt(0)
s_barrier
TR v[64:65],v16,0
TR v[66:67],v16,1024
TR v[68:69],v16,8192
TR v[70:71],v16,9216
TR v[72:73],v17,0
TR v[74:75],v17,1024
TR v[76:77],v17,8192
TR v[78:79],v17,9216
TR v[80:81],v18,0
TR v[82:83],v18,1024
TR v[84:85],v18,8192
TR v[86:87],v18,9216
buffer_load_dwordx4 a[128:131], v12, s[16:19], s32 offen offset:0 sc1
buffer_load_dwordx4 a[136:139], v12, s[16:19], s32 offen offset:1024 sc1
buffer_load_dwordx4 a[144:147], v12, s[16:19], s32 offen offset:2048 sc1
buffer_load_dwordx4 a[152:155], v12, s[16:19], s32 offen offset:3072 sc1
s_add_u32 s32, s32, 131072
buffer_load_dwordx4 a[132:135], v12, s[16:19], s32 offen offset:0 sc1
buffer_load_dwordx4 a[140:143], v12, s[16:19], s32 offen offset:1024 sc1
buffer_load_dwordx4 a[148:151], v12, s[16:19], s32 offen offset:2048 sc1
buffer_load_dwordx4 a[156:159], v12, s[16:19], s32 offen offset:3072 sc1
s_add_u32 s32, s32, 131072
buffer_load_dwordx4 a[160:163], v12, s[16:19], s32 offen offset:0 sc1
buffer_load_dwordx4 a[168:171], v12, s[16:19], s32 offen offset:1024 sc1
buffer_load_dwordx4 a[176:179], v12, s[16:19], s32 offen offset:2048 sc1
buffer_load_dwordx4 a[184:187], v12, s[16:19], s32 offen offset:3072 sc1
s_add_u32 s32, s32, 131072
buffer_load_dwordx4 a[164:167], v12, s[16:19], s32 offen offset:0 sc1
buffer_load_dwordx4 a[172:175], v12, s[16:19], s32 offen offset:1024 sc1
buffer_load_dwordx4 a[180:183], v12, s[16:19], s32 offen offset:2048 sc1
buffer_load_dwordx4 a[188:191], v12, s[16:19], s32 offen offset:3072 sc1
s_add_u32 s32, s32, 131072
s_mov_b32 s34, 0
.p2align 6
L_gateup_kernel_loop:
s_waitcnt vmcnt(15) lgkmcnt(10)
MM v[128:131],v[64:67],a[128:131],v[128:131]
s_waitcnt vmcnt(11) lgkmcnt(8)
TR v[88:89],v19,0
MM v[128:131],v[68:71],a[132:135],v[128:131]
MM v[132:135],v[64:67],a[136:139],v[132:135]
s_waitcnt vmcnt(10)
TR v[90:91],v19,1024
MM v[132:135],v[68:71],a[140:143],v[132:135]
buffer_load_dword v61, v60, s[88:91], s59 offen
MM v[136:139],v[64:67],a[144:147],v[136:139]
s_waitcnt vmcnt(10)
TR v[92:93],v19,8192
MM v[136:139],v[68:71],a[148:151],v[136:139]
MM v[140:143],v[64:67],a[152:155],v[140:143]
s_waitcnt vmcnt(9)
TR v[94:95],v19,9216
MM v[140:143],v[68:71],a[156:159],v[140:143]
s_waitcnt lgkmcnt(10)
MM v[144:147],v[72:75],a[128:131],v[144:147]
s_waitcnt lgkmcnt(8)
s_add_u32 m0, s33, 32768
TR v[64:65],v20,0
MM v[144:147],v[76:79],a[132:135],v[144:147]
buffer_load_dwordx4 v8, s[8:11], s31 offen offset:0 lds
MM v[148:151],v[72:75],a[136:139],v[148:151]
TR v[66:67],v20,1024
MM v[148:151],v[76:79],a[140:143],v[148:151]
MM v[152:155],v[72:75],a[144:147],v[152:155]
TR v[68:69],v20,8192
MM v[152:155],v[76:79],a[148:151],v[152:155]
MM v[156:159],v[72:75],a[152:155],v[156:159]
TR v[70:71],v20,9216
MM v[156:159],v[76:79],a[156:159],v[156:159]
s_waitcnt lgkmcnt(10)
buffer_load_dwordx4 v9, s[8:11], s31 offen offset:1024 lds
MM v[160:163],v[80:83],a[128:131],v[160:163]
s_waitcnt lgkmcnt(8)
TR v[72:73],v21,0
MM v[160:163],v[84:87],a[132:135],v[160:163]
MM v[164:167],v[80:83],a[136:139],v[164:167]
TR v[74:75],v21,1024
MM v[164:167],v[84:87],a[140:143],v[164:167]
MM v[168:171],v[80:83],a[144:147],v[168:171]
TR v[76:77],v21,8192
MM v[168:171],v[84:87],a[148:151],v[168:171]
buffer_load_dwordx4 v10, s[8:11], s31 offen offset:2048 lds
MM v[172:175],v[80:83],a[152:155],v[172:175]
TR v[78:79],v21,9216
MM v[172:175],v[84:87],a[156:159],v[172:175]
s_waitcnt lgkmcnt(10)
MM v[176:179],v[88:91],a[128:131],v[176:179]
s_waitcnt lgkmcnt(8)
TR v[80:81],v22,0
MM v[176:179],v[92:95],a[132:135],v[176:179]
MM v[180:183],v[88:91],a[136:139],v[180:183]
TR v[82:83],v22,1024
MM v[180:183],v[92:95],a[140:143],v[180:183]
buffer_load_dwordx4 v11, s[8:11], s31 offen offset:3072 lds
MM v[184:187],v[88:91],a[144:147],v[184:187]
TR v[84:85],v22,8192
MM v[184:187],v[92:95],a[148:151],v[184:187]
MM v[188:191],v[88:91],a[152:155],v[188:191]
TR v[86:87],v22,9216
MM v[188:191],v[92:95],a[156:159],v[188:191]
s_waitcnt lgkmcnt(10)
MM v[192:195],v[64:67],a[128:131],v[192:195]
s_waitcnt lgkmcnt(8)
s_add_u32 m0, s33, 98304
TR v[88:89],v23,0
MM v[192:195],v[68:71],a[132:135],v[192:195]
buffer_load_dwordx4 v8, s[12:15], s31 offen offset:0 lds
MM v[196:199],v[64:67],a[136:139],v[196:199]
TR v[90:91],v23,1024
MM v[196:199],v[68:71],a[140:143],v[196:199]
MM v[200:203],v[64:67],a[144:147],v[200:203]
TR v[92:93],v23,8192
MM v[200:203],v[68:71],a[148:151],v[200:203]
MM v[204:207],v[64:67],a[152:155],v[204:207]
TR v[94:95],v23,9216
MM v[204:207],v[68:71],a[156:159],v[204:207]
s_waitcnt lgkmcnt(10)
buffer_load_dwordx4 v9, s[12:15], s31 offen offset:1024 lds
MM v[208:211],v[72:75],a[128:131],v[208:211]
s_waitcnt lgkmcnt(8)
TR v[64:65],v24,0
MM v[208:211],v[76:79],a[132:135],v[208:211]
MM v[212:215],v[72:75],a[136:139],v[212:215]
TR v[66:67],v24,1024
MM v[212:215],v[76:79],a[140:143],v[212:215]
MM v[216:219],v[72:75],a[144:147],v[216:219]
TR v[68:69],v24,8192
MM v[216:219],v[76:79],a[148:151],v[216:219]
buffer_load_dwordx4 v10, s[12:15], s31 offen offset:2048 lds
MM v[220:223],v[72:75],a[152:155],v[220:223]
TR v[70:71],v24,9216
MM v[220:223],v[76:79],a[156:159],v[220:223]
s_waitcnt lgkmcnt(10)
MM v[224:227],v[80:83],a[128:131],v[224:227]
s_waitcnt lgkmcnt(8)
TR v[72:73],v25,0
MM v[224:227],v[84:87],a[132:135],v[224:227]
MM v[228:231],v[80:83],a[136:139],v[228:231]
TR v[74:75],v25,1024
MM v[228:231],v[84:87],a[140:143],v[228:231]
buffer_load_dwordx4 v11, s[12:15], s31 offen offset:3072 lds
MM v[232:235],v[80:83],a[144:147],v[232:235]
TR v[76:77],v25,8192
MM v[232:235],v[84:87],a[148:151],v[232:235]
MM v[236:239],v[80:83],a[152:155],v[236:239]
TR v[78:79],v25,9216
MM v[236:239],v[84:87],a[156:159],v[236:239]
s_waitcnt lgkmcnt(10)
MM a[0:3],v[88:91],a[128:131],a[0:3]
s_waitcnt lgkmcnt(8)
TR v[80:81],v26,0
MM a[0:3],v[92:95],a[132:135],a[0:3]
buffer_load_dwordx4 a[192:195], v12, s[16:19], s32 offen offset:0 sc1
MM a[4:7],v[88:91],a[136:139],a[4:7]
TR v[82:83],v26,1024
MM a[4:7],v[92:95],a[140:143],a[4:7]
MM a[8:11],v[88:91],a[144:147],a[8:11]
TR v[84:85],v26,8192
MM a[8:11],v[92:95],a[148:151],a[8:11]
MM a[12:15],v[88:91],a[152:155],a[12:15]
TR v[86:87],v26,9216
MM a[12:15],v[92:95],a[156:159],a[12:15]
s_waitcnt lgkmcnt(10)
buffer_load_dwordx4 a[200:203], v12, s[16:19], s32 offen offset:1024 sc1
MM a[16:19],v[64:67],a[128:131],a[16:19]
s_waitcnt lgkmcnt(8)
TR v[88:89],v27,0
MM a[16:19],v[68:71],a[132:135],a[16:19]
MM a[20:23],v[64:67],a[136:139],a[20:23]
TR v[90:91],v27,1024
MM a[20:23],v[68:71],a[140:143],a[20:23]
MM a[24:27],v[64:67],a[144:147],a[24:27]
TR v[92:93],v27,8192
MM a[24:27],v[68:71],a[148:151],a[24:27]
buffer_load_dwordx4 a[208:211], v12, s[16:19], s32 offen offset:2048 sc1
MM a[28:31],v[64:67],a[152:155],a[28:31]
TR v[94:95],v27,9216
MM a[28:31],v[68:71],a[156:159],a[28:31]
s_waitcnt lgkmcnt(10)
MM a[32:35],v[72:75],a[128:131],a[32:35]
s_waitcnt lgkmcnt(8)
TR v[64:65],v28,0
MM a[32:35],v[76:79],a[132:135],a[32:35]
MM a[36:39],v[72:75],a[136:139],a[36:39]
TR v[66:67],v28,1024
MM a[36:39],v[76:79],a[140:143],a[36:39]
buffer_load_dwordx4 a[216:219], v12, s[16:19], s32 offen offset:3072 sc1
MM a[40:43],v[72:75],a[144:147],a[40:43]
TR v[68:69],v28,8192
MM a[40:43],v[76:79],a[148:151],a[40:43]
MM a[44:47],v[72:75],a[152:155],a[44:47]
TR v[70:71],v28,9216
MM a[44:47],v[76:79],a[156:159],a[44:47]
s_waitcnt lgkmcnt(10)
MM a[48:51],v[80:83],a[128:131],a[48:51]
s_waitcnt lgkmcnt(8)
s_add_u32 s32, s32, 131072
TR v[72:73],v29,0
MM a[48:51],v[84:87],a[132:135],a[48:51]
buffer_load_dwordx4 a[196:199], v12, s[16:19], s32 offen offset:0 sc1
MM a[52:55],v[80:83],a[136:139],a[52:55]
TR v[74:75],v29,1024
MM a[52:55],v[84:87],a[140:143],a[52:55]
MM a[56:59],v[80:83],a[144:147],a[56:59]
TR v[76:77],v29,8192
MM a[56:59],v[84:87],a[148:151],a[56:59]
MM a[60:63],v[80:83],a[152:155],a[60:63]
TR v[78:79],v29,9216
MM a[60:63],v[84:87],a[156:159],a[60:63]
s_waitcnt vmcnt(21) lgkmcnt(10)
MM a[64:67],v[88:91],a[128:131],a[64:67]
s_barrier
s_waitcnt lgkmcnt(8)
MM a[64:67],v[92:95],a[132:135],a[64:67]
TR v[80:81],v16,16384
MM a[68:71],v[88:91],a[136:139],a[68:71]
TR v[82:83],v16,17408
MM a[68:71],v[92:95],a[140:143],a[68:71]
TR v[84:85],v16,24576
MM a[72:75],v[88:91],a[144:147],a[72:75]
TR v[86:87],v16,25600
MM a[72:75],v[92:95],a[148:151],a[72:75]
buffer_load_dwordx4 a[204:207], v12, s[16:19], s32 offen offset:1024 sc1
MM a[76:79],v[88:91],a[152:155],a[76:79]
MM a[76:79],v[92:95],a[156:159],a[76:79]
s_waitcnt lgkmcnt(10)
MM a[80:83],v[64:67],a[128:131],a[80:83]
s_waitcnt lgkmcnt(8)
TR v[88:89],v17,16384
MM a[80:83],v[68:71],a[132:135],a[80:83]
buffer_load_dwordx4 a[212:215], v12, s[16:19], s32 offen offset:2048 sc1
MM a[84:87],v[64:67],a[136:139],a[84:87]
TR v[90:91],v17,17408
MM a[84:87],v[68:71],a[140:143],a[84:87]
MM a[88:91],v[64:67],a[144:147],a[88:91]
TR v[92:93],v17,24576
MM a[88:91],v[68:71],a[148:151],a[88:91]
MM a[92:95],v[64:67],a[152:155],a[92:95]
TR v[94:95],v17,25600
MM a[92:95],v[68:71],a[156:159],a[92:95]
s_waitcnt lgkmcnt(10)
buffer_load_dwordx4 a[220:223], v12, s[16:19], s32 offen offset:3072 sc1
MM a[96:99],v[72:75],a[128:131],a[96:99]
s_waitcnt lgkmcnt(8)
s_add_u32 s32, s32, 131072
s_add_u32 s31, s31, 458752
TR v[64:65],v18,16384
MM a[96:99],v[76:79],a[132:135],a[96:99]
MM a[100:103],v[72:75],a[136:139],a[100:103]
TR v[66:67],v18,17408
MM a[100:103],v[76:79],a[140:143],a[100:103]
MM a[104:107],v[72:75],a[144:147],a[104:107]
TR v[68:69],v18,24576
MM a[104:107],v[76:79],a[148:151],a[104:107]
MM a[108:111],v[72:75],a[152:155],a[108:111]
TR v[70:71],v18,25600
MM a[108:111],v[76:79],a[156:159],a[108:111]
s_waitcnt lgkmcnt(10)
MM v[128:131],v[80:83],a[160:163],v[128:131]
s_waitcnt vmcnt(20) lgkmcnt(8)
TR v[72:73],v19,16384
MM v[128:131],v[84:87],a[164:167],v[128:131]
MM v[132:135],v[80:83],a[168:171],v[132:135]
s_waitcnt vmcnt(19)
s_add_u32 m0, s33, 49152
TR v[74:75],v19,17408
MM v[132:135],v[84:87],a[172:175],v[132:135]
buffer_load_dwordx4 v8, s[8:11], s31 offen offset:0 lds
MM v[136:139],v[80:83],a[176:179],v[136:139]
s_waitcnt vmcnt(19)
TR v[76:77],v19,24576
MM v[136:139],v[84:87],a[180:183],v[136:139]
MM v[140:143],v[80:83],a[184:187],v[140:143]
s_waitcnt vmcnt(18)
TR v[78:79],v19,25600
MM v[140:143],v[84:87],a[188:191],v[140:143]
s_waitcnt lgkmcnt(10)
MM v[144:147],v[88:91],a[160:163],v[144:147]
s_waitcnt lgkmcnt(8)
TR v[80:81],v20,16384
MM v[144:147],v[92:95],a[164:167],v[144:147]
buffer_load_dwordx4 v9, s[8:11], s31 offen offset:1024 lds
MM v[148:151],v[88:91],a[168:171],v[148:151]
TR v[82:83],v20,17408
MM v[148:151],v[92:95],a[172:175],v[148:151]
MM v[152:155],v[88:91],a[176:179],v[152:155]
TR v[84:85],v20,24576
MM v[152:155],v[92:95],a[180:183],v[152:155]
MM v[156:159],v[88:91],a[184:187],v[156:159]
TR v[86:87],v20,25600
MM v[156:159],v[92:95],a[188:191],v[156:159]
s_waitcnt lgkmcnt(10)
buffer_load_dwordx4 v10, s[8:11], s31 offen offset:2048 lds
MM v[160:163],v[64:67],a[160:163],v[160:163]
s_waitcnt lgkmcnt(8)
TR v[88:89],v21,16384
MM v[160:163],v[68:71],a[164:167],v[160:163]
MM v[164:167],v[64:67],a[168:171],v[164:167]
TR v[90:91],v21,17408
MM v[164:167],v[68:71],a[172:175],v[164:167]
MM v[168:171],v[64:67],a[176:179],v[168:171]
TR v[92:93],v21,24576
MM v[168:171],v[68:71],a[180:183],v[168:171]
buffer_load_dwordx4 v11, s[8:11], s31 offen offset:3072 lds
MM v[172:175],v[64:67],a[184:187],v[172:175]
TR v[94:95],v21,25600
MM v[172:175],v[68:71],a[188:191],v[172:175]
s_waitcnt lgkmcnt(10)
MM v[176:179],v[72:75],a[160:163],v[176:179]
s_waitcnt lgkmcnt(8)
TR v[64:65],v22,16384
MM v[176:179],v[76:79],a[164:167],v[176:179]
MM v[180:183],v[72:75],a[168:171],v[180:183]
s_add_u32 m0, s33, 114688
TR v[66:67],v22,17408
MM v[180:183],v[76:79],a[172:175],v[180:183]
buffer_load_dwordx4 v8, s[12:15], s31 offen offset:0 lds
MM v[184:187],v[72:75],a[176:179],v[184:187]
TR v[68:69],v22,24576
MM v[184:187],v[76:79],a[180:183],v[184:187]
MM v[188:191],v[72:75],a[184:187],v[188:191]
TR v[70:71],v22,25600
MM v[188:191],v[76:79],a[188:191],v[188:191]
s_waitcnt lgkmcnt(10)
MM v[192:195],v[80:83],a[160:163],v[192:195]
s_waitcnt lgkmcnt(8)
TR v[72:73],v23,16384
MM v[192:195],v[84:87],a[164:167],v[192:195]
buffer_load_dwordx4 v9, s[12:15], s31 offen offset:1024 lds
MM v[196:199],v[80:83],a[168:171],v[196:199]
TR v[74:75],v23,17408
MM v[196:199],v[84:87],a[172:175],v[196:199]
MM v[200:203],v[80:83],a[176:179],v[200:203]
TR v[76:77],v23,24576
MM v[200:203],v[84:87],a[180:183],v[200:203]
MM v[204:207],v[80:83],a[184:187],v[204:207]
TR v[78:79],v23,25600
MM v[204:207],v[84:87],a[188:191],v[204:207]
s_waitcnt lgkmcnt(10)
MM v[208:211],v[88:91],a[160:163],v[208:211]
s_waitcnt lgkmcnt(8)
TR v[80:81],v24,16384
MM v[208:211],v[92:95],a[164:167],v[208:211]
buffer_load_dwordx4 v10, s[12:15], s31 offen offset:2048 lds
MM v[212:215],v[88:91],a[168:171],v[212:215]
TR v[82:83],v24,17408
MM v[212:215],v[92:95],a[172:175],v[212:215]
MM v[216:219],v[88:91],a[176:179],v[216:219]
TR v[84:85],v24,24576
MM v[216:219],v[92:95],a[180:183],v[216:219]
MM v[220:223],v[88:91],a[184:187],v[220:223]
TR v[86:87],v24,25600
MM v[220:223],v[92:95],a[188:191],v[220:223]
s_waitcnt lgkmcnt(10)
buffer_load_dwordx4 v11, s[12:15], s31 offen offset:3072 lds
MM v[224:227],v[64:67],a[160:163],v[224:227]
s_waitcnt lgkmcnt(8)
TR v[88:89],v25,16384
MM v[224:227],v[68:71],a[164:167],v[224:227]
MM v[228:231],v[64:67],a[168:171],v[228:231]
TR v[90:91],v25,17408
MM v[228:231],v[68:71],a[172:175],v[228:231]
MM v[232:235],v[64:67],a[176:179],v[232:235]
TR v[92:93],v25,24576
MM v[232:235],v[68:71],a[180:183],v[232:235]
buffer_load_dwordx4 a[224:227], v12, s[16:19], s32 offen offset:0 sc1
MM v[236:239],v[64:67],a[184:187],v[236:239]
TR v[94:95],v25,25600
MM v[236:239],v[68:71],a[188:191],v[236:239]
s_waitcnt lgkmcnt(10)
MM a[0:3],v[72:75],a[160:163],a[0:3]
s_waitcnt lgkmcnt(8)
TR v[64:65],v26,16384
MM a[0:3],v[76:79],a[164:167],a[0:3]
MM a[4:7],v[72:75],a[168:171],a[4:7]
TR v[66:67],v26,17408
MM a[4:7],v[76:79],a[172:175],a[4:7]
buffer_load_dwordx4 a[232:235], v12, s[16:19], s32 offen offset:1024 sc1
MM a[8:11],v[72:75],a[176:179],a[8:11]
TR v[68:69],v26,24576
MM a[8:11],v[76:79],a[180:183],a[8:11]
MM a[12:15],v[72:75],a[184:187],a[12:15]
TR v[70:71],v26,25600
MM a[12:15],v[76:79],a[188:191],a[12:15]
s_waitcnt lgkmcnt(10)
MM a[16:19],v[80:83],a[160:163],a[16:19]
s_waitcnt lgkmcnt(8)
TR v[72:73],v27,16384
MM a[16:19],v[84:87],a[164:167],a[16:19]
buffer_load_dwordx4 a[240:243], v12, s[16:19], s32 offen offset:2048 sc1
MM a[20:23],v[80:83],a[168:171],a[20:23]
TR v[74:75],v27,17408
MM a[20:23],v[84:87],a[172:175],a[20:23]
MM a[24:27],v[80:83],a[176:179],a[24:27]
TR v[76:77],v27,24576
MM a[24:27],v[84:87],a[180:183],a[24:27]
MM a[28:31],v[80:83],a[184:187],a[28:31]
TR v[78:79],v27,25600
MM a[28:31],v[84:87],a[188:191],a[28:31]
s_waitcnt lgkmcnt(10)
MM a[32:35],v[88:91],a[160:163],a[32:35]
s_waitcnt lgkmcnt(8)
TR v[80:81],v28,16384
MM a[32:35],v[92:95],a[164:167],a[32:35]
buffer_load_dwordx4 a[248:251], v12, s[16:19], s32 offen offset:3072 sc1
MM a[36:39],v[88:91],a[168:171],a[36:39]
TR v[82:83],v28,17408
MM a[36:39],v[92:95],a[172:175],a[36:39]
MM a[40:43],v[88:91],a[176:179],a[40:43]
TR v[84:85],v28,24576
MM a[40:43],v[92:95],a[180:183],a[40:43]
MM a[44:47],v[88:91],a[184:187],a[44:47]
s_add_u32 s32, s32, 131072
TR v[86:87],v28,25600
MM a[44:47],v[92:95],a[188:191],a[44:47]
s_waitcnt lgkmcnt(10)
buffer_load_dwordx4 a[228:231], v12, s[16:19], s32 offen offset:0 sc1
MM a[48:51],v[64:67],a[160:163],a[48:51]
s_waitcnt lgkmcnt(8)
TR v[88:89],v29,16384
MM a[48:51],v[68:71],a[164:167],a[48:51]
MM a[52:55],v[64:67],a[168:171],a[52:55]
TR v[90:91],v29,17408
MM a[52:55],v[68:71],a[172:175],a[52:55]
MM a[56:59],v[64:67],a[176:179],a[56:59]
TR v[92:93],v29,24576
MM a[56:59],v[68:71],a[180:183],a[56:59]
buffer_load_dwordx4 a[236:239], v12, s[16:19], s32 offen offset:1024 sc1
MM a[60:63],v[64:67],a[184:187],a[60:63]
TR v[94:95],v29,25600
MM a[60:63],v[68:71],a[188:191],a[60:63]
s_waitcnt vmcnt(22) lgkmcnt(10)
MM a[64:67],v[72:75],a[160:163],a[64:67]
s_barrier
s_waitcnt lgkmcnt(8)
MM a[64:67],v[76:79],a[164:167],a[64:67]
TR v[64:65],v16,32768
MM a[68:71],v[72:75],a[168:171],a[68:71]
TR v[66:67],v16,33792
MM a[68:71],v[76:79],a[172:175],a[68:71]
TR v[68:69],v16,40960
MM a[72:75],v[72:75],a[176:179],a[72:75]
TR v[70:71],v16,41984
MM a[72:75],v[76:79],a[180:183],a[72:75]
MM a[76:79],v[72:75],a[184:187],a[76:79]
MM a[76:79],v[76:79],a[188:191],a[76:79]
s_waitcnt lgkmcnt(10)
buffer_load_dwordx4 a[244:247], v12, s[16:19], s32 offen offset:2048 sc1
MM a[80:83],v[80:83],a[160:163],a[80:83]
s_waitcnt lgkmcnt(8)
TR v[72:73],v17,32768
MM a[80:83],v[84:87],a[164:167],a[80:83]
MM a[84:87],v[80:83],a[168:171],a[84:87]
TR v[74:75],v17,33792
MM a[84:87],v[84:87],a[172:175],a[84:87]
MM a[88:91],v[80:83],a[176:179],a[88:91]
TR v[76:77],v17,40960
MM a[88:91],v[84:87],a[180:183],a[88:91]
buffer_load_dwordx4 a[252:255], v12, s[16:19], s32 offen offset:3072 sc1
MM a[92:95],v[80:83],a[184:187],a[92:95]
s_add_u32 s32, s32, 131072
s_add_u32 s31, s31, 458752
TR v[78:79],v17,41984
MM a[92:95],v[84:87],a[188:191],a[92:95]
s_waitcnt lgkmcnt(10)
MM a[96:99],v[88:91],a[160:163],a[96:99]
s_waitcnt lgkmcnt(8)
TR v[80:81],v18,32768
MM a[96:99],v[92:95],a[164:167],a[96:99]
MM a[100:103],v[88:91],a[168:171],a[100:103]
TR v[82:83],v18,33792
MM a[100:103],v[92:95],a[172:175],a[100:103]
MM a[104:107],v[88:91],a[176:179],a[104:107]
TR v[84:85],v18,40960
MM a[104:107],v[92:95],a[180:183],a[104:107]
MM a[108:111],v[88:91],a[184:187],a[108:111]
TR v[86:87],v18,41984
MM a[108:111],v[92:95],a[188:191],a[108:111]
s_waitcnt vmcnt(23) lgkmcnt(10)
MM v[128:131],v[64:67],a[192:195],v[128:131]
s_waitcnt vmcnt(19) lgkmcnt(8)
TR v[88:89],v19,32768
MM v[128:131],v[68:71],a[196:199],v[128:131]
MM v[132:135],v[64:67],a[200:203],v[132:135]
s_waitcnt vmcnt(18)
s_add_u32 m0, s33, 0
TR v[90:91],v19,33792
MM v[132:135],v[68:71],a[204:207],v[132:135]
buffer_load_dwordx4 v8, s[8:11], s31 offen offset:0 lds
MM v[136:139],v[64:67],a[208:211],v[136:139]
s_waitcnt vmcnt(18)
TR v[92:93],v19,40960
MM v[136:139],v[68:71],a[212:215],v[136:139]
MM v[140:143],v[64:67],a[216:219],v[140:143]
s_waitcnt vmcnt(17)
TR v[94:95],v19,41984
MM v[140:143],v[68:71],a[220:223],v[140:143]
s_waitcnt lgkmcnt(10)
MM v[144:147],v[72:75],a[192:195],v[144:147]
s_waitcnt lgkmcnt(8)
TR v[64:65],v20,32768
MM v[144:147],v[76:79],a[196:199],v[144:147]
buffer_load_dwordx4 v9, s[8:11], s31 offen offset:1024 lds
MM v[148:151],v[72:75],a[200:203],v[148:151]
TR v[66:67],v20,33792
MM v[148:151],v[76:79],a[204:207],v[148:151]
MM v[152:155],v[72:75],a[208:211],v[152:155]
TR v[68:69],v20,40960
MM v[152:155],v[76:79],a[212:215],v[152:155]
MM v[156:159],v[72:75],a[216:219],v[156:159]
TR v[70:71],v20,41984
MM v[156:159],v[76:79],a[220:223],v[156:159]
s_waitcnt lgkmcnt(10)
buffer_load_dwordx4 v10, s[8:11], s31 offen offset:2048 lds
MM v[160:163],v[80:83],a[192:195],v[160:163]
s_waitcnt lgkmcnt(8)
TR v[72:73],v21,32768
MM v[160:163],v[84:87],a[196:199],v[160:163]
MM v[164:167],v[80:83],a[200:203],v[164:167]
TR v[74:75],v21,33792
MM v[164:167],v[84:87],a[204:207],v[164:167]
MM v[168:171],v[80:83],a[208:211],v[168:171]
TR v[76:77],v21,40960
MM v[168:171],v[84:87],a[212:215],v[168:171]
buffer_load_dwordx4 v11, s[8:11], s31 offen offset:3072 lds
MM v[172:175],v[80:83],a[216:219],v[172:175]
TR v[78:79],v21,41984
MM v[172:175],v[84:87],a[220:223],v[172:175]
s_waitcnt lgkmcnt(10)
MM v[176:179],v[88:91],a[192:195],v[176:179]
s_waitcnt lgkmcnt(8)
TR v[80:81],v22,32768
MM v[176:179],v[92:95],a[196:199],v[176:179]
MM v[180:183],v[88:91],a[200:203],v[180:183]
s_add_u32 m0, s33, 65536
TR v[82:83],v22,33792
MM v[180:183],v[92:95],a[204:207],v[180:183]
buffer_load_dwordx4 v8, s[12:15], s31 offen offset:0 lds
MM v[184:187],v[88:91],a[208:211],v[184:187]
TR v[84:85],v22,40960
MM v[184:187],v[92:95],a[212:215],v[184:187]
MM v[188:191],v[88:91],a[216:219],v[188:191]
TR v[86:87],v22,41984
MM v[188:191],v[92:95],a[220:223],v[188:191]
s_waitcnt lgkmcnt(10)
MM v[192:195],v[64:67],a[192:195],v[192:195]
s_waitcnt lgkmcnt(8)
TR v[88:89],v23,32768
MM v[192:195],v[68:71],a[196:199],v[192:195]
buffer_load_dwordx4 v9, s[12:15], s31 offen offset:1024 lds
MM v[196:199],v[64:67],a[200:203],v[196:199]
TR v[90:91],v23,33792
MM v[196:199],v[68:71],a[204:207],v[196:199]
MM v[200:203],v[64:67],a[208:211],v[200:203]
TR v[92:93],v23,40960
MM v[200:203],v[68:71],a[212:215],v[200:203]
MM v[204:207],v[64:67],a[216:219],v[204:207]
TR v[94:95],v23,41984
MM v[204:207],v[68:71],a[220:223],v[204:207]
s_waitcnt lgkmcnt(10)
MM v[208:211],v[72:75],a[192:195],v[208:211]
s_waitcnt lgkmcnt(8)
TR v[64:65],v24,32768
MM v[208:211],v[76:79],a[196:199],v[208:211]
buffer_load_dwordx4 v10, s[12:15], s31 offen offset:2048 lds
MM v[212:215],v[72:75],a[200:203],v[212:215]
TR v[66:67],v24,33792
MM v[212:215],v[76:79],a[204:207],v[212:215]
MM v[216:219],v[72:75],a[208:211],v[216:219]
TR v[68:69],v24,40960
MM v[216:219],v[76:79],a[212:215],v[216:219]
MM v[220:223],v[72:75],a[216:219],v[220:223]
TR v[70:71],v24,41984
MM v[220:223],v[76:79],a[220:223],v[220:223]
s_waitcnt lgkmcnt(10)
buffer_load_dwordx4 v11, s[12:15], s31 offen offset:3072 lds
MM v[224:227],v[80:83],a[192:195],v[224:227]
s_waitcnt lgkmcnt(8)
TR v[72:73],v25,32768
MM v[224:227],v[84:87],a[196:199],v[224:227]
MM v[228:231],v[80:83],a[200:203],v[228:231]
TR v[74:75],v25,33792
MM v[228:231],v[84:87],a[204:207],v[228:231]
MM v[232:235],v[80:83],a[208:211],v[232:235]
TR v[76:77],v25,40960
MM v[232:235],v[84:87],a[212:215],v[232:235]
buffer_load_dwordx4 a[128:131], v12, s[16:19], s32 offen offset:0 sc1
MM v[236:239],v[80:83],a[216:219],v[236:239]
TR v[78:79],v25,41984
MM v[236:239],v[84:87],a[220:223],v[236:239]
s_waitcnt lgkmcnt(10)
MM a[0:3],v[88:91],a[192:195],a[0:3]
s_waitcnt lgkmcnt(8)
TR v[80:81],v26,32768
MM a[0:3],v[92:95],a[196:199],a[0:3]
MM a[4:7],v[88:91],a[200:203],a[4:7]
TR v[82:83],v26,33792
MM a[4:7],v[92:95],a[204:207],a[4:7]
buffer_load_dwordx4 a[136:139], v12, s[16:19], s32 offen offset:1024 sc1
MM a[8:11],v[88:91],a[208:211],a[8:11]
TR v[84:85],v26,40960
MM a[8:11],v[92:95],a[212:215],a[8:11]
MM a[12:15],v[88:91],a[216:219],a[12:15]
TR v[86:87],v26,41984
MM a[12:15],v[92:95],a[220:223],a[12:15]
s_waitcnt lgkmcnt(10)
MM a[16:19],v[64:67],a[192:195],a[16:19]
s_waitcnt lgkmcnt(8)
TR v[88:89],v27,32768
MM a[16:19],v[68:71],a[196:199],a[16:19]
buffer_load_dwordx4 a[144:147], v12, s[16:19], s32 offen offset:2048 sc1
MM a[20:23],v[64:67],a[200:203],a[20:23]
TR v[90:91],v27,33792
MM a[20:23],v[68:71],a[204:207],a[20:23]
MM a[24:27],v[64:67],a[208:211],a[24:27]
TR v[92:93],v27,40960
MM a[24:27],v[68:71],a[212:215],a[24:27]
MM a[28:31],v[64:67],a[216:219],a[28:31]
TR v[94:95],v27,41984
MM a[28:31],v[68:71],a[220:223],a[28:31]
s_waitcnt lgkmcnt(10)
MM a[32:35],v[72:75],a[192:195],a[32:35]
s_waitcnt lgkmcnt(8)
TR v[64:65],v28,32768
MM a[32:35],v[76:79],a[196:199],a[32:35]
buffer_load_dwordx4 a[152:155], v12, s[16:19], s32 offen offset:3072 sc1
MM a[36:39],v[72:75],a[200:203],a[36:39]
TR v[66:67],v28,33792
MM a[36:39],v[76:79],a[204:207],a[36:39]
MM a[40:43],v[72:75],a[208:211],a[40:43]
TR v[68:69],v28,40960
MM a[40:43],v[76:79],a[212:215],a[40:43]
MM a[44:47],v[72:75],a[216:219],a[44:47]
s_add_u32 s32, s32, 131072
TR v[70:71],v28,41984
MM a[44:47],v[76:79],a[220:223],a[44:47]
s_waitcnt lgkmcnt(10)
buffer_load_dwordx4 a[132:135], v12, s[16:19], s32 offen offset:0 sc1
MM a[48:51],v[80:83],a[192:195],a[48:51]
s_waitcnt lgkmcnt(8)
TR v[72:73],v29,32768
MM a[48:51],v[84:87],a[196:199],a[48:51]
MM a[52:55],v[80:83],a[200:203],a[52:55]
TR v[74:75],v29,33792
MM a[52:55],v[84:87],a[204:207],a[52:55]
MM a[56:59],v[80:83],a[208:211],a[56:59]
TR v[76:77],v29,40960
MM a[56:59],v[84:87],a[212:215],a[56:59]
buffer_load_dwordx4 a[140:143], v12, s[16:19], s32 offen offset:1024 sc1
MM a[60:63],v[80:83],a[216:219],a[60:63]
TR v[78:79],v29,41984
MM a[60:63],v[84:87],a[220:223],a[60:63]
s_waitcnt vmcnt(22) lgkmcnt(10)
MM a[64:67],v[88:91],a[192:195],a[64:67]
s_barrier
s_waitcnt lgkmcnt(8)
MM a[64:67],v[92:95],a[196:199],a[64:67]
TR v[80:81],v16,49152
MM a[68:71],v[88:91],a[200:203],a[68:71]
TR v[82:83],v16,50176
MM a[68:71],v[92:95],a[204:207],a[68:71]
TR v[84:85],v16,57344
MM a[72:75],v[88:91],a[208:211],a[72:75]
TR v[86:87],v16,58368
MM a[72:75],v[92:95],a[212:215],a[72:75]
MM a[76:79],v[88:91],a[216:219],a[76:79]
MM a[76:79],v[92:95],a[220:223],a[76:79]
s_waitcnt lgkmcnt(10)
buffer_load_dwordx4 a[148:151], v12, s[16:19], s32 offen offset:2048 sc1
MM a[80:83],v[64:67],a[192:195],a[80:83]
s_waitcnt lgkmcnt(8)
TR v[88:89],v17,49152
MM a[80:83],v[68:71],a[196:199],a[80:83]
MM a[84:87],v[64:67],a[200:203],a[84:87]
TR v[90:91],v17,50176
MM a[84:87],v[68:71],a[204:207],a[84:87]
MM a[88:91],v[64:67],a[208:211],a[88:91]
TR v[92:93],v17,57344
MM a[88:91],v[68:71],a[212:215],a[88:91]
buffer_load_dwordx4 a[156:159], v12, s[16:19], s32 offen offset:3072 sc1
MM a[92:95],v[64:67],a[216:219],a[92:95]
s_add_u32 s32, s32, 131072
s_add_u32 s31, s31, 458752
TR v[94:95],v17,58368
MM a[92:95],v[68:71],a[220:223],a[92:95]
s_waitcnt lgkmcnt(10)
MM a[96:99],v[72:75],a[192:195],a[96:99]
s_waitcnt lgkmcnt(8)
TR v[64:65],v18,49152
MM a[96:99],v[76:79],a[196:199],a[96:99]
MM a[100:103],v[72:75],a[200:203],a[100:103]
TR v[66:67],v18,50176
MM a[100:103],v[76:79],a[204:207],a[100:103]
MM a[104:107],v[72:75],a[208:211],a[104:107]
TR v[68:69],v18,57344
MM a[104:107],v[76:79],a[212:215],a[104:107]
MM a[108:111],v[72:75],a[216:219],a[108:111]
TR v[70:71],v18,58368
MM a[108:111],v[76:79],a[220:223],a[108:111]
s_waitcnt vmcnt(23) lgkmcnt(10)
MM v[128:131],v[80:83],a[224:227],v[128:131]
s_waitcnt vmcnt(19) lgkmcnt(8)
TR v[72:73],v19,49152
MM v[128:131],v[84:87],a[228:231],v[128:131]
MM v[132:135],v[80:83],a[232:235],v[132:135]
s_waitcnt vmcnt(18)
s_add_u32 m0, s33, 16384
TR v[74:75],v19,50176
MM v[132:135],v[84:87],a[236:239],v[132:135]
buffer_load_dwordx4 v8, s[8:11], s31 offen offset:0 lds
MM v[136:139],v[80:83],a[240:243],v[136:139]
s_waitcnt vmcnt(18)
TR v[76:77],v19,57344
MM v[136:139],v[84:87],a[244:247],v[136:139]
MM v[140:143],v[80:83],a[248:251],v[140:143]
s_waitcnt vmcnt(17)
TR v[78:79],v19,58368
MM v[140:143],v[84:87],a[252:255],v[140:143]
s_waitcnt lgkmcnt(10)
MM v[144:147],v[88:91],a[224:227],v[144:147]
s_waitcnt lgkmcnt(8)
TR v[80:81],v20,49152
MM v[144:147],v[92:95],a[228:231],v[144:147]
buffer_load_dwordx4 v9, s[8:11], s31 offen offset:1024 lds
MM v[148:151],v[88:91],a[232:235],v[148:151]
TR v[82:83],v20,50176
MM v[148:151],v[92:95],a[236:239],v[148:151]
MM v[152:155],v[88:91],a[240:243],v[152:155]
TR v[84:85],v20,57344
MM v[152:155],v[92:95],a[244:247],v[152:155]
MM v[156:159],v[88:91],a[248:251],v[156:159]
TR v[86:87],v20,58368
MM v[156:159],v[92:95],a[252:255],v[156:159]
s_waitcnt lgkmcnt(10)
buffer_load_dwordx4 v10, s[8:11], s31 offen offset:2048 lds
MM v[160:163],v[64:67],a[224:227],v[160:163]
s_waitcnt lgkmcnt(8)
TR v[88:89],v21,49152
MM v[160:163],v[68:71],a[228:231],v[160:163]
MM v[164:167],v[64:67],a[232:235],v[164:167]
TR v[90:91],v21,50176
MM v[164:167],v[68:71],a[236:239],v[164:167]
MM v[168:171],v[64:67],a[240:243],v[168:171]
TR v[92:93],v21,57344
MM v[168:171],v[68:71],a[244:247],v[168:171]
buffer_load_dwordx4 v11, s[8:11], s31 offen offset:3072 lds
MM v[172:175],v[64:67],a[248:251],v[172:175]
TR v[94:95],v21,58368
MM v[172:175],v[68:71],a[252:255],v[172:175]
s_waitcnt lgkmcnt(10)
MM v[176:179],v[72:75],a[224:227],v[176:179]
s_waitcnt lgkmcnt(8)
TR v[64:65],v22,49152
MM v[176:179],v[76:79],a[228:231],v[176:179]
MM v[180:183],v[72:75],a[232:235],v[180:183]
s_add_u32 m0, s33, 81920
TR v[66:67],v22,50176
MM v[180:183],v[76:79],a[236:239],v[180:183]
buffer_load_dwordx4 v8, s[12:15], s31 offen offset:0 lds
MM v[184:187],v[72:75],a[240:243],v[184:187]
TR v[68:69],v22,57344
MM v[184:187],v[76:79],a[244:247],v[184:187]
MM v[188:191],v[72:75],a[248:251],v[188:191]
TR v[70:71],v22,58368
MM v[188:191],v[76:79],a[252:255],v[188:191]
s_waitcnt lgkmcnt(10)
MM v[192:195],v[80:83],a[224:227],v[192:195]
s_waitcnt lgkmcnt(8)
TR v[72:73],v23,49152
MM v[192:195],v[84:87],a[228:231],v[192:195]
buffer_load_dwordx4 v9, s[12:15], s31 offen offset:1024 lds
MM v[196:199],v[80:83],a[232:235],v[196:199]
TR v[74:75],v23,50176
MM v[196:199],v[84:87],a[236:239],v[196:199]
MM v[200:203],v[80:83],a[240:243],v[200:203]
TR v[76:77],v23,57344
MM v[200:203],v[84:87],a[244:247],v[200:203]
MM v[204:207],v[80:83],a[248:251],v[204:207]
TR v[78:79],v23,58368
MM v[204:207],v[84:87],a[252:255],v[204:207]
s_waitcnt lgkmcnt(10)
MM v[208:211],v[88:91],a[224:227],v[208:211]
s_waitcnt lgkmcnt(8)
TR v[80:81],v24,49152
MM v[208:211],v[92:95],a[228:231],v[208:211]
buffer_load_dwordx4 v10, s[12:15], s31 offen offset:2048 lds
MM v[212:215],v[88:91],a[232:235],v[212:215]
TR v[82:83],v24,50176
MM v[212:215],v[92:95],a[236:239],v[212:215]
MM v[216:219],v[88:91],a[240:243],v[216:219]
TR v[84:85],v24,57344
MM v[216:219],v[92:95],a[244:247],v[216:219]
MM v[220:223],v[88:91],a[248:251],v[220:223]
TR v[86:87],v24,58368
MM v[220:223],v[92:95],a[252:255],v[220:223]
s_waitcnt lgkmcnt(10)
buffer_load_dwordx4 v11, s[12:15], s31 offen offset:3072 lds
MM v[224:227],v[64:67],a[224:227],v[224:227]
s_waitcnt lgkmcnt(8)
TR v[88:89],v25,49152
MM v[224:227],v[68:71],a[228:231],v[224:227]
MM v[228:231],v[64:67],a[232:235],v[228:231]
TR v[90:91],v25,50176
MM v[228:231],v[68:71],a[236:239],v[228:231]
MM v[232:235],v[64:67],a[240:243],v[232:235]
TR v[92:93],v25,57344
MM v[232:235],v[68:71],a[244:247],v[232:235]
buffer_load_dwordx4 a[160:163], v12, s[16:19], s32 offen offset:0 sc1
MM v[236:239],v[64:67],a[248:251],v[236:239]
TR v[94:95],v25,58368
MM v[236:239],v[68:71],a[252:255],v[236:239]
s_waitcnt lgkmcnt(10)
MM a[0:3],v[72:75],a[224:227],a[0:3]
s_waitcnt lgkmcnt(8)
TR v[64:65],v26,49152
MM a[0:3],v[76:79],a[228:231],a[0:3]
MM a[4:7],v[72:75],a[232:235],a[4:7]
TR v[66:67],v26,50176
MM a[4:7],v[76:79],a[236:239],a[4:7]
buffer_load_dwordx4 a[168:171], v12, s[16:19], s32 offen offset:1024 sc1
MM a[8:11],v[72:75],a[240:243],a[8:11]
TR v[68:69],v26,57344
MM a[8:11],v[76:79],a[244:247],a[8:11]
MM a[12:15],v[72:75],a[248:251],a[12:15]
TR v[70:71],v26,58368
MM a[12:15],v[76:79],a[252:255],a[12:15]
s_waitcnt lgkmcnt(10)
MM a[16:19],v[80:83],a[224:227],a[16:19]
s_waitcnt lgkmcnt(8)
TR v[72:73],v27,49152
MM a[16:19],v[84:87],a[228:231],a[16:19]
buffer_load_dwordx4 a[176:179], v12, s[16:19], s32 offen offset:2048 sc1
MM a[20:23],v[80:83],a[232:235],a[20:23]
TR v[74:75],v27,50176
MM a[20:23],v[84:87],a[236:239],a[20:23]
MM a[24:27],v[80:83],a[240:243],a[24:27]
TR v[76:77],v27,57344
MM a[24:27],v[84:87],a[244:247],a[24:27]
MM a[28:31],v[80:83],a[248:251],a[28:31]
TR v[78:79],v27,58368
MM a[28:31],v[84:87],a[252:255],a[28:31]
s_waitcnt lgkmcnt(10)
MM a[32:35],v[88:91],a[224:227],a[32:35]
s_waitcnt lgkmcnt(8)
TR v[80:81],v28,49152
MM a[32:35],v[92:95],a[228:231],a[32:35]
buffer_load_dwordx4 a[184:187], v12, s[16:19], s32 offen offset:3072 sc1
MM a[36:39],v[88:91],a[232:235],a[36:39]
TR v[82:83],v28,50176
MM a[36:39],v[92:95],a[236:239],a[36:39]
MM a[40:43],v[88:91],a[240:243],a[40:43]
TR v[84:85],v28,57344
MM a[40:43],v[92:95],a[244:247],a[40:43]
MM a[44:47],v[88:91],a[248:251],a[44:47]
s_add_u32 s32, s32, 131072
TR v[86:87],v28,58368
MM a[44:47],v[92:95],a[252:255],a[44:47]
s_waitcnt lgkmcnt(10)
buffer_load_dwordx4 a[164:167], v12, s[16:19], s32 offen offset:0 sc1
MM a[48:51],v[64:67],a[224:227],a[48:51]
s_waitcnt lgkmcnt(8)
TR v[88:89],v29,49152
MM a[48:51],v[68:71],a[228:231],a[48:51]
MM a[52:55],v[64:67],a[232:235],a[52:55]
TR v[90:91],v29,50176
MM a[52:55],v[68:71],a[236:239],a[52:55]
MM a[56:59],v[64:67],a[240:243],a[56:59]
TR v[92:93],v29,57344
MM a[56:59],v[68:71],a[244:247],a[56:59]
buffer_load_dwordx4 a[172:175], v12, s[16:19], s32 offen offset:1024 sc1
MM a[60:63],v[64:67],a[248:251],a[60:63]
TR v[94:95],v29,58368
MM a[60:63],v[68:71],a[252:255],a[60:63]
s_waitcnt vmcnt(22) lgkmcnt(10)
MM a[64:67],v[72:75],a[224:227],a[64:67]
s_barrier
s_waitcnt lgkmcnt(8)
MM a[64:67],v[76:79],a[228:231],a[64:67]
TR v[64:65],v16,0
MM a[68:71],v[72:75],a[232:235],a[68:71]
TR v[66:67],v16,1024
MM a[68:71],v[76:79],a[236:239],a[68:71]
TR v[68:69],v16,8192
MM a[72:75],v[72:75],a[240:243],a[72:75]
TR v[70:71],v16,9216
MM a[72:75],v[76:79],a[244:247],a[72:75]
MM a[76:79],v[72:75],a[248:251],a[76:79]
MM a[76:79],v[76:79],a[252:255],a[76:79]
s_waitcnt lgkmcnt(10)
buffer_load_dwordx4 a[180:183], v12, s[16:19], s32 offen offset:2048 sc1
MM a[80:83],v[80:83],a[224:227],a[80:83]
s_waitcnt lgkmcnt(8)
TR v[72:73],v17,0
MM a[80:83],v[84:87],a[228:231],a[80:83]
MM a[84:87],v[80:83],a[232:235],a[84:87]
TR v[74:75],v17,1024
MM a[84:87],v[84:87],a[236:239],a[84:87]
MM a[88:91],v[80:83],a[240:243],a[88:91]
TR v[76:77],v17,8192
MM a[88:91],v[84:87],a[244:247],a[88:91]
buffer_load_dwordx4 a[188:191], v12, s[16:19], s32 offen offset:3072 sc1
MM a[92:95],v[80:83],a[248:251],a[92:95]
s_add_u32 s32, s32, 131072
s_add_u32 s31, s31, 458752
TR v[78:79],v17,9216
MM a[92:95],v[84:87],a[252:255],a[92:95]
s_waitcnt lgkmcnt(10)
MM a[96:99],v[88:91],a[224:227],a[96:99]
s_waitcnt lgkmcnt(8)
TR v[80:81],v18,0
MM a[96:99],v[92:95],a[228:231],a[96:99]
MM a[100:103],v[88:91],a[232:235],a[100:103]
TR v[82:83],v18,1024
MM a[100:103],v[92:95],a[236:239],a[100:103]
MM a[104:107],v[88:91],a[240:243],a[104:107]
TR v[84:85],v18,8192
MM a[104:107],v[92:95],a[244:247],a[104:107]
s_add_u32 s34, s34, 1
MM a[108:111],v[88:91],a[248:251],a[108:111]
s_cmp_lt_u32 s34, 4
TR v[86:87],v18,9216
MM a[108:111],v[92:95],a[252:255],a[108:111]
s_cbranch_scc1 L_gateup_kernel_loop
s_waitcnt vmcnt(0)
v_mov_b32 v8, 0xc0135761
v_mov_b32 v9, 0xc0135761
v_mov_b32 v10, 0xbdd2d3e8
v_mov_b32 v11, 0xbdd2d3e8
v_mov_b32 v14, 1.0
v_mov_b32 v15, 1.0
s_lshr_b32 s48, s43, 4
s_mul_i32 s48, s48, 56
s_and_b32 s52, s43, 15
s_lshr_b32 s51, s52, 1
s_add_u32 s51, s51, s48
s_add_u32 s51, s51, 48
s_lshl_b32 s51, s51, 17
s_add_u32 s51, s51, s47
s_lshl_b32 s53, s39, 10
s_add_u32 s51, s51, s53
s_mul_i32 s52, s52, 3
s_add_u32 s48, s48, s52
s_lshl_b32 s48, s48, 17
s_add_u32 s48, s48, s47
v_accvgpr_read_b32 v32, a96
v_accvgpr_read_b32 v33, a97
v_accvgpr_read_b32 v34, a98
v_accvgpr_read_b32 v35, a99
v_accvgpr_read_b32 v36, a100
v_accvgpr_read_b32 v37, a101
v_accvgpr_read_b32 v38, a102
v_accvgpr_read_b32 v39, a103
v_pk_mul_f32 v[40:41], v[224:225], v[224:225]
v_pk_mul_f32 v[42:43], v[226:227], v[226:227]
v_pk_mul_f32 v[44:45], v[228:229], v[228:229]
v_pk_mul_f32 v[46:47], v[230:231], v[230:231]
v_pk_fma_f32 v[40:41], v[40:41], v[10:11], v[8:9]
v_pk_fma_f32 v[42:43], v[42:43], v[10:11], v[8:9]
v_pk_fma_f32 v[44:45], v[44:45], v[10:11], v[8:9]
v_pk_fma_f32 v[46:47], v[46:47], v[10:11], v[8:9]
v_pk_mul_f32 v[40:41], v[40:41], v[224:225]
v_pk_mul_f32 v[42:43], v[42:43], v[226:227]
v_pk_mul_f32 v[44:45], v[44:45], v[228:229]
v_pk_mul_f32 v[46:47], v[46:47], v[230:231]
v_exp_f32 v40, v40
v_exp_f32 v41, v41
v_exp_f32 v42, v42
v_exp_f32 v43, v43
v_exp_f32 v44, v44
v_exp_f32 v45, v45
v_exp_f32 v46, v46
v_exp_f32 v47, v47
v_pk_mul_f32 v[32:33], v[32:33], v[224:225]
v_pk_mul_f32 v[34:35], v[34:35], v[226:227]
v_pk_mul_f32 v[36:37], v[36:37], v[228:229]
v_pk_mul_f32 v[38:39], v[38:39], v[230:231]
v_pk_add_f32 v[40:41], v[40:41], v[14:15]
v_pk_add_f32 v[42:43], v[42:43], v[14:15]
v_pk_add_f32 v[44:45], v[44:45], v[14:15]
v_pk_add_f32 v[46:47], v[46:47], v[14:15]
v_rcp_f32 v40, v40
v_rcp_f32 v41, v41
v_rcp_f32 v42, v42
v_rcp_f32 v43, v43
v_rcp_f32 v44, v44
v_rcp_f32 v45, v45
v_rcp_f32 v46, v46
v_rcp_f32 v47, v47
v_pk_mul_f32 v[32:33], v[32:33], v[40:41]
v_pk_mul_f32 v[34:35], v[34:35], v[42:43]
v_pk_mul_f32 v[36:37], v[36:37], v[44:45]
v_pk_mul_f32 v[38:39], v[38:39], v[46:47]
v_cvt_pk_bf16_f32 v48, v32, v33
v_cvt_pk_bf16_f32 v49, v34, v35
v_cvt_pk_bf16_f32 v50, v36, v37
v_cvt_pk_bf16_f32 v51, v38, v39
buffer_store_dwordx4 v[48:51], v12, s[20:23], s51 offen offset:0 sc1
v_accvgpr_read_b32 v56, a104
v_accvgpr_read_b32 v57, a105
v_accvgpr_read_b32 v58, a106
v_accvgpr_read_b32 v59, a107
v_accvgpr_read_b32 v60, a108
v_accvgpr_read_b32 v61, a109
v_accvgpr_read_b32 v62, a110
v_accvgpr_read_b32 v63, a111
s_waitcnt lgkmcnt(11)
v_pk_mul_f32 v[64:65], v[232:233], v[232:233]
s_waitcnt lgkmcnt(10)
v_pk_mul_f32 v[66:67], v[234:235], v[234:235]
s_waitcnt lgkmcnt(9)
v_pk_mul_f32 v[68:69], v[236:237], v[236:237]
s_waitcnt lgkmcnt(8)
v_pk_mul_f32 v[70:71], v[238:239], v[238:239]
v_pk_fma_f32 v[64:65], v[64:65], v[10:11], v[8:9]
v_pk_fma_f32 v[66:67], v[66:67], v[10:11], v[8:9]
v_pk_fma_f32 v[68:69], v[68:69], v[10:11], v[8:9]
v_pk_fma_f32 v[70:71], v[70:71], v[10:11], v[8:9]
v_pk_mul_f32 v[64:65], v[64:65], v[232:233]
v_pk_mul_f32 v[66:67], v[66:67], v[234:235]
v_pk_mul_f32 v[68:69], v[68:69], v[236:237]
v_pk_mul_f32 v[70:71], v[70:71], v[238:239]
v_exp_f32 v64, v64
v_exp_f32 v65, v65
v_exp_f32 v66, v66
v_exp_f32 v67, v67
v_exp_f32 v68, v68
v_exp_f32 v69, v69
v_exp_f32 v70, v70
v_exp_f32 v71, v71
v_pk_mul_f32 v[56:57], v[56:57], v[232:233]
v_pk_mul_f32 v[58:59], v[58:59], v[234:235]
v_pk_mul_f32 v[60:61], v[60:61], v[236:237]
v_pk_mul_f32 v[62:63], v[62:63], v[238:239]
v_pk_add_f32 v[64:65], v[64:65], v[14:15]
v_pk_add_f32 v[66:67], v[66:67], v[14:15]
v_pk_add_f32 v[68:69], v[68:69], v[14:15]
v_pk_add_f32 v[70:71], v[70:71], v[14:15]
v_rcp_f32 v64, v64
v_rcp_f32 v65, v65
v_rcp_f32 v66, v66
v_rcp_f32 v67, v67
v_rcp_f32 v68, v68
v_rcp_f32 v69, v69
v_rcp_f32 v70, v70
v_rcp_f32 v71, v71
v_pk_mul_f32 v[56:57], v[56:57], v[64:65]
v_pk_mul_f32 v[58:59], v[58:59], v[66:67]
v_pk_mul_f32 v[60:61], v[60:61], v[68:69]
v_pk_mul_f32 v[62:63], v[62:63], v[70:71]
s_waitcnt lgkmcnt(7)
v_cvt_pk_bf16_f32 v72, v56, v57
v_cvt_pk_bf16_f32 v73, v58, v59
s_waitcnt lgkmcnt(6)
v_cvt_pk_bf16_f32 v74, v60, v61
v_cvt_pk_bf16_f32 v75, v62, v63
buffer_store_dwordx4 v[72:75], v12, s[20:23], s51 offen offset:2048 sc1
s_add_u32 s49, s48, 0
v_accvgpr_read_b32 v32, a0
v_accvgpr_read_b32 v33, a1
v_accvgpr_read_b32 v34, a2
v_accvgpr_read_b32 v35, a3
v_accvgpr_read_b32 v36, a16
v_accvgpr_read_b32 v37, a17
v_accvgpr_read_b32 v38, a18
v_accvgpr_read_b32 v39, a19
v_pk_mul_f32 v[40:41], v[128:129], v[128:129]
v_pk_mul_f32 v[42:43], v[130:131], v[130:131]
v_pk_mul_f32 v[44:45], v[144:145], v[144:145]
v_pk_mul_f32 v[46:47], v[146:147], v[146:147]
v_pk_fma_f32 v[40:41], v[40:41], v[10:11], v[8:9]
v_pk_fma_f32 v[42:43], v[42:43], v[10:11], v[8:9]
v_pk_fma_f32 v[44:45], v[44:45], v[10:11], v[8:9]
v_pk_fma_f32 v[46:47], v[46:47], v[10:11], v[8:9]
v_pk_mul_f32 v[40:41], v[40:41], v[128:129]
v_pk_mul_f32 v[42:43], v[42:43], v[130:131]
v_pk_mul_f32 v[44:45], v[44:45], v[144:145]
v_pk_mul_f32 v[46:47], v[46:47], v[146:147]
v_exp_f32 v40, v40
v_exp_f32 v41, v41
v_exp_f32 v42, v42
v_exp_f32 v43, v43
v_exp_f32 v44, v44
v_exp_f32 v45, v45
v_exp_f32 v46, v46
v_exp_f32 v47, v47
v_pk_mul_f32 v[32:33], v[32:33], v[128:129]
v_pk_mul_f32 v[34:35], v[34:35], v[130:131]
v_pk_mul_f32 v[36:37], v[36:37], v[144:145]
v_pk_mul_f32 v[38:39], v[38:39], v[146:147]
v_pk_add_f32 v[40:41], v[40:41], v[14:15]
v_pk_add_f32 v[42:43], v[42:43], v[14:15]
v_pk_add_f32 v[44:45], v[44:45], v[14:15]
v_pk_add_f32 v[46:47], v[46:47], v[14:15]
v_rcp_f32 v40, v40
v_rcp_f32 v41, v41
v_rcp_f32 v42, v42
v_rcp_f32 v43, v43
v_rcp_f32 v44, v44
v_rcp_f32 v45, v45
v_rcp_f32 v46, v46
v_rcp_f32 v47, v47
v_pk_mul_f32 v[32:33], v[32:33], v[40:41]
v_pk_mul_f32 v[34:35], v[34:35], v[42:43]
v_pk_mul_f32 v[36:37], v[36:37], v[44:45]
v_pk_mul_f32 v[38:39], v[38:39], v[46:47]
v_cvt_pk_bf16_f32 v48, v32, v33
v_cvt_pk_bf16_f32 v49, v34, v35
v_cvt_pk_bf16_f32 v50, v36, v37
v_cvt_pk_bf16_f32 v51, v38, v39
buffer_store_dwordx4 v[48:51], v12, s[20:23], s49 offen offset:0 sc1
v_accvgpr_read_b32 v56, a4
v_accvgpr_read_b32 v57, a5
v_accvgpr_read_b32 v58, a6
v_accvgpr_read_b32 v59, a7
v_accvgpr_read_b32 v60, a20
v_accvgpr_read_b32 v61, a21
v_accvgpr_read_b32 v62, a22
v_accvgpr_read_b32 v63, a23
v_pk_mul_f32 v[64:65], v[132:133], v[132:133]
v_pk_mul_f32 v[66:67], v[134:135], v[134:135]
v_pk_mul_f32 v[68:69], v[148:149], v[148:149]
v_pk_mul_f32 v[70:71], v[150:151], v[150:151]
v_pk_fma_f32 v[64:65], v[64:65], v[10:11], v[8:9]
v_pk_fma_f32 v[66:67], v[66:67], v[10:11], v[8:9]
v_pk_fma_f32 v[68:69], v[68:69], v[10:11], v[8:9]
v_pk_fma_f32 v[70:71], v[70:71], v[10:11], v[8:9]
v_pk_mul_f32 v[64:65], v[64:65], v[132:133]
v_pk_mul_f32 v[66:67], v[66:67], v[134:135]
v_pk_mul_f32 v[68:69], v[68:69], v[148:149]
v_pk_mul_f32 v[70:71], v[70:71], v[150:151]
v_exp_f32 v64, v64
v_exp_f32 v65, v65
v_exp_f32 v66, v66
v_exp_f32 v67, v67
v_exp_f32 v68, v68
v_exp_f32 v69, v69
v_exp_f32 v70, v70
v_exp_f32 v71, v71
v_pk_mul_f32 v[56:57], v[56:57], v[132:133]
v_pk_mul_f32 v[58:59], v[58:59], v[134:135]
v_pk_mul_f32 v[60:61], v[60:61], v[148:149]
v_pk_mul_f32 v[62:63], v[62:63], v[150:151]
v_pk_add_f32 v[64:65], v[64:65], v[14:15]
v_pk_add_f32 v[66:67], v[66:67], v[14:15]
v_pk_add_f32 v[68:69], v[68:69], v[14:15]
v_pk_add_f32 v[70:71], v[70:71], v[14:15]
v_rcp_f32 v64, v64
v_rcp_f32 v65, v65
v_rcp_f32 v66, v66
v_rcp_f32 v67, v67
v_rcp_f32 v68, v68
v_rcp_f32 v69, v69
v_rcp_f32 v70, v70
v_rcp_f32 v71, v71
v_pk_mul_f32 v[56:57], v[56:57], v[64:65]
v_pk_mul_f32 v[58:59], v[58:59], v[66:67]
v_pk_mul_f32 v[60:61], v[60:61], v[68:69]
v_pk_mul_f32 v[62:63], v[62:63], v[70:71]
v_cvt_pk_bf16_f32 v72, v56, v57
v_cvt_pk_bf16_f32 v73, v58, v59
v_cvt_pk_bf16_f32 v74, v60, v61
v_cvt_pk_bf16_f32 v75, v62, v63
buffer_store_dwordx4 v[72:75], v12, s[20:23], s49 offen offset:1024 sc1
v_accvgpr_read_b32 v32, a8
v_accvgpr_read_b32 v33, a9
v_accvgpr_read_b32 v34, a10
v_accvgpr_read_b32 v35, a11
v_accvgpr_read_b32 v36, a24
v_accvgpr_read_b32 v37, a25
v_accvgpr_read_b32 v38, a26
v_accvgpr_read_b32 v39, a27
v_pk_mul_f32 v[40:41], v[136:137], v[136:137]
v_pk_mul_f32 v[42:43], v[138:139], v[138:139]
v_pk_mul_f32 v[44:45], v[152:153], v[152:153]
v_pk_mul_f32 v[46:47], v[154:155], v[154:155]
v_pk_fma_f32 v[40:41], v[40:41], v[10:11], v[8:9]
v_pk_fma_f32 v[42:43], v[42:43], v[10:11], v[8:9]
v_pk_fma_f32 v[44:45], v[44:45], v[10:11], v[8:9]
v_pk_fma_f32 v[46:47], v[46:47], v[10:11], v[8:9]
v_pk_mul_f32 v[40:41], v[40:41], v[136:137]
v_pk_mul_f32 v[42:43], v[42:43], v[138:139]
v_pk_mul_f32 v[44:45], v[44:45], v[152:153]
v_pk_mul_f32 v[46:47], v[46:47], v[154:155]
v_exp_f32 v40, v40
v_exp_f32 v41, v41
v_exp_f32 v42, v42
v_exp_f32 v43, v43
v_exp_f32 v44, v44
v_exp_f32 v45, v45
v_exp_f32 v46, v46
v_exp_f32 v47, v47
v_pk_mul_f32 v[32:33], v[32:33], v[136:137]
v_pk_mul_f32 v[34:35], v[34:35], v[138:139]
v_pk_mul_f32 v[36:37], v[36:37], v[152:153]
v_pk_mul_f32 v[38:39], v[38:39], v[154:155]
v_pk_add_f32 v[40:41], v[40:41], v[14:15]
v_pk_add_f32 v[42:43], v[42:43], v[14:15]
v_pk_add_f32 v[44:45], v[44:45], v[14:15]
v_pk_add_f32 v[46:47], v[46:47], v[14:15]
v_rcp_f32 v40, v40
v_rcp_f32 v41, v41
v_rcp_f32 v42, v42
v_rcp_f32 v43, v43
v_rcp_f32 v44, v44
v_rcp_f32 v45, v45
v_rcp_f32 v46, v46
v_rcp_f32 v47, v47
v_pk_mul_f32 v[32:33], v[32:33], v[40:41]
v_pk_mul_f32 v[34:35], v[34:35], v[42:43]
v_pk_mul_f32 v[36:37], v[36:37], v[44:45]
v_pk_mul_f32 v[38:39], v[38:39], v[46:47]
v_cvt_pk_bf16_f32 v48, v32, v33
v_cvt_pk_bf16_f32 v49, v34, v35
v_cvt_pk_bf16_f32 v50, v36, v37
v_cvt_pk_bf16_f32 v51, v38, v39
buffer_store_dwordx4 v[48:51], v12, s[20:23], s49 offen offset:2048 sc1
v_accvgpr_read_b32 v56, a12
v_accvgpr_read_b32 v57, a13
v_accvgpr_read_b32 v58, a14
v_accvgpr_read_b32 v59, a15
v_accvgpr_read_b32 v60, a28
v_accvgpr_read_b32 v61, a29
v_accvgpr_read_b32 v62, a30
v_accvgpr_read_b32 v63, a31
v_pk_mul_f32 v[64:65], v[140:141], v[140:141]
v_pk_mul_f32 v[66:67], v[142:143], v[142:143]
v_pk_mul_f32 v[68:69], v[156:157], v[156:157]
v_pk_mul_f32 v[70:71], v[158:159], v[158:159]
v_pk_fma_f32 v[64:65], v[64:65], v[10:11], v[8:9]
v_pk_fma_f32 v[66:67], v[66:67], v[10:11], v[8:9]
v_pk_fma_f32 v[68:69], v[68:69], v[10:11], v[8:9]
v_pk_fma_f32 v[70:71], v[70:71], v[10:11], v[8:9]
v_pk_mul_f32 v[64:65], v[64:65], v[140:141]
v_pk_mul_f32 v[66:67], v[66:67], v[142:143]
v_pk_mul_f32 v[68:69], v[68:69], v[156:157]
v_pk_mul_f32 v[70:71], v[70:71], v[158:159]
v_exp_f32 v64, v64
v_exp_f32 v65, v65
v_exp_f32 v66, v66
v_exp_f32 v67, v67
v_exp_f32 v68, v68
v_exp_f32 v69, v69
v_exp_f32 v70, v70
v_exp_f32 v71, v71
v_pk_mul_f32 v[56:57], v[56:57], v[140:141]
v_pk_mul_f32 v[58:59], v[58:59], v[142:143]
v_pk_mul_f32 v[60:61], v[60:61], v[156:157]
v_pk_mul_f32 v[62:63], v[62:63], v[158:159]
v_pk_add_f32 v[64:65], v[64:65], v[14:15]
v_pk_add_f32 v[66:67], v[66:67], v[14:15]
v_pk_add_f32 v[68:69], v[68:69], v[14:15]
v_pk_add_f32 v[70:71], v[70:71], v[14:15]
v_rcp_f32 v64, v64
v_rcp_f32 v65, v65
v_rcp_f32 v66, v66
v_rcp_f32 v67, v67
v_rcp_f32 v68, v68
v_rcp_f32 v69, v69
v_rcp_f32 v70, v70
v_rcp_f32 v71, v71
v_pk_mul_f32 v[56:57], v[56:57], v[64:65]
v_pk_mul_f32 v[58:59], v[58:59], v[66:67]
v_pk_mul_f32 v[60:61], v[60:61], v[68:69]
v_pk_mul_f32 v[62:63], v[62:63], v[70:71]
v_cvt_pk_bf16_f32 v72, v56, v57
v_cvt_pk_bf16_f32 v73, v58, v59
v_cvt_pk_bf16_f32 v74, v60, v61
v_cvt_pk_bf16_f32 v75, v62, v63
buffer_store_dwordx4 v[72:75], v12, s[20:23], s49 offen offset:3072 sc1
s_add_u32 s49, s48, 131072
v_accvgpr_read_b32 v32, a32
v_accvgpr_read_b32 v33, a33
v_accvgpr_read_b32 v34, a34
v_accvgpr_read_b32 v35, a35
v_accvgpr_read_b32 v36, a48
v_accvgpr_read_b32 v37, a49
v_accvgpr_read_b32 v38, a50
v_accvgpr_read_b32 v39, a51
v_pk_mul_f32 v[40:41], v[160:161], v[160:161]
v_pk_mul_f32 v[42:43], v[162:163], v[162:163]
v_pk_mul_f32 v[44:45], v[176:177], v[176:177]
v_pk_mul_f32 v[46:47], v[178:179], v[178:179]
v_pk_fma_f32 v[40:41], v[40:41], v[10:11], v[8:9]
v_pk_fma_f32 v[42:43], v[42:43], v[10:11], v[8:9]
v_pk_fma_f32 v[44:45], v[44:45], v[10:11], v[8:9]
v_pk_fma_f32 v[46:47], v[46:47], v[10:11], v[8:9]
v_pk_mul_f32 v[40:41], v[40:41], v[160:161]
v_pk_mul_f32 v[42:43], v[42:43], v[162:163]
v_pk_mul_f32 v[44:45], v[44:45], v[176:177]
v_pk_mul_f32 v[46:47], v[46:47], v[178:179]
v_exp_f32 v40, v40
v_exp_f32 v41, v41
v_exp_f32 v42, v42
v_exp_f32 v43, v43
v_exp_f32 v44, v44
v_exp_f32 v45, v45
v_exp_f32 v46, v46
v_exp_f32 v47, v47
v_pk_mul_f32 v[32:33], v[32:33], v[160:161]
v_pk_mul_f32 v[34:35], v[34:35], v[162:163]
v_pk_mul_f32 v[36:37], v[36:37], v[176:177]
v_pk_mul_f32 v[38:39], v[38:39], v[178:179]
v_pk_add_f32 v[40:41], v[40:41], v[14:15]
v_pk_add_f32 v[42:43], v[42:43], v[14:15]
v_pk_add_f32 v[44:45], v[44:45], v[14:15]
v_pk_add_f32 v[46:47], v[46:47], v[14:15]
v_rcp_f32 v40, v40
v_rcp_f32 v41, v41
v_rcp_f32 v42, v42
v_rcp_f32 v43, v43
v_rcp_f32 v44, v44
v_rcp_f32 v45, v45
v_rcp_f32 v46, v46
v_rcp_f32 v47, v47
v_pk_mul_f32 v[32:33], v[32:33], v[40:41]
v_pk_mul_f32 v[34:35], v[34:35], v[42:43]
v_pk_mul_f32 v[36:37], v[36:37], v[44:45]
v_pk_mul_f32 v[38:39], v[38:39], v[46:47]
v_cvt_pk_bf16_f32 v48, v32, v33
v_cvt_pk_bf16_f32 v49, v34, v35
v_cvt_pk_bf16_f32 v50, v36, v37
v_cvt_pk_bf16_f32 v51, v38, v39
buffer_store_dwordx4 v[48:51], v12, s[20:23], s49 offen offset:0 sc1
v_accvgpr_read_b32 v56, a36
v_accvgpr_read_b32 v57, a37
v_accvgpr_read_b32 v58, a38
v_accvgpr_read_b32 v59, a39
v_accvgpr_read_b32 v60, a52
v_accvgpr_read_b32 v61, a53
v_accvgpr_read_b32 v62, a54
v_accvgpr_read_b32 v63, a55
v_pk_mul_f32 v[64:65], v[164:165], v[164:165]
v_pk_mul_f32 v[66:67], v[166:167], v[166:167]
v_pk_mul_f32 v[68:69], v[180:181], v[180:181]
v_pk_mul_f32 v[70:71], v[182:183], v[182:183]
v_pk_fma_f32 v[64:65], v[64:65], v[10:11], v[8:9]
v_pk_fma_f32 v[66:67], v[66:67], v[10:11], v[8:9]
v_pk_fma_f32 v[68:69], v[68:69], v[10:11], v[8:9]
v_pk_fma_f32 v[70:71], v[70:71], v[10:11], v[8:9]
v_pk_mul_f32 v[64:65], v[64:65], v[164:165]
v_pk_mul_f32 v[66:67], v[66:67], v[166:167]
v_pk_mul_f32 v[68:69], v[68:69], v[180:181]
v_pk_mul_f32 v[70:71], v[70:71], v[182:183]
v_exp_f32 v64, v64
v_exp_f32 v65, v65
v_exp_f32 v66, v66
v_exp_f32 v67, v67
v_exp_f32 v68, v68
v_exp_f32 v69, v69
v_exp_f32 v70, v70
v_exp_f32 v71, v71
v_pk_mul_f32 v[56:57], v[56:57], v[164:165]
v_pk_mul_f32 v[58:59], v[58:59], v[166:167]
v_pk_mul_f32 v[60:61], v[60:61], v[180:181]
v_pk_mul_f32 v[62:63], v[62:63], v[182:183]
v_pk_add_f32 v[64:65], v[64:65], v[14:15]
v_pk_add_f32 v[66:67], v[66:67], v[14:15]
v_pk_add_f32 v[68:69], v[68:69], v[14:15]
v_pk_add_f32 v[70:71], v[70:71], v[14:15]
v_rcp_f32 v64, v64
v_rcp_f32 v65, v65
v_rcp_f32 v66, v66
v_rcp_f32 v67, v67
v_rcp_f32 v68, v68
v_rcp_f32 v69, v69
v_rcp_f32 v70, v70
v_rcp_f32 v71, v71
v_pk_mul_f32 v[56:57], v[56:57], v[64:65]
v_pk_mul_f32 v[58:59], v[58:59], v[66:67]
v_pk_mul_f32 v[60:61], v[60:61], v[68:69]
v_pk_mul_f32 v[62:63], v[62:63], v[70:71]
v_cvt_pk_bf16_f32 v72, v56, v57
v_cvt_pk_bf16_f32 v73, v58, v59
v_cvt_pk_bf16_f32 v74, v60, v61
v_cvt_pk_bf16_f32 v75, v62, v63
buffer_store_dwordx4 v[72:75], v12, s[20:23], s49 offen offset:1024 sc1
v_accvgpr_read_b32 v32, a40
v_accvgpr_read_b32 v33, a41
v_accvgpr_read_b32 v34, a42
v_accvgpr_read_b32 v35, a43
v_accvgpr_read_b32 v36, a56
v_accvgpr_read_b32 v37, a57
v_accvgpr_read_b32 v38, a58
v_accvgpr_read_b32 v39, a59
v_pk_mul_f32 v[40:41], v[168:169], v[168:169]
v_pk_mul_f32 v[42:43], v[170:171], v[170:171]
v_pk_mul_f32 v[44:45], v[184:185], v[184:185]
v_pk_mul_f32 v[46:47], v[186:187], v[186:187]
v_pk_fma_f32 v[40:41], v[40:41], v[10:11], v[8:9]
v_pk_fma_f32 v[42:43], v[42:43], v[10:11], v[8:9]
v_pk_fma_f32 v[44:45], v[44:45], v[10:11], v[8:9]
v_pk_fma_f32 v[46:47], v[46:47], v[10:11], v[8:9]
v_pk_mul_f32 v[40:41], v[40:41], v[168:169]
v_pk_mul_f32 v[42:43], v[42:43], v[170:171]
v_pk_mul_f32 v[44:45], v[44:45], v[184:185]
v_pk_mul_f32 v[46:47], v[46:47], v[186:187]
v_exp_f32 v40, v40
v_exp_f32 v41, v41
v_exp_f32 v42, v42
v_exp_f32 v43, v43
v_exp_f32 v44, v44
v_exp_f32 v45, v45
v_exp_f32 v46, v46
v_exp_f32 v47, v47
v_pk_mul_f32 v[32:33], v[32:33], v[168:169]
v_pk_mul_f32 v[34:35], v[34:35], v[170:171]
v_pk_mul_f32 v[36:37], v[36:37], v[184:185]
v_pk_mul_f32 v[38:39], v[38:39], v[186:187]
v_pk_add_f32 v[40:41], v[40:41], v[14:15]
v_pk_add_f32 v[42:43], v[42:43], v[14:15]
v_pk_add_f32 v[44:45], v[44:45], v[14:15]
v_pk_add_f32 v[46:47], v[46:47], v[14:15]
v_rcp_f32 v40, v40
v_rcp_f32 v41, v41
v_rcp_f32 v42, v42
v_rcp_f32 v43, v43
v_rcp_f32 v44, v44
v_rcp_f32 v45, v45
v_rcp_f32 v46, v46
v_rcp_f32 v47, v47
v_pk_mul_f32 v[32:33], v[32:33], v[40:41]
v_pk_mul_f32 v[34:35], v[34:35], v[42:43]
v_pk_mul_f32 v[36:37], v[36:37], v[44:45]
v_pk_mul_f32 v[38:39], v[38:39], v[46:47]
v_cvt_pk_bf16_f32 v48, v32, v33
v_cvt_pk_bf16_f32 v49, v34, v35
v_cvt_pk_bf16_f32 v50, v36, v37
v_cvt_pk_bf16_f32 v51, v38, v39
buffer_store_dwordx4 v[48:51], v12, s[20:23], s49 offen offset:2048 sc1
v_accvgpr_read_b32 v56, a44
v_accvgpr_read_b32 v57, a45
v_accvgpr_read_b32 v58, a46
v_accvgpr_read_b32 v59, a47
v_accvgpr_read_b32 v60, a60
v_accvgpr_read_b32 v61, a61
v_accvgpr_read_b32 v62, a62
v_accvgpr_read_b32 v63, a63
v_pk_mul_f32 v[64:65], v[172:173], v[172:173]
v_pk_mul_f32 v[66:67], v[174:175], v[174:175]
v_pk_mul_f32 v[68:69], v[188:189], v[188:189]
v_pk_mul_f32 v[70:71], v[190:191], v[190:191]
v_pk_fma_f32 v[64:65], v[64:65], v[10:11], v[8:9]
v_pk_fma_f32 v[66:67], v[66:67], v[10:11], v[8:9]
v_pk_fma_f32 v[68:69], v[68:69], v[10:11], v[8:9]
v_pk_fma_f32 v[70:71], v[70:71], v[10:11], v[8:9]
v_pk_mul_f32 v[64:65], v[64:65], v[172:173]
v_pk_mul_f32 v[66:67], v[66:67], v[174:175]
v_pk_mul_f32 v[68:69], v[68:69], v[188:189]
v_pk_mul_f32 v[70:71], v[70:71], v[190:191]
v_exp_f32 v64, v64
v_exp_f32 v65, v65
v_exp_f32 v66, v66
v_exp_f32 v67, v67
v_exp_f32 v68, v68
v_exp_f32 v69, v69
v_exp_f32 v70, v70
v_exp_f32 v71, v71
v_pk_mul_f32 v[56:57], v[56:57], v[172:173]
v_pk_mul_f32 v[58:59], v[58:59], v[174:175]
v_pk_mul_f32 v[60:61], v[60:61], v[188:189]
v_pk_mul_f32 v[62:63], v[62:63], v[190:191]
v_pk_add_f32 v[64:65], v[64:65], v[14:15]
v_pk_add_f32 v[66:67], v[66:67], v[14:15]
v_pk_add_f32 v[68:69], v[68:69], v[14:15]
v_pk_add_f32 v[70:71], v[70:71], v[14:15]
v_rcp_f32 v64, v64
v_rcp_f32 v65, v65
v_rcp_f32 v66, v66
v_rcp_f32 v67, v67
v_rcp_f32 v68, v68
v_rcp_f32 v69, v69
v_rcp_f32 v70, v70
v_rcp_f32 v71, v71
v_pk_mul_f32 v[56:57], v[56:57], v[64:65]
v_pk_mul_f32 v[58:59], v[58:59], v[66:67]
v_pk_mul_f32 v[60:61], v[60:61], v[68:69]
v_pk_mul_f32 v[62:63], v[62:63], v[70:71]
v_cvt_pk_bf16_f32 v72, v56, v57
v_cvt_pk_bf16_f32 v73, v58, v59
v_cvt_pk_bf16_f32 v74, v60, v61
v_cvt_pk_bf16_f32 v75, v62, v63
buffer_store_dwordx4 v[72:75], v12, s[20:23], s49 offen offset:3072 sc1
s_add_u32 s49, s48, 262144
v_accvgpr_read_b32 v32, a64
v_accvgpr_read_b32 v33, a65
v_accvgpr_read_b32 v34, a66
v_accvgpr_read_b32 v35, a67
v_accvgpr_read_b32 v36, a80
v_accvgpr_read_b32 v37, a81
v_accvgpr_read_b32 v38, a82
v_accvgpr_read_b32 v39, a83
v_pk_mul_f32 v[40:41], v[192:193], v[192:193]
v_pk_mul_f32 v[42:43], v[194:195], v[194:195]
v_pk_mul_f32 v[44:45], v[208:209], v[208:209]
v_pk_mul_f32 v[46:47], v[210:211], v[210:211]
v_pk_fma_f32 v[40:41], v[40:41], v[10:11], v[8:9]
v_pk_fma_f32 v[42:43], v[42:43], v[10:11], v[8:9]
v_pk_fma_f32 v[44:45], v[44:45], v[10:11], v[8:9]
v_pk_fma_f32 v[46:47], v[46:47], v[10:11], v[8:9]
v_pk_mul_f32 v[40:41], v[40:41], v[192:193]
v_pk_mul_f32 v[42:43], v[42:43], v[194:195]
v_pk_mul_f32 v[44:45], v[44:45], v[208:209]
v_pk_mul_f32 v[46:47], v[46:47], v[210:211]
v_exp_f32 v40, v40
v_exp_f32 v41, v41
v_exp_f32 v42, v42
v_exp_f32 v43, v43
v_exp_f32 v44, v44
v_exp_f32 v45, v45
v_exp_f32 v46, v46
v_exp_f32 v47, v47
v_pk_mul_f32 v[32:33], v[32:33], v[192:193]
v_pk_mul_f32 v[34:35], v[34:35], v[194:195]
v_pk_mul_f32 v[36:37], v[36:37], v[208:209]
v_pk_mul_f32 v[38:39], v[38:39], v[210:211]
v_pk_add_f32 v[40:41], v[40:41], v[14:15]
v_pk_add_f32 v[42:43], v[42:43], v[14:15]
v_pk_add_f32 v[44:45], v[44:45], v[14:15]
v_pk_add_f32 v[46:47], v[46:47], v[14:15]
v_rcp_f32 v40, v40
v_rcp_f32 v41, v41
v_rcp_f32 v42, v42
v_rcp_f32 v43, v43
v_rcp_f32 v44, v44
v_rcp_f32 v45, v45
v_rcp_f32 v46, v46
v_rcp_f32 v47, v47
v_pk_mul_f32 v[32:33], v[32:33], v[40:41]
v_pk_mul_f32 v[34:35], v[34:35], v[42:43]
v_pk_mul_f32 v[36:37], v[36:37], v[44:45]
v_pk_mul_f32 v[38:39], v[38:39], v[46:47]
v_cvt_pk_bf16_f32 v48, v32, v33
v_cvt_pk_bf16_f32 v49, v34, v35
v_cvt_pk_bf16_f32 v50, v36, v37
v_cvt_pk_bf16_f32 v51, v38, v39
buffer_store_dwordx4 v[48:51], v12, s[20:23], s49 offen offset:0 sc1
v_accvgpr_read_b32 v56, a68
v_accvgpr_read_b32 v57, a69
v_accvgpr_read_b32 v58, a70
v_accvgpr_read_b32 v59, a71
v_accvgpr_read_b32 v60, a84
v_accvgpr_read_b32 v61, a85
v_accvgpr_read_b32 v62, a86
v_accvgpr_read_b32 v63, a87
v_pk_mul_f32 v[64:65], v[196:197], v[196:197]
v_pk_mul_f32 v[66:67], v[198:199], v[198:199]
v_pk_mul_f32 v[68:69], v[212:213], v[212:213]
v_pk_mul_f32 v[70:71], v[214:215], v[214:215]
v_pk_fma_f32 v[64:65], v[64:65], v[10:11], v[8:9]
v_pk_fma_f32 v[66:67], v[66:67], v[10:11], v[8:9]
v_pk_fma_f32 v[68:69], v[68:69], v[10:11], v[8:9]
v_pk_fma_f32 v[70:71], v[70:71], v[10:11], v[8:9]
v_pk_mul_f32 v[64:65], v[64:65], v[196:197]
v_pk_mul_f32 v[66:67], v[66:67], v[198:199]
v_pk_mul_f32 v[68:69], v[68:69], v[212:213]
v_pk_mul_f32 v[70:71], v[70:71], v[214:215]
v_exp_f32 v64, v64
v_exp_f32 v65, v65
v_exp_f32 v66, v66
v_exp_f32 v67, v67
v_exp_f32 v68, v68
v_exp_f32 v69, v69
v_exp_f32 v70, v70
v_exp_f32 v71, v71
v_pk_mul_f32 v[56:57], v[56:57], v[196:197]
v_pk_mul_f32 v[58:59], v[58:59], v[198:199]
v_pk_mul_f32 v[60:61], v[60:61], v[212:213]
v_pk_mul_f32 v[62:63], v[62:63], v[214:215]
v_pk_add_f32 v[64:65], v[64:65], v[14:15]
v_pk_add_f32 v[66:67], v[66:67], v[14:15]
v_pk_add_f32 v[68:69], v[68:69], v[14:15]
v_pk_add_f32 v[70:71], v[70:71], v[14:15]
v_rcp_f32 v64, v64
v_rcp_f32 v65, v65
v_rcp_f32 v66, v66
v_rcp_f32 v67, v67
v_rcp_f32 v68, v68
v_rcp_f32 v69, v69
v_rcp_f32 v70, v70
v_rcp_f32 v71, v71
v_pk_mul_f32 v[56:57], v[56:57], v[64:65]
v_pk_mul_f32 v[58:59], v[58:59], v[66:67]
v_pk_mul_f32 v[60:61], v[60:61], v[68:69]
v_pk_mul_f32 v[62:63], v[62:63], v[70:71]
v_cvt_pk_bf16_f32 v72, v56, v57
v_cvt_pk_bf16_f32 v73, v58, v59
v_cvt_pk_bf16_f32 v74, v60, v61
v_cvt_pk_bf16_f32 v75, v62, v63
buffer_store_dwordx4 v[72:75], v12, s[20:23], s49 offen offset:1024 sc1
v_accvgpr_read_b32 v32, a72
v_accvgpr_read_b32 v33, a73
v_accvgpr_read_b32 v34, a74
v_accvgpr_read_b32 v35, a75
v_accvgpr_read_b32 v36, a88
v_accvgpr_read_b32 v37, a89
v_accvgpr_read_b32 v38, a90
v_accvgpr_read_b32 v39, a91
v_pk_mul_f32 v[40:41], v[200:201], v[200:201]
v_pk_mul_f32 v[42:43], v[202:203], v[202:203]
v_pk_mul_f32 v[44:45], v[216:217], v[216:217]
v_pk_mul_f32 v[46:47], v[218:219], v[218:219]
v_pk_fma_f32 v[40:41], v[40:41], v[10:11], v[8:9]
v_pk_fma_f32 v[42:43], v[42:43], v[10:11], v[8:9]
v_pk_fma_f32 v[44:45], v[44:45], v[10:11], v[8:9]
v_pk_fma_f32 v[46:47], v[46:47], v[10:11], v[8:9]
v_pk_mul_f32 v[40:41], v[40:41], v[200:201]
v_pk_mul_f32 v[42:43], v[42:43], v[202:203]
v_pk_mul_f32 v[44:45], v[44:45], v[216:217]
v_pk_mul_f32 v[46:47], v[46:47], v[218:219]
v_exp_f32 v40, v40
v_exp_f32 v41, v41
v_exp_f32 v42, v42
v_exp_f32 v43, v43
v_exp_f32 v44, v44
v_exp_f32 v45, v45
v_exp_f32 v46, v46
v_exp_f32 v47, v47
v_pk_mul_f32 v[32:33], v[32:33], v[200:201]
v_pk_mul_f32 v[34:35], v[34:35], v[202:203]
v_pk_mul_f32 v[36:37], v[36:37], v[216:217]
v_pk_mul_f32 v[38:39], v[38:39], v[218:219]
v_pk_add_f32 v[40:41], v[40:41], v[14:15]
v_pk_add_f32 v[42:43], v[42:43], v[14:15]
v_pk_add_f32 v[44:45], v[44:45], v[14:15]
v_pk_add_f32 v[46:47], v[46:47], v[14:15]
v_rcp_f32 v40, v40
v_rcp_f32 v41, v41
v_rcp_f32 v42, v42
v_rcp_f32 v43, v43
v_rcp_f32 v44, v44
v_rcp_f32 v45, v45
v_rcp_f32 v46, v46
v_rcp_f32 v47, v47
v_pk_mul_f32 v[32:33], v[32:33], v[40:41]
v_pk_mul_f32 v[34:35], v[34:35], v[42:43]
v_pk_mul_f32 v[36:37], v[36:37], v[44:45]
v_pk_mul_f32 v[38:39], v[38:39], v[46:47]
v_cvt_pk_bf16_f32 v48, v32, v33
v_cvt_pk_bf16_f32 v49, v34, v35
v_cvt_pk_bf16_f32 v50, v36, v37
v_cvt_pk_bf16_f32 v51, v38, v39
buffer_store_dwordx4 v[48:51], v12, s[20:23], s49 offen offset:2048 sc1
v_accvgpr_read_b32 v56, a76
v_accvgpr_read_b32 v57, a77
v_accvgpr_read_b32 v58, a78
v_accvgpr_read_b32 v59, a79
v_accvgpr_read_b32 v60, a92
v_accvgpr_read_b32 v61, a93
v_accvgpr_read_b32 v62, a94
v_accvgpr_read_b32 v63, a95
v_pk_mul_f32 v[64:65], v[204:205], v[204:205]
v_pk_mul_f32 v[66:67], v[206:207], v[206:207]
v_pk_mul_f32 v[68:69], v[220:221], v[220:221]
v_pk_mul_f32 v[70:71], v[222:223], v[222:223]
v_pk_fma_f32 v[64:65], v[64:65], v[10:11], v[8:9]
v_pk_fma_f32 v[66:67], v[66:67], v[10:11], v[8:9]
v_pk_fma_f32 v[68:69], v[68:69], v[10:11], v[8:9]
v_pk_fma_f32 v[70:71], v[70:71], v[10:11], v[8:9]
v_pk_mul_f32 v[64:65], v[64:65], v[204:205]
v_pk_mul_f32 v[66:67], v[66:67], v[206:207]
v_pk_mul_f32 v[68:69], v[68:69], v[220:221]
v_pk_mul_f32 v[70:71], v[70:71], v[222:223]
v_exp_f32 v64, v64
v_exp_f32 v65, v65
v_exp_f32 v66, v66
v_exp_f32 v67, v67
v_exp_f32 v68, v68
v_exp_f32 v69, v69
v_exp_f32 v70, v70
v_exp_f32 v71, v71
v_pk_mul_f32 v[56:57], v[56:57], v[204:205]
v_pk_mul_f32 v[58:59], v[58:59], v[206:207]
v_pk_mul_f32 v[60:61], v[60:61], v[220:221]
v_pk_mul_f32 v[62:63], v[62:63], v[222:223]
v_pk_add_f32 v[64:65], v[64:65], v[14:15]
v_pk_add_f32 v[66:67], v[66:67], v[14:15]
v_pk_add_f32 v[68:69], v[68:69], v[14:15]
v_pk_add_f32 v[70:71], v[70:71], v[14:15]
v_rcp_f32 v64, v64
v_rcp_f32 v65, v65
v_rcp_f32 v66, v66
v_rcp_f32 v67, v67
v_rcp_f32 v68, v68
v_rcp_f32 v69, v69
v_rcp_f32 v70, v70
v_rcp_f32 v71, v71
v_pk_mul_f32 v[56:57], v[56:57], v[64:65]
v_pk_mul_f32 v[58:59], v[58:59], v[66:67]
v_pk_mul_f32 v[60:61], v[60:61], v[68:69]
v_pk_mul_f32 v[62:63], v[62:63], v[70:71]
v_cvt_pk_bf16_f32 v72, v56, v57
v_cvt_pk_bf16_f32 v73, v58, v59
v_cvt_pk_bf16_f32 v74, v60, v61
v_cvt_pk_bf16_f32 v75, v62, v63
buffer_store_dwordx4 v[72:75], v12, s[20:23], s49 offen offset:3072 sc1
s_lshl_b32 s3, s42, 5
s_add_u32 s3, s3, s43
s_lshl_b32 s3, s3, 2
s_add_u32 s3, s3, 63113216
s_branch L_down_kernel_entry
L_gateup_kernel_end:
s_endpgm
L_gateup_kernel_codeend:
L_down_kernel_entry:
s_load_dwordx2 s[4:5], s[0:1], 64
s_load_dwordx2 s[44:45], s[0:1], 104
s_load_dwordx2 s[6:7], s[0:1], 104
s_load_dwordx2 s[28:29], s[0:1], 88
v_lshrrev_b32 v2, 6, v0
v_and_b32 v1, 63, v0
v_readfirstlane_b32 s30, v2
v_and_b32 v2, 15, v1
v_lshrrev_b32 v3, 4, v1
s_getpc_b64 s[92:93]
L_down_kernel_pc1:
s_mov_b32 s94, L_down_kernel_codeend-L_down_kernel_pc1
s_mov_b32 s95, 0x00020000
s_lshr_b32 s59, s2, 3
s_lshl_b32 s59, s59, 2
s_add_u32 s59, s59, s30
s_and_b32 s59, s59, 31
s_lshl_b32 s59, s59, 9
v_lshlrev_b32 v39, 7, v1
v_cmp_gt_u32 vcc, 4, v1
v_mov_b32 v6, 0x40000000
s_nop 0
v_cndmask_b32 v39, v6, v39, vcc
buffer_load_dword v38, v39, s[92:95], s59 offen
s_and_b32 s39, s2, 1
s_bfe_u32 s42, s2, 0x10002
s_lshl_b32 s42, s42, 3
s_bfe_u32 s43, s2, 0x30003
s_add_u32 s42, s42, s43
s_bfe_u32 s43, s2, 0x10001
s_lshl_b32 s43, s43, 2
s_lshr_b32 s46, s2, 6
s_add_u32 s43, s43, s46
s_lshl_b32 s43, s43, 1
s_lshl_b32 s46, s43, 7
s_mul_i32 s40, s39, 1
s_add_u32 s43, s43, s40
s_mul_i32 s40, s39, 3670016
s_add_u32 s40, s40, s46
s_lshl_b32 s33, s30, 13
s_lshl_b32 s47, s30, 16
v_lshlrev_b32 v4, 11, v3
s_mov_b32 s36, s30
s_cmp_eq_u32 s30, 3
s_cselect_b32 s37, 4, s30
v_add_u32 v5, 0, v3
v_lshlrev_b32 v5, 1, v5
v_xor_b32 v5, v5, v2
v_lshl_add_u32 v5, v5, 4, v4
v_add_u32 v8, 0, v5
v_add_u32 v5, 4, v3
v_lshlrev_b32 v5, 1, v5
v_xor_b32 v5, v5, v2
v_lshl_add_u32 v5, v5, 4, v4
v_add_u32 v9, 7168, v5
v_add_u32 v5, 0, v3
v_lshlrev_b32 v5, 1, v5
v_xor_b32 v5, v5, v2
v_lshl_add_u32 v5, v5, 4, v4
v_add_u32 v10, 14336, v5
v_add_u32 v5, 4, v3
v_lshlrev_b32 v5, 1, v5
v_xor_b32 v5, v5, v2
v_lshl_add_u32 v5, v5, 4, v4
v_add_u32 v11, 21504, v5
v_lshlrev_b32 v12, 4, v1
s_lshl_b32 s47, s42, 2
s_add_u32 s47, s47, s30
s_lshl_b32 s32, s47, 11
s_mul_i32 s41, s39, 7340032
s_add_u32 s32, s32, s41
s_sub_u32 s35, s32, 131072
s_mov_b32 s31, 4294737920
s_waitcnt lgkmcnt(0)
s_add_u32 s8, s4, s40
s_addc_u32 s9, s5, 0
s_mov_b32 s10, 3668224
s_mov_b32 s11, 0x00020000
s_add_u32 s16, s44, 33554432
s_addc_u32 s17, s45, 0
s_mov_b32 s18, 14680064
s_mov_b32 s19, 0x00020000
s_mov_b32 s24, s44
s_mov_b32 s25, s45
s_mov_b32 s26, 67108864
s_mov_b32 s27, 0x00020000
v_mov_b32 v36, 0
v_mov_b32 v37, 1
s_waitcnt vmcnt(0) lgkmcnt(0)
s_barrier
s_cmp_lg_u32 s30, 0
s_cbranch_scc1 L_down_kernel_pub2
buffer_store_dword v37, v36, s[24:27], s3 offen sc1
L_down_kernel_pub2:
s_add_u32 m0, s33, 0
s_lshl_b32 s31, s37, 16
buffer_load_dwordx4 v8, s[8:11], s31 offen offset:0  lds
s_add_u32 s36, s36, 4
s_add_u32 s37, s36, 3
buffer_load_dwordx4 v9, s[8:11], s31 offen offset:1024  lds
s_mul_hi_u32 s37, s37, 0x2aaaaaab
buffer_load_dwordx4 v10, s[8:11], s31 offen offset:2048  lds
s_add_u32 s37, s37, s36
buffer_load_dwordx4 v11, s[8:11], s31 offen offset:3072  lds
s_add_u32 m0, s33, 4096
s_add_u32 s31, s31, 32768
buffer_load_dwordx4 v8, s[8:11], s31 offen offset:0  lds
s_mul_i32 s38, s36, 7
buffer_load_dwordx4 v9, s[8:11], s31 offen offset:1024  lds
s_sub_u32 s38, s38, 333
buffer_load_dwordx4 v10, s[8:11], s31 offen offset:2048  lds
s_cmp_lt_u32 s36, 48
s_cselect_b32 s37, s37, s38
buffer_load_dwordx4 v11, s[8:11], s31 offen offset:3072  lds
s_add_u32 m0, s33, 32768
s_lshl_b32 s31, s37, 16
buffer_load_dwordx4 v8, s[8:11], s31 offen offset:0  lds
s_add_u32 s36, s36, 4
s_add_u32 s37, s36, 3
buffer_load_dwordx4 v9, s[8:11], s31 offen offset:1024  lds
s_mul_hi_u32 s37, s37, 0x2aaaaaab
buffer_load_dwordx4 v10, s[8:11], s31 offen offset:2048  lds
s_add_u32 s37, s37, s36
buffer_load_dwordx4 v11, s[8:11], s31 offen offset:3072  lds
s_add_u32 m0, s33, 36864
s_add_u32 s31, s31, 32768
buffer_load_dwordx4 v8, s[8:11], s31 offen offset:0  lds
s_mul_i32 s38, s36, 7
buffer_load_dwordx4 v9, s[8:11], s31 offen offset:1024  lds
s_sub_u32 s38, s38, 333
buffer_load_dwordx4 v10, s[8:11], s31 offen offset:2048  lds
s_cmp_lt_u32 s36, 48
s_cselect_b32 s37, s37, s38
buffer_load_dwordx4 v11, s[8:11], s31 offen offset:3072  lds
s_add_u32 s12, s6, 25165824
s_addc_u32 s13, s7, 0
s_mov_b32 s14, 4194304
s_mov_b32 s15, 0x00020000
s_mov_b32 s20, s28
s_mov_b32 s21, s29
s_mov_b32 s22, 4194304
s_mov_b32 s23, 0x00020000
v_lshrrev_b32 v4, 2, v2
v_lshl_add_u32 v4, v3, 2, v4
v_and_b32 v5, 7, v4
v_lshlrev_b32 v5, 1, v5
v_bfe_u32 v6, v2, 1, 1
v_xor_b32 v5, v5, v6
s_lshl_b32 s48, s39, 3
v_xor_b32 v5, s48, v5
v_lshlrev_b32 v4, 8, v4
v_and_b32 v6, 1, v2
v_lshl_add_u32 v4, v6, 3, v4
v_xor_b32 v6, 0, v5
v_lshl_add_u32 v16, v6, 4, v4
v_add_u32 v24, 0x10000, v16
v_xor_b32 v6, 2, v5
v_lshl_add_u32 v17, v6, 4, v4
v_add_u32 v25, 0x10000, v17
v_xor_b32 v6, 4, v5
v_lshl_add_u32 v18, v6, 4, v4
v_add_u32 v26, 0x10000, v18
v_xor_b32 v6, 6, v5
v_lshl_add_u32 v19, v6, 4, v4
v_add_u32 v27, 0x10000, v19
v_xor_b32 v6, 8, v5
v_lshl_add_u32 v20, v6, 4, v4
v_add_u32 v28, 0x10000, v20
v_xor_b32 v6, 10, v5
v_lshl_add_u32 v21, v6, 4, v4
v_add_u32 v29, 0x10000, v21
v_xor_b32 v6, 12, v5
v_lshl_add_u32 v22, v6, 4, v4
v_add_u32 v30, 0x10000, v22
v_xor_b32 v6, 14, v5
v_lshl_add_u32 v23, v6, 4, v4
v_add_u32 v31, 0x10000, v23
s_mul_i32 s48, s30, 8704
s_movk_i32 s49, 272
v_mul_lo_u32 v32, v2, s49
v_lshl_add_u32 v32, v3, 4, v32
v_add_u32 v32, s48, v32
v_lshrrev_b32 v4, 3, v1
v_and_b32 v5, 7, v1
v_mul_lo_u32 v33, v4, s49
v_lshl_add_u32 v33, v5, 5, v33
v_add_u32 v33, s48, v33
v_lshlrev_b32 v34, 11, v4
v_lshl_add_u32 v34, v5, 4, v34
v_lshlrev_b32 v35, 5, v5
s_lshl_b32 s50, s47, 16
s_lshl_b32 s51, s43, 7
s_add_u32 s50, s50, s51
s_lshl_b32 s51, s43, 8
s_add_u32 s51, s51, 20480
s_lshl_b32 s53, s2, 2
s_add_u32 s53, s53, s30
s_xor_b32 s54, s53, 4
s_lshl_b32 s55, s53, 10
s_add_u32 s55, s55, 54525952
s_lshl_b32 s56, s54, 10
s_add_u32 s56, s56, 54525952
s_lshl_b32 s57, s53, 6
s_add_u32 s57, s57, 62980096
s_lshl_b32 s58, s54, 6
s_add_u32 s58, s58, 62980096
v_mov_b32 v36, 0
v_mov_b32 v37, 1
v_mov_b64 v[128:129], 0
v_mov_b64 v[130:131], 0
v_mov_b64 v[132:133], 0
v_mov_b64 v[134:135], 0
v_mov_b64 v[136:137], 0
v_mov_b64 v[138:139], 0
v_mov_b64 v[140:141], 0
v_mov_b64 v[142:143], 0
v_mov_b64 v[144:145], 0
v_mov_b64 v[146:147], 0
v_mov_b64 v[148:149], 0
v_mov_b64 v[150:151], 0
v_mov_b64 v[152:153], 0
v_mov_b64 v[154:155], 0
v_mov_b64 v[156:157], 0
v_mov_b64 v[158:159], 0
v_mov_b64 v[160:161], 0
v_mov_b64 v[162:163], 0
v_mov_b64 v[164:165], 0
v_mov_b64 v[166:167], 0
v_mov_b64 v[168:169], 0
v_mov_b64 v[170:171], 0
v_mov_b64 v[172:173], 0
v_mov_b64 v[174:175], 0
v_mov_b64 v[176:177], 0
v_mov_b64 v[178:179], 0
v_mov_b64 v[180:181], 0
v_mov_b64 v[182:183], 0
v_mov_b64 v[184:185], 0
v_mov_b64 v[186:187], 0
v_mov_b64 v[188:189], 0
v_mov_b64 v[190:191], 0
s_mov_b32 s34, 0
s_mov_b32 s80, s4
s_mov_b32 s81, s5
s_mov_b32 s82, 7340032
s_mov_b32 s83, 0x00020000
s_lshr_b32 s84, s2, 3
s_lshl_b32 s84, s84, 2
s_add_u32 s84, s84, s30
s_lshl_b32 s84, s84, 11
s_mul_i32 s85, s39, 3670016
s_add_u32 s84, s84, s85
s_bfe_u32 s85, s2, 0x10001
s_lshl_b32 s85, s85, 10
s_add_u32 s84, s84, s85
s_add_u32 s84, s84, 524288
v_lshlrev_b32 v7, 7, v1
v_cmp_gt_u32 vcc, 8, v1
v_mov_b32 v6, 0x40000000
s_nop 0
v_cndmask_b32 v7, v6, v7, vcc
buffer_load_dword v38, v7, s[80:83], s84 offen
s_add_u32 s84, s84, 262144
buffer_load_dword v38, v7, s[80:83], s84 offen
s_add_u32 s84, s84, 262144
s_lshr_b32 s52, s42, 1
s_lshl_b32 s52, s52, 7
s_lshl_b32 s49, s39, 6
s_add_u32 s52, s52, s49
s_add_u32 s52, s52, 63113216
v_lshlrev_b32 v41, 2, v2
s_cmp_lg_u32 s30, 0
s_cbranch_scc1 L_down_kernel_pd4
s_mov_b32 s49, 0
L_down_kernel_pw3:
buffer_load_dword v40, v41, s[24:27], s52 offen sc1
s_waitcnt vmcnt(0)
v_cmp_ne_u32 vcc, 1, v40
s_cbranch_vccz L_down_kernel_pd4
s_sleep 3
s_add_u32 s49, s49, 1
s_cmp_lt_u32 s49, 0x40000
s_cbranch_scc1 L_down_kernel_pw3
L_down_kernel_pd4:
s_waitcnt vmcnt(0)
s_barrier
TR v[64:65],v20,0
TR v[66:67],v20,4096
TR v[68:69],v20,8192
TR v[70:71],v20,12288
TR v[72:73],v20,16384
TR v[74:75],v20,20480
TR v[76:77],v20,24576
TR v[78:79],v20,28672
TR v[80:81],v21,0
TR v[82:83],v21,4096
TR v[84:85],v21,8192
TR v[86:87],v21,12288
TR v[88:89],v21,16384
TR v[90:91],v21,20480
TR v[92:93],v21,24576
TR v[94:95],v21,28672
s_add_u32 s35, s35, 131072
buffer_load_dwordx4 a[0:3], v12, s[16:19], s35 offen offset:0 sc1
buffer_load_dwordx4 a[16:19], v12, s[16:19], s35 offen offset:1024 sc1
s_add_u32 s35, s35, 131072
buffer_load_dwordx4 a[4:7], v12, s[16:19], s35 offen offset:0 sc1
buffer_load_dwordx4 a[20:23], v12, s[16:19], s35 offen offset:1024 sc1
s_add_u32 s35, s35, 131072
buffer_load_dwordx4 a[8:11], v12, s[16:19], s35 offen offset:0 sc1
buffer_load_dwordx4 a[24:27], v12, s[16:19], s35 offen offset:1024 sc1
s_add_u32 s35, s35, 131072
buffer_load_dwordx4 a[12:15], v12, s[16:19], s35 offen offset:0 sc1
buffer_load_dwordx4 a[28:31], v12, s[16:19], s35 offen offset:1024 sc1
s_add_u32 s35, s35, 131072
buffer_load_dwordx4 a[32:35], v12, s[16:19], s35 offen offset:0 sc1
buffer_load_dwordx4 a[48:51], v12, s[16:19], s35 offen offset:1024 sc1
s_add_u32 s35, s35, 131072
buffer_load_dwordx4 a[36:39], v12, s[16:19], s35 offen offset:0 sc1
buffer_load_dwordx4 a[52:55], v12, s[16:19], s35 offen offset:1024 sc1
s_add_u32 s35, s35, 131072
buffer_load_dwordx4 a[40:43], v12, s[16:19], s35 offen offset:0 sc1
buffer_load_dwordx4 a[56:59], v12, s[16:19], s35 offen offset:1024 sc1
s_add_u32 s35, s35, 131072
buffer_load_dwordx4 a[44:47], v12, s[16:19], s35 offen offset:0 sc1
buffer_load_dwordx4 a[60:63], v12, s[16:19], s35 offen offset:1024 sc1
.p2align 6
L_down_kernel_loop:
s_waitcnt vmcnt(15) lgkmcnt(14)
MM v[160:163],v[64:67],a[0:3],v[160:163]
s_waitcnt vmcnt(13) lgkmcnt(12)
s_add_u32 m0, s33, 65536
s_lshl_b32 s31, s37, 16
TR v[96:97],v22,0
MM v[160:163],v[68:71],a[4:7],v[160:163]
s_waitcnt vmcnt(11) lgkmcnt(11)
TR v[98:99],v22,4096
buffer_load_dwordx4 v8, s[8:11], s31 offen offset:0  lds
MM v[160:163],v[72:75],a[8:11],v[160:163]
s_waitcnt vmcnt(10) lgkmcnt(10)
TR v[100:101],v22,8192
MM v[160:163],v[76:79],a[12:15],v[160:163]
TR v[102:103],v22,12288
buffer_load_dword v38, v7, s[80:83], s84 offen
MM v[164:167],v[64:67],a[16:19],v[164:167]
s_add_u32 s36, s36, 4
s_add_u32 s37, s36, 3
TR v[104:105],v22,16384
MM v[164:167],v[68:71],a[20:23],v[164:167]
TR v[106:107],v22,20480
buffer_load_dwordx4 v9, s[8:11], s31 offen offset:1024  lds
MM v[164:167],v[72:75],a[24:27],v[164:167]
s_waitcnt vmcnt(11)
s_add_u32 s84, s84, 262144
TR v[108:109],v22,24576
MM v[164:167],v[76:79],a[28:31],v[164:167]
s_waitcnt lgkmcnt(13)
TR v[110:111],v22,28672
MM v[168:171],v[80:83],a[0:3],v[168:171]
s_waitcnt lgkmcnt(12)
s_mul_hi_u32 s37, s37, 0x2aaaaaab
TR v[112:113],v23,0
MM v[168:171],v[84:87],a[4:7],v[168:171]
s_waitcnt lgkmcnt(11)
TR v[114:115],v23,4096
buffer_load_dwordx4 v10, s[8:11], s31 offen offset:2048  lds
MM v[168:171],v[88:91],a[8:11],v[168:171]
s_waitcnt lgkmcnt(10)
TR v[116:117],v23,8192
MM v[168:171],v[92:95],a[12:15],v[168:171]
TR v[118:119],v23,12288
MM v[172:175],v[80:83],a[16:19],v[172:175]
s_add_u32 s37, s37, s36
TR v[120:121],v23,16384
MM v[172:175],v[84:87],a[20:23],v[172:175]
TR v[122:123],v23,20480
buffer_load_dwordx4 v11, s[8:11], s31 offen offset:3072  lds
MM v[172:175],v[88:91],a[24:27],v[172:175]
TR v[124:125],v23,24576
MM v[172:175],v[92:95],a[28:31],v[172:175]
s_waitcnt lgkmcnt(13)
TR v[126:127],v23,28672
MM v[176:179],v[96:99],a[0:3],v[176:179]
s_waitcnt lgkmcnt(12)
s_add_u32 m0, s33, 69632
s_add_u32 s31, s31, 32768
TR v[64:65],v16,0
MM v[176:179],v[100:103],a[4:7],v[176:179]
s_waitcnt lgkmcnt(11)
TR v[66:67],v16,4096
buffer_load_dwordx4 v8, s[8:11], s31 offen offset:0  lds
MM v[176:179],v[104:107],a[8:11],v[176:179]
s_waitcnt lgkmcnt(10)
TR v[68:69],v16,8192
MM v[176:179],v[108:111],a[12:15],v[176:179]
TR v[70:71],v16,12288
MM v[180:183],v[96:99],a[16:19],v[180:183]
s_mul_i32 s38, s36, 7
TR v[72:73],v16,16384
MM v[180:183],v[100:103],a[20:23],v[180:183]
TR v[74:75],v16,20480
buffer_load_dwordx4 v9, s[8:11], s31 offen offset:1024  lds
MM v[180:183],v[104:107],a[24:27],v[180:183]
TR v[76:77],v16,24576
MM v[180:183],v[108:111],a[28:31],v[180:183]
s_waitcnt lgkmcnt(13)
TR v[78:79],v16,28672
MM v[184:187],v[112:115],a[0:3],v[184:187]
s_waitcnt lgkmcnt(12)
s_sub_u32 s38, s38, 333
TR v[80:81],v17,0
MM v[184:187],v[116:119],a[4:7],v[184:187]
s_waitcnt lgkmcnt(11)
TR v[82:83],v17,4096
buffer_load_dwordx4 v10, s[8:11], s31 offen offset:2048  lds
MM v[184:187],v[120:123],a[8:11],v[184:187]
s_waitcnt lgkmcnt(10)
TR v[84:85],v17,8192
MM v[184:187],v[124:127],a[12:15],v[184:187]
TR v[86:87],v17,12288
MM v[188:191],v[112:115],a[16:19],v[188:191]
s_cmp_lt_u32 s36, 48
s_cselect_b32 s37, s37, s38
TR v[88:89],v17,16384
MM v[188:191],v[116:119],a[20:23],v[188:191]
TR v[90:91],v17,20480
buffer_load_dwordx4 v11, s[8:11], s31 offen offset:3072  lds
MM v[188:191],v[120:123],a[24:27],v[188:191]
TR v[92:93],v17,24576
MM v[188:191],v[124:127],a[28:31],v[188:191]
s_waitcnt lgkmcnt(13)
TR v[94:95],v17,28672
MM v[128:131],v[64:67],a[0:3],v[128:131]
s_waitcnt lgkmcnt(12)
s_add_u32 s35, s35, 131072
TR v[96:97],v18,0
MM v[128:131],v[68:71],a[4:7],v[128:131]
s_waitcnt lgkmcnt(11)
TR v[98:99],v18,4096
buffer_load_dwordx4 a[64:67], v12, s[16:19], s35 offen offset:0 sc1
MM v[128:131],v[72:75],a[8:11],v[128:131]
s_waitcnt lgkmcnt(10)
TR v[100:101],v18,8192
MM v[128:131],v[76:79],a[12:15],v[128:131]
TR v[102:103],v18,12288
MM v[132:135],v[64:67],a[16:19],v[132:135]
TR v[104:105],v18,16384
MM v[132:135],v[68:71],a[20:23],v[132:135]
TR v[106:107],v18,20480
buffer_load_dwordx4 a[80:83], v12, s[16:19], s35 offen offset:1024 sc1
MM v[132:135],v[72:75],a[24:27],v[132:135]
TR v[108:109],v18,24576
MM v[132:135],v[76:79],a[28:31],v[132:135]
s_waitcnt lgkmcnt(13)
TR v[110:111],v18,28672
MM v[136:139],v[80:83],a[0:3],v[136:139]
s_waitcnt lgkmcnt(12)
s_add_u32 s35, s35, 131072
TR v[112:113],v19,0
MM v[136:139],v[84:87],a[4:7],v[136:139]
s_waitcnt lgkmcnt(11)
TR v[114:115],v19,4096
buffer_load_dwordx4 a[68:71], v12, s[16:19], s35 offen offset:0 sc1
MM v[136:139],v[88:91],a[8:11],v[136:139]
s_waitcnt lgkmcnt(10)
TR v[116:117],v19,8192
MM v[136:139],v[92:95],a[12:15],v[136:139]
TR v[118:119],v19,12288
MM v[140:143],v[80:83],a[16:19],v[140:143]
TR v[120:121],v19,16384
MM v[140:143],v[84:87],a[20:23],v[140:143]
TR v[122:123],v19,20480
buffer_load_dwordx4 a[84:87], v12, s[16:19], s35 offen offset:1024 sc1
MM v[140:143],v[88:91],a[24:27],v[140:143]
TR v[124:125],v19,24576
MM v[140:143],v[92:95],a[28:31],v[140:143]
s_waitcnt vmcnt(21) lgkmcnt(13)
TR v[126:127],v19,28672
MM v[144:147],v[96:99],a[0:3],v[144:147]
s_barrier
s_waitcnt lgkmcnt(12)
MM v[144:147],v[100:103],a[4:7],v[144:147]
s_waitcnt lgkmcnt(10)
s_add_u32 s35, s35, 131072
TR v[64:65],v20,32768
MM v[144:147],v[104:107],a[8:11],v[144:147]
s_waitcnt lgkmcnt(9)
TR v[66:67],v20,36864
buffer_load_dwordx4 a[72:75], v12, s[16:19], s35 offen offset:0 sc1
MM v[144:147],v[108:111],a[12:15],v[144:147]
TR v[68:69],v20,40960
MM v[148:151],v[96:99],a[16:19],v[148:151]
TR v[70:71],v20,45056
MM v[148:151],v[100:103],a[20:23],v[148:151]
TR v[72:73],v20,49152
MM v[148:151],v[104:107],a[24:27],v[148:151]
TR v[74:75],v20,53248
buffer_load_dwordx4 a[88:91], v12, s[16:19], s35 offen offset:1024 sc1
MM v[148:151],v[108:111],a[28:31],v[148:151]
s_waitcnt lgkmcnt(12)
TR v[76:77],v20,57344
TR v[78:79],v20,61440
MM v[152:155],v[112:115],a[0:3],v[152:155]
s_waitcnt lgkmcnt(12)
TR v[80:81],v21,32768
MM v[152:155],v[116:119],a[4:7],v[152:155]
s_waitcnt lgkmcnt(11)
s_add_u32 s35, s35, 131072
TR v[82:83],v21,36864
MM v[152:155],v[120:123],a[8:11],v[152:155]
s_waitcnt lgkmcnt(10)
TR v[84:85],v21,40960
buffer_load_dwordx4 a[76:79], v12, s[16:19], s35 offen offset:0 sc1
MM v[152:155],v[124:127],a[12:15],v[152:155]
TR v[86:87],v21,45056
MM v[156:159],v[112:115],a[16:19],v[156:159]
TR v[88:89],v21,49152
MM v[156:159],v[116:119],a[20:23],v[156:159]
TR v[90:91],v21,53248
MM v[156:159],v[120:123],a[24:27],v[156:159]
TR v[92:93],v21,57344
buffer_load_dwordx4 a[92:95], v12, s[16:19], s35 offen offset:1024 sc1
MM v[156:159],v[124:127],a[28:31],v[156:159]
s_waitcnt vmcnt(24) lgkmcnt(13)
TR v[94:95],v21,61440
MM v[160:163],v[64:67],a[32:35],v[160:163]
s_waitcnt vmcnt(22) lgkmcnt(12)
s_add_u32 m0, s33, 98304
s_lshl_b32 s31, s37, 16
TR v[96:97],v22,32768
MM v[160:163],v[68:71],a[36:39],v[160:163]
s_waitcnt vmcnt(20) lgkmcnt(11)
TR v[98:99],v22,36864
buffer_load_dwordx4 v8, s[8:11], s31 offen offset:0  lds
MM v[160:163],v[72:75],a[40:43],v[160:163]
s_waitcnt vmcnt(19) lgkmcnt(10)
TR v[100:101],v22,40960
MM v[160:163],v[76:79],a[44:47],v[160:163]
TR v[102:103],v22,45056
buffer_load_dword v38, v7, s[80:83], s84 offen
MM v[164:167],v[64:67],a[48:51],v[164:167]
s_add_u32 s36, s36, 4
s_add_u32 s37, s36, 3
TR v[104:105],v22,49152
MM v[164:167],v[68:71],a[52:55],v[164:167]
TR v[106:107],v22,53248
buffer_load_dwordx4 v9, s[8:11], s31 offen offset:1024  lds
MM v[164:167],v[72:75],a[56:59],v[164:167]
s_waitcnt vmcnt(20)
s_add_u32 s84, s84, 262144
TR v[108:109],v22,57344
MM v[164:167],v[76:79],a[60:63],v[164:167]
s_waitcnt lgkmcnt(13)
TR v[110:111],v22,61440
MM v[168:171],v[80:83],a[32:35],v[168:171]
s_waitcnt lgkmcnt(12)
s_mul_hi_u32 s37, s37, 0x2aaaaaab
TR v[112:113],v23,32768
MM v[168:171],v[84:87],a[36:39],v[168:171]
s_waitcnt lgkmcnt(11)
TR v[114:115],v23,36864
buffer_load_dwordx4 v10, s[8:11], s31 offen offset:2048  lds
MM v[168:171],v[88:91],a[40:43],v[168:171]
s_waitcnt lgkmcnt(10)
TR v[116:117],v23,40960
MM v[168:171],v[92:95],a[44:47],v[168:171]
TR v[118:119],v23,45056
MM v[172:175],v[80:83],a[48:51],v[172:175]
s_add_u32 s37, s37, s36
TR v[120:121],v23,49152
MM v[172:175],v[84:87],a[52:55],v[172:175]
TR v[122:123],v23,53248
buffer_load_dwordx4 v11, s[8:11], s31 offen offset:3072  lds
MM v[172:175],v[88:91],a[56:59],v[172:175]
TR v[124:125],v23,57344
MM v[172:175],v[92:95],a[60:63],v[172:175]
s_waitcnt lgkmcnt(13)
TR v[126:127],v23,61440
MM v[176:179],v[96:99],a[32:35],v[176:179]
s_waitcnt lgkmcnt(12)
s_add_u32 m0, s33, 102400
s_add_u32 s31, s31, 32768
TR v[64:65],v16,32768
MM v[176:179],v[100:103],a[36:39],v[176:179]
s_waitcnt lgkmcnt(11)
TR v[66:67],v16,36864
buffer_load_dwordx4 v8, s[8:11], s31 offen offset:0  lds
MM v[176:179],v[104:107],a[40:43],v[176:179]
s_waitcnt lgkmcnt(10)
TR v[68:69],v16,40960
MM v[176:179],v[108:111],a[44:47],v[176:179]
TR v[70:71],v16,45056
MM v[180:183],v[96:99],a[48:51],v[180:183]
s_mul_i32 s38, s36, 7
TR v[72:73],v16,49152
MM v[180:183],v[100:103],a[52:55],v[180:183]
TR v[74:75],v16,53248
buffer_load_dwordx4 v9, s[8:11], s31 offen offset:1024  lds
MM v[180:183],v[104:107],a[56:59],v[180:183]
TR v[76:77],v16,57344
MM v[180:183],v[108:111],a[60:63],v[180:183]
s_waitcnt lgkmcnt(13)
TR v[78:79],v16,61440
MM v[184:187],v[112:115],a[32:35],v[184:187]
s_waitcnt lgkmcnt(12)
s_sub_u32 s38, s38, 333
TR v[80:81],v17,32768
MM v[184:187],v[116:119],a[36:39],v[184:187]
s_waitcnt lgkmcnt(11)
TR v[82:83],v17,36864
buffer_load_dwordx4 v10, s[8:11], s31 offen offset:2048  lds
MM v[184:187],v[120:123],a[40:43],v[184:187]
s_waitcnt lgkmcnt(10)
TR v[84:85],v17,40960
MM v[184:187],v[124:127],a[44:47],v[184:187]
TR v[86:87],v17,45056
MM v[188:191],v[112:115],a[48:51],v[188:191]
s_cmp_lt_u32 s36, 48
s_cselect_b32 s37, s37, s38
TR v[88:89],v17,49152
MM v[188:191],v[116:119],a[52:55],v[188:191]
TR v[90:91],v17,53248
buffer_load_dwordx4 v11, s[8:11], s31 offen offset:3072  lds
MM v[188:191],v[120:123],a[56:59],v[188:191]
TR v[92:93],v17,57344
MM v[188:191],v[124:127],a[60:63],v[188:191]
s_waitcnt lgkmcnt(13)
TR v[94:95],v17,61440
MM v[128:131],v[64:67],a[32:35],v[128:131]
s_waitcnt lgkmcnt(12)
s_add_u32 s35, s35, 131072
TR v[96:97],v18,32768
MM v[128:131],v[68:71],a[36:39],v[128:131]
s_waitcnt lgkmcnt(11)
TR v[98:99],v18,36864
buffer_load_dwordx4 a[96:99], v12, s[16:19], s35 offen offset:0 sc1
MM v[128:131],v[72:75],a[40:43],v[128:131]
s_waitcnt lgkmcnt(10)
TR v[100:101],v18,40960
MM v[128:131],v[76:79],a[44:47],v[128:131]
TR v[102:103],v18,45056
MM v[132:135],v[64:67],a[48:51],v[132:135]
TR v[104:105],v18,49152
MM v[132:135],v[68:71],a[52:55],v[132:135]
TR v[106:107],v18,53248
buffer_load_dwordx4 a[112:115], v12, s[16:19], s35 offen offset:1024 sc1
MM v[132:135],v[72:75],a[56:59],v[132:135]
TR v[108:109],v18,57344
MM v[132:135],v[76:79],a[60:63],v[132:135]
s_waitcnt lgkmcnt(13)
TR v[110:111],v18,61440
MM v[136:139],v[80:83],a[32:35],v[136:139]
s_waitcnt lgkmcnt(12)
s_add_u32 s35, s35, 131072
TR v[112:113],v19,32768
MM v[136:139],v[84:87],a[36:39],v[136:139]
s_waitcnt lgkmcnt(11)
TR v[114:115],v19,36864
buffer_load_dwordx4 a[100:103], v12, s[16:19], s35 offen offset:0 sc1
MM v[136:139],v[88:91],a[40:43],v[136:139]
s_waitcnt lgkmcnt(10)
TR v[116:117],v19,40960
MM v[136:139],v[92:95],a[44:47],v[136:139]
TR v[118:119],v19,45056
MM v[140:143],v[80:83],a[48:51],v[140:143]
TR v[120:121],v19,49152
MM v[140:143],v[84:87],a[52:55],v[140:143]
TR v[122:123],v19,53248
buffer_load_dwordx4 a[116:119], v12, s[16:19], s35 offen offset:1024 sc1
MM v[140:143],v[88:91],a[56:59],v[140:143]
TR v[124:125],v19,57344
MM v[140:143],v[92:95],a[60:63],v[140:143]
s_waitcnt vmcnt(21) lgkmcnt(13)
TR v[126:127],v19,61440
MM v[144:147],v[96:99],a[32:35],v[144:147]
s_barrier
s_waitcnt lgkmcnt(12)
MM v[144:147],v[100:103],a[36:39],v[144:147]
s_waitcnt lgkmcnt(10)
s_add_u32 s35, s35, 131072
TR v[64:65],v28,0
MM v[144:147],v[104:107],a[40:43],v[144:147]
s_waitcnt lgkmcnt(9)
TR v[66:67],v28,4096
buffer_load_dwordx4 a[104:107], v12, s[16:19], s35 offen offset:0 sc1
MM v[144:147],v[108:111],a[44:47],v[144:147]
TR v[68:69],v28,8192
MM v[148:151],v[96:99],a[48:51],v[148:151]
TR v[70:71],v28,12288
MM v[148:151],v[100:103],a[52:55],v[148:151]
TR v[72:73],v28,16384
MM v[148:151],v[104:107],a[56:59],v[148:151]
TR v[74:75],v28,20480
buffer_load_dwordx4 a[120:123], v12, s[16:19], s35 offen offset:1024 sc1
MM v[148:151],v[108:111],a[60:63],v[148:151]
s_waitcnt lgkmcnt(12)
TR v[76:77],v28,24576
TR v[78:79],v28,28672
MM v[152:155],v[112:115],a[32:35],v[152:155]
s_waitcnt lgkmcnt(12)
TR v[80:81],v29,0
MM v[152:155],v[116:119],a[36:39],v[152:155]
s_waitcnt lgkmcnt(11)
s_add_u32 s35, s35, 131072
TR v[82:83],v29,4096
MM v[152:155],v[120:123],a[40:43],v[152:155]
s_waitcnt lgkmcnt(10)
TR v[84:85],v29,8192
buffer_load_dwordx4 a[108:111], v12, s[16:19], s35 offen offset:0 sc1
MM v[152:155],v[124:127],a[44:47],v[152:155]
TR v[86:87],v29,12288
MM v[156:159],v[112:115],a[48:51],v[156:159]
TR v[88:89],v29,16384
MM v[156:159],v[116:119],a[52:55],v[156:159]
TR v[90:91],v29,20480
MM v[156:159],v[120:123],a[56:59],v[156:159]
TR v[92:93],v29,24576
buffer_load_dwordx4 a[124:127], v12, s[16:19], s35 offen offset:1024 sc1
MM v[156:159],v[124:127],a[60:63],v[156:159]
s_waitcnt vmcnt(24) lgkmcnt(13)
TR v[94:95],v29,28672
MM v[160:163],v[64:67],a[64:67],v[160:163]
s_waitcnt vmcnt(22) lgkmcnt(12)
s_add_u32 m0, s33, 0
s_lshl_b32 s31, s37, 16
TR v[96:97],v30,0
MM v[160:163],v[68:71],a[68:71],v[160:163]
s_waitcnt vmcnt(20) lgkmcnt(11)
TR v[98:99],v30,4096
buffer_load_dwordx4 v8, s[8:11], s31 offen offset:0  lds
MM v[160:163],v[72:75],a[72:75],v[160:163]
s_waitcnt vmcnt(19) lgkmcnt(10)
TR v[100:101],v30,8192
MM v[160:163],v[76:79],a[76:79],v[160:163]
TR v[102:103],v30,12288
buffer_load_dword v38, v7, s[80:83], s84 offen
MM v[164:167],v[64:67],a[80:83],v[164:167]
s_add_u32 s36, s36, 4
s_add_u32 s37, s36, 3
TR v[104:105],v30,16384
MM v[164:167],v[68:71],a[84:87],v[164:167]
TR v[106:107],v30,20480
buffer_load_dwordx4 v9, s[8:11], s31 offen offset:1024  lds
MM v[164:167],v[72:75],a[88:91],v[164:167]
s_waitcnt vmcnt(20)
s_add_u32 s84, s84, 262144
TR v[108:109],v30,24576
MM v[164:167],v[76:79],a[92:95],v[164:167]
s_waitcnt lgkmcnt(13)
TR v[110:111],v30,28672
MM v[168:171],v[80:83],a[64:67],v[168:171]
s_waitcnt lgkmcnt(12)
s_mul_hi_u32 s37, s37, 0x2aaaaaab
TR v[112:113],v31,0
MM v[168:171],v[84:87],a[68:71],v[168:171]
s_waitcnt lgkmcnt(11)
TR v[114:115],v31,4096
buffer_load_dwordx4 v10, s[8:11], s31 offen offset:2048  lds
MM v[168:171],v[88:91],a[72:75],v[168:171]
s_waitcnt lgkmcnt(10)
TR v[116:117],v31,8192
MM v[168:171],v[92:95],a[76:79],v[168:171]
TR v[118:119],v31,12288
MM v[172:175],v[80:83],a[80:83],v[172:175]
s_add_u32 s37, s37, s36
TR v[120:121],v31,16384
MM v[172:175],v[84:87],a[84:87],v[172:175]
TR v[122:123],v31,20480
buffer_load_dwordx4 v11, s[8:11], s31 offen offset:3072  lds
MM v[172:175],v[88:91],a[88:91],v[172:175]
TR v[124:125],v31,24576
MM v[172:175],v[92:95],a[92:95],v[172:175]
s_waitcnt lgkmcnt(13)
TR v[126:127],v31,28672
MM v[176:179],v[96:99],a[64:67],v[176:179]
s_waitcnt lgkmcnt(12)
s_add_u32 m0, s33, 4096
s_add_u32 s31, s31, 32768
TR v[64:65],v24,0
MM v[176:179],v[100:103],a[68:71],v[176:179]
s_waitcnt lgkmcnt(11)
TR v[66:67],v24,4096
buffer_load_dwordx4 v8, s[8:11], s31 offen offset:0  lds
MM v[176:179],v[104:107],a[72:75],v[176:179]
s_waitcnt lgkmcnt(10)
TR v[68:69],v24,8192
MM v[176:179],v[108:111],a[76:79],v[176:179]
TR v[70:71],v24,12288
MM v[180:183],v[96:99],a[80:83],v[180:183]
s_mul_i32 s38, s36, 7
TR v[72:73],v24,16384
MM v[180:183],v[100:103],a[84:87],v[180:183]
TR v[74:75],v24,20480
buffer_load_dwordx4 v9, s[8:11], s31 offen offset:1024  lds
MM v[180:183],v[104:107],a[88:91],v[180:183]
TR v[76:77],v24,24576
MM v[180:183],v[108:111],a[92:95],v[180:183]
s_waitcnt lgkmcnt(13)
TR v[78:79],v24,28672
MM v[184:187],v[112:115],a[64:67],v[184:187]
s_waitcnt lgkmcnt(12)
s_sub_u32 s38, s38, 333
TR v[80:81],v25,0
MM v[184:187],v[116:119],a[68:71],v[184:187]
s_waitcnt lgkmcnt(11)
TR v[82:83],v25,4096
buffer_load_dwordx4 v10, s[8:11], s31 offen offset:2048  lds
MM v[184:187],v[120:123],a[72:75],v[184:187]
s_waitcnt lgkmcnt(10)
TR v[84:85],v25,8192
MM v[184:187],v[124:127],a[76:79],v[184:187]
TR v[86:87],v25,12288
MM v[188:191],v[112:115],a[80:83],v[188:191]
s_cmp_lt_u32 s36, 48
s_cselect_b32 s37, s37, s38
TR v[88:89],v25,16384
MM v[188:191],v[116:119],a[84:87],v[188:191]
TR v[90:91],v25,20480
buffer_load_dwordx4 v11, s[8:11], s31 offen offset:3072  lds
MM v[188:191],v[120:123],a[88:91],v[188:191]
TR v[92:93],v25,24576
MM v[188:191],v[124:127],a[92:95],v[188:191]
s_waitcnt lgkmcnt(13)
TR v[94:95],v25,28672
MM v[128:131],v[64:67],a[64:67],v[128:131]
s_waitcnt lgkmcnt(12)
s_add_u32 s35, s35, 131072
TR v[96:97],v26,0
buffer_load_dword v38, v39, s[92:95], s59 offen
MM v[128:131],v[68:71],a[68:71],v[128:131]
s_waitcnt lgkmcnt(11)
TR v[98:99],v26,4096
buffer_load_dwordx4 a[0:3], v12, s[16:19], s35 offen offset:0 sc1
MM v[128:131],v[72:75],a[72:75],v[128:131]
s_waitcnt lgkmcnt(10)
TR v[100:101],v26,8192
MM v[128:131],v[76:79],a[76:79],v[128:131]
TR v[102:103],v26,12288
MM v[132:135],v[64:67],a[80:83],v[132:135]
TR v[104:105],v26,16384
MM v[132:135],v[68:71],a[84:87],v[132:135]
TR v[106:107],v26,20480
buffer_load_dwordx4 a[16:19], v12, s[16:19], s35 offen offset:1024 sc1
MM v[132:135],v[72:75],a[88:91],v[132:135]
TR v[108:109],v26,24576
MM v[132:135],v[76:79],a[92:95],v[132:135]
s_waitcnt lgkmcnt(13)
TR v[110:111],v26,28672
MM v[136:139],v[80:83],a[64:67],v[136:139]
s_waitcnt lgkmcnt(12)
s_add_u32 s35, s35, 131072
TR v[112:113],v27,0
MM v[136:139],v[84:87],a[68:71],v[136:139]
s_waitcnt lgkmcnt(11)
TR v[114:115],v27,4096
buffer_load_dwordx4 a[4:7], v12, s[16:19], s35 offen offset:0 sc1
MM v[136:139],v[88:91],a[72:75],v[136:139]
s_waitcnt lgkmcnt(10)
TR v[116:117],v27,8192
MM v[136:139],v[92:95],a[76:79],v[136:139]
TR v[118:119],v27,12288
MM v[140:143],v[80:83],a[80:83],v[140:143]
TR v[120:121],v27,16384
MM v[140:143],v[84:87],a[84:87],v[140:143]
TR v[122:123],v27,20480
buffer_load_dwordx4 a[20:23], v12, s[16:19], s35 offen offset:1024 sc1
MM v[140:143],v[88:91],a[88:91],v[140:143]
TR v[124:125],v27,24576
MM v[140:143],v[92:95],a[92:95],v[140:143]
s_waitcnt vmcnt(22) lgkmcnt(13)
TR v[126:127],v27,28672
MM v[144:147],v[96:99],a[64:67],v[144:147]
s_barrier
s_waitcnt lgkmcnt(12)
MM v[144:147],v[100:103],a[68:71],v[144:147]
s_waitcnt lgkmcnt(10)
s_add_u32 s35, s35, 131072
TR v[64:65],v28,32768
MM v[144:147],v[104:107],a[72:75],v[144:147]
s_waitcnt lgkmcnt(9)
TR v[66:67],v28,36864
buffer_load_dwordx4 a[8:11], v12, s[16:19], s35 offen offset:0 sc1
MM v[144:147],v[108:111],a[76:79],v[144:147]
TR v[68:69],v28,40960
MM v[148:151],v[96:99],a[80:83],v[148:151]
TR v[70:71],v28,45056
MM v[148:151],v[100:103],a[84:87],v[148:151]
TR v[72:73],v28,49152
MM v[148:151],v[104:107],a[88:91],v[148:151]
TR v[74:75],v28,53248
buffer_load_dwordx4 a[24:27], v12, s[16:19], s35 offen offset:1024 sc1
MM v[148:151],v[108:111],a[92:95],v[148:151]
s_waitcnt lgkmcnt(12)
TR v[76:77],v28,57344
TR v[78:79],v28,61440
MM v[152:155],v[112:115],a[64:67],v[152:155]
s_waitcnt lgkmcnt(12)
TR v[80:81],v29,32768
MM v[152:155],v[116:119],a[68:71],v[152:155]
s_waitcnt lgkmcnt(11)
s_add_u32 s35, s35, 131072
TR v[82:83],v29,36864
MM v[152:155],v[120:123],a[72:75],v[152:155]
s_waitcnt lgkmcnt(10)
TR v[84:85],v29,40960
buffer_load_dwordx4 a[12:15], v12, s[16:19], s35 offen offset:0 sc1
MM v[152:155],v[124:127],a[76:79],v[152:155]
TR v[86:87],v29,45056
MM v[156:159],v[112:115],a[80:83],v[156:159]
TR v[88:89],v29,49152
MM v[156:159],v[116:119],a[84:87],v[156:159]
TR v[90:91],v29,53248
MM v[156:159],v[120:123],a[88:91],v[156:159]
TR v[92:93],v29,57344
buffer_load_dwordx4 a[28:31], v12, s[16:19], s35 offen offset:1024 sc1
MM v[156:159],v[124:127],a[92:95],v[156:159]
s_waitcnt vmcnt(25) lgkmcnt(13)
TR v[94:95],v29,61440
MM v[160:163],v[64:67],a[96:99],v[160:163]
s_waitcnt vmcnt(23) lgkmcnt(12)
s_add_u32 m0, s33, 32768
s_lshl_b32 s31, s37, 16
TR v[96:97],v30,32768
MM v[160:163],v[68:71],a[100:103],v[160:163]
s_waitcnt vmcnt(21) lgkmcnt(11)
TR v[98:99],v30,36864
buffer_load_dwordx4 v8, s[8:11], s31 offen offset:0  lds
MM v[160:163],v[72:75],a[104:107],v[160:163]
s_waitcnt vmcnt(20) lgkmcnt(10)
TR v[100:101],v30,40960
MM v[160:163],v[76:79],a[108:111],v[160:163]
TR v[102:103],v30,45056
buffer_load_dword v38, v7, s[80:83], s84 offen
MM v[164:167],v[64:67],a[112:115],v[164:167]
s_add_u32 s36, s36, 4
s_add_u32 s37, s36, 3
TR v[104:105],v30,49152
MM v[164:167],v[68:71],a[116:119],v[164:167]
TR v[106:107],v30,53248
buffer_load_dwordx4 v9, s[8:11], s31 offen offset:1024  lds
MM v[164:167],v[72:75],a[120:123],v[164:167]
s_waitcnt vmcnt(21)
s_add_u32 s84, s84, 262144
TR v[108:109],v30,57344
MM v[164:167],v[76:79],a[124:127],v[164:167]
s_waitcnt lgkmcnt(13)
TR v[110:111],v30,61440
MM v[168:171],v[80:83],a[96:99],v[168:171]
s_waitcnt lgkmcnt(12)
s_mul_hi_u32 s37, s37, 0x2aaaaaab
TR v[112:113],v31,32768
MM v[168:171],v[84:87],a[100:103],v[168:171]
s_waitcnt lgkmcnt(11)
TR v[114:115],v31,36864
buffer_load_dwordx4 v10, s[8:11], s31 offen offset:2048  lds
MM v[168:171],v[88:91],a[104:107],v[168:171]
s_waitcnt lgkmcnt(10)
TR v[116:117],v31,40960
MM v[168:171],v[92:95],a[108:111],v[168:171]
TR v[118:119],v31,45056
MM v[172:175],v[80:83],a[112:115],v[172:175]
s_add_u32 s37, s37, s36
TR v[120:121],v31,49152
MM v[172:175],v[84:87],a[116:119],v[172:175]
TR v[122:123],v31,53248
buffer_load_dwordx4 v11, s[8:11], s31 offen offset:3072  lds
MM v[172:175],v[88:91],a[120:123],v[172:175]
TR v[124:125],v31,57344
MM v[172:175],v[92:95],a[124:127],v[172:175]
s_waitcnt lgkmcnt(13)
TR v[126:127],v31,61440
MM v[176:179],v[96:99],a[96:99],v[176:179]
s_waitcnt lgkmcnt(12)
s_add_u32 m0, s33, 36864
s_add_u32 s31, s31, 32768
TR v[64:65],v24,32768
MM v[176:179],v[100:103],a[100:103],v[176:179]
s_waitcnt lgkmcnt(11)
TR v[66:67],v24,36864
buffer_load_dwordx4 v8, s[8:11], s31 offen offset:0  lds
MM v[176:179],v[104:107],a[104:107],v[176:179]
s_waitcnt lgkmcnt(10)
TR v[68:69],v24,40960
MM v[176:179],v[108:111],a[108:111],v[176:179]
TR v[70:71],v24,45056
MM v[180:183],v[96:99],a[112:115],v[180:183]
s_mul_i32 s38, s36, 7
TR v[72:73],v24,49152
MM v[180:183],v[100:103],a[116:119],v[180:183]
TR v[74:75],v24,53248
buffer_load_dwordx4 v9, s[8:11], s31 offen offset:1024  lds
MM v[180:183],v[104:107],a[120:123],v[180:183]
TR v[76:77],v24,57344
MM v[180:183],v[108:111],a[124:127],v[180:183]
s_waitcnt lgkmcnt(13)
TR v[78:79],v24,61440
MM v[184:187],v[112:115],a[96:99],v[184:187]
s_waitcnt lgkmcnt(12)
s_sub_u32 s38, s38, 333
TR v[80:81],v25,32768
MM v[184:187],v[116:119],a[100:103],v[184:187]
s_waitcnt lgkmcnt(11)
TR v[82:83],v25,36864
buffer_load_dwordx4 v10, s[8:11], s31 offen offset:2048  lds
MM v[184:187],v[120:123],a[104:107],v[184:187]
s_waitcnt lgkmcnt(10)
TR v[84:85],v25,40960
MM v[184:187],v[124:127],a[108:111],v[184:187]
TR v[86:87],v25,45056
MM v[188:191],v[112:115],a[112:115],v[188:191]
s_cmp_lt_u32 s36, 48
s_cselect_b32 s37, s37, s38
TR v[88:89],v25,49152
MM v[188:191],v[116:119],a[116:119],v[188:191]
TR v[90:91],v25,53248
buffer_load_dwordx4 v11, s[8:11], s31 offen offset:3072  lds
MM v[188:191],v[120:123],a[120:123],v[188:191]
TR v[92:93],v25,57344
MM v[188:191],v[124:127],a[124:127],v[188:191]
s_waitcnt lgkmcnt(13)
TR v[94:95],v25,61440
MM v[128:131],v[64:67],a[96:99],v[128:131]
s_waitcnt lgkmcnt(12)
s_add_u32 s35, s35, 131072
TR v[96:97],v26,32768
MM v[128:131],v[68:71],a[100:103],v[128:131]
s_waitcnt lgkmcnt(11)
TR v[98:99],v26,36864
buffer_load_dwordx4 a[32:35], v12, s[16:19], s35 offen offset:0 sc1
MM v[128:131],v[72:75],a[104:107],v[128:131]
s_waitcnt lgkmcnt(10)
TR v[100:101],v26,40960
MM v[128:131],v[76:79],a[108:111],v[128:131]
TR v[102:103],v26,45056
MM v[132:135],v[64:67],a[112:115],v[132:135]
TR v[104:105],v26,49152
MM v[132:135],v[68:71],a[116:119],v[132:135]
TR v[106:107],v26,53248
buffer_load_dwordx4 a[48:51], v12, s[16:19], s35 offen offset:1024 sc1
MM v[132:135],v[72:75],a[120:123],v[132:135]
TR v[108:109],v26,57344
MM v[132:135],v[76:79],a[124:127],v[132:135]
s_waitcnt lgkmcnt(13)
TR v[110:111],v26,61440
MM v[136:139],v[80:83],a[96:99],v[136:139]
s_waitcnt lgkmcnt(12)
s_add_u32 s35, s35, 131072
TR v[112:113],v27,32768
MM v[136:139],v[84:87],a[100:103],v[136:139]
s_waitcnt lgkmcnt(11)
TR v[114:115],v27,36864
buffer_load_dwordx4 a[36:39], v12, s[16:19], s35 offen offset:0 sc1
MM v[136:139],v[88:91],a[104:107],v[136:139]
s_waitcnt lgkmcnt(10)
TR v[116:117],v27,40960
MM v[136:139],v[92:95],a[108:111],v[136:139]
TR v[118:119],v27,45056
MM v[140:143],v[80:83],a[112:115],v[140:143]
TR v[120:121],v27,49152
MM v[140:143],v[84:87],a[116:119],v[140:143]
TR v[122:123],v27,53248
buffer_load_dwordx4 a[52:55], v12, s[16:19], s35 offen offset:1024 sc1
MM v[140:143],v[88:91],a[120:123],v[140:143]
TR v[124:125],v27,57344
MM v[140:143],v[92:95],a[124:127],v[140:143]
s_waitcnt vmcnt(22) lgkmcnt(13)
TR v[126:127],v27,61440
MM v[144:147],v[96:99],a[96:99],v[144:147]
s_barrier
s_waitcnt lgkmcnt(12)
MM v[144:147],v[100:103],a[100:103],v[144:147]
s_waitcnt lgkmcnt(10)
s_add_u32 s35, s35, 131072
TR v[64:65],v20,0
MM v[144:147],v[104:107],a[104:107],v[144:147]
s_waitcnt lgkmcnt(9)
TR v[66:67],v20,4096
buffer_load_dwordx4 a[40:43], v12, s[16:19], s35 offen offset:0 sc1
MM v[144:147],v[108:111],a[108:111],v[144:147]
TR v[68:69],v20,8192
MM v[148:151],v[96:99],a[112:115],v[148:151]
TR v[70:71],v20,12288
MM v[148:151],v[100:103],a[116:119],v[148:151]
TR v[72:73],v20,16384
MM v[148:151],v[104:107],a[120:123],v[148:151]
TR v[74:75],v20,20480
buffer_load_dwordx4 a[56:59], v12, s[16:19], s35 offen offset:1024 sc1
MM v[148:151],v[108:111],a[124:127],v[148:151]
s_waitcnt lgkmcnt(12)
TR v[76:77],v20,24576
TR v[78:79],v20,28672
MM v[152:155],v[112:115],a[96:99],v[152:155]
s_waitcnt lgkmcnt(12)
TR v[80:81],v21,0
MM v[152:155],v[116:119],a[100:103],v[152:155]
s_waitcnt lgkmcnt(11)
s_add_u32 s35, s35, 131072
TR v[82:83],v21,4096
MM v[152:155],v[120:123],a[104:107],v[152:155]
s_waitcnt lgkmcnt(10)
TR v[84:85],v21,8192
buffer_load_dwordx4 a[44:47], v12, s[16:19], s35 offen offset:0 sc1
MM v[152:155],v[124:127],a[108:111],v[152:155]
s_add_u32 s34, s34, 1
TR v[86:87],v21,12288
MM v[156:159],v[112:115],a[112:115],v[156:159]
TR v[88:89],v21,16384
MM v[156:159],v[116:119],a[116:119],v[156:159]
TR v[90:91],v21,20480
MM v[156:159],v[120:123],a[120:123],v[156:159]
TR v[92:93],v21,24576
buffer_load_dwordx4 a[60:63], v12, s[16:19], s35 offen offset:1024 sc1
MM v[156:159],v[124:127],a[124:127],v[156:159]
TR v[94:95],v21,28672
s_cmp_lt_u32 s34, 3
s_cbranch_scc1 L_down_kernel_loop
s_waitcnt vmcnt(24)
v_accvgpr_mov_b32 a128, a2
v_accvgpr_mov_b32 a129, a3
s_waitcnt vmcnt(23)
v_accvgpr_mov_b32 a2, a16
v_accvgpr_mov_b32 a3, a17
v_accvgpr_mov_b32 a16, a128
v_accvgpr_mov_b32 a17, a129
s_waitcnt vmcnt(22)
v_accvgpr_mov_b32 a128, a6
v_accvgpr_mov_b32 a129, a7
s_waitcnt vmcnt(21)
v_accvgpr_mov_b32 a6, a20
v_accvgpr_mov_b32 a7, a21
v_accvgpr_mov_b32 a20, a128
v_accvgpr_mov_b32 a21, a129
s_waitcnt vmcnt(20)
v_accvgpr_mov_b32 a128, a10
v_accvgpr_mov_b32 a129, a11
s_waitcnt vmcnt(19)
v_accvgpr_mov_b32 a10, a24
v_accvgpr_mov_b32 a11, a25
v_accvgpr_mov_b32 a24, a128
v_accvgpr_mov_b32 a25, a129
s_waitcnt vmcnt(18)
v_accvgpr_mov_b32 a128, a14
v_accvgpr_mov_b32 a129, a15
s_waitcnt vmcnt(17)
v_accvgpr_mov_b32 a14, a28
v_accvgpr_mov_b32 a15, a29
v_accvgpr_mov_b32 a28, a128
v_accvgpr_mov_b32 a29, a129
s_waitcnt lgkmcnt(14)
MM v[160:163],v[64:67],a[0:3],v[160:163]
s_waitcnt lgkmcnt(12)
TR v[96:97],v22,0
MM v[160:163],v[68:71],a[4:7],v[160:163]
s_waitcnt lgkmcnt(11)
TR v[98:99],v22,4096
MM v[160:163],v[72:75],a[8:11],v[160:163]
s_waitcnt lgkmcnt(10)
TR v[100:101],v22,8192
MM v[160:163],v[76:79],a[12:15],v[160:163]
TR v[102:103],v22,12288
MM v[164:167],v[64:67],a[16:19],v[164:167]
TR v[104:105],v22,16384
MM v[164:167],v[68:71],a[20:23],v[164:167]
TR v[106:107],v22,20480
MM v[164:167],v[72:75],a[24:27],v[164:167]
TR v[108:109],v22,24576
s_waitcnt vmcnt(7)
v_accvgpr_mov_b32 a128, a34
MM v[164:167],v[76:79],a[28:31],v[164:167]
s_waitcnt lgkmcnt(13)
TR v[110:111],v22,28672
v_accvgpr_mov_b32 a129, a35
MM v[168:171],v[80:83],a[0:3],v[168:171]
s_waitcnt lgkmcnt(12)
TR v[112:113],v23,0
s_waitcnt vmcnt(6)
v_accvgpr_mov_b32 a34, a48
MM v[168:171],v[84:87],a[4:7],v[168:171]
s_waitcnt lgkmcnt(11)
TR v[114:115],v23,4096
v_accvgpr_mov_b32 a35, a49
MM v[168:171],v[88:91],a[8:11],v[168:171]
s_waitcnt lgkmcnt(10)
TR v[116:117],v23,8192
v_accvgpr_mov_b32 a48, a128
MM v[168:171],v[92:95],a[12:15],v[168:171]
TR v[118:119],v23,12288
v_accvgpr_mov_b32 a49, a129
MM v[172:175],v[80:83],a[16:19],v[172:175]
TR v[120:121],v23,16384
s_waitcnt vmcnt(5)
v_accvgpr_mov_b32 a128, a38
MM v[172:175],v[84:87],a[20:23],v[172:175]
TR v[122:123],v23,20480
v_accvgpr_mov_b32 a129, a39
MM v[172:175],v[88:91],a[24:27],v[172:175]
TR v[124:125],v23,24576
s_waitcnt vmcnt(4)
v_accvgpr_mov_b32 a38, a52
MM v[172:175],v[92:95],a[28:31],v[172:175]
s_waitcnt vmcnt(8) lgkmcnt(13)
TR v[126:127],v23,28672
v_accvgpr_mov_b32 a39, a53
MM v[176:179],v[96:99],a[0:3],v[176:179]
s_barrier
v_accvgpr_mov_b32 a52, a128
s_waitcnt lgkmcnt(12)
MM v[176:179],v[100:103],a[4:7],v[176:179]
s_waitcnt lgkmcnt(10)
TR v[64:65],v20,32768
v_accvgpr_mov_b32 a53, a129
MM v[176:179],v[104:107],a[8:11],v[176:179]
s_waitcnt lgkmcnt(9)
TR v[66:67],v20,36864
s_waitcnt vmcnt(3)
v_accvgpr_mov_b32 a128, a42
MM v[176:179],v[108:111],a[12:15],v[176:179]
TR v[68:69],v20,40960
v_accvgpr_mov_b32 a129, a43
MM v[180:183],v[96:99],a[16:19],v[180:183]
TR v[70:71],v20,45056
s_waitcnt vmcnt(2)
v_accvgpr_mov_b32 a42, a56
MM v[180:183],v[100:103],a[20:23],v[180:183]
TR v[72:73],v20,49152
v_accvgpr_mov_b32 a43, a57
MM v[180:183],v[104:107],a[24:27],v[180:183]
TR v[74:75],v20,53248
v_accvgpr_mov_b32 a56, a128
MM v[180:183],v[108:111],a[28:31],v[180:183]
s_waitcnt lgkmcnt(12)
TR v[76:77],v20,57344
TR v[78:79],v20,61440
v_accvgpr_mov_b32 a57, a129
MM v[184:187],v[112:115],a[0:3],v[184:187]
s_waitcnt lgkmcnt(12)
TR v[80:81],v21,32768
s_waitcnt vmcnt(1)
v_accvgpr_mov_b32 a128, a46
MM v[184:187],v[116:119],a[4:7],v[184:187]
s_waitcnt lgkmcnt(11)
TR v[82:83],v21,36864
v_accvgpr_mov_b32 a129, a47
MM v[184:187],v[120:123],a[8:11],v[184:187]
s_waitcnt lgkmcnt(10)
TR v[84:85],v21,40960
s_waitcnt vmcnt(0)
v_accvgpr_mov_b32 a46, a60
MM v[184:187],v[124:127],a[12:15],v[184:187]
TR v[86:87],v21,45056
v_accvgpr_mov_b32 a47, a61
MM v[188:191],v[112:115],a[16:19],v[188:191]
TR v[88:89],v21,49152
v_accvgpr_mov_b32 a60, a128
MM v[188:191],v[116:119],a[20:23],v[188:191]
TR v[90:91],v21,53248
v_accvgpr_mov_b32 a61, a129
MM v[188:191],v[120:123],a[24:27],v[188:191]
TR v[92:93],v21,57344
MM v[188:191],v[124:127],a[28:31],v[188:191]
s_waitcnt lgkmcnt(13)
TR v[94:95],v21,61440
MM v[160:163],v[64:67],a[32:35],v[160:163]
s_waitcnt lgkmcnt(12)
TR v[96:97],v22,32768
MM v[160:163],v[68:71],a[36:39],v[160:163]
s_waitcnt lgkmcnt(11)
TR v[98:99],v22,36864
MM v[160:163],v[72:75],a[40:43],v[160:163]
s_waitcnt lgkmcnt(10)
TR v[100:101],v22,40960
MM v[160:163],v[76:79],a[44:47],v[160:163]
TR v[102:103],v22,45056
MM v[164:167],v[64:67],a[48:51],v[164:167]
TR v[104:105],v22,49152
MM v[164:167],v[68:71],a[52:55],v[164:167]
TR v[106:107],v22,53248
MM v[164:167],v[72:75],a[56:59],v[164:167]
TR v[108:109],v22,57344
MM v[164:167],v[76:79],a[60:63],v[164:167]
s_waitcnt lgkmcnt(13)
TR v[110:111],v22,61440
MM v[168:171],v[80:83],a[32:35],v[168:171]
s_waitcnt lgkmcnt(12)
TR v[112:113],v23,32768
MM v[168:171],v[84:87],a[36:39],v[168:171]
s_waitcnt lgkmcnt(11)
TR v[114:115],v23,36864
MM v[168:171],v[88:91],a[40:43],v[168:171]
s_waitcnt lgkmcnt(10)
TR v[116:117],v23,40960
s_add_u32 s52, s50, 0
MM v[168:171],v[92:95],a[44:47],v[168:171]
TR v[118:119],v23,45056
buffer_load_dwordx4 v[40:43], v34, s[12:15], s52 offen sc1
MM v[172:175],v[80:83],a[48:51],v[172:175]
TR v[120:121],v23,49152
s_add_u32 s52, s50, 16384
MM v[172:175],v[84:87],a[52:55],v[172:175]
TR v[122:123],v23,53248
buffer_load_dwordx4 v[44:47], v34, s[12:15], s52 offen sc1
MM v[172:175],v[88:91],a[56:59],v[172:175]
TR v[124:125],v23,57344
s_add_u32 s52, s50, 32768
MM v[172:175],v[92:95],a[60:63],v[172:175]
s_waitcnt lgkmcnt(13)
TR v[126:127],v23,61440
buffer_load_dwordx4 v[48:51], v34, s[12:15], s52 offen sc1
MM v[176:179],v[96:99],a[32:35],v[176:179]
s_waitcnt lgkmcnt(12)
TR v[64:65],v16,0
s_add_u32 s52, s50, 49152
MM v[176:179],v[100:103],a[36:39],v[176:179]
s_waitcnt lgkmcnt(11)
TR v[66:67],v16,4096
buffer_load_dwordx4 v[52:55], v34, s[12:15], s52 offen sc1
MM v[176:179],v[104:107],a[40:43],v[176:179]
s_waitcnt lgkmcnt(10)
TR v[68:69],v16,8192
buffer_load_dwordx4 v[56:59], v35, s[24:27], s51 offen sc1
MM v[176:179],v[108:111],a[44:47],v[176:179]
TR v[70:71],v16,12288
buffer_load_dwordx4 v[60:63], v35, s[24:27], s51 offen offset:16 sc1
MM v[180:183],v[96:99],a[48:51],v[180:183]
TR v[72:73],v16,16384
MM v[180:183],v[100:103],a[52:55],v[180:183]
TR v[74:75],v16,20480
MM v[180:183],v[104:107],a[56:59],v[180:183]
TR v[76:77],v16,24576
MM v[180:183],v[108:111],a[60:63],v[180:183]
s_waitcnt lgkmcnt(13)
TR v[78:79],v16,28672
MM v[184:187],v[112:115],a[32:35],v[184:187]
s_waitcnt lgkmcnt(12)
TR v[80:81],v17,0
MM v[184:187],v[116:119],a[36:39],v[184:187]
s_waitcnt lgkmcnt(11)
TR v[82:83],v17,4096
MM v[184:187],v[120:123],a[40:43],v[184:187]
s_waitcnt lgkmcnt(10)
TR v[84:85],v17,8192
MM v[184:187],v[124:127],a[44:47],v[184:187]
TR v[86:87],v17,12288
MM v[188:191],v[112:115],a[48:51],v[188:191]
TR v[88:89],v17,16384
MM v[188:191],v[116:119],a[52:55],v[188:191]
TR v[90:91],v17,20480
MM v[188:191],v[120:123],a[56:59],v[188:191]
TR v[92:93],v17,24576
MM v[188:191],v[124:127],a[60:63],v[188:191]
s_waitcnt lgkmcnt(13)
TR v[94:95],v17,28672
MM v[128:131],v[64:67],a[0:3],v[128:131]
s_waitcnt lgkmcnt(12)
TR v[96:97],v18,0
MM v[128:131],v[68:71],a[4:7],v[128:131]
s_waitcnt lgkmcnt(11)
TR v[98:99],v18,4096
MM v[128:131],v[72:75],a[8:11],v[128:131]
s_waitcnt lgkmcnt(10)
TR v[100:101],v18,8192
v_cvt_pk_bf16_f32 v160, v160, v161
MM v[128:131],v[76:79],a[12:15],v[128:131]
TR v[102:103],v18,12288
v_cvt_pk_bf16_f32 v161, v162, v163
MM v[132:135],v[64:67],a[16:19],v[132:135]
TR v[104:105],v18,16384
v_cvt_pk_bf16_f32 v162, v164, v165
MM v[132:135],v[68:71],a[20:23],v[132:135]
TR v[106:107],v18,20480
v_cvt_pk_bf16_f32 v163, v166, v167
MM v[132:135],v[72:75],a[24:27],v[132:135]
TR v[108:109],v18,24576
buffer_store_dwordx4 v[160:163], v12, s[24:27], s55 offen sc1
MM v[132:135],v[76:79],a[28:31],v[132:135]
s_waitcnt lgkmcnt(13)
TR v[110:111],v18,28672
v_cvt_pk_bf16_f32 v168, v168, v169
MM v[136:139],v[80:83],a[0:3],v[136:139]
s_waitcnt lgkmcnt(12)
TR v[112:113],v19,0
v_cvt_pk_bf16_f32 v169, v170, v171
MM v[136:139],v[84:87],a[4:7],v[136:139]
s_waitcnt lgkmcnt(11)
TR v[114:115],v19,4096
v_cvt_pk_bf16_f32 v170, v172, v173
MM v[136:139],v[88:91],a[8:11],v[136:139]
s_waitcnt lgkmcnt(10)
TR v[116:117],v19,8192
v_cvt_pk_bf16_f32 v171, v174, v175
MM v[136:139],v[92:95],a[12:15],v[136:139]
TR v[118:119],v19,12288
s_add_u32 s55, s55, 1048576
MM v[140:143],v[80:83],a[16:19],v[140:143]
TR v[120:121],v19,16384
buffer_store_dwordx4 v[168:171], v12, s[24:27], s55 offen sc1
MM v[140:143],v[84:87],a[20:23],v[140:143]
TR v[122:123],v19,20480
v_cvt_pk_bf16_f32 v176, v176, v177
MM v[140:143],v[88:91],a[24:27],v[140:143]
TR v[124:125],v19,24576
v_cvt_pk_bf16_f32 v177, v178, v179
MM v[140:143],v[92:95],a[28:31],v[140:143]
s_waitcnt lgkmcnt(13)
TR v[126:127],v19,28672
v_cvt_pk_bf16_f32 v178, v180, v181
MM v[144:147],v[96:99],a[0:3],v[144:147]
s_waitcnt lgkmcnt(12)
TR v[64:65],v16,32768
v_cvt_pk_bf16_f32 v179, v182, v183
MM v[144:147],v[100:103],a[4:7],v[144:147]
s_waitcnt lgkmcnt(11)
TR v[66:67],v16,36864
s_add_u32 s55, s55, 1048576
MM v[144:147],v[104:107],a[8:11],v[144:147]
s_waitcnt lgkmcnt(10)
TR v[68:69],v16,40960
buffer_store_dwordx4 v[176:179], v12, s[24:27], s55 offen sc1
MM v[144:147],v[108:111],a[12:15],v[144:147]
TR v[70:71],v16,45056
v_cvt_pk_bf16_f32 v184, v184, v185
MM v[148:151],v[96:99],a[16:19],v[148:151]
TR v[72:73],v16,49152
v_cvt_pk_bf16_f32 v185, v186, v187
MM v[148:151],v[100:103],a[20:23],v[148:151]
TR v[74:75],v16,53248
v_cvt_pk_bf16_f32 v186, v188, v189
MM v[148:151],v[104:107],a[24:27],v[148:151]
TR v[76:77],v16,57344
v_cvt_pk_bf16_f32 v187, v190, v191
MM v[148:151],v[108:111],a[28:31],v[148:151]
s_waitcnt lgkmcnt(13)
TR v[78:79],v16,61440
s_add_u32 s55, s55, 1048576
MM v[152:155],v[112:115],a[0:3],v[152:155]
s_waitcnt lgkmcnt(12)
TR v[80:81],v17,32768
buffer_store_dwordx4 v[184:187], v12, s[24:27], s55 offen sc1
MM v[152:155],v[116:119],a[4:7],v[152:155]
s_waitcnt lgkmcnt(11)
TR v[82:83],v17,36864
MM v[152:155],v[120:123],a[8:11],v[152:155]
s_waitcnt lgkmcnt(10)
TR v[84:85],v17,40960
MM v[152:155],v[124:127],a[12:15],v[152:155]
TR v[86:87],v17,45056
MM v[156:159],v[112:115],a[16:19],v[156:159]
TR v[88:89],v17,49152
MM v[156:159],v[116:119],a[20:23],v[156:159]
TR v[90:91],v17,53248
MM v[156:159],v[120:123],a[24:27],v[156:159]
TR v[92:93],v17,57344
MM v[156:159],v[124:127],a[28:31],v[156:159]
s_waitcnt lgkmcnt(13)
TR v[94:95],v17,61440
MM v[128:131],v[64:67],a[32:35],v[128:131]
s_waitcnt lgkmcnt(12)
TR v[96:97],v18,32768
MM v[128:131],v[68:71],a[36:39],v[128:131]
s_waitcnt lgkmcnt(11)
TR v[98:99],v18,36864
MM v[128:131],v[72:75],a[40:43],v[128:131]
s_waitcnt lgkmcnt(10)
TR v[100:101],v18,40960
MM v[128:131],v[76:79],a[44:47],v[128:131]
TR v[102:103],v18,45056
MM v[132:135],v[64:67],a[48:51],v[132:135]
TR v[104:105],v18,49152
MM v[132:135],v[68:71],a[52:55],v[132:135]
TR v[106:107],v18,53248
MM v[132:135],v[72:75],a[56:59],v[132:135]
TR v[108:109],v18,57344
MM v[132:135],v[76:79],a[60:63],v[132:135]
s_waitcnt lgkmcnt(13)
TR v[110:111],v18,61440
MM v[136:139],v[80:83],a[32:35],v[136:139]
s_waitcnt lgkmcnt(12)
TR v[112:113],v19,32768
MM v[136:139],v[84:87],a[36:39],v[136:139]
s_waitcnt lgkmcnt(11)
TR v[114:115],v19,36864
MM v[136:139],v[88:91],a[40:43],v[136:139]
s_waitcnt lgkmcnt(10)
TR v[116:117],v19,40960
MM v[136:139],v[92:95],a[44:47],v[136:139]
TR v[118:119],v19,45056
MM v[140:143],v[80:83],a[48:51],v[140:143]
TR v[120:121],v19,49152
MM v[140:143],v[84:87],a[52:55],v[140:143]
TR v[122:123],v19,53248
MM v[140:143],v[88:91],a[56:59],v[140:143]
TR v[124:125],v19,57344
MM v[140:143],v[92:95],a[60:63],v[140:143]
s_waitcnt lgkmcnt(13)
TR v[126:127],v19,61440
MM v[144:147],v[96:99],a[32:35],v[144:147]
s_waitcnt lgkmcnt(12)
MM v[144:147],v[100:103],a[36:39],v[144:147]
s_waitcnt lgkmcnt(10)
MM v[144:147],v[104:107],a[40:43],v[144:147]
s_waitcnt lgkmcnt(8)
MM v[144:147],v[108:111],a[44:47],v[144:147]
MM v[148:151],v[96:99],a[48:51],v[148:151]
MM v[148:151],v[100:103],a[52:55],v[148:151]
MM v[148:151],v[104:107],a[56:59],v[148:151]
MM v[148:151],v[108:111],a[60:63],v[148:151]
s_waitcnt lgkmcnt(6)
MM v[152:155],v[112:115],a[32:35],v[152:155]
s_waitcnt lgkmcnt(4)
MM v[152:155],v[116:119],a[36:39],v[152:155]
s_waitcnt lgkmcnt(2)
MM v[152:155],v[120:123],a[40:43],v[152:155]
s_waitcnt lgkmcnt(0)
MM v[152:155],v[124:127],a[44:47],v[152:155]
MM v[156:159],v[112:115],a[48:51],v[156:159]
MM v[156:159],v[116:119],a[52:55],v[156:159]
MM v[156:159],v[120:123],a[56:59],v[156:159]
MM v[156:159],v[124:127],a[60:63],v[156:159]
s_waitcnt vmcnt(0)
buffer_store_dword v37, v36, s[24:27], s57 offen sc1
s_barrier
s_mov_b32 s59, 0
L_down_kernel_poll:
buffer_load_dword v38, v36, s[24:27], s58 offen sc1
s_waitcnt vmcnt(0)
v_cmp_ne_u32 vcc, 1, v38
s_cbranch_vccz L_down_kernel_got
s_sleep 2
s_add_u32 s59, s59, 1
s_cmp_lt_u32 s59, 0x40000
s_cbranch_scc1 L_down_kernel_poll
L_down_kernel_got:
buffer_load_dwordx4 v[192:195], v12, s[24:27], s56 offen sc1
s_add_u32 s56, s56, 1048576
buffer_load_dwordx4 v[196:199], v12, s[24:27], s56 offen sc1
s_add_u32 s56, s56, 1048576
buffer_load_dwordx4 v[200:203], v12, s[24:27], s56 offen sc1
s_add_u32 s56, s56, 1048576
buffer_load_dwordx4 v[204:207], v12, s[24:27], s56 offen sc1
s_waitcnt vmcnt(3)
v_lshlrev_b32 v208, 16, v192
v_and_b32 v209, 0xffff0000, v192
v_pk_add_f32 v[128:129], v[128:129], v[208:209]
v_lshlrev_b32 v210, 16, v193
v_and_b32 v211, 0xffff0000, v193
v_pk_add_f32 v[130:131], v[130:131], v[210:211]
ds_write_b128 v32, v[128:131] offset:0
v_lshlrev_b32 v212, 16, v194
v_and_b32 v213, 0xffff0000, v194
v_pk_add_f32 v[132:133], v[132:133], v[212:213]
v_lshlrev_b32 v214, 16, v195
v_and_b32 v215, 0xffff0000, v195
v_pk_add_f32 v[134:135], v[134:135], v[214:215]
ds_write_b128 v32, v[132:135] offset:4352
s_waitcnt vmcnt(2)
v_lshlrev_b32 v216, 16, v196
v_and_b32 v217, 0xffff0000, v196
v_pk_add_f32 v[136:137], v[136:137], v[216:217]
v_lshlrev_b32 v218, 16, v197
v_and_b32 v219, 0xffff0000, v197
v_pk_add_f32 v[138:139], v[138:139], v[218:219]
ds_write_b128 v32, v[136:139] offset:64
v_lshlrev_b32 v220, 16, v198
v_and_b32 v221, 0xffff0000, v198
v_pk_add_f32 v[140:141], v[140:141], v[220:221]
v_lshlrev_b32 v222, 16, v199
v_and_b32 v223, 0xffff0000, v199
v_pk_add_f32 v[142:143], v[142:143], v[222:223]
ds_write_b128 v32, v[140:143] offset:4416
s_waitcnt vmcnt(1)
v_lshlrev_b32 v208, 16, v200
v_and_b32 v209, 0xffff0000, v200
v_pk_add_f32 v[144:145], v[144:145], v[208:209]
v_lshlrev_b32 v210, 16, v201
v_and_b32 v211, 0xffff0000, v201
v_pk_add_f32 v[146:147], v[146:147], v[210:211]
ds_write_b128 v32, v[144:147] offset:128
v_lshlrev_b32 v212, 16, v202
v_and_b32 v213, 0xffff0000, v202
v_pk_add_f32 v[148:149], v[148:149], v[212:213]
v_lshlrev_b32 v214, 16, v203
v_and_b32 v215, 0xffff0000, v203
v_pk_add_f32 v[150:151], v[150:151], v[214:215]
ds_write_b128 v32, v[148:151] offset:4480
s_waitcnt vmcnt(0)
v_lshlrev_b32 v216, 16, v204
v_and_b32 v217, 0xffff0000, v204
v_pk_add_f32 v[152:153], v[152:153], v[216:217]
v_lshlrev_b32 v218, 16, v205
v_and_b32 v219, 0xffff0000, v205
v_pk_add_f32 v[154:155], v[154:155], v[218:219]
ds_write_b128 v32, v[152:155] offset:192
v_lshlrev_b32 v220, 16, v206
v_and_b32 v221, 0xffff0000, v206
v_pk_add_f32 v[156:157], v[156:157], v[220:221]
v_lshlrev_b32 v222, 16, v207
v_and_b32 v223, 0xffff0000, v207
v_pk_add_f32 v[158:159], v[158:159], v[222:223]
ds_write_b128 v32, v[156:159] offset:4544
s_waitcnt lgkmcnt(0)
ds_read_b128 v[64:67], v33 offset:0
ds_read_b128 v[68:71], v33 offset:16
ds_read_b128 v[72:75], v33 offset:2176
ds_read_b128 v[76:79], v33 offset:2192
ds_read_b128 v[80:83], v33 offset:4352
ds_read_b128 v[84:87], v33 offset:4368
ds_read_b128 v[88:91], v33 offset:6528
ds_read_b128 v[92:95], v33 offset:6544
v_lshlrev_b32 v4, 16, v40
v_and_b32 v5, 0xffff0000, v40
s_waitcnt lgkmcnt(7)
v_pk_fma_f32 v[4:5], v[64:65], v[56:57], v[4:5]
v_cvt_pk_bf16_f32 v40, v4, v5
v_lshlrev_b32 v4, 16, v41
v_and_b32 v5, 0xffff0000, v41
v_pk_fma_f32 v[4:5], v[66:67], v[58:59], v[4:5]
v_cvt_pk_bf16_f32 v41, v4, v5
v_lshlrev_b32 v4, 16, v42
v_and_b32 v5, 0xffff0000, v42
s_waitcnt lgkmcnt(6)
v_pk_fma_f32 v[4:5], v[68:69], v[60:61], v[4:5]
v_cvt_pk_bf16_f32 v42, v4, v5
v_lshlrev_b32 v4, 16, v43
v_and_b32 v5, 0xffff0000, v43
v_pk_fma_f32 v[4:5], v[70:71], v[62:63], v[4:5]
v_cvt_pk_bf16_f32 v43, v4, v5
s_add_u32 s52, s50, 0
buffer_store_dwordx4 v[40:43], v34, s[20:23], s52 offen sc1
v_lshlrev_b32 v4, 16, v44
v_and_b32 v5, 0xffff0000, v44
s_waitcnt lgkmcnt(5)
v_pk_fma_f32 v[4:5], v[72:73], v[56:57], v[4:5]
v_cvt_pk_bf16_f32 v44, v4, v5
v_lshlrev_b32 v4, 16, v45
v_and_b32 v5, 0xffff0000, v45
v_pk_fma_f32 v[4:5], v[74:75], v[58:59], v[4:5]
v_cvt_pk_bf16_f32 v45, v4, v5
v_lshlrev_b32 v4, 16, v46
v_and_b32 v5, 0xffff0000, v46
s_waitcnt lgkmcnt(4)
v_pk_fma_f32 v[4:5], v[76:77], v[60:61], v[4:5]
v_cvt_pk_bf16_f32 v46, v4, v5
v_lshlrev_b32 v4, 16, v47
v_and_b32 v5, 0xffff0000, v47
v_pk_fma_f32 v[4:5], v[78:79], v[62:63], v[4:5]
v_cvt_pk_bf16_f32 v47, v4, v5
s_add_u32 s52, s50, 16384
buffer_store_dwordx4 v[44:47], v34, s[20:23], s52 offen sc1
v_lshlrev_b32 v4, 16, v48
v_and_b32 v5, 0xffff0000, v48
s_waitcnt lgkmcnt(3)
v_pk_fma_f32 v[4:5], v[80:81], v[56:57], v[4:5]
v_cvt_pk_bf16_f32 v48, v4, v5
v_lshlrev_b32 v4, 16, v49
v_and_b32 v5, 0xffff0000, v49
v_pk_fma_f32 v[4:5], v[82:83], v[58:59], v[4:5]
v_cvt_pk_bf16_f32 v49, v4, v5
v_lshlrev_b32 v4, 16, v50
v_and_b32 v5, 0xffff0000, v50
s_waitcnt lgkmcnt(2)
v_pk_fma_f32 v[4:5], v[84:85], v[60:61], v[4:5]
v_cvt_pk_bf16_f32 v50, v4, v5
v_lshlrev_b32 v4, 16, v51
v_and_b32 v5, 0xffff0000, v51
v_pk_fma_f32 v[4:5], v[86:87], v[62:63], v[4:5]
v_cvt_pk_bf16_f32 v51, v4, v5
s_add_u32 s52, s50, 32768
buffer_store_dwordx4 v[48:51], v34, s[20:23], s52 offen sc1
v_lshlrev_b32 v4, 16, v52
v_and_b32 v5, 0xffff0000, v52
s_waitcnt lgkmcnt(1)
v_pk_fma_f32 v[4:5], v[88:89], v[56:57], v[4:5]
v_cvt_pk_bf16_f32 v52, v4, v5
v_lshlrev_b32 v4, 16, v53
v_and_b32 v5, 0xffff0000, v53
v_pk_fma_f32 v[4:5], v[90:91], v[58:59], v[4:5]
v_cvt_pk_bf16_f32 v53, v4, v5
v_lshlrev_b32 v4, 16, v54
v_and_b32 v5, 0xffff0000, v54
s_waitcnt lgkmcnt(0)
v_pk_fma_f32 v[4:5], v[92:93], v[60:61], v[4:5]
v_cvt_pk_bf16_f32 v54, v4, v5
v_lshlrev_b32 v4, 16, v55
v_and_b32 v5, 0xffff0000, v55
v_pk_fma_f32 v[4:5], v[94:95], v[62:63], v[4:5]
v_cvt_pk_bf16_f32 v55, v4, v5
s_add_u32 s52, s50, 49152
buffer_store_dwordx4 v[52:55], v34, s[20:23], s52 offen sc1
L_down_kernel_end:
s_endpgm
L_down_kernel_codeend:
L_mattn_kernel_codeend:
.section .rodata,"a"
.p2align 6
.amdhsa_kernel modp_kernel
  .amdhsa_next_free_vgpr 64
  .amdhsa_next_free_sgpr 64
  .amdhsa_accum_offset 64
  .amdhsa_group_segment_fixed_size 0
  .amdhsa_kernarg_size 112
  .amdhsa_user_sgpr_count 2
  .amdhsa_user_sgpr_kernarg_segment_ptr 1
  .amdhsa_system_sgpr_workgroup_id_x 1
.end_amdhsa_kernel
.p2align 6
.amdhsa_kernel mattn_kernel
  .amdhsa_next_free_vgpr 512
  .amdhsa_next_free_sgpr 96
  .amdhsa_accum_offset 256
  .amdhsa_group_segment_fixed_size 0
  .amdhsa_kernarg_size 112
  .amdhsa_user_sgpr_count 2
  .amdhsa_user_sgpr_kernarg_segment_ptr 1
  .amdhsa_system_sgpr_workgroup_id_x 1
.end_amdhsa_kernel
```
